```python
import torch

def _softmax(x, axis=-1):
    return torch.softmax(x, dim=axis)
def _gelu(x):
    return torch.nn.functional.gelu(x, approximate="tanh")
def _silu(x):
    return torch.nn.functional.silu(x)
def _sigmoid(x):
    return torch.sigmoid(x)
def _layernorm(x, axis=-1, eps=1e-5):
    m = x.mean(dim=axis, keepdim=True)
    v = x.var(dim=axis, keepdim=True, unbiased=False)
    return (x - m) / torch.sqrt(v + eps)
def _scatter_add(tgt, idx, src, axis=0):
    return tgt.clone().index_add_(axis, idx, src)
def _segment_sum(src, seg, n):
    out = torch.zeros((n,) + src.shape[1:], dtype=src.dtype)
    return out.index_add_(0, seg, src)
def _pad(x, pw):
    flat = tuple(v for pair in reversed(pw) for v in pair)
    return torch.nn.functional.pad(x, flat)

kernel_name = 'parallel_sum__compressed_kv_cla__glu_gated_geglu__prompt'

def setup_inputs():

    _w = (lambda a: (lambda t: t.to(torch.bfloat16) if t.is_floating_point() else t)(torch.as_tensor(a)))
    def _A_setup():
        B, H, Sq, Sk, D, M = 1, 32, 2048, 2048, 128, 512
        Dc = 4 * D
        return {
            "x": _w((lambda *s: torch.randn(*s, dtype=torch.bfloat16) * 0.05)(B, Sq, M)),
            "c_kv": _w((lambda *s: torch.randn(*s, dtype=torch.bfloat16) * 0.4)(B, Sk, Dc)),
            "w_q": _w((lambda *s: torch.randn(*s, dtype=torch.bfloat16) * 3.2)(M, H, D) * (M ** -0.5)),
            "w_uk": _w((lambda *s: torch.randn(*s, dtype=torch.bfloat16) * 3.2)(Dc, H, D) * (Dc ** -0.5)),
            "w_uv": _w((lambda *s: torch.randn(*s, dtype=torch.bfloat16) * 0.4)(Dc, H, D) * (Dc ** -0.5)),
            "w_o": _w((lambda *s: torch.randn(*s, dtype=torch.bfloat16) * 0.4)(H, D, M) * ((H * D) ** -0.5)),
        }
    _A_in = _A_setup()

    def _B_setup():
        B, S, Dm, Df = 1, 2048, 512, 1792
        return {
            "x": _w((lambda *s: torch.randn(*s, dtype=torch.bfloat16) * 0.05)(B, S, Dm)),
            "w_gate": _w((lambda *s: torch.randn(*s, dtype=torch.bfloat16) * 0.4)(Dm, Df) * (Dm ** -0.5)),
            "w_up": _w((lambda *s: torch.randn(*s, dtype=torch.bfloat16) * 0.4)(Dm, Df) * (Dm ** -0.5)),
            "w_down": _w((lambda *s: torch.randn(*s, dtype=torch.bfloat16) * 0.4)(Df, Dm) * (Df ** -0.5)),
        }
    _B_in = _B_setup()

    return {
        "A_x": _A_in["x"],
        "A_c_kv": _A_in["c_kv"],
        "A_w_q": _A_in["w_q"],
        "A_w_uk": _A_in["w_uk"],
        "A_w_uv": _A_in["w_uv"],
        "A_w_o": _A_in["w_o"],
        "B_x": _B_in["x"],
        "B_w_gate": _B_in["w_gate"],
        "B_w_up": _B_in["w_up"],
        "B_w_down": _B_in["w_down"],
    }

def reference(A_x, A_c_kv, A_w_q, A_w_uk, A_w_uv, A_w_o, B_x, B_w_gate, B_w_up, B_w_down):
    def _A_ref(x, c_kv, w_q, w_uk, w_uv, w_o):
        B, Sq, M = x.shape[0], x.shape[1], x.shape[2]
        Sk = c_kv.shape[1]
        H, D = w_q.shape[1], w_q.shape[2]
        q = torch.einsum("bqm,mhd->bhqd", x, w_q)
        k = torch.einsum("bkc,chd->bhkd", c_kv, w_uk)
        v = torch.einsum("bkc,chd->bhkd", c_kv, w_uv)
        scores = torch.einsum("bhqd,bhkd->bhqk", q, k) * (D ** -0.5)
        off = Sk - Sq
        qi = torch.arange(Sq)[:, None]
        kj = torch.arange(Sk)[None, :]
        cmask = kj <= (qi + off)
        scores = torch.where(cmask[None, None], scores, -1e9)
        p = _softmax(scores, axis=-1)
        ctx = torch.einsum("bhqk,bhkd->bhqd", p, v)
        return torch.einsum("bhqd,hdm->bqm", ctx, w_o)

    def _B_ref(x, w_gate, w_up, w_down):
        g = torch.einsum("bsd,df->bsf", x, w_gate)
        u = torch.einsum("bsd,df->bsf", x, w_up)
        h = _gelu(g) * u
        return torch.einsum("bsf,fd->bsd", h, w_down)

    x = A_x
    xn = _layernorm(x, axis=-1)
    return x + _A_ref(xn, A_c_kv, A_w_q, A_w_uk, A_w_uv, A_w_o) + _B_ref(xn, B_w_gate, B_w_up, B_w_down)
```

```asm
; @launch grid=(256,1,1) block=(256,1,1) lds=163840
.amdgcn_target "amdgcn-amd-amdhsa--gfx950"
.text
.globl parallel_sum__compressed_kv_cla__glu_gated_geglu__prompt_kernel
.p2align 8
.type parallel_sum__compressed_kv_cla__glu_gated_geglu__prompt_kernel,@function
parallel_sum__compressed_kv_cla__glu_gated_geglu__prompt_kernel:
    s_cmp_ge_u32 s2, 256
    s_cbranch_scc1 K_END
    s_load_dwordx2 s[8:9], s[0:1], 8
    s_load_dwordx2 s[16:17], s[0:1], 24
    s_load_dwordx2 s[4:5], s[0:1], 0
    s_load_dwordx2 s[12:13], s[0:1], 16
    s_load_dwordx2 s[20:21], s[0:1], 32
    s_load_dwordx2 s[24:25], s[0:1], 40
    s_load_dwordx2 s[28:29], s[0:1], 56
    s_load_dwordx2 s[32:33], s[0:1], 64
    s_load_dwordx2 s[48:49], s[0:1], 72
    s_load_dwordx2 s[36:37], s[0:1], 80
    s_load_dwordx2 s[40:41], s[0:1], 88
    s_load_dwordx2 s[44:45], s[0:1], 96
    s_getpc_b64 s[52:53]
    s_lshr_b32 s59, s2, 3
    s_lshl_b32 s60, s59, 12
    v_lshl_add_u32 v1, v0, 4, s60
    v_min_u32 v1, 63868, v1
    v_mov_b32 v3, s53
    v_add_co_u32 v2, vcc, s52, v1
    s_nop 1
    v_addc_co_u32 v3, vcc, 0, v3, vcc
    global_load_dword v2, v[2:3], off
    v_lshl_add_u32 v18, s2, 8, v0
    v_cmp_eq_u32 vcc, 0, v0
    v_mov_b32 v19, 0x7fffff00
    v_lshrrev_b32 v1, 6, v0
    v_and_b32 v0, 63, v0
    v_readfirstlane_b32 s3, v1
    v_cndmask_b32 v19, v19, v0, vcc
    s_mov_b32 s10, 0x200000
    s_mov_b32 s11, 0x20000
    s_mov_b32 s18, 0x400000
    s_mov_b32 s19, 0x20000
    s_mov_b32 s6, 0x200000
    s_mov_b32 s7, 0x20000
    s_mov_b32 s14, 0x400000
    s_mov_b32 s15, 0x20000
    s_mov_b32 s22, 0x400000
    s_mov_b32 s23, 0x20000
    s_mov_b32 s30, 0x1c0000
    s_mov_b32 s31, 0x20000
    s_mov_b32 s34, 0x1c0000
    s_mov_b32 s35, 0x20000
    s_mov_b32 s38, 0x200000
    s_mov_b32 s39, 0x20000
    s_mov_b32 s42, 0x100
    s_mov_b32 s43, 0x20000
    s_mov_b32 s46, 0x5000000
    s_mov_b32 s47, 0x20000
    s_and_b32 s59, s2, 1
    s_lshl_b32 s59, s59, 2
    s_bfe_u32 s60, s2, 0x20003
    s_add_u32 s57, s59, s60
    s_bfe_u32 s59, s2, 0x20001
    s_add_u32 s81, s59, s60
    s_lshl_b32 s59, s59, 3
    s_lshr_b32 s60, s2, 6
    s_xor_b32 s60, s60, 2
    s_add_u32 s59, s59, s60
    s_bfe_u32 s60, s2, 0x10005
    s_lshl_b32 s60, s60, 2
    s_add_u32 s58, s59, s60
    s_and_b32 s81, s81, 3
    s_lshl_b32 s81, s81, 3
    s_lshr_b32 s81, 0xb49c78e4, s81
    s_lshl_b32 s59, s57, 2
    s_add_u32 s59, s59, s3
    s_lshl_b32 s65, s59, 16
    s_lshl_b32 s60, s58, 20
    s_lshl_b32 s59, s59, 15
    s_add_u32 s68, s59, s60
    s_add_u32 s68, s68, 0x200000
    s_lshl_b32 s59, s3, 18
    s_lshl_b32 s60, s58, 8
    s_add_u32 s66, s59, s60
    s_and_b32 s59, s59, 0x40000
    s_add_u32 s84, s59, s60
    s_lshr_b32 s53, s3, 1
    s_lshl_b32 s62, s3, 12
    s_lshl_b32 s67, s3, 14
    s_add_u32 s67, s67, 65536
    s_lshl_b32 s72, s58, 7
    s_add_u32 s72, s72, 0x3900000
    v_lshrrev_b32 v24, 3, v0
    v_lshlrev_b32 v24, 10, v24
    v_lshrrev_b32 v25, 4, v0
    v_and_b32 v26, 7, v0
    v_xor_b32 v25, v25, v26
    v_xor_b32 v26, 4, v25
    v_lshl_add_u32 v25, v25, 4, v24
    v_lshl_add_u32 v26, v26, 4, v24
    v_add_u32 v12, 0, v25
    v_add_u32 v13, 7168, v26
    v_add_u32 v14, 14336, v25
    v_add_u32 v15, 21504, v26
    v_lshrrev_b32 v24, 3, v0
    v_mul_u32_u24 v24, 8192, v24
    v_bfe_u32 v25, v0, 4, 1
    v_lshlrev_b32 v25, 1, v25
    v_and_b32 v26, 7, v0
    v_xor_b32 v25, v25, v26
    v_xor_b32 v26, 4, v25
    v_lshl_add_u32 v25, v25, 4, v24
    v_lshl_add_u32 v26, v26, 4, v24
    v_add_u32 v8, 0, v25
    v_add_u32 v9, 64512, v26
    v_add_u32 v10, 129024, v25
    v_add_u32 v11, 193536, v26
    s_waitcnt lgkmcnt(0)
    s_mov_b32 s0, s81
    s_bfe_u32 s56, s0, 0x20000
    s_mul_i32 s56, s56, 256
    s_add_u32 s56, s56, s65
    s_add_u32 m0, s67, 0
    s_nop 0
    buffer_load_dwordx4 v12, s[8:11], s56 offen offset:0 lds
    buffer_load_dwordx4 v13, s[8:11], s56 offen offset:1024 lds
    buffer_load_dwordx4 v14, s[8:11], s56 offen offset:2048 lds
    buffer_load_dwordx4 v15, s[8:11], s56 offen offset:3072 lds
    s_add_u32 s56, s56, 32768
    s_add_u32 m0, s67, 4096
    s_nop 0
    buffer_load_dwordx4 v12, s[8:11], s56 offen offset:0 lds
    buffer_load_dwordx4 v13, s[8:11], s56 offen offset:1024 lds
    buffer_load_dwordx4 v14, s[8:11], s56 offen offset:2048 lds
    buffer_load_dwordx4 v15, s[8:11], s56 offen offset:3072 lds
    s_add_u32 m0, s62, 0
    s_bfe_u32 s56, s0, 0x20000
    s_lshl_b32 s56, s56, 20
    s_add_u32 s56, s56, s84
    s_mul_i32 s58, s53, 128
    s_add_u32 s56, s56, s58
    buffer_load_dwordx4 v8, s[16:19], s56 offen offset:0 lds
    buffer_load_dwordx4 v9, s[16:19], s56 offen offset:1024 lds
    buffer_load_dwordx4 v10, s[16:19], s56 offen offset:2048 lds
    buffer_load_dwordx4 v11, s[16:19], s56 offen offset:3072 lds
    v_lshlrev_b32 v1, 4, v0
    s_mov_b32 s71, 0x3c853526
    v_lshrrev_b32 v24, 4, v0
    v_bfe_u32 v25, v0, 2, 2
    v_lshl_add_u32 v26, v24, 3, v25
    v_lshlrev_b32 v26, 7, v26
    v_and_b32 v27, 3, v0
    v_lshl_add_u32 v26, v27, 3, v26
    v_and_b32 v24, 1, v24
    v_lshrrev_b32 v25, 1, v25
    v_lshl_or_b32 v24, v24, 1, v25
    v_xor_b32 v25, 0, v24
    v_lshl_add_u32 v4, v25, 5, v26
    v_xor_b32 v25, 1, v24
    v_lshl_add_u32 v5, v25, 5, v26
    v_xor_b32 v25, 2, v24
    v_lshl_add_u32 v6, v25, 5, v26
    v_xor_b32 v25, 3, v24
    v_lshl_add_u32 v7, v25, 5, v26
    v_and_b32 v24, 15, v0
    v_lshrrev_b32 v25, 1, v24
    v_lshrrev_b32 v26, 4, v0
    v_xor_b32 v25, v25, v26
    v_lshlrev_b32 v24, 7, v24
    v_add_u32 v24, s67, v24
    v_lshl_add_u32 v16, v25, 4, v24
    v_xor_b32 v17, 64, v16
    s_lshl_b32 s59, s2, 2
    s_add_u32 s59, s59, s3
    s_lshl_b32 s69, s59, 11
    s_lshr_b32 s59, s2, 2
    s_lshl_b32 s70, s59, 15
    s_bfe_u32 s59, s2, 0x10001
    s_lshl_b32 s59, s59, 10
    s_add_u32 s70, s70, s59
    s_and_b32 s59, s2, 1
    s_lshl_b32 s59, s59, 7
    s_add_u32 s70, s70, s59
    s_lshl_b32 s59, s3, 13
    s_add_u32 s70, s70, s59
    s_bfe_u32 s59, s2, 0x20001
    s_lshl_b32 s59, s59, 3
    s_bfe_u32 s60, s2, 0x30003
    s_add_u32 s64, s59, s60
    s_and_b32 s59, s2, 1
    s_lshl_b32 s59, s59, 2
    s_lshr_b32 s60, s2, 6
    s_add_u32 s63, s59, s60
    s_lshl_b32 s101, s63, 5
    s_add_u32 s101, s101, s64
    s_lshl_b32 s59, s63, 2
    s_add_u32 s85, s59, s3
    s_sub_u32 s60, 60, s59
    s_add_u32 s61, s60, s3
    s_lshl_b32 s73, s61, 15
    s_lshl_b32 s74, s85, 15
    s_lshl_b32 s59, s3, 18
    s_lshl_b32 s60, s64, 8
    s_add_u32 s75, s59, s60
    s_add_u32 s60, s64, 1
    s_lshr_b32 s60, s60, 3
    s_sub_u32 s60, s64, s60
    s_lshl_b32 s60, s60, 7
    s_mul_i32 s59, s3, 114688
    s_add_u32 s76, s59, s60
    s_lshr_b32 s59, s61, 1
    s_mul_i32 s59, s59, 753664
    s_and_b32 s60, s61, 1
    s_lshl_b32 s60, s60, 11
    s_add_u32 s59, s59, s60
    s_add_u32 s59, s59, 0x2200000
    s_add_u32 s60, s64, 1
    s_lshr_b32 s60, s60, 3
    s_sub_u32 s60, s64, s60
    s_lshl_b32 s60, s60, 13
    s_add_u32 s77, s59, s60
    s_lshl_b32 s60, s64, 14
    s_add_u32 s59, s59, s60
    s_add_u32 s81, s59, 229376
    s_lshr_b32 s59, s85, 1
    s_mul_i32 s59, s59, 753664
    s_and_b32 s60, s85, 1
    s_lshl_b32 s60, s60, 11
    s_add_u32 s59, s59, s60
    s_add_u32 s59, s59, 0x2200000
    s_add_u32 s60, s64, 1
    s_lshr_b32 s60, s60, 3
    s_sub_u32 s60, s64, s60
    s_lshl_b32 s60, s60, 13
    s_add_u32 s78, s59, s60
    s_lshl_b32 s60, s64, 14
    s_add_u32 s59, s59, s60
    s_add_u32 s82, s59, 229376
    s_cmp_lt_u32 s101, 56
    s_cselect_b32 s24, s48, s24
    s_cselect_b32 s25, s49, s25
    s_cselect_b32 s59, 0, 56
    s_mov_b32 s60, 0x400000
    s_cselect_b32 s26, 0x1c0000, s60
    s_mov_b32 s27, 0x20000
    s_min_u32 s60, s101, 183
    s_sub_u32 s59, s60, s59
    s_lshl_b32 s59, s59, 15
    s_lshl_b32 s79, s3, 8
    s_add_u32 s79, s79, s59
    s_lshl_b32 s60, s60, 12
    s_mul_i32 s59, s3, 1507328
    s_add_u32 s80, s59, s60
    s_add_u32 s80, s80, 0x3a00000
    s_lshl_b32 s59, s64, 20
    s_add_u32 s59, s59, 0x200000
    s_add_u32 s48, s44, s59
    s_addc_u32 s49, s45, 0
    s_lshl_b32 s59, s63, 16
    s_sub_u32 s50, 0x100000, s59
    s_mov_b32 s51, 0x20000
    s_cmp_lt_u32 s3, 2
    s_cselect_b32 s59, 0xc000, 0
    s_add_u32 s83, s59, s62
    s_mov_b64 s[86:87], 0
    s_mov_b32 s1, s63
    v_cmp_gt_u32 vcc, 64, v18
    v_lshlrev_b32 v20, 7, v0
    v_mov_b32 v21, 0x7fffff00
    v_cndmask_b32 v20, v21, v20, vcc
    v_cmp_eq_u32 vcc, 0, v18
    v_mov_b32 v22, 0
    v_mov_b32 v23, 1
    v_cndmask_b32 v21, v21, v22, vcc
    v_lshrrev_b32 v18, 1, v0
    v_mul_u32_u24 v18, 3584, v18
    v_add_u32 v18, s96, v18
    s_mov_b32 s96, 0x3900000
    s_mov_b32 s97, 0x3902000
    v_lshrrev_b32 v24, 4, v0
    v_lshlrev_b32 v24, 2, v24
    v_and_b32 v25, 15, v0
    v_add_u32 v26, 0, v24
    v_cmp_gt_u32 s[88:89], v26, v25
    v_add_u32 v26, 1, v24
    v_cmp_gt_u32 s[90:91], v26, v25
    v_add_u32 v26, 2, v24
    v_cmp_gt_u32 s[92:93], v26, v25
    v_add_u32 v26, 3, v24
    v_cmp_gt_u32 s[94:95], v26, v25
    v_mov_b32 v3, 0xc2469614
    v_lshrrev_b32 v24, 5, v0
    v_and_b32 v25, 31, v0
    v_lshlrev_b32 v25, 4, v25
    v_lshl_add_u32 v26, v24, 10, v25
    s_mov_b32 s100, 1
    s_cmp_eq_u32 s3, 0
    s_cbranch_scc1 K_PG0
    s_cmp_eq_u32 s3, 1
    s_cbranch_scc1 K_PG1
    s_cmp_eq_u32 s3, 2
    s_cbranch_scc1 K_PG2
    s_branch K_PG3
S0:
    s_mov_b32 s97, 524288
S0_L:
    buffer_load_dword v90, v22, s[40:43], 0 offen sc1
    s_sub_u32 s97, s97, 1
    s_waitcnt vmcnt(0)
    s_cbranch_scc1 S0_RET
    v_cmp_gt_u32 vcc, 1, v90
    s_cbranch_vccnz S0_L
    s_branch S0_RET
S1:
    s_mov_b32 s97, 524288
S1_L:
    buffer_load_dword v13, v12, s[44:47], s96 offen sc1
    s_sub_u32 s97, s97, 1
    s_waitcnt vmcnt(0)
    s_cbranch_scc1 S1_RET
    v_cmp_gt_u32 vcc, 16, v13
    s_cbranch_vccnz S1_L
    s_branch S1_RET
S2:
    s_mov_b32 s97, 524288
S2_L:
    buffer_load_dword v13, v12, s[44:47], s96 offen sc1
    s_sub_u32 s97, s97, 1
    s_waitcnt vmcnt(0)
    s_cbranch_scc1 S2_RET
    v_cmp_gt_u32 vcc, 8, v13
    s_cbranch_vccnz S2_L
    s_branch S2_RET
K_NM0:
    v_mov_b32 v24, s76
    v_mov_b32 v25, s76
    v_mov_b32 v26, s76
    v_mov_b32 v27, s76
    v_cndmask_b32 v16, v16, v24, s[88:89]
    v_cndmask_b32 v17, v17, v24, s[90:91]
    v_cndmask_b32 v18, v18, v24, s[92:93]
    v_cndmask_b32 v19, v19, v24, s[94:95]
    v_cndmask_b32 v28, v28, v24, s[88:89]
    v_cndmask_b32 v29, v29, v24, s[90:91]
    v_cndmask_b32 v30, v30, v24, s[92:93]
    v_cndmask_b32 v31, v31, v24, s[94:95]
    s_branch K_NM0_RET
S3:
    s_mov_b32 s97, 524288
S3_L:
    buffer_load_dword v13, v30, s[44:47], s96 offen sc1
    s_sub_u32 s97, s97, 1
    s_waitcnt vmcnt(0)
    s_cbranch_scc1 S3_RET
    v_cmp_gt_u32 vcc, 128, v13
    s_cbranch_vccnz S3_L
    s_branch S3_RET
K_XBL:
    s_barrier
    s_sub_u32 s75, s75, 1
    s_branch K_XB
K_YBL:
    s_barrier
    s_sub_u32 s78, s78, 1
    s_cmp_lg_u32 s78, 0
    s_cbranch_scc1 K_YBL
    s_branch K_YBD
S4:
    s_mov_b32 s97, 524288
S4_L:
    buffer_load_dword v13, v12, s[44:47], s71 offen sc1
    s_sub_u32 s97, s97, 1
    s_waitcnt vmcnt(0)
    s_cbranch_scc1 S4_RET
    v_cmp_gt_u32 vcc, 8, v13
    s_cbranch_vccnz S4_L
    s_branch S4_RET
S7:
    s_mov_b32 s97, 524288
S7_L:
    buffer_load_dword v13, v12, s[44:47], s96 offen sc1
    s_sub_u32 s97, s97, 1
    s_waitcnt vmcnt(0)
    s_cbranch_scc1 S7_RET
    v_cmp_gt_u32 vcc, 8, v13
    s_cbranch_vccnz S7_L
    s_branch S7_RET
K_XR0:
    buffer_load_dwordx4 v[128:131], v1, s[44:47], s70 offen offset:0 sc1
    buffer_load_dwordx4 v[132:135], v1, s[44:47], s70 offen offset:1024 sc1
    s_branch K_XN0
K_XR1:
    buffer_load_dwordx4 v[136:139], v1, s[44:47], s70 offen offset:2048 sc1
    buffer_load_dwordx4 v[140:143], v1, s[44:47], s70 offen offset:3072 sc1
    s_branch K_XN1
K_XR2:
    buffer_load_dwordx4 v[144:147], v1, s[44:47], s60 offen offset:0 sc1
    buffer_load_dwordx4 v[148:151], v1, s[44:47], s60 offen offset:1024 sc1
    s_branch K_XN2
K_XW:
    s_sub_u32 s97, s97, 1
    s_waitcnt vmcnt(0)
    s_cbranch_scc0 K_XL
    s_branch K_XD
.p2align 12
K_MAIN:
    s_mov_b32 s100, 0
    s_add_u32 m0, s62, 16384
    s_mul_i32 s56, s53, 2
    s_add_u32 s56, s56, 0x20000
    s_bfe_u32 s56, s0, s56
    s_lshl_b32 s56, s56, 20
    s_add_u32 s56, s56, s84
    s_mul_i32 s58, s53, -524288
    s_add_u32 s56, s56, s58
    s_add_u32 s56, s56, 524288
    buffer_load_dwordx4 v8, s[16:19], s56 offen offset:0 lds
    buffer_load_dwordx4 v9, s[16:19], s56 offen offset:1024 lds
    buffer_load_dwordx4 v10, s[16:19], s56 offen offset:2048 lds
    buffer_load_dwordx4 v11, s[16:19], s56 offen offset:3072 lds
    s_bfe_u32 s56, s0, 0x20000
    s_mul_i32 s56, s56, 256
    s_add_u32 s56, s56, s65
    s_add_u32 s56, s56, 128
    s_add_u32 m0, s67, 8192
    s_nop 0
    buffer_load_dwordx4 v12, s[8:11], s56 offen offset:0 lds
    buffer_load_dwordx4 v13, s[8:11], s56 offen offset:1024 lds
    buffer_load_dwordx4 v14, s[8:11], s56 offen offset:2048 lds
    buffer_load_dwordx4 v15, s[8:11], s56 offen offset:3072 lds
    s_add_u32 s56, s56, 32768
    s_add_u32 m0, s67, 12288
    s_nop 0
    buffer_load_dwordx4 v12, s[8:11], s56 offen offset:0 lds
    buffer_load_dwordx4 v13, s[8:11], s56 offen offset:1024 lds
    buffer_load_dwordx4 v14, s[8:11], s56 offen offset:2048 lds
    buffer_load_dwordx4 v15, s[8:11], s56 offen offset:3072 lds
    s_waitcnt vmcnt(12)
    s_barrier
    ds_read_b128 a[0:3], v16 offset:0
    ds_read_b128 a[4:7], v16 offset:2048
    ds_read_b128 a[8:11], v16 offset:4096
    ds_read_b128 a[12:15], v16 offset:6144
    ds_read_b128 a[16:19], v17 offset:0
    ds_read_b128 a[20:23], v17 offset:2048
    ds_read_b128 a[24:27], v17 offset:4096
    ds_read_b128 a[28:31], v17 offset:6144
    ds_read_b64_tr_b16 v[40:41], v4 offset:0
    ds_read_b64_tr_b16 v[42:43], v4 offset:512
    ds_read_b64_tr_b16 v[44:45], v4 offset:4096
    ds_read_b64_tr_b16 v[46:47], v4 offset:4608
    ds_read_b64_tr_b16 v[48:49], v5 offset:0
    ds_read_b64_tr_b16 v[50:51], v5 offset:512
    ds_read_b64_tr_b16 v[52:53], v5 offset:4096
    s_waitcnt lgkmcnt(11)
    ds_read_b64_tr_b16 v[54:55], v5 offset:4608
    s_waitcnt lgkmcnt(6)
    v_mfma_f32_16x16x32_bf16 v[128:131], v[40:43], a[0:3], 0
    s_waitcnt lgkmcnt(4)
    s_bfe_u32 s56, s0, 0x20002
    ds_read_b64_tr_b16 v[56:57], v6 offset:0
    v_mfma_f32_16x16x32_bf16 v[128:131], v[44:47], a[16:19], v[128:131]
    s_mul_i32 s56, s56, 256
    s_add_u32 s56, s56, s65
    ds_read_b64_tr_b16 v[58:59], v6 offset:512
    v_mfma_f32_16x16x32_bf16 v[144:147], v[44:47], a[20:23], 0
    s_add_u32 m0, s67, 0
    ds_read_b64_tr_b16 v[60:61], v6 offset:4096
    v_mfma_f32_16x16x32_bf16 v[144:147], v[40:43], a[4:7], v[144:147]
    ds_read_b64_tr_b16 v[62:63], v6 offset:4608
    buffer_load_dwordx4 v12, s[8:11], s56 offen offset:0 lds
    v_mfma_f32_16x16x32_bf16 v[160:163], v[40:43], a[8:11], 0
    v_mfma_f32_16x16x32_bf16 v[160:163], v[44:47], a[24:27], v[160:163]
    buffer_load_dwordx4 v13, s[8:11], s56 offen offset:1024 lds
    v_mfma_f32_16x16x32_bf16 v[176:179], v[44:47], a[28:31], 0
    v_mfma_f32_16x16x32_bf16 v[176:179], v[40:43], a[12:15], v[176:179]
    s_waitcnt lgkmcnt(4)
    v_mfma_f32_16x16x32_bf16 v[180:183], v[48:51], a[12:15], 0
    ds_read_b64_tr_b16 v[40:41], v7 offset:0
    v_mfma_f32_16x16x32_bf16 v[180:183], v[52:55], a[28:31], v[180:183]
    ds_read_b64_tr_b16 v[42:43], v7 offset:512
    buffer_load_dwordx4 v14, s[8:11], s56 offen offset:2048 lds
    v_mfma_f32_16x16x32_bf16 v[164:167], v[52:55], a[24:27], 0
    ds_read_b64_tr_b16 v[44:45], v7 offset:4096
    v_mfma_f32_16x16x32_bf16 v[164:167], v[48:51], a[8:11], v[164:167]
    ds_read_b64_tr_b16 v[46:47], v7 offset:4608
    v_mfma_f32_16x16x32_bf16 v[148:151], v[48:51], a[4:7], 0
    v_mfma_f32_16x16x32_bf16 v[148:151], v[52:55], a[20:23], v[148:151]
    buffer_load_dwordx4 v15, s[8:11], s56 offen offset:3072 lds
    v_mfma_f32_16x16x32_bf16 v[132:135], v[52:55], a[16:19], 0
    s_add_u32 s56, s56, 32768
    s_add_u32 m0, s67, 4096
    v_mfma_f32_16x16x32_bf16 v[132:135], v[48:51], a[0:3], v[132:135]
    s_waitcnt lgkmcnt(4)
    v_mfma_f32_16x16x32_bf16 v[136:139], v[56:59], a[0:3], 0
    ds_read_b64_tr_b16 v[48:49], v4 offset:8192
    buffer_load_dwordx4 v12, s[8:11], s56 offen offset:0 lds
    v_mfma_f32_16x16x32_bf16 v[136:139], v[60:63], a[16:19], v[136:139]
    ds_read_b64_tr_b16 v[50:51], v4 offset:8704
    v_mfma_f32_16x16x32_bf16 v[152:155], v[60:63], a[20:23], 0
    ds_read_b64_tr_b16 v[52:53], v4 offset:12288
    v_mfma_f32_16x16x32_bf16 v[152:155], v[56:59], a[4:7], v[152:155]
    ds_read_b64_tr_b16 v[54:55], v4 offset:12800
    v_mfma_f32_16x16x32_bf16 v[168:171], v[56:59], a[8:11], 0
    buffer_load_dwordx4 v13, s[8:11], s56 offen offset:1024 lds
    v_mfma_f32_16x16x32_bf16 v[168:171], v[60:63], a[24:27], v[168:171]
    v_mfma_f32_16x16x32_bf16 v[184:187], v[60:63], a[28:31], 0
    v_mfma_f32_16x16x32_bf16 v[184:187], v[56:59], a[12:15], v[184:187]
    s_waitcnt lgkmcnt(4)
    v_mfma_f32_16x16x32_bf16 v[188:191], v[40:43], a[12:15], 0
    ds_read_b64_tr_b16 v[56:57], v5 offset:8192
    buffer_load_dwordx4 v14, s[8:11], s56 offen offset:2048 lds
    v_mfma_f32_16x16x32_bf16 v[188:191], v[44:47], a[28:31], v[188:191]
    ds_read_b64_tr_b16 v[58:59], v5 offset:8704
    v_mfma_f32_16x16x32_bf16 v[172:175], v[44:47], a[24:27], 0
    ds_read_b64_tr_b16 v[60:61], v5 offset:12288
    v_mfma_f32_16x16x32_bf16 v[172:175], v[40:43], a[8:11], v[172:175]
    ds_read_b64_tr_b16 v[62:63], v5 offset:12800
    buffer_load_dwordx4 v15, s[8:11], s56 offen offset:3072 lds
    v_mfma_f32_16x16x32_bf16 v[156:159], v[40:43], a[4:7], 0
    s_mul_i32 s56, s53, 2
    s_add_u32 s56, s56, 0x20000
    v_mfma_f32_16x16x32_bf16 v[156:159], v[44:47], a[20:23], v[156:159]
    s_bfe_u32 s56, s0, s56
    s_lshl_b32 s56, s56, 20
    v_mfma_f32_16x16x32_bf16 v[140:143], v[44:47], a[16:19], 0
    s_add_u32 s56, s56, s84
    s_mul_i32 s58, s53, -128
    v_mfma_f32_16x16x32_bf16 v[140:143], v[40:43], a[0:3], v[140:143]
    s_waitcnt lgkmcnt(4)
    s_add_u32 s56, s56, s58
    v_mfma_f32_16x16x32_bf16 v[192:195], v[48:51], a[0:3], 0
    s_add_u32 s56, s56, 524416
    s_add_u32 m0, s62, 32768
    ds_read_b64_tr_b16 v[40:41], v6 offset:8192
    v_mfma_f32_16x16x32_bf16 v[192:195], v[52:55], a[16:19], v[192:195]
    ds_read_b64_tr_b16 v[42:43], v6 offset:8704
    buffer_load_dwordx4 v8, s[16:19], s56 offen offset:0 lds
    v_mfma_f32_16x16x32_bf16 v[208:211], v[52:55], a[20:23], 0
    ds_read_b64_tr_b16 v[44:45], v6 offset:12288
    v_mfma_f32_16x16x32_bf16 v[208:211], v[48:51], a[4:7], v[208:211]
    ds_read_b64_tr_b16 v[46:47], v6 offset:12800
    buffer_load_dwordx4 v9, s[16:19], s56 offen offset:1024 lds
    v_mfma_f32_16x16x32_bf16 v[224:227], v[48:51], a[8:11], 0
    v_mfma_f32_16x16x32_bf16 v[224:227], v[52:55], a[24:27], v[224:227]
    v_mfma_f32_16x16x32_bf16 v[240:243], v[52:55], a[28:31], 0
    v_mfma_f32_16x16x32_bf16 v[240:243], v[48:51], a[12:15], v[240:243]
    s_waitcnt lgkmcnt(4)
    buffer_load_dwordx4 v10, s[16:19], s56 offen offset:2048 lds
    v_mfma_f32_16x16x32_bf16 v[244:247], v[56:59], a[12:15], 0
    ds_read_b64_tr_b16 v[48:49], v7 offset:8192
    v_mfma_f32_16x16x32_bf16 v[244:247], v[60:63], a[28:31], v[244:247]
    ds_read_b64_tr_b16 v[50:51], v7 offset:8704
    v_mfma_f32_16x16x32_bf16 v[228:231], v[60:63], a[24:27], 0
    ds_read_b64_tr_b16 v[52:53], v7 offset:12288
    buffer_load_dwordx4 v11, s[16:19], s56 offen offset:3072 lds
    v_mfma_f32_16x16x32_bf16 v[228:231], v[56:59], a[8:11], v[228:231]
    s_waitcnt vmcnt(12)
    ds_read_b64_tr_b16 v[54:55], v7 offset:12800
    v_mfma_f32_16x16x32_bf16 v[212:215], v[56:59], a[4:7], 0
    ds_read_b128 a[32:35], v16 offset:8192
    ds_read_b128 a[36:39], v16 offset:10240
    v_mfma_f32_16x16x32_bf16 v[212:215], v[60:63], a[20:23], v[212:215]
    ds_read_b128 a[40:43], v16 offset:12288
    ds_read_b128 a[44:47], v16 offset:14336
    v_mfma_f32_16x16x32_bf16 v[196:199], v[60:63], a[16:19], 0
    s_waitcnt lgkmcnt(0)
    ds_read_b128 a[48:51], v17 offset:8192
    ds_read_b128 a[52:55], v17 offset:10240
    v_mfma_f32_16x16x32_bf16 v[196:199], v[56:59], a[0:3], v[196:199]
    s_barrier
    ds_read_b128 a[56:59], v17 offset:12288
    ds_read_b128 a[60:63], v17 offset:14336
    v_mfma_f32_16x16x32_bf16 v[200:203], v[40:43], a[0:3], 0
    ds_read_b64_tr_b16 v[56:57], v4 offset:16384
    buffer_load_dwordx4 v[64:67], v26, s[4:7], s69 offen
    v_mfma_f32_16x16x32_bf16 v[200:203], v[44:47], a[16:19], v[200:203]
    ds_read_b64_tr_b16 v[58:59], v4 offset:16896
    v_mfma_f32_16x16x32_bf16 v[216:219], v[44:47], a[20:23], 0
    ds_read_b64_tr_b16 v[60:61], v4 offset:20480
    buffer_load_dwordx4 v[68:71], v26, s[4:7], s69 offen offset:512
    v_mfma_f32_16x16x32_bf16 v[216:219], v[40:43], a[4:7], v[216:219]
    ds_read_b64_tr_b16 v[62:63], v4 offset:20992
    v_mfma_f32_16x16x32_bf16 v[232:235], v[40:43], a[8:11], 0
    v_mfma_f32_16x16x32_bf16 v[232:235], v[44:47], a[24:27], v[232:235]
    buffer_store_dword v22, v20, s[44:47], s96 offen sc1
    v_mfma_f32_16x16x32_bf16 v[248:251], v[44:47], a[28:31], 0
    v_mfma_f32_16x16x32_bf16 v[248:251], v[40:43], a[12:15], v[248:251]
    v_mfma_f32_16x16x32_bf16 v[252:255], v[48:51], a[12:15], 0
    ds_read_b64_tr_b16 v[40:41], v5 offset:16384
    v_mfma_f32_16x16x32_bf16 v[252:255], v[52:55], a[28:31], v[252:255]
    ds_read_b64_tr_b16 v[42:43], v5 offset:16896
    buffer_store_dword v22, v20, s[44:47], s97 offen sc1
    v_mfma_f32_16x16x32_bf16 v[236:239], v[52:55], a[24:27], 0
    s_waitcnt lgkmcnt(6)
    s_bfe_u32 s56, s0, 0x20002
    ds_read_b64_tr_b16 v[44:45], v5 offset:20480
    v_mfma_f32_16x16x32_bf16 v[236:239], v[48:51], a[8:11], v[236:239]
    s_mul_i32 s56, s56, 256
    s_add_u32 s56, s56, s65
    ds_read_b64_tr_b16 v[46:47], v5 offset:20992
    v_mfma_f32_16x16x32_bf16 v[220:223], v[48:51], a[4:7], 0
    s_add_u32 s56, s56, 128
    s_add_u32 m0, s67, 8192
    v_mfma_f32_16x16x32_bf16 v[220:223], v[52:55], a[20:23], v[220:223]
    buffer_load_dwordx4 v12, s[8:11], s56 offen offset:0 lds
    v_mfma_f32_16x16x32_bf16 v[204:207], v[52:55], a[16:19], 0
    v_mfma_f32_16x16x32_bf16 v[204:207], v[48:51], a[0:3], v[204:207]
    s_waitcnt lgkmcnt(4)
    v_mfma_f32_16x16x32_bf16 v[128:131], v[56:59], a[32:35], v[128:131]
    ds_read_b64_tr_b16 v[48:49], v6 offset:16384
    buffer_load_dwordx4 v13, s[8:11], s56 offen offset:1024 lds
    v_mfma_f32_16x16x32_bf16 v[128:131], v[60:63], a[48:51], v[128:131]
    ds_read_b64_tr_b16 v[50:51], v6 offset:16896
    v_mfma_f32_16x16x32_bf16 v[144:147], v[60:63], a[52:55], v[144:147]
    ds_read_b64_tr_b16 v[52:53], v6 offset:20480
    v_mfma_f32_16x16x32_bf16 v[144:147], v[56:59], a[36:39], v[144:147]
    ds_read_b64_tr_b16 v[54:55], v6 offset:20992
    v_mfma_f32_16x16x32_bf16 v[160:163], v[56:59], a[40:43], v[160:163]
    buffer_load_dwordx4 v14, s[8:11], s56 offen offset:2048 lds
    v_mfma_f32_16x16x32_bf16 v[160:163], v[60:63], a[56:59], v[160:163]
    v_mfma_f32_16x16x32_bf16 v[176:179], v[60:63], a[60:63], v[176:179]
    v_mfma_f32_16x16x32_bf16 v[176:179], v[56:59], a[44:47], v[176:179]
    s_waitcnt lgkmcnt(4)
    v_mfma_f32_16x16x32_bf16 v[180:183], v[40:43], a[44:47], v[180:183]
    ds_read_b64_tr_b16 v[56:57], v7 offset:16384
    buffer_load_dwordx4 v15, s[8:11], s56 offen offset:3072 lds
    v_mfma_f32_16x16x32_bf16 v[180:183], v[44:47], a[60:63], v[180:183]
    s_add_u32 s56, s56, 32768
    s_add_u32 m0, s67, 12288
    ds_read_b64_tr_b16 v[58:59], v7 offset:16896
    v_mfma_f32_16x16x32_bf16 v[164:167], v[44:47], a[56:59], v[164:167]
    ds_read_b64_tr_b16 v[60:61], v7 offset:20480
    v_mfma_f32_16x16x32_bf16 v[164:167], v[40:43], a[40:43], v[164:167]
    ds_read_b64_tr_b16 v[62:63], v7 offset:20992
    v_mfma_f32_16x16x32_bf16 v[148:151], v[40:43], a[36:39], v[148:151]
    buffer_load_dwordx4 v12, s[8:11], s56 offen offset:0 lds
    v_mfma_f32_16x16x32_bf16 v[148:151], v[44:47], a[52:55], v[148:151]
    v_mfma_f32_16x16x32_bf16 v[132:135], v[44:47], a[48:51], v[132:135]
    v_mfma_f32_16x16x32_bf16 v[132:135], v[40:43], a[32:35], v[132:135]
    s_waitcnt lgkmcnt(4)
    buffer_load_dwordx4 v13, s[8:11], s56 offen offset:1024 lds
    v_mfma_f32_16x16x32_bf16 v[136:139], v[48:51], a[32:35], v[136:139]
    ds_read_b64_tr_b16 v[40:41], v4 offset:24576
    v_mfma_f32_16x16x32_bf16 v[136:139], v[52:55], a[48:51], v[136:139]
    ds_read_b64_tr_b16 v[42:43], v4 offset:25088
    v_mfma_f32_16x16x32_bf16 v[152:155], v[52:55], a[52:55], v[152:155]
    ds_read_b64_tr_b16 v[44:45], v4 offset:28672
    v_mfma_f32_16x16x32_bf16 v[152:155], v[48:51], a[36:39], v[152:155]
    s_waitcnt vmcnt(14)
    ds_read_b64_tr_b16 v[46:47], v4 offset:29184
    buffer_load_dwordx4 v14, s[8:11], s56 offen offset:2048 lds
    v_mfma_f32_16x16x32_bf16 v[168:171], v[48:51], a[40:43], v[168:171]
    ds_read_b128 a[64:67], v16 offset:0
    ds_read_b128 a[68:71], v16 offset:2048
    v_mfma_f32_16x16x32_bf16 v[168:171], v[52:55], a[56:59], v[168:171]
    ds_read_b128 a[72:75], v16 offset:4096
    ds_read_b128 a[76:79], v16 offset:6144
    v_mfma_f32_16x16x32_bf16 v[184:187], v[52:55], a[60:63], v[184:187]
    ds_read_b128 a[80:83], v17 offset:0
    ds_read_b128 a[84:87], v17 offset:2048
    v_mfma_f32_16x16x32_bf16 v[184:187], v[48:51], a[44:47], v[184:187]
    s_waitcnt lgkmcnt(10)
    ds_read_b128 a[88:91], v17 offset:4096
    ds_read_b128 a[92:95], v17 offset:6144
    v_mfma_f32_16x16x32_bf16 v[188:191], v[56:59], a[44:47], v[188:191]
    ds_read_b64_tr_b16 v[48:49], v5 offset:24576
    buffer_load_dwordx4 v15, s[8:11], s56 offen offset:3072 lds
    v_mfma_f32_16x16x32_bf16 v[188:191], v[60:63], a[60:63], v[188:191]
    s_mul_i32 s56, s53, -2
    s_add_u32 s56, s56, 0x20004
    ds_read_b64_tr_b16 v[50:51], v5 offset:25088
    v_mfma_f32_16x16x32_bf16 v[172:175], v[60:63], a[56:59], v[172:175]
    s_bfe_u32 s56, s0, s56
    s_lshl_b32 s56, s56, 20
    ds_read_b64_tr_b16 v[52:53], v5 offset:28672
    v_mfma_f32_16x16x32_bf16 v[172:175], v[56:59], a[40:43], v[172:175]
    s_waitcnt lgkmcnt(11)
    s_add_u32 s56, s56, s84
    s_mul_i32 s58, s53, 128
    ds_read_b64_tr_b16 v[54:55], v5 offset:29184
    v_mfma_f32_16x16x32_bf16 v[156:159], v[56:59], a[36:39], v[156:159]
    s_add_u32 s56, s56, s58
    s_add_u32 m0, s62, 49152
    v_mfma_f32_16x16x32_bf16 v[156:159], v[60:63], a[52:55], v[156:159]
    buffer_load_dwordx4 v8, s[16:19], s56 offen offset:0 lds
    v_mfma_f32_16x16x32_bf16 v[140:143], v[60:63], a[48:51], v[140:143]
    buffer_load_dwordx4 v9, s[16:19], s56 offen offset:1024 lds
    v_mfma_f32_16x16x32_bf16 v[140:143], v[56:59], a[32:35], v[140:143]
    s_waitcnt lgkmcnt(11)
    v_mfma_f32_16x16x32_bf16 v[128:131], v[40:43], a[64:67], v[128:131]
    s_waitcnt lgkmcnt(7)
    ds_read_b64_tr_b16 v[56:57], v6 offset:24576
    v_mfma_f32_16x16x32_bf16 v[128:131], v[44:47], a[80:83], v[128:131]
    s_waitcnt lgkmcnt(7)
    ds_read_b64_tr_b16 v[58:59], v6 offset:25088
    v_mfma_f32_16x16x32_bf16 v[144:147], v[44:47], a[84:87], v[144:147]
    ds_read_b64_tr_b16 v[60:61], v6 offset:28672
    buffer_load_dwordx4 v10, s[16:19], s56 offen offset:2048 lds
    v_mfma_f32_16x16x32_bf16 v[144:147], v[40:43], a[68:71], v[144:147]
    ds_read_b64_tr_b16 v[62:63], v6 offset:29184
    v_mfma_f32_16x16x32_bf16 v[160:163], v[40:43], a[72:75], v[160:163]
    s_waitcnt lgkmcnt(9)
    v_mfma_f32_16x16x32_bf16 v[160:163], v[44:47], a[88:91], v[160:163]
    s_waitcnt lgkmcnt(8)
    buffer_load_dwordx4 v11, s[16:19], s56 offen offset:3072 lds
    v_mfma_f32_16x16x32_bf16 v[176:179], v[44:47], a[92:95], v[176:179]
    s_bfe_u32 s56, s0, 0x20004
    v_mfma_f32_16x16x32_bf16 v[176:179], v[40:43], a[76:79], v[176:179]
    s_waitcnt lgkmcnt(4)
    s_mul_i32 s56, s56, 256
    v_mfma_f32_16x16x32_bf16 v[180:183], v[48:51], a[76:79], v[180:183]
    s_add_u32 s56, s56, s65
    s_add_u32 m0, s67, 0
    ds_read_b64_tr_b16 v[40:41], v7 offset:24576
    v_mfma_f32_16x16x32_bf16 v[180:183], v[52:55], a[92:95], v[180:183]
    ds_read_b64_tr_b16 v[42:43], v7 offset:25088
    buffer_load_dwordx4 v12, s[8:11], s56 offen offset:0 lds
    v_mfma_f32_16x16x32_bf16 v[164:167], v[52:55], a[88:91], v[164:167]
    ds_read_b64_tr_b16 v[44:45], v7 offset:28672
    v_mfma_f32_16x16x32_bf16 v[164:167], v[48:51], a[72:75], v[164:167]
    ds_read_b64_tr_b16 v[46:47], v7 offset:29184
    v_mfma_f32_16x16x32_bf16 v[148:151], v[48:51], a[68:71], v[148:151]
    s_waitcnt vmcnt(13)
    v_mfma_f32_16x16x32_bf16 v[148:151], v[52:55], a[84:87], v[148:151]
    buffer_load_dwordx4 v13, s[8:11], s56 offen offset:1024 lds
    v_mfma_f32_16x16x32_bf16 v[132:135], v[52:55], a[80:83], v[132:135]
    s_waitcnt lgkmcnt(0)
    buffer_store_dword v23, v21, s[40:43], 0 offen sc1
    v_mfma_f32_16x16x32_bf16 v[132:135], v[48:51], a[64:67], v[132:135]
    s_barrier
    v_mfma_f32_16x16x32_bf16 v[136:139], v[56:59], a[64:67], v[136:139]
    ds_read_b64_tr_b16 v[48:49], v4 offset:32768
    v_mfma_f32_16x16x32_bf16 v[136:139], v[60:63], a[80:83], v[136:139]
    ds_read_b64_tr_b16 v[50:51], v4 offset:33280
    buffer_load_dwordx4 v14, s[8:11], s56 offen offset:2048 lds
    v_mfma_f32_16x16x32_bf16 v[152:155], v[60:63], a[84:87], v[152:155]
    ds_read_b64_tr_b16 v[52:53], v4 offset:36864
    v_mfma_f32_16x16x32_bf16 v[152:155], v[56:59], a[68:71], v[152:155]
    ds_read_b64_tr_b16 v[54:55], v4 offset:37376
    v_mfma_f32_16x16x32_bf16 v[168:171], v[56:59], a[72:75], v[168:171]
    buffer_load_dwordx4 v15, s[8:11], s56 offen offset:3072 lds
    v_mfma_f32_16x16x32_bf16 v[168:171], v[60:63], a[88:91], v[168:171]
    s_add_u32 s56, s56, 32768
    s_add_u32 m0, s67, 4096
    v_mfma_f32_16x16x32_bf16 v[184:187], v[60:63], a[92:95], v[184:187]
    v_mfma_f32_16x16x32_bf16 v[184:187], v[56:59], a[76:79], v[184:187]
    v_mfma_f32_16x16x32_bf16 v[188:191], v[40:43], a[76:79], v[188:191]
    ds_read_b64_tr_b16 v[56:57], v5 offset:32768
    buffer_load_dwordx4 v12, s[8:11], s56 offen offset:0 lds
    v_mfma_f32_16x16x32_bf16 v[188:191], v[44:47], a[92:95], v[188:191]
    ds_read_b64_tr_b16 v[58:59], v5 offset:33280
    v_lshlrev_b32 v72, 16, v64
    v_mfma_f32_16x16x32_bf16 v[172:175], v[44:47], a[88:91], v[172:175]
    ds_read_b64_tr_b16 v[60:61], v5 offset:36864
    v_and_b32 v73, 0xffff0000, v64
    v_mfma_f32_16x16x32_bf16 v[172:175], v[40:43], a[72:75], v[172:175]
    ds_read_b64_tr_b16 v[62:63], v5 offset:37376
    v_lshlrev_b32 v74, 16, v65
    v_mfma_f32_16x16x32_bf16 v[156:159], v[40:43], a[68:71], v[156:159]
    buffer_load_dwordx4 v13, s[8:11], s56 offen offset:1024 lds
    v_and_b32 v75, 0xffff0000, v65
    v_mfma_f32_16x16x32_bf16 v[156:159], v[44:47], a[84:87], v[156:159]
    v_lshlrev_b32 v76, 16, v66
    v_and_b32 v77, 0xffff0000, v66
    v_mfma_f32_16x16x32_bf16 v[140:143], v[44:47], a[80:83], v[140:143]
    v_lshlrev_b32 v78, 16, v67
    v_and_b32 v79, 0xffff0000, v67
    v_mfma_f32_16x16x32_bf16 v[140:143], v[40:43], a[64:67], v[140:143]
    s_waitcnt lgkmcnt(4)
    buffer_load_dwordx4 v14, s[8:11], s56 offen offset:2048 lds
    v_lshlrev_b32 v80, 16, v68
    v_mfma_f32_16x16x32_bf16 v[192:195], v[48:51], a[32:35], v[192:195]
    ds_read_b64_tr_b16 v[40:41], v6 offset:32768
    v_and_b32 v81, 0xffff0000, v68
    v_mfma_f32_16x16x32_bf16 v[192:195], v[52:55], a[48:51], v[192:195]
    ds_read_b64_tr_b16 v[42:43], v6 offset:33280
    v_lshlrev_b32 v82, 16, v69
    v_mfma_f32_16x16x32_bf16 v[208:211], v[52:55], a[52:55], v[208:211]
    ds_read_b64_tr_b16 v[44:45], v6 offset:36864
    v_and_b32 v83, 0xffff0000, v69
    v_mfma_f32_16x16x32_bf16 v[208:211], v[48:51], a[36:39], v[208:211]
    ds_read_b64_tr_b16 v[46:47], v6 offset:37376
    buffer_load_dwordx4 v15, s[8:11], s56 offen offset:3072 lds
    v_mfma_f32_16x16x32_bf16 v[224:227], v[48:51], a[40:43], v[224:227]
    s_mul_i32 s56, s53, 2
    s_add_u32 s56, s56, 0x20004
    v_lshlrev_b32 v84, 16, v70
    v_mfma_f32_16x16x32_bf16 v[224:227], v[52:55], a[56:59], v[224:227]
    s_bfe_u32 s56, s0, s56
    s_lshl_b32 s56, s56, 20
    v_and_b32 v85, 0xffff0000, v70
    v_mfma_f32_16x16x32_bf16 v[240:243], v[52:55], a[60:63], v[240:243]
    s_add_u32 s56, s56, s84
    s_mul_i32 s58, s53, -524288
    v_lshlrev_b32 v86, 16, v71
    v_mfma_f32_16x16x32_bf16 v[240:243], v[48:51], a[44:47], v[240:243]
    s_waitcnt lgkmcnt(4)
    s_add_u32 s56, s56, s58
    v_and_b32 v87, 0xffff0000, v71
    v_mfma_f32_16x16x32_bf16 v[244:247], v[56:59], a[44:47], v[244:247]
    s_add_u32 s56, s56, 524288
    s_add_u32 m0, s62, 0
    ds_read_b64_tr_b16 v[48:49], v7 offset:32768
    v_mfma_f32_16x16x32_bf16 v[244:247], v[60:63], a[60:63], v[244:247]
    ds_read_b64_tr_b16 v[50:51], v7 offset:33280
    buffer_load_dwordx4 v8, s[16:19], s56 offen offset:0 lds
    v_mfma_f32_16x16x32_bf16 v[228:231], v[60:63], a[56:59], v[228:231]
    ds_read_b64_tr_b16 v[52:53], v7 offset:36864
    buffer_load_dwordx4 v9, s[16:19], s56 offen offset:1024 lds
    v_mfma_f32_16x16x32_bf16 v[228:231], v[56:59], a[40:43], v[228:231]
    ds_read_b64_tr_b16 v[54:55], v7 offset:37376
    v_add_f32 v27, v72, v73
    v_mfma_f32_16x16x32_bf16 v[212:215], v[56:59], a[36:39], v[212:215]
    v_add_f32 v28, v74, v75
    v_add_f32 v27, v27, v76
    v_mfma_f32_16x16x32_bf16 v[212:215], v[60:63], a[52:55], v[212:215]
    v_add_f32 v28, v28, v77
    v_add_f32 v27, v27, v78
    v_mfma_f32_16x16x32_bf16 v[196:199], v[60:63], a[48:51], v[196:199]
    buffer_load_dwordx4 v10, s[16:19], s56 offen offset:2048 lds
    v_add_f32 v28, v28, v79
    v_mfma_f32_16x16x32_bf16 v[196:199], v[56:59], a[32:35], v[196:199]
    s_waitcnt lgkmcnt(4)
    v_add_f32 v27, v27, v80
    v_add_f32 v28, v28, v81
    v_mfma_f32_16x16x32_bf16 v[200:203], v[40:43], a[32:35], v[200:203]
    ds_read_b64_tr_b16 v[56:57], v4 offset:40960
    v_add_f32 v27, v27, v82
    v_mfma_f32_16x16x32_bf16 v[200:203], v[44:47], a[48:51], v[200:203]
    ds_read_b64_tr_b16 v[58:59], v4 offset:41472
    v_add_f32 v28, v28, v83
    v_mfma_f32_16x16x32_bf16 v[216:219], v[44:47], a[52:55], v[216:219]
    ds_read_b64_tr_b16 v[60:61], v4 offset:45056
    buffer_load_dwordx4 v11, s[16:19], s56 offen offset:3072 lds
    v_mfma_f32_16x16x32_bf16 v[216:219], v[40:43], a[36:39], v[216:219]
    s_waitcnt vmcnt(17)
    ds_read_b64_tr_b16 v[62:63], v4 offset:45568
    v_add_f32 v27, v27, v84
    v_mfma_f32_16x16x32_bf16 v[232:235], v[40:43], a[40:43], v[232:235]
    ds_read_b128 a[96:99], v16 offset:8192
    ds_read_b128 a[100:103], v16 offset:10240
    v_mfma_f32_16x16x32_bf16 v[232:235], v[44:47], a[56:59], v[232:235]
    ds_read_b128 a[104:107], v16 offset:12288
    ds_read_b128 a[108:111], v16 offset:14336
    v_mfma_f32_16x16x32_bf16 v[248:251], v[44:47], a[60:63], v[248:251]
    ds_read_b128 a[112:115], v17 offset:8192
    ds_read_b128 a[116:119], v17 offset:10240
    v_mfma_f32_16x16x32_bf16 v[248:251], v[40:43], a[44:47], v[248:251]
    s_waitcnt lgkmcnt(10)
    ds_read_b128 a[120:123], v17 offset:12288
    ds_read_b128 a[124:127], v17 offset:14336
    v_mfma_f32_16x16x32_bf16 v[252:255], v[48:51], a[44:47], v[252:255]
    ds_read_b64_tr_b16 v[40:41], v5 offset:40960
    v_add_f32 v28, v28, v85
    v_mfma_f32_16x16x32_bf16 v[252:255], v[52:55], a[60:63], v[252:255]
    ds_read_b64_tr_b16 v[42:43], v5 offset:41472
    v_add_f32 v27, v27, v86
    v_mfma_f32_16x16x32_bf16 v[236:239], v[52:55], a[56:59], v[236:239]
    ds_read_b64_tr_b16 v[44:45], v5 offset:45056
    v_add_f32 v28, v28, v87
    v_mfma_f32_16x16x32_bf16 v[236:239], v[48:51], a[40:43], v[236:239]
    s_waitcnt lgkmcnt(11)
    ds_read_b64_tr_b16 v[46:47], v5 offset:45568
    v_add_f32 v27, v27, v28
    v_mfma_f32_16x16x32_bf16 v[220:223], v[48:51], a[36:39], v[220:223]
    s_waitcnt lgkmcnt(4)
    s_bfe_u32 s56, s0, 0x20004
    v_mfma_f32_16x16x32_bf16 v[220:223], v[52:55], a[52:55], v[220:223]
    s_mul_i32 s56, s56, 256
    s_add_u32 s56, s56, s65
    v_add_f32_dpp v27, v27, v27 row_ror:8 row_mask:0xf bank_mask:0xf
    v_mfma_f32_16x16x32_bf16 v[204:207], v[52:55], a[48:51], v[204:207]
    s_add_u32 s56, s56, 128
    s_add_u32 m0, s67, 8192
    v_mfma_f32_16x16x32_bf16 v[204:207], v[48:51], a[32:35], v[204:207]
    buffer_load_dwordx4 v12, s[8:11], s56 offen offset:0 lds
    v_add_f32_dpp v27, v27, v27 row_ror:4 row_mask:0xf bank_mask:0xf
    v_mfma_f32_16x16x32_bf16 v[128:131], v[56:59], a[96:99], v[128:131]
    ds_read_b64_tr_b16 v[48:49], v6 offset:40960
    v_mfma_f32_16x16x32_bf16 v[128:131], v[60:63], a[112:115], v[128:131]
    ds_read_b64_tr_b16 v[50:51], v6 offset:41472
    v_add_f32_dpp v27, v27, v27 row_ror:2 row_mask:0xf bank_mask:0xf
    v_mfma_f32_16x16x32_bf16 v[144:147], v[60:63], a[116:119], v[144:147]
    ds_read_b64_tr_b16 v[52:53], v6 offset:45056
    buffer_load_dwordx4 v13, s[8:11], s56 offen offset:1024 lds
    v_mfma_f32_16x16x32_bf16 v[144:147], v[56:59], a[100:103], v[144:147]
    ds_read_b64_tr_b16 v[54:55], v6 offset:45568
    v_add_f32_dpp v27, v27, v27 row_ror:1 row_mask:0xf bank_mask:0xf
    v_mfma_f32_16x16x32_bf16 v[160:163], v[56:59], a[104:107], v[160:163]
    v_mov_b32 v26, v27
    v_mfma_f32_16x16x32_bf16 v[160:163], v[60:63], a[120:123], v[160:163]
    v_mfma_f32_16x16x32_bf16 v[176:179], v[60:63], a[124:127], v[176:179]
    buffer_load_dwordx4 v14, s[8:11], s56 offen offset:2048 lds
    v_permlane16_swap_b32 v27, v26
    v_mfma_f32_16x16x32_bf16 v[176:179], v[56:59], a[108:111], v[176:179]
    s_waitcnt lgkmcnt(4)
    v_add_f32 v27, v27, v26
    v_mul_f32 v27, 0x3b000000, v27
    v_mfma_f32_16x16x32_bf16 v[180:183], v[40:43], a[108:111], v[180:183]
    ds_read_b64_tr_b16 v[56:57], v7 offset:40960
    v_sub_f32 v72, v72, v27
    v_mfma_f32_16x16x32_bf16 v[180:183], v[44:47], a[124:127], v[180:183]
    ds_read_b64_tr_b16 v[58:59], v7 offset:41472
    v_sub_f32 v73, v73, v27
    v_mfma_f32_16x16x32_bf16 v[164:167], v[44:47], a[120:123], v[164:167]
    ds_read_b64_tr_b16 v[60:61], v7 offset:45056
    buffer_load_dwordx4 v15, s[8:11], s56 offen offset:3072 lds
    v_mfma_f32_16x16x32_bf16 v[164:167], v[40:43], a[104:107], v[164:167]
    s_add_u32 s56, s56, 32768
    s_add_u32 m0, s67, 12288
    ds_read_b64_tr_b16 v[62:63], v7 offset:45568
    v_mfma_f32_16x16x32_bf16 v[148:151], v[40:43], a[100:103], v[148:151]
    v_sub_f32 v74, v74, v27
    v_sub_f32 v75, v75, v27
    v_mfma_f32_16x16x32_bf16 v[148:151], v[44:47], a[116:119], v[148:151]
    buffer_load_dwordx4 v12, s[8:11], s56 offen offset:0 lds
    v_sub_f32 v76, v76, v27
    v_mfma_f32_16x16x32_bf16 v[132:135], v[44:47], a[112:115], v[132:135]
    s_waitcnt vmcnt(18) lgkmcnt(0)
    v_sub_f32 v77, v77, v27
    v_sub_f32 v78, v78, v27
    v_mfma_f32_16x16x32_bf16 v[132:135], v[40:43], a[96:99], v[132:135]
    s_barrier
    v_sub_f32 v79, v79, v27
    v_sub_f32 v80, v80, v27
    v_mfma_f32_16x16x32_bf16 v[136:139], v[48:51], a[96:99], v[136:139]
    ds_read_b64_tr_b16 v[40:41], v4 offset:49152
    v_sub_f32 v81, v81, v27
    v_mfma_f32_16x16x32_bf16 v[136:139], v[52:55], a[112:115], v[136:139]
    ds_read_b64_tr_b16 v[42:43], v4 offset:49664
    buffer_load_dwordx4 v13, s[8:11], s56 offen offset:1024 lds
    v_mfma_f32_16x16x32_bf16 v[152:155], v[52:55], a[116:119], v[152:155]
    ds_read_b64_tr_b16 v[44:45], v4 offset:53248
    v_sub_f32 v82, v82, v27
    v_mfma_f32_16x16x32_bf16 v[152:155], v[48:51], a[100:103], v[152:155]
    s_waitcnt vmcnt(10)
    ds_read_b64_tr_b16 v[46:47], v4 offset:53760
    v_sub_f32 v83, v83, v27
    v_mfma_f32_16x16x32_bf16 v[168:171], v[48:51], a[104:107], v[168:171]
    ds_read_b128 a[128:131], v16 offset:0
    ds_read_b128 a[132:135], v16 offset:2048
    v_mfma_f32_16x16x32_bf16 v[168:171], v[52:55], a[120:123], v[168:171]
    ds_read_b128 a[136:139], v16 offset:4096
    ds_read_b128 a[140:143], v16 offset:6144
    v_mfma_f32_16x16x32_bf16 v[184:187], v[52:55], a[124:127], v[184:187]
    ds_read_b128 a[144:147], v17 offset:0
    ds_read_b128 a[148:151], v17 offset:2048
    v_mfma_f32_16x16x32_bf16 v[184:187], v[48:51], a[108:111], v[184:187]
    ds_read_b128 a[152:155], v17 offset:4096
    ds_read_b128 a[156:159], v17 offset:6144
    v_mfma_f32_16x16x32_bf16 v[188:191], v[56:59], a[108:111], v[188:191]
    ds_read_b64_tr_b16 v[48:49], v5 offset:49152
    buffer_load_dwordx4 v14, s[8:11], s56 offen offset:2048 lds
    v_mfma_f32_16x16x32_bf16 v[188:191], v[60:63], a[124:127], v[188:191]
    ds_read_b64_tr_b16 v[50:51], v5 offset:49664
    buffer_load_dwordx4 v15, s[8:11], s56 offen offset:3072 lds
    v_mfma_f32_16x16x32_bf16 v[172:175], v[60:63], a[120:123], v[172:175]
    ds_read_b64_tr_b16 v[52:53], v5 offset:53248
    v_sub_f32 v84, v84, v27
    v_mfma_f32_16x16x32_bf16 v[172:175], v[56:59], a[104:107], v[172:175]
    s_waitcnt lgkmcnt(11)
    ds_read_b64_tr_b16 v[54:55], v5 offset:53760
    v_sub_f32 v85, v85, v27
    v_mfma_f32_16x16x32_bf16 v[156:159], v[56:59], a[100:103], v[156:159]
    s_waitcnt lgkmcnt(4)
    s_bfe_u32 s56, s0, 0x20006
    v_sub_f32 v86, v86, v27
    v_mfma_f32_16x16x32_bf16 v[156:159], v[60:63], a[116:119], v[156:159]
    s_mul_i32 s56, s56, 256
    s_add_u32 s56, s56, s65
    v_sub_f32 v87, v87, v27
    v_mfma_f32_16x16x32_bf16 v[140:143], v[60:63], a[112:115], v[140:143]
    s_add_u32 m0, s67, 0
    v_mul_f32 v27, v72, v72
    v_mul_f32 v28, v73, v73
    v_mfma_f32_16x16x32_bf16 v[140:143], v[56:59], a[96:99], v[140:143]
    buffer_load_dwordx4 v12, s[8:11], s56 offen offset:0 lds
    v_fmac_f32 v27, v74, v74
    v_mfma_f32_16x16x32_bf16 v[128:131], v[40:43], a[128:131], v[128:131]
K_PG0:
    s_cmp_eq_u32 s100, 1
    s_cbranch_scc1 K_PG4
    ds_read_b64_tr_b16 v[56:57], v6 offset:49152
    v_fmac_f32 v28, v75, v75
    v_mfma_f32_16x16x32_bf16 v[128:131], v[44:47], a[144:147], v[128:131]
    ds_read_b64_tr_b16 v[58:59], v6 offset:49664
    v_fmac_f32 v27, v76, v76
    v_mfma_f32_16x16x32_bf16 v[144:147], v[44:47], a[148:151], v[144:147]
    ds_read_b64_tr_b16 v[60:61], v6 offset:53248
    buffer_load_dwordx4 v13, s[8:11], s56 offen offset:1024 lds
    v_mfma_f32_16x16x32_bf16 v[144:147], v[40:43], a[132:135], v[144:147]
    ds_read_b64_tr_b16 v[62:63], v6 offset:53760
    v_fmac_f32 v28, v77, v77
    v_mfma_f32_16x16x32_bf16 v[160:163], v[40:43], a[136:139], v[160:163]
    v_fmac_f32 v27, v78, v78
    v_fmac_f32 v28, v79, v79
    v_mfma_f32_16x16x32_bf16 v[160:163], v[44:47], a[152:155], v[160:163]
    v_fmac_f32 v27, v80, v80
    v_fmac_f32 v28, v81, v81
    v_mfma_f32_16x16x32_bf16 v[176:179], v[44:47], a[156:159], v[176:179]
    buffer_load_dwordx4 v14, s[8:11], s56 offen offset:2048 lds
    v_fmac_f32 v27, v82, v82
    v_mfma_f32_16x16x32_bf16 v[176:179], v[40:43], a[140:143], v[176:179]
    s_waitcnt lgkmcnt(4)
    v_fmac_f32 v28, v83, v83
    v_fmac_f32 v27, v84, v84
    v_mfma_f32_16x16x32_bf16 v[180:183], v[48:51], a[140:143], v[180:183]
    ds_read_b64_tr_b16 v[40:41], v7 offset:49152
    v_fmac_f32 v28, v85, v85
    v_mfma_f32_16x16x32_bf16 v[180:183], v[52:55], a[156:159], v[180:183]
    ds_read_b64_tr_b16 v[42:43], v7 offset:49664
    v_fmac_f32 v27, v86, v86
    v_mfma_f32_16x16x32_bf16 v[164:167], v[52:55], a[152:155], v[164:167]
    ds_read_b64_tr_b16 v[44:45], v7 offset:53248
    buffer_load_dwordx4 v15, s[8:11], s56 offen offset:3072 lds
    v_mfma_f32_16x16x32_bf16 v[164:167], v[48:51], a[136:139], v[164:167]
    s_add_u32 s56, s56, 32768
    s_add_u32 m0, s67, 4096
    ds_read_b64_tr_b16 v[46:47], v7 offset:53760
    v_mfma_f32_16x16x32_bf16 v[148:151], v[48:51], a[132:135], v[148:151]
    v_fmac_f32 v28, v87, v87
    v_add_f32 v27, v27, v28
    v_mfma_f32_16x16x32_bf16 v[148:151], v[52:55], a[148:151], v[148:151]
    buffer_load_dwordx4 v12, s[8:11], s56 offen offset:0 lds
    v_mfma_f32_16x16x32_bf16 v[132:135], v[52:55], a[144:147], v[132:135]
    v_add_f32_dpp v27, v27, v27 row_ror:8 row_mask:0xf bank_mask:0xf
    v_mfma_f32_16x16x32_bf16 v[132:135], v[48:51], a[128:131], v[132:135]
    s_waitcnt lgkmcnt(4)
    v_mfma_f32_16x16x32_bf16 v[136:139], v[56:59], a[128:131], v[136:139]
    ds_read_b64_tr_b16 v[48:49], v4 offset:57344
    v_add_f32_dpp v27, v27, v27 row_ror:4 row_mask:0xf bank_mask:0xf
    v_mfma_f32_16x16x32_bf16 v[136:139], v[60:63], a[144:147], v[136:139]
    ds_read_b64_tr_b16 v[50:51], v4 offset:57856
    buffer_load_dwordx4 v13, s[8:11], s56 offen offset:1024 lds
    v_mfma_f32_16x16x32_bf16 v[152:155], v[60:63], a[148:151], v[152:155]
    ds_read_b64_tr_b16 v[52:53], v4 offset:61440
    v_add_f32_dpp v27, v27, v27 row_ror:2 row_mask:0xf bank_mask:0xf
    v_mfma_f32_16x16x32_bf16 v[152:155], v[56:59], a[132:135], v[152:155]
    ds_read_b64_tr_b16 v[54:55], v4 offset:61952
    v_mfma_f32_16x16x32_bf16 v[168:171], v[56:59], a[136:139], v[168:171]
    v_add_f32_dpp v27, v27, v27 row_ror:1 row_mask:0xf bank_mask:0xf
    v_mov_b32 v26, v27
    v_mfma_f32_16x16x32_bf16 v[168:171], v[60:63], a[152:155], v[168:171]
    buffer_load_dwordx4 v14, s[8:11], s56 offen offset:2048 lds
    v_mfma_f32_16x16x32_bf16 v[184:187], v[60:63], a[156:159], v[184:187]
    v_permlane16_swap_b32 v27, v26
    v_add_f32 v27, v27, v26
    v_mfma_f32_16x16x32_bf16 v[184:187], v[56:59], a[140:143], v[184:187]
    s_waitcnt lgkmcnt(4)
    v_mov_b32 v28, 0x3df5fdf0
    v_fmaak_f32 v27, v27, v28, 0x3a21369a
    v_mfma_f32_16x16x32_bf16 v[188:191], v[40:43], a[140:143], v[188:191]
    ds_read_b64_tr_b16 v[56:57], v5 offset:57344
    buffer_load_dwordx4 v15, s[8:11], s56 offen offset:3072 lds
    v_mfma_f32_16x16x32_bf16 v[188:191], v[44:47], a[156:159], v[188:191]
    s_mul_i32 s56, s53, 4
    s_add_u32 s56, s56, 0x20002
    ds_read_b64_tr_b16 v[58:59], v5 offset:57856
    v_mfma_f32_16x16x32_bf16 v[172:175], v[44:47], a[152:155], v[172:175]
    s_bfe_u32 s56, s0, s56
    s_lshl_b32 s56, s56, 20
    ds_read_b64_tr_b16 v[60:61], v5 offset:61440
    v_mfma_f32_16x16x32_bf16 v[172:175], v[40:43], a[136:139], v[172:175]
    s_add_u32 s56, s56, s84
    s_mul_i32 s58, s53, -128
    ds_read_b64_tr_b16 v[62:63], v5 offset:61952
    v_mfma_f32_16x16x32_bf16 v[156:159], v[40:43], a[132:135], v[156:159]
    s_add_u32 s56, s56, s58
    s_add_u32 s56, s56, 524416
    v_mfma_f32_16x16x32_bf16 v[156:159], v[44:47], a[148:151], v[156:159]
    s_add_u32 m0, s62, 16384
    v_rsq_f32 v27, v27
    v_mfma_f32_16x16x32_bf16 v[140:143], v[44:47], a[144:147], v[140:143]
    buffer_load_dwordx4 v8, s[16:19], s56 offen offset:0 lds
    v_mul_f32 v72, v72, v27
    v_mfma_f32_16x16x32_bf16 v[140:143], v[40:43], a[128:131], v[140:143]
    s_waitcnt lgkmcnt(4)
    v_mul_f32 v73, v73, v27
    v_mul_f32 v74, v74, v27
    v_mfma_f32_16x16x32_bf16 v[192:195], v[48:51], a[64:67], v[192:195]
    ds_read_b64_tr_b16 v[40:41], v6 offset:57344
    buffer_load_dwordx4 v9, s[16:19], s56 offen offset:1024 lds
    v_mfma_f32_16x16x32_bf16 v[192:195], v[52:55], a[80:83], v[192:195]
    ds_read_b64_tr_b16 v[42:43], v6 offset:57856
    v_mul_f32 v75, v75, v27
    v_mfma_f32_16x16x32_bf16 v[208:211], v[52:55], a[84:87], v[208:211]
    ds_read_b64_tr_b16 v[44:45], v6 offset:61440
    v_mul_f32 v76, v76, v27
    v_mfma_f32_16x16x32_bf16 v[208:211], v[48:51], a[68:71], v[208:211]
    ds_read_b64_tr_b16 v[46:47], v6 offset:61952
    buffer_load_dwordx4 v10, s[16:19], s56 offen offset:2048 lds
    v_mfma_f32_16x16x32_bf16 v[224:227], v[48:51], a[72:75], v[224:227]
    v_mul_f32 v77, v77, v27
    v_mul_f32 v78, v78, v27
    v_mfma_f32_16x16x32_bf16 v[224:227], v[52:55], a[88:91], v[224:227]
    v_mul_f32 v79, v79, v27
    v_mul_f32 v80, v80, v27
    v_mfma_f32_16x16x32_bf16 v[240:243], v[52:55], a[92:95], v[240:243]
    v_mul_f32 v81, v81, v27
    v_mul_f32 v82, v82, v27
    v_mfma_f32_16x16x32_bf16 v[240:243], v[48:51], a[76:79], v[240:243]
    s_waitcnt lgkmcnt(4)
    buffer_load_dwordx4 v11, s[16:19], s56 offen offset:3072 lds
    v_mul_f32 v83, v83, v27
    v_mfma_f32_16x16x32_bf16 v[244:247], v[56:59], a[76:79], v[244:247]
    ds_read_b64_tr_b16 v[48:49], v7 offset:57344
    v_mul_f32 v84, v84, v27
    v_mfma_f32_16x16x32_bf16 v[244:247], v[60:63], a[92:95], v[244:247]
    ds_read_b64_tr_b16 v[50:51], v7 offset:57856
    v_mul_f32 v85, v85, v27
    v_mfma_f32_16x16x32_bf16 v[228:231], v[60:63], a[88:91], v[228:231]
    ds_read_b64_tr_b16 v[52:53], v7 offset:61440
    v_mul_f32 v86, v86, v27
    v_mfma_f32_16x16x32_bf16 v[228:231], v[56:59], a[72:75], v[228:231]
    ds_read_b64_tr_b16 v[54:55], v7 offset:61952
    v_mul_f32 v87, v87, v27
    v_mfma_f32_16x16x32_bf16 v[212:215], v[56:59], a[68:71], v[212:215]
    v_cvt_pk_bf16_f32 v64, v72, v73
    v_cvt_pk_bf16_f32 v65, v74, v75
    v_mfma_f32_16x16x32_bf16 v[212:215], v[60:63], a[84:87], v[212:215]
    v_cvt_pk_bf16_f32 v66, v76, v77
    v_cvt_pk_bf16_f32 v67, v78, v79
    v_mfma_f32_16x16x32_bf16 v[196:199], v[60:63], a[80:83], v[196:199]
    s_waitcnt vmcnt(20) lgkmcnt(0)
    v_cvt_pk_bf16_f32 v68, v80, v81
    v_cvt_pk_bf16_f32 v69, v82, v83
    v_mfma_f32_16x16x32_bf16 v[196:199], v[56:59], a[64:67], v[196:199]
    s_barrier
    v_cvt_pk_bf16_f32 v70, v84, v85
    v_cvt_pk_bf16_f32 v71, v86, v87
    v_mfma_f32_16x16x32_bf16 v[200:203], v[40:43], a[64:67], v[200:203]
    s_lshl_b32 s59, s3, 5
    ds_read_b64_tr_b16 v[56:57], v4 offset:0
    v_mfma_f32_16x16x32_bf16 v[200:203], v[44:47], a[80:83], v[200:203]
    s_add_u32 s59, s59, 131072
    ds_read_b64_tr_b16 v[58:59], v4 offset:512
    v_mfma_f32_16x16x32_bf16 v[216:219], v[44:47], a[84:87], v[216:219]
    ds_read_b64_tr_b16 v[60:61], v4 offset:4096
    v_mul_u32_u24 v26, 9, v25
    v_mfma_f32_16x16x32_bf16 v[216:219], v[40:43], a[68:71], v[216:219]
    s_waitcnt vmcnt(12)
    ds_read_b64_tr_b16 v[62:63], v4 offset:4608
    v_lshl_add_u32 v26, v24, 4, v26
    v_mfma_f32_16x16x32_bf16 v[232:235], v[40:43], a[72:75], v[232:235]
    ds_read_b128 a[160:163], v16 offset:8192
    ds_read_b128 a[164:167], v16 offset:10240
    v_mfma_f32_16x16x32_bf16 v[232:235], v[44:47], a[88:91], v[232:235]
    ds_read_b128 a[168:171], v16 offset:12288
    ds_read_b128 a[172:175], v16 offset:14336
    v_mfma_f32_16x16x32_bf16 v[248:251], v[44:47], a[92:95], v[248:251]
    ds_read_b128 a[176:179], v17 offset:8192
    ds_read_b128 a[180:183], v17 offset:10240
    v_mfma_f32_16x16x32_bf16 v[248:251], v[40:43], a[76:79], v[248:251]
    ds_read_b128 a[184:187], v17 offset:12288
    ds_read_b128 a[188:191], v17 offset:14336
    v_mfma_f32_16x16x32_bf16 v[252:255], v[48:51], a[76:79], v[252:255]
    ds_read_b64_tr_b16 v[40:41], v5 offset:0
    v_add_u32 v26, s59, v26
    v_mfma_f32_16x16x32_bf16 v[252:255], v[52:55], a[92:95], v[252:255]
    ds_read_b64_tr_b16 v[42:43], v5 offset:512
    ds_write_b128 v26, v[64:67]
    v_mfma_f32_16x16x32_bf16 v[236:239], v[52:55], a[88:91], v[236:239]
    s_waitcnt lgkmcnt(11)
    ds_read_b64_tr_b16 v[44:45], v5 offset:4096
    ds_write_b128 v26, v[68:71] offset:4608
    v_mfma_f32_16x16x32_bf16 v[236:239], v[48:51], a[72:75], v[236:239]
    s_mul_i32 s59, s3, 2304
    ds_read_b64_tr_b16 v[46:47], v5 offset:4608
    v_mfma_f32_16x16x32_bf16 v[220:223], v[48:51], a[68:71], v[220:223]
    s_waitcnt lgkmcnt(6)
    s_bfe_u32 s56, s0, 0x20006
    v_mfma_f32_16x16x32_bf16 v[220:223], v[52:55], a[84:87], v[220:223]
    s_mul_i32 s56, s56, 256
    s_add_u32 s56, s56, s65
    v_mfma_f32_16x16x32_bf16 v[204:207], v[52:55], a[80:83], v[204:207]
    s_add_u32 s56, s56, 128
    s_add_u32 m0, s67, 8192
    v_mfma_f32_16x16x32_bf16 v[204:207], v[48:51], a[64:67], v[204:207]
    buffer_load_dwordx4 v12, s[8:11], s56 offen offset:0 lds
    v_mfma_f32_16x16x32_bf16 v[128:131], v[56:59], a[160:163], v[128:131]
    s_add_u32 s59, s59, 131072
    ds_read_b64_tr_b16 v[48:49], v6 offset:0
    v_mfma_f32_16x16x32_bf16 v[128:131], v[60:63], a[176:179], v[128:131]
    ds_read_b64_tr_b16 v[50:51], v6 offset:512
    v_lshrrev_b32 v27, 3, v0
    v_mfma_f32_16x16x32_bf16 v[144:147], v[60:63], a[180:183], v[144:147]
    ds_read_b64_tr_b16 v[52:53], v6 offset:4096
    buffer_load_dwordx4 v13, s[8:11], s56 offen offset:1024 lds
    v_mfma_f32_16x16x32_bf16 v[144:147], v[56:59], a[164:167], v[144:147]
    ds_read_b64_tr_b16 v[54:55], v6 offset:4608
    v_lshl_add_u32 v27, v27, 4, v1
    v_mfma_f32_16x16x32_bf16 v[160:163], v[56:59], a[168:171], v[160:163]
    v_add_u32 v27, s59, v27
    v_bfe_u32 v26, v0, 3, 2
    v_mfma_f32_16x16x32_bf16 v[160:163], v[60:63], a[184:187], v[160:163]
    buffer_load_dword v90, v22, s[40:43], 0 offen sc1
    v_and_b32 v28, 7, v0
    v_mfma_f32_16x16x32_bf16 v[176:179], v[60:63], a[188:191], v[176:179]
    buffer_load_dwordx4 v14, s[8:11], s56 offen offset:2048 lds
    v_lshlrev_b32 v28, 4, v28
    v_mfma_f32_16x16x32_bf16 v[176:179], v[56:59], a[172:175], v[176:179]
    s_waitcnt lgkmcnt(4)
    v_lshl_add_u32 v28, v26, 8, v28
    v_lshl_add_u32 v28, v24, 11, v28
    v_mfma_f32_16x16x32_bf16 v[180:183], v[40:43], a[172:175], v[180:183]
    s_add_u32 s69, s70, 4096
    ds_read_b64_tr_b16 v[56:57], v7 offset:0
    v_mfma_f32_16x16x32_bf16 v[180:183], v[44:47], a[188:191], v[180:183]
    ds_read_b64_tr_b16 v[58:59], v7 offset:512
    v_mfma_f32_16x16x32_bf16 v[164:167], v[44:47], a[184:187], v[164:167]
    ds_read_b64_tr_b16 v[60:61], v7 offset:4096
    buffer_load_dwordx4 v15, s[8:11], s56 offen offset:3072 lds
    v_mfma_f32_16x16x32_bf16 v[164:167], v[40:43], a[168:171], v[164:167]
    s_add_u32 s56, s56, 32768
    s_add_u32 m0, s67, 12288
    ds_read_b64_tr_b16 v[62:63], v7 offset:4608
    v_mfma_f32_16x16x32_bf16 v[148:151], v[40:43], a[164:167], v[148:151]
    v_mfma_f32_16x16x32_bf16 v[148:151], v[44:47], a[180:183], v[148:151]
    buffer_load_dwordx4 v12, s[8:11], s56 offen offset:0 lds
    v_mfma_f32_16x16x32_bf16 v[132:135], v[44:47], a[176:179], v[132:135]
    v_mfma_f32_16x16x32_bf16 v[132:135], v[40:43], a[160:163], v[132:135]
    s_waitcnt lgkmcnt(4)
    v_mfma_f32_16x16x32_bf16 v[136:139], v[48:51], a[160:163], v[136:139]
    ds_read_b64_tr_b16 v[40:41], v4 offset:8192
    v_mfma_f32_16x16x32_bf16 v[136:139], v[52:55], a[176:179], v[136:139]
    ds_read_b64_tr_b16 v[42:43], v4 offset:8704
    buffer_load_dwordx4 v13, s[8:11], s56 offen offset:1024 lds
    v_mfma_f32_16x16x32_bf16 v[152:155], v[52:55], a[180:183], v[152:155]
    ds_read_b64_tr_b16 v[44:45], v4 offset:12288
    v_mfma_f32_16x16x32_bf16 v[152:155], v[48:51], a[164:167], v[152:155]
    s_waitcnt vmcnt(11)
    ds_read_b64_tr_b16 v[46:47], v4 offset:12800
    v_mfma_f32_16x16x32_bf16 v[168:171], v[48:51], a[168:171], v[168:171]
    ds_read_b128 a[192:195], v16 offset:0
    ds_read_b128 a[196:199], v16 offset:2048
    v_mfma_f32_16x16x32_bf16 v[168:171], v[52:55], a[184:187], v[168:171]
    ds_read_b128 a[200:203], v16 offset:4096
    ds_read_b128 a[204:207], v16 offset:6144
    v_mfma_f32_16x16x32_bf16 v[184:187], v[52:55], a[188:191], v[184:187]
    ds_read_b128 a[208:211], v17 offset:0
    ds_read_b128 a[212:215], v17 offset:2048
    v_mfma_f32_16x16x32_bf16 v[184:187], v[48:51], a[172:175], v[184:187]
    s_waitcnt lgkmcnt(10)
    ds_read_b128 a[216:219], v17 offset:4096
    ds_read_b128 a[220:223], v17 offset:6144
    v_mfma_f32_16x16x32_bf16 v[188:191], v[56:59], a[172:175], v[188:191]
    ds_read_b64_tr_b16 v[48:49], v5 offset:8192
    buffer_load_dwordx4 v14, s[8:11], s56 offen offset:2048 lds
    v_mfma_f32_16x16x32_bf16 v[188:191], v[60:63], a[188:191], v[188:191]
    ds_read_b64_tr_b16 v[50:51], v5 offset:8704
    buffer_load_dwordx4 v15, s[8:11], s56 offen offset:3072 lds
    v_mfma_f32_16x16x32_bf16 v[172:175], v[60:63], a[184:187], v[172:175]
    s_bfe_u32 s56, s0, 0x20004
    s_lshl_b32 s56, s56, 20
    ds_read_b64_tr_b16 v[52:53], v5 offset:12288
    v_mfma_f32_16x16x32_bf16 v[172:175], v[56:59], a[168:171], v[172:175]
    s_waitcnt lgkmcnt(11)
    s_add_u32 s56, s56, s84
    s_mul_i32 s58, s53, 524288
    ds_read_b64_tr_b16 v[54:55], v5 offset:12800
    v_mfma_f32_16x16x32_bf16 v[156:159], v[56:59], a[164:167], v[156:159]
    s_add_u32 s56, s56, s58
    s_add_u32 s56, s56, 128
    v_mov_b32 v14, v19
    v_mfma_f32_16x16x32_bf16 v[156:159], v[60:63], a[180:183], v[156:159]
    s_add_u32 m0, s62, 32768
    v_mov_b32 v12, 0
    v_mfma_f32_16x16x32_bf16 v[140:143], v[60:63], a[176:179], v[140:143]
    buffer_load_dwordx4 v8, s[16:19], s56 offen offset:0 lds
    v_mfma_f32_16x16x32_bf16 v[140:143], v[56:59], a[160:163], v[140:143]
    s_waitcnt lgkmcnt(11)
    v_mfma_f32_16x16x32_bf16 v[128:131], v[40:43], a[192:195], v[128:131]
    s_waitcnt lgkmcnt(7)
    ds_read_b64_tr_b16 v[56:57], v6 offset:8192
    buffer_load_dwordx4 v9, s[16:19], s56 offen offset:1024 lds
    v_mfma_f32_16x16x32_bf16 v[128:131], v[44:47], a[208:211], v[128:131]
    s_waitcnt lgkmcnt(7)
    ds_read_b64_tr_b16 v[58:59], v6 offset:8704
    v_mfma_f32_16x16x32_bf16 v[144:147], v[44:47], a[212:215], v[144:147]
    ds_read_b64_tr_b16 v[60:61], v6 offset:12288
    v_mfma_f32_16x16x32_bf16 v[144:147], v[40:43], a[196:199], v[144:147]
    ds_read_b64_tr_b16 v[62:63], v6 offset:12800
    buffer_load_dwordx4 v10, s[16:19], s56 offen offset:2048 lds
    v_mfma_f32_16x16x32_bf16 v[160:163], v[40:43], a[200:203], v[160:163]
    s_waitcnt lgkmcnt(9)
    v_mfma_f32_16x16x32_bf16 v[160:163], v[44:47], a[216:219], v[160:163]
    s_waitcnt lgkmcnt(8)
    v_mfma_f32_16x16x32_bf16 v[176:179], v[44:47], a[220:223], v[176:179]
    v_mfma_f32_16x16x32_bf16 v[176:179], v[40:43], a[204:207], v[176:179]
    s_waitcnt lgkmcnt(4)
    buffer_load_dwordx4 v11, s[16:19], s56 offen offset:3072 lds
    v_mfma_f32_16x16x32_bf16 v[180:183], v[48:51], a[204:207], v[180:183]
    ds_read_b64_tr_b16 v[40:41], v7 offset:8192
    v_mfma_f32_16x16x32_bf16 v[180:183], v[52:55], a[220:223], v[180:183]
    ds_read_b64_tr_b16 v[42:43], v7 offset:8704
    v_mfma_f32_16x16x32_bf16 v[164:167], v[52:55], a[216:219], v[164:167]
    s_bfe_u32 s56, s0, 0x20006
    s_lshl_b32 s56, s56, 20
    ds_read_b64_tr_b16 v[44:45], v7 offset:12288
    v_mfma_f32_16x16x32_bf16 v[164:167], v[48:51], a[200:203], v[164:167]
    s_add_u32 s56, s56, s84
    s_mul_i32 s58, s53, 524288
    ds_read_b64_tr_b16 v[46:47], v7 offset:12800
    v_mfma_f32_16x16x32_bf16 v[148:151], v[48:51], a[196:199], v[148:151]
    s_add_u32 s56, s56, s58
    s_add_u32 s56, s56, 128
    v_mfma_f32_16x16x32_bf16 v[148:151], v[52:55], a[212:215], v[148:151]
    s_add_u32 m0, s62, 49152
    v_mfma_f32_16x16x32_bf16 v[132:135], v[52:55], a[208:211], v[132:135]
    s_waitcnt vmcnt(13) lgkmcnt(0)
    buffer_load_dwordx4 v8, s[16:19], s56 offen offset:0 lds
    v_mfma_f32_16x16x32_bf16 v[132:135], v[48:51], a[192:195], v[132:135]
    s_barrier
    v_mfma_f32_16x16x32_bf16 v[136:139], v[56:59], a[192:195], v[136:139]
    ds_read_b64_tr_b16 v[48:49], v4 offset:16384
    buffer_load_dwordx4 v9, s[16:19], s56 offen offset:1024 lds
    v_mfma_f32_16x16x32_bf16 v[136:139], v[60:63], a[208:211], v[136:139]
    ds_read_b64_tr_b16 v[50:51], v4 offset:16896
    ds_read_b128 v[64:67], v27
    v_mfma_f32_16x16x32_bf16 v[152:155], v[60:63], a[212:215], v[152:155]
    ds_read_b64_tr_b16 v[52:53], v4 offset:20480
    ds_read_b128 v[68:71], v27 offset:1152
    v_mfma_f32_16x16x32_bf16 v[152:155], v[56:59], a[196:199], v[152:155]
    ds_read_b64_tr_b16 v[54:55], v4 offset:20992
    v_mfma_f32_16x16x32_bf16 v[168:171], v[56:59], a[200:203], v[168:171]
    buffer_load_dwordx4 v10, s[16:19], s56 offen offset:2048 lds
    v_mfma_f32_16x16x32_bf16 v[168:171], v[60:63], a[216:219], v[168:171]
    v_mfma_f32_16x16x32_bf16 v[184:187], v[60:63], a[220:223], v[184:187]
    v_mfma_f32_16x16x32_bf16 v[184:187], v[56:59], a[204:207], v[184:187]
    v_mfma_f32_16x16x32_bf16 v[188:191], v[40:43], a[204:207], v[188:191]
    ds_read_b64_tr_b16 v[56:57], v5 offset:16384
    buffer_load_dwordx4 v11, s[16:19], s56 offen offset:3072 lds
    v_mfma_f32_16x16x32_bf16 v[188:191], v[44:47], a[220:223], v[188:191]
    ds_read_b64_tr_b16 v[58:59], v5 offset:16896
    v_mfma_f32_16x16x32_bf16 v[172:175], v[44:47], a[216:219], v[172:175]
    s_waitcnt lgkmcnt(5)
    ds_read_b64_tr_b16 v[60:61], v5 offset:20480
    buffer_store_dwordx4 v[64:67], v28, s[44:47], s70 offen sc1
    v_mfma_f32_16x16x32_bf16 v[172:175], v[40:43], a[200:203], v[172:175]
    ds_read_b64_tr_b16 v[62:63], v5 offset:20992
    v_mfma_f32_16x16x32_bf16 v[156:159], v[40:43], a[196:199], v[156:159]
    s_waitcnt lgkmcnt(5)
    s_add_u32 m0, s62, 0
    buffer_store_dwordx4 v[68:71], v28, s[44:47], s69 offen sc1
    v_mfma_f32_16x16x32_bf16 v[156:159], v[44:47], a[212:215], v[156:159]
    s_bfe_u32 s56, s0, 0x20000
    v_mfma_f32_16x16x32_bf16 v[140:143], v[44:47], a[208:211], v[140:143]
    s_mul_i32 s56, s56, 1048576
    v_mfma_f32_16x16x32_bf16 v[140:143], v[40:43], a[192:195], v[140:143]
    s_waitcnt lgkmcnt(4)
    v_mfma_f32_16x16x32_bf16 v[192:195], v[48:51], a[96:99], v[192:195]
    s_add_u32 s56, s56, s66
    ds_read_b64_tr_b16 v[40:41], v6 offset:16384
    v_mfma_f32_16x16x32_bf16 v[192:195], v[52:55], a[112:115], v[192:195]
    ds_read_b64_tr_b16 v[42:43], v6 offset:16896
    buffer_load_dwordx4 v8, s[20:23], s56 offen offset:0 lds
    v_mfma_f32_16x16x32_bf16 v[208:211], v[52:55], a[116:119], v[208:211]
    ds_read_b64_tr_b16 v[44:45], v6 offset:20480
    v_mfma_f32_16x16x32_bf16 v[208:211], v[48:51], a[100:103], v[208:211]
    ds_read_b64_tr_b16 v[46:47], v6 offset:20992
    v_mfma_f32_16x16x32_bf16 v[224:227], v[48:51], a[104:107], v[224:227]
    buffer_load_dwordx4 v9, s[20:23], s56 offen offset:1024 lds
    v_mfma_f32_16x16x32_bf16 v[224:227], v[52:55], a[120:123], v[224:227]
    v_mfma_f32_16x16x32_bf16 v[240:243], v[52:55], a[124:127], v[240:243]
    v_mfma_f32_16x16x32_bf16 v[240:243], v[48:51], a[108:111], v[240:243]
    s_waitcnt lgkmcnt(4)
    buffer_load_dwordx4 v10, s[20:23], s56 offen offset:2048 lds
    v_mfma_f32_16x16x32_bf16 v[244:247], v[56:59], a[108:111], v[244:247]
    ds_read_b64_tr_b16 v[48:49], v7 offset:16384
    v_mfma_f32_16x16x32_bf16 v[244:247], v[60:63], a[124:127], v[244:247]
    ds_read_b64_tr_b16 v[50:51], v7 offset:16896
    v_mfma_f32_16x16x32_bf16 v[228:231], v[60:63], a[120:123], v[228:231]
    ds_read_b64_tr_b16 v[52:53], v7 offset:20480
    buffer_load_dwordx4 v11, s[20:23], s56 offen offset:3072 lds
    v_mfma_f32_16x16x32_bf16 v[228:231], v[56:59], a[104:107], v[228:231]
    s_waitcnt vmcnt(20)
    ds_read_b64_tr_b16 v[54:55], v7 offset:20992
    v_cmp_gt_u32 vcc, 1, v90
    v_mfma_f32_16x16x32_bf16 v[212:215], v[56:59], a[100:103], v[212:215]
    s_cbranch_vccnz S0
S0_RET:
    v_mfma_f32_16x16x32_bf16 v[212:215], v[60:63], a[116:119], v[212:215]
    v_mfma_f32_16x16x32_bf16 v[196:199], v[60:63], a[112:115], v[196:199]
    v_mfma_f32_16x16x32_bf16 v[196:199], v[56:59], a[96:99], v[196:199]
    s_waitcnt lgkmcnt(4)
    v_mfma_f32_16x16x32_bf16 v[200:203], v[40:43], a[96:99], v[200:203]
    ds_read_b64_tr_b16 v[56:57], v4 offset:24576
    v_mfma_f32_16x16x32_bf16 v[200:203], v[44:47], a[112:115], v[200:203]
    ds_read_b64_tr_b16 v[58:59], v4 offset:25088
    v_mfma_f32_16x16x32_bf16 v[216:219], v[44:47], a[116:119], v[216:219]
    ds_read_b64_tr_b16 v[60:61], v4 offset:28672
    v_mfma_f32_16x16x32_bf16 v[216:219], v[40:43], a[100:103], v[216:219]
    s_waitcnt vmcnt(14)
    ds_read_b64_tr_b16 v[62:63], v4 offset:29184
    v_mfma_f32_16x16x32_bf16 v[232:235], v[40:43], a[104:107], v[232:235]
    ds_read_b128 a[224:227], v16 offset:8192
    ds_read_b128 a[228:231], v16 offset:10240
    v_mfma_f32_16x16x32_bf16 v[232:235], v[44:47], a[120:123], v[232:235]
    ds_read_b128 a[232:235], v16 offset:12288
    ds_read_b128 a[236:239], v16 offset:14336
    v_mfma_f32_16x16x32_bf16 v[248:251], v[44:47], a[124:127], v[248:251]
    ds_read_b128 a[240:243], v17 offset:8192
    ds_read_b128 a[244:247], v17 offset:10240
    v_mfma_f32_16x16x32_bf16 v[248:251], v[40:43], a[108:111], v[248:251]
    s_waitcnt lgkmcnt(10)
    ds_read_b128 a[248:251], v17 offset:12288
    ds_read_b128 a[252:255], v17 offset:14336
    v_mfma_f32_16x16x32_bf16 v[252:255], v[48:51], a[108:111], v[252:255]
    ds_read_b64_tr_b16 v[40:41], v5 offset:24576
    v_mfma_f32_16x16x32_bf16 v[252:255], v[52:55], a[124:127], v[252:255]
    ds_read_b64_tr_b16 v[42:43], v5 offset:25088
    v_mfma_f32_16x16x32_bf16 v[236:239], v[52:55], a[120:123], v[236:239]
    ds_read_b64_tr_b16 v[44:45], v5 offset:28672
    v_mfma_f32_16x16x32_bf16 v[236:239], v[48:51], a[104:107], v[236:239]
    s_waitcnt lgkmcnt(11)
    ds_read_b64_tr_b16 v[46:47], v5 offset:29184
    v_mfma_f32_16x16x32_bf16 v[220:223], v[48:51], a[100:103], v[220:223]
    v_mfma_f32_16x16x32_bf16 v[220:223], v[52:55], a[116:119], v[220:223]
    v_mfma_f32_16x16x32_bf16 v[204:207], v[52:55], a[112:115], v[204:207]
    v_mfma_f32_16x16x32_bf16 v[204:207], v[48:51], a[96:99], v[204:207]
    s_waitcnt lgkmcnt(11)
    v_mfma_f32_16x16x32_bf16 v[128:131], v[56:59], a[224:227], v[128:131]
    s_waitcnt lgkmcnt(7)
    ds_read_b64_tr_b16 v[48:49], v6 offset:24576
    v_mfma_f32_16x16x32_bf16 v[128:131], v[60:63], a[240:243], v[128:131]
    s_waitcnt lgkmcnt(7)
    ds_read_b64_tr_b16 v[50:51], v6 offset:25088
    v_mfma_f32_16x16x32_bf16 v[144:147], v[60:63], a[244:247], v[144:147]
    ds_read_b64_tr_b16 v[52:53], v6 offset:28672
    v_mfma_f32_16x16x32_bf16 v[144:147], v[56:59], a[228:231], v[144:147]
    ds_read_b64_tr_b16 v[54:55], v6 offset:29184
    v_mfma_f32_16x16x32_bf16 v[160:163], v[56:59], a[232:235], v[160:163]
    s_waitcnt lgkmcnt(9)
    v_mfma_f32_16x16x32_bf16 v[160:163], v[60:63], a[248:251], v[160:163]
    s_waitcnt lgkmcnt(8)
    v_mfma_f32_16x16x32_bf16 v[176:179], v[60:63], a[252:255], v[176:179]
    v_mfma_f32_16x16x32_bf16 v[176:179], v[56:59], a[236:239], v[176:179]
    s_waitcnt lgkmcnt(4)
    v_mfma_f32_16x16x32_bf16 v[132:135], v[40:43], a[224:227], v[132:135]
    ds_read_b64_tr_b16 v[56:57], v7 offset:24576
    v_mfma_f32_16x16x32_bf16 v[132:135], v[44:47], a[240:243], v[132:135]
    ds_read_b64_tr_b16 v[58:59], v7 offset:25088
    v_mfma_f32_16x16x32_bf16 v[148:151], v[44:47], a[244:247], v[148:151]
    ds_read_b64_tr_b16 v[60:61], v7 offset:28672
    v_mfma_f32_16x16x32_bf16 v[148:151], v[40:43], a[228:231], v[148:151]
    ds_read_b64_tr_b16 v[62:63], v7 offset:29184
    v_mfma_f32_16x16x32_bf16 v[164:167], v[40:43], a[232:235], v[164:167]
    v_mfma_f32_16x16x32_bf16 v[164:167], v[44:47], a[248:251], v[164:167]
    v_mfma_f32_16x16x32_bf16 v[180:183], v[44:47], a[252:255], v[180:183]
    s_waitcnt vmcnt(10) lgkmcnt(0)
    v_mfma_f32_16x16x32_bf16 v[180:183], v[40:43], a[236:239], v[180:183]
    s_barrier
    v_mfma_f32_16x16x32_bf16 v[136:139], v[48:51], a[224:227], v[136:139]
    ds_read_b64_tr_b16 v[40:41], v4 offset:32768
    v_mfma_f32_16x16x32_bf16 v[136:139], v[52:55], a[240:243], v[136:139]
    ds_read_b64_tr_b16 v[42:43], v4 offset:33280
    v_mfma_f32_16x16x32_bf16 v[152:155], v[52:55], a[244:247], v[152:155]
    s_add_u32 m0, s62, 65536
    ds_read_b64_tr_b16 v[44:45], v4 offset:36864
    v_mfma_f32_16x16x32_bf16 v[152:155], v[48:51], a[228:231], v[152:155]
    s_bfe_u32 s56, s0, 0x20000
    ds_read_b64_tr_b16 v[46:47], v4 offset:37376
    v_mfma_f32_16x16x32_bf16 v[168:171], v[48:51], a[232:235], v[168:171]
    s_mul_i32 s56, s56, 1048576
    v_mfma_f32_16x16x32_bf16 v[168:171], v[52:55], a[248:251], v[168:171]
    s_add_u32 s56, s56, s66
    v_mfma_f32_16x16x32_bf16 v[184:187], v[52:55], a[252:255], v[184:187]
    s_add_u32 s56, s56, 128
    v_mfma_f32_16x16x32_bf16 v[184:187], v[48:51], a[236:239], v[184:187]
    buffer_load_dwordx4 v8, s[20:23], s56 offen offset:0 lds
    v_mfma_f32_16x16x32_bf16 v[140:143], v[56:59], a[224:227], v[140:143]
    ds_read_b64_tr_b16 v[48:49], v5 offset:32768
    v_mfma_f32_16x16x32_bf16 v[140:143], v[60:63], a[240:243], v[140:143]
    ds_read_b64_tr_b16 v[50:51], v5 offset:33280
    v_mfma_f32_16x16x32_bf16 v[156:159], v[60:63], a[244:247], v[156:159]
    ds_read_b64_tr_b16 v[52:53], v5 offset:36864
    buffer_load_dwordx4 v9, s[20:23], s56 offen offset:1024 lds
    v_mfma_f32_16x16x32_bf16 v[156:159], v[56:59], a[228:231], v[156:159]
    ds_read_b64_tr_b16 v[54:55], v5 offset:37376
    v_mfma_f32_16x16x32_bf16 v[172:175], v[56:59], a[232:235], v[172:175]
    v_mfma_f32_16x16x32_bf16 v[172:175], v[60:63], a[248:251], v[172:175]
    buffer_load_dwordx4 v10, s[20:23], s56 offen offset:2048 lds
    v_mfma_f32_16x16x32_bf16 v[188:191], v[60:63], a[252:255], v[188:191]
    v_mfma_f32_16x16x32_bf16 v[188:191], v[56:59], a[236:239], v[188:191]
    s_waitcnt lgkmcnt(4)
    v_mfma_f32_16x16x32_bf16 v[192:195], v[40:43], a[128:131], v[192:195]
    ds_read_b64_tr_b16 v[56:57], v6 offset:32768
    buffer_load_dwordx4 v11, s[20:23], s56 offen offset:3072 lds
    v_mfma_f32_16x16x32_bf16 v[192:195], v[44:47], a[144:147], v[192:195]
    ds_read_b64_tr_b16 v[58:59], v6 offset:33280
    v_mfma_f32_16x16x32_bf16 v[208:211], v[44:47], a[148:151], v[208:211]
    ds_read_b64_tr_b16 v[60:61], v6 offset:36864
    v_mfma_f32_16x16x32_bf16 v[208:211], v[40:43], a[132:135], v[208:211]
    ds_read_b64_tr_b16 v[62:63], v6 offset:37376
    v_mfma_f32_16x16x32_bf16 v[224:227], v[40:43], a[136:139], v[224:227]
    v_mfma_f32_16x16x32_bf16 v[224:227], v[44:47], a[152:155], v[224:227]
    v_mfma_f32_16x16x32_bf16 v[240:243], v[44:47], a[156:159], v[240:243]
    v_cvt_pk_bf16_f32 v128, v128, v129
    v_cvt_pk_bf16_f32 v129, v130, v131
    v_mfma_f32_16x16x32_bf16 v[240:243], v[40:43], a[140:143], v[240:243]
    s_waitcnt lgkmcnt(4)
    v_cvt_pk_bf16_f32 v130, v132, v133
    v_cvt_pk_bf16_f32 v131, v134, v135
    v_mfma_f32_16x16x32_bf16 v[244:247], v[48:51], a[140:143], v[244:247]
    s_add_u32 s61, s68, 0
    ds_read_b64_tr_b16 v[40:41], v7 offset:32768
    v_mfma_f32_16x16x32_bf16 v[244:247], v[52:55], a[156:159], v[244:247]
    ds_read_b64_tr_b16 v[42:43], v7 offset:33280
    buffer_store_dwordx4 v[128:131], v1, s[44:47], s61 offen offset:0 sc1
    v_mfma_f32_16x16x32_bf16 v[228:231], v[52:55], a[152:155], v[228:231]
    ds_read_b64_tr_b16 v[44:45], v7 offset:36864
    v_mfma_f32_16x16x32_bf16 v[228:231], v[48:51], a[136:139], v[228:231]
    ds_read_b64_tr_b16 v[46:47], v7 offset:37376
    v_mfma_f32_16x16x32_bf16 v[212:215], v[48:51], a[132:135], v[212:215]
    v_mfma_f32_16x16x32_bf16 v[212:215], v[52:55], a[148:151], v[212:215]
    v_mfma_f32_16x16x32_bf16 v[196:199], v[52:55], a[144:147], v[196:199]
    v_mfma_f32_16x16x32_bf16 v[196:199], v[48:51], a[128:131], v[196:199]
    s_waitcnt lgkmcnt(4)
    v_mfma_f32_16x16x32_bf16 v[200:203], v[56:59], a[128:131], v[200:203]
    ds_read_b64_tr_b16 v[48:49], v4 offset:40960
    v_mfma_f32_16x16x32_bf16 v[200:203], v[60:63], a[144:147], v[200:203]
    ds_read_b64_tr_b16 v[50:51], v4 offset:41472
    v_mfma_f32_16x16x32_bf16 v[216:219], v[60:63], a[148:151], v[216:219]
    ds_read_b64_tr_b16 v[52:53], v4 offset:45056
    v_mfma_f32_16x16x32_bf16 v[216:219], v[56:59], a[132:135], v[216:219]
    ds_read_b64_tr_b16 v[54:55], v4 offset:45568
    v_mfma_f32_16x16x32_bf16 v[232:235], v[56:59], a[136:139], v[232:235]
    v_mfma_f32_16x16x32_bf16 v[232:235], v[60:63], a[152:155], v[232:235]
    v_mfma_f32_16x16x32_bf16 v[248:251], v[60:63], a[156:159], v[248:251]
    v_mfma_f32_16x16x32_bf16 v[248:251], v[56:59], a[140:143], v[248:251]
    s_waitcnt lgkmcnt(4)
    v_mfma_f32_16x16x32_bf16 v[252:255], v[40:43], a[140:143], v[252:255]
    ds_read_b64_tr_b16 v[56:57], v5 offset:40960
    v_mfma_f32_16x16x32_bf16 v[252:255], v[44:47], a[156:159], v[252:255]
    ds_read_b64_tr_b16 v[58:59], v5 offset:41472
    v_mfma_f32_16x16x32_bf16 v[236:239], v[44:47], a[152:155], v[236:239]
    s_add_u32 m0, s62, 16384
    ds_read_b64_tr_b16 v[60:61], v5 offset:45056
    v_mfma_f32_16x16x32_bf16 v[236:239], v[40:43], a[136:139], v[236:239]
    s_bfe_u32 s56, s0, 0x20002
    ds_read_b64_tr_b16 v[62:63], v5 offset:45568
    v_mfma_f32_16x16x32_bf16 v[220:223], v[40:43], a[132:135], v[220:223]
    s_mul_i32 s56, s56, 1048576
    v_mfma_f32_16x16x32_bf16 v[220:223], v[44:47], a[148:151], v[220:223]
    s_add_u32 s56, s56, s66
    v_mfma_f32_16x16x32_bf16 v[204:207], v[44:47], a[144:147], v[204:207]
K_PG1:
    s_cmp_eq_u32 s100, 1
    s_cbranch_scc1 K_PG5
    buffer_load_dwordx4 v8, s[20:23], s56 offen offset:0 lds
    v_mfma_f32_16x16x32_bf16 v[204:207], v[40:43], a[128:131], v[204:207]
    s_waitcnt lgkmcnt(4)
    v_mfma_f32_16x16x32_bf16 v[192:195], v[48:51], a[160:163], v[192:195]
    ds_read_b64_tr_b16 v[40:41], v6 offset:40960
    v_mfma_f32_16x16x32_bf16 v[192:195], v[52:55], a[176:179], v[192:195]
    ds_read_b64_tr_b16 v[42:43], v6 offset:41472
    buffer_load_dwordx4 v9, s[20:23], s56 offen offset:1024 lds
    v_mfma_f32_16x16x32_bf16 v[208:211], v[52:55], a[180:183], v[208:211]
    ds_read_b64_tr_b16 v[44:45], v6 offset:45056
    v_cvt_pk_bf16_f32 v136, v136, v137
    v_mfma_f32_16x16x32_bf16 v[208:211], v[48:51], a[164:167], v[208:211]
    ds_read_b64_tr_b16 v[46:47], v6 offset:45568
    v_cvt_pk_bf16_f32 v137, v138, v139
    v_mfma_f32_16x16x32_bf16 v[224:227], v[48:51], a[168:171], v[224:227]
    buffer_load_dwordx4 v10, s[20:23], s56 offen offset:2048 lds
    v_cvt_pk_bf16_f32 v138, v140, v141
    v_mfma_f32_16x16x32_bf16 v[224:227], v[52:55], a[184:187], v[224:227]
    v_cvt_pk_bf16_f32 v139, v142, v143
    v_mfma_f32_16x16x32_bf16 v[240:243], v[52:55], a[188:191], v[240:243]
    v_mfma_f32_16x16x32_bf16 v[240:243], v[48:51], a[172:175], v[240:243]
    s_waitcnt lgkmcnt(4)
    buffer_load_dwordx4 v11, s[20:23], s56 offen offset:3072 lds
    v_mfma_f32_16x16x32_bf16 v[244:247], v[56:59], a[172:175], v[244:247]
    ds_read_b64_tr_b16 v[48:49], v7 offset:40960
    v_mfma_f32_16x16x32_bf16 v[244:247], v[60:63], a[188:191], v[244:247]
    ds_read_b64_tr_b16 v[50:51], v7 offset:41472
    v_mfma_f32_16x16x32_bf16 v[228:231], v[60:63], a[184:187], v[228:231]
    s_add_u32 s61, s68, 0
    ds_read_b64_tr_b16 v[52:53], v7 offset:45056
    v_mfma_f32_16x16x32_bf16 v[228:231], v[56:59], a[168:171], v[228:231]
    ds_read_b64_tr_b16 v[54:55], v7 offset:45568
    buffer_store_dwordx4 v[136:139], v1, s[44:47], s61 offen offset:1024 sc1
    v_mfma_f32_16x16x32_bf16 v[212:215], v[56:59], a[164:167], v[212:215]
    v_mfma_f32_16x16x32_bf16 v[212:215], v[60:63], a[180:183], v[212:215]
    v_mfma_f32_16x16x32_bf16 v[196:199], v[60:63], a[176:179], v[196:199]
    s_waitcnt vmcnt(14) lgkmcnt(0)
    v_mfma_f32_16x16x32_bf16 v[196:199], v[56:59], a[160:163], v[196:199]
    s_barrier
    v_mfma_f32_16x16x32_bf16 v[200:203], v[40:43], a[160:163], v[200:203]
    s_lshr_b32 s96, s2, 4
    ds_read_b64_tr_b16 v[56:57], v4 offset:49152
    v_mfma_f32_16x16x32_bf16 v[200:203], v[44:47], a[176:179], v[200:203]
    s_lshl_b32 s96, s96, 7
    ds_read_b64_tr_b16 v[58:59], v4 offset:49664
    v_mfma_f32_16x16x32_bf16 v[216:219], v[44:47], a[180:183], v[216:219]
    s_add_u32 s96, s96, 0x3903000
    ds_read_b64_tr_b16 v[60:61], v4 offset:53248
    v_mfma_f32_16x16x32_bf16 v[216:219], v[40:43], a[164:167], v[216:219]
    ds_read_b64_tr_b16 v[62:63], v4 offset:53760
    v_mov_b32 v90, 1
    v_mfma_f32_16x16x32_bf16 v[232:235], v[40:43], a[168:171], v[232:235]
    buffer_atomic_add v90, v19, s[44:47], s96 offen
    v_mfma_f32_16x16x32_bf16 v[232:235], v[44:47], a[184:187], v[232:235]
    v_mfma_f32_16x16x32_bf16 v[248:251], v[44:47], a[188:191], v[248:251]
    v_mfma_f32_16x16x32_bf16 v[248:251], v[40:43], a[172:175], v[248:251]
    v_mfma_f32_16x16x32_bf16 v[252:255], v[48:51], a[172:175], v[252:255]
    ds_read_b64_tr_b16 v[40:41], v5 offset:49152
    v_mfma_f32_16x16x32_bf16 v[252:255], v[52:55], a[188:191], v[252:255]
    ds_read_b64_tr_b16 v[42:43], v5 offset:49664
    v_mfma_f32_16x16x32_bf16 v[236:239], v[52:55], a[184:187], v[236:239]
    ds_read_b64_tr_b16 v[44:45], v5 offset:53248
    v_mfma_f32_16x16x32_bf16 v[236:239], v[48:51], a[168:171], v[236:239]
    ds_read_b64_tr_b16 v[46:47], v5 offset:53760
    v_mfma_f32_16x16x32_bf16 v[220:223], v[48:51], a[164:167], v[220:223]
    v_mfma_f32_16x16x32_bf16 v[220:223], v[52:55], a[180:183], v[220:223]
    v_mfma_f32_16x16x32_bf16 v[204:207], v[52:55], a[176:179], v[204:207]
    v_cvt_pk_bf16_f32 v144, v144, v145
    v_cvt_pk_bf16_f32 v145, v146, v147
    v_mfma_f32_16x16x32_bf16 v[204:207], v[48:51], a[160:163], v[204:207]
    s_waitcnt lgkmcnt(4)
    v_cvt_pk_bf16_f32 v146, v148, v149
    v_cvt_pk_bf16_f32 v147, v150, v151
    v_mfma_f32_16x16x32_bf16 v[192:195], v[56:59], a[192:195], v[192:195]
    ds_read_b64_tr_b16 v[48:49], v6 offset:49152
    v_mfma_f32_16x16x32_bf16 v[192:195], v[60:63], a[208:211], v[192:195]
    ds_read_b64_tr_b16 v[50:51], v6 offset:49664
    v_mfma_f32_16x16x32_bf16 v[208:211], v[60:63], a[212:215], v[208:211]
    ds_read_b64_tr_b16 v[52:53], v6 offset:53248
    v_mfma_f32_16x16x32_bf16 v[208:211], v[56:59], a[196:199], v[208:211]
    ds_read_b64_tr_b16 v[54:55], v6 offset:53760
    v_mfma_f32_16x16x32_bf16 v[224:227], v[56:59], a[200:203], v[224:227]
    s_add_u32 m0, s62, 32768
    v_mfma_f32_16x16x32_bf16 v[224:227], v[60:63], a[216:219], v[224:227]
    s_bfe_u32 s56, s0, 0x20004
    v_mfma_f32_16x16x32_bf16 v[240:243], v[60:63], a[220:223], v[240:243]
    s_mul_i32 s56, s56, 1048576
    v_mfma_f32_16x16x32_bf16 v[240:243], v[56:59], a[204:207], v[240:243]
    s_waitcnt lgkmcnt(4)
    v_mfma_f32_16x16x32_bf16 v[244:247], v[40:43], a[204:207], v[244:247]
    s_add_u32 s56, s56, s66
    ds_read_b64_tr_b16 v[56:57], v7 offset:49152
    v_mfma_f32_16x16x32_bf16 v[244:247], v[44:47], a[220:223], v[244:247]
    ds_read_b64_tr_b16 v[58:59], v7 offset:49664
    v_mfma_f32_16x16x32_bf16 v[228:231], v[44:47], a[216:219], v[228:231]
    ds_read_b64_tr_b16 v[60:61], v7 offset:53248
    v_mfma_f32_16x16x32_bf16 v[228:231], v[40:43], a[200:203], v[228:231]
    ds_read_b64_tr_b16 v[62:63], v7 offset:53760
    v_mfma_f32_16x16x32_bf16 v[212:215], v[40:43], a[196:199], v[212:215]
    s_add_u32 s61, s68, 4096
    buffer_load_dwordx4 v8, s[20:23], s56 offen offset:0 lds
    v_mfma_f32_16x16x32_bf16 v[212:215], v[44:47], a[212:215], v[212:215]
    v_lshrrev_b32 v34, 3, v0
    v_mul_u32_u24 v34, 3584, v34
    v_mfma_f32_16x16x32_bf16 v[196:199], v[44:47], a[208:211], v[196:199]
    v_bfe_u32 v35, v0, 4, 1
    v_lshlrev_b32 v35, 1, v35
    v_mfma_f32_16x16x32_bf16 v[196:199], v[40:43], a[192:195], v[196:199]
    s_waitcnt lgkmcnt(4)
    buffer_load_dwordx4 v9, s[20:23], s56 offen offset:1024 lds
    v_mfma_f32_16x16x32_bf16 v[200:203], v[48:51], a[192:195], v[200:203]
    ds_read_b64_tr_b16 v[40:41], v4 offset:57344
    v_and_b32 v36, 7, v0
    v_mfma_f32_16x16x32_bf16 v[200:203], v[52:55], a[208:211], v[200:203]
    ds_read_b64_tr_b16 v[42:43], v4 offset:57856
    v_xor_b32 v35, v35, v36
    v_mfma_f32_16x16x32_bf16 v[216:219], v[52:55], a[212:215], v[216:219]
    ds_read_b64_tr_b16 v[44:45], v4 offset:61440
    v_xor_b32 v36, 4, v35
    v_mfma_f32_16x16x32_bf16 v[216:219], v[48:51], a[196:199], v[216:219]
    ds_read_b64_tr_b16 v[46:47], v4 offset:61952
    v_lshl_add_u32 v35, v35, 4, v34
    v_mfma_f32_16x16x32_bf16 v[232:235], v[48:51], a[200:203], v[232:235]
    buffer_load_dwordx4 v10, s[20:23], s56 offen offset:2048 lds
    v_mfma_f32_16x16x32_bf16 v[232:235], v[52:55], a[216:219], v[232:235]
    v_lshl_add_u32 v36, v36, 4, v34
    v_mfma_f32_16x16x32_bf16 v[248:251], v[52:55], a[220:223], v[248:251]
    s_and_b32 s59, s64, 7
    v_mfma_f32_16x16x32_bf16 v[248:251], v[48:51], a[204:207], v[248:251]
    s_waitcnt lgkmcnt(4)
    buffer_load_dwordx4 v11, s[20:23], s56 offen offset:3072 lds
    v_mfma_f32_16x16x32_bf16 v[252:255], v[56:59], a[204:207], v[252:255]
    s_sub_u32 s59, 6, s59
    ds_read_b64_tr_b16 v[48:49], v5 offset:57344
    v_mfma_f32_16x16x32_bf16 v[252:255], v[60:63], a[220:223], v[252:255]
    s_and_b32 s59, s59, 0x40000000
    ds_read_b64_tr_b16 v[50:51], v5 offset:57856
    v_mfma_f32_16x16x32_bf16 v[236:239], v[60:63], a[216:219], v[236:239]
    ds_read_b64_tr_b16 v[52:53], v5 offset:61440
    v_or_b32 v28, s59, v1
    v_mfma_f32_16x16x32_bf16 v[236:239], v[56:59], a[200:203], v[236:239]
    ds_read_b64_tr_b16 v[54:55], v5 offset:61952
    v_or_b32 v35, s59, v35
    v_mfma_f32_16x16x32_bf16 v[220:223], v[56:59], a[196:199], v[220:223]
    v_or_b32 v36, s59, v36
    v_add_u32 v30, 0, v35
    v_mfma_f32_16x16x32_bf16 v[220:223], v[60:63], a[212:215], v[220:223]
    v_add_u32 v31, 27648, v36
    v_add_u32 v16, 55296, v35
    v_mfma_f32_16x16x32_bf16 v[204:207], v[60:63], a[208:211], v[204:207]
    v_add_u32 v17, 82944, v36
    v_cvt_pk_bf16_f32 v152, v152, v153
    v_mfma_f32_16x16x32_bf16 v[204:207], v[56:59], a[192:195], v[204:207]
    s_waitcnt lgkmcnt(4)
    buffer_store_dwordx4 v[144:147], v1, s[44:47], s61 offen offset:0 sc1
    v_mfma_f32_16x16x32_bf16 v[192:195], v[40:43], a[224:227], v[192:195]
    ds_read_b64_tr_b16 v[56:57], v6 offset:57344
    v_cvt_pk_bf16_f32 v153, v154, v155
    v_mfma_f32_16x16x32_bf16 v[192:195], v[44:47], a[240:243], v[192:195]
    ds_read_b64_tr_b16 v[58:59], v6 offset:57856
    v_cvt_pk_bf16_f32 v154, v156, v157
    v_mfma_f32_16x16x32_bf16 v[208:211], v[44:47], a[244:247], v[208:211]
    ds_read_b64_tr_b16 v[60:61], v6 offset:61440
    v_cvt_pk_bf16_f32 v155, v158, v159
    v_mfma_f32_16x16x32_bf16 v[208:211], v[40:43], a[228:231], v[208:211]
    ds_read_b64_tr_b16 v[62:63], v6 offset:61952
    v_mfma_f32_16x16x32_bf16 v[224:227], v[40:43], a[232:235], v[224:227]
    v_mfma_f32_16x16x32_bf16 v[224:227], v[44:47], a[248:251], v[224:227]
    v_mfma_f32_16x16x32_bf16 v[240:243], v[44:47], a[252:255], v[240:243]
    v_mfma_f32_16x16x32_bf16 v[240:243], v[40:43], a[236:239], v[240:243]
    s_waitcnt lgkmcnt(4)
    v_mfma_f32_16x16x32_bf16 v[196:199], v[48:51], a[224:227], v[196:199]
    ds_read_b64_tr_b16 v[40:41], v7 offset:57344
    v_mfma_f32_16x16x32_bf16 v[196:199], v[52:55], a[240:243], v[196:199]
    ds_read_b64_tr_b16 v[42:43], v7 offset:57856
    v_mfma_f32_16x16x32_bf16 v[212:215], v[52:55], a[244:247], v[212:215]
    ds_read_b64_tr_b16 v[44:45], v7 offset:61440
    v_mfma_f32_16x16x32_bf16 v[212:215], v[48:51], a[228:231], v[212:215]
    ds_read_b64_tr_b16 v[46:47], v7 offset:61952
    v_mfma_f32_16x16x32_bf16 v[228:231], v[48:51], a[232:235], v[228:231]
    v_mfma_f32_16x16x32_bf16 v[228:231], v[52:55], a[248:251], v[228:231]
    v_mfma_f32_16x16x32_bf16 v[244:247], v[52:55], a[252:255], v[244:247]
    s_waitcnt vmcnt(16) lgkmcnt(0)
    v_mfma_f32_16x16x32_bf16 v[244:247], v[48:51], a[236:239], v[244:247]
    s_barrier
    v_mfma_f32_16x16x32_bf16 v[200:203], v[56:59], a[224:227], v[200:203]
    s_add_u32 s61, s68, 4096
    ds_read_b64_tr_b16 v[48:49], v4 offset:0
    v_mfma_f32_16x16x32_bf16 v[200:203], v[60:63], a[240:243], v[200:203]
    ds_read_b64_tr_b16 v[50:51], v4 offset:512
    v_mfma_f32_16x16x32_bf16 v[216:219], v[60:63], a[244:247], v[216:219]
    ds_read_b64_tr_b16 v[52:53], v4 offset:4096
    v_mfma_f32_16x16x32_bf16 v[216:219], v[56:59], a[228:231], v[216:219]
    ds_read_b64_tr_b16 v[54:55], v4 offset:4608
    v_mfma_f32_16x16x32_bf16 v[232:235], v[56:59], a[232:235], v[232:235]
    s_add_u32 m0, s62, 49152
    buffer_store_dwordx4 v[152:155], v1, s[44:47], s61 offen offset:1024 sc1
    v_mfma_f32_16x16x32_bf16 v[232:235], v[60:63], a[248:251], v[232:235]
    s_bfe_u32 s56, s0, 0x20006
    v_mfma_f32_16x16x32_bf16 v[248:251], v[60:63], a[252:255], v[248:251]
    s_mul_i32 s56, s56, 1048576
    v_cvt_pk_bf16_f32 v160, v160, v161
    v_cvt_pk_bf16_f32 v161, v162, v163
    v_mfma_f32_16x16x32_bf16 v[248:251], v[56:59], a[236:239], v[248:251]
    s_add_u32 s56, s56, s66
    v_cvt_pk_bf16_f32 v162, v164, v165
    v_cvt_pk_bf16_f32 v163, v166, v167
    v_mfma_f32_16x16x32_bf16 v[204:207], v[40:43], a[224:227], v[204:207]
    ds_read_b64_tr_b16 v[56:57], v5 offset:0
    v_mfma_f32_16x16x32_bf16 v[204:207], v[44:47], a[240:243], v[204:207]
    ds_read_b64_tr_b16 v[58:59], v5 offset:512
    v_mfma_f32_16x16x32_bf16 v[220:223], v[44:47], a[244:247], v[220:223]
    ds_read_b64_tr_b16 v[60:61], v5 offset:4096
    v_mfma_f32_16x16x32_bf16 v[220:223], v[40:43], a[228:231], v[220:223]
    ds_read_b64_tr_b16 v[62:63], v5 offset:4608
    v_mfma_f32_16x16x32_bf16 v[236:239], v[40:43], a[232:235], v[236:239]
    buffer_load_dwordx4 v8, s[20:23], s56 offen offset:0 lds
    v_mfma_f32_16x16x32_bf16 v[236:239], v[44:47], a[248:251], v[236:239]
    v_mfma_f32_16x16x32_bf16 v[252:255], v[44:47], a[252:255], v[252:255]
    v_mfma_f32_16x16x32_bf16 v[252:255], v[40:43], a[236:239], v[252:255]
    s_waitcnt lgkmcnt(4)
    buffer_load_dwordx4 v9, s[20:23], s56 offen offset:1024 lds
    v_mfma_f32_16x16x32_bf16 v[64:67], a[0:3], v[48:51], 0
    ds_read_b64_tr_b16 v[40:41], v6 offset:0
    v_mfma_f32_16x16x32_bf16 v[64:67], a[16:19], v[52:55], v[64:67]
    ds_read_b64_tr_b16 v[42:43], v6 offset:512
    v_mfma_f32_16x16x32_bf16 v[68:71], a[20:23], v[52:55], 0
    ds_read_b64_tr_b16 v[44:45], v6 offset:4096
    v_mfma_f32_16x16x32_bf16 v[68:71], a[4:7], v[48:51], v[68:71]
    ds_read_b64_tr_b16 v[46:47], v6 offset:4608
    v_mfma_f32_16x16x32_bf16 v[72:75], a[8:11], v[48:51], 0
    buffer_load_dwordx4 v10, s[20:23], s56 offen offset:2048 lds
    v_mfma_f32_16x16x32_bf16 v[72:75], a[24:27], v[52:55], v[72:75]
    v_mfma_f32_16x16x32_bf16 v[76:79], a[28:31], v[52:55], 0
    v_cvt_pk_bf16_f32 v192, v192, v193
    v_cvt_pk_bf16_f32 v193, v194, v195
    v_mfma_f32_16x16x32_bf16 v[76:79], a[12:15], v[48:51], v[76:79]
    s_waitcnt lgkmcnt(4)
    buffer_load_dwordx4 v11, s[20:23], s56 offen offset:3072 lds
    v_mfma_f32_16x16x32_bf16 v[92:95], a[12:15], v[56:59], 0
    ds_read_b64_tr_b16 v[48:49], v7 offset:0
    v_cvt_pk_bf16_f32 v194, v196, v197
    v_mfma_f32_16x16x32_bf16 v[92:95], a[28:31], v[60:63], v[92:95]
    ds_read_b64_tr_b16 v[50:51], v7 offset:512
    v_cvt_pk_bf16_f32 v195, v198, v199
    v_mfma_f32_16x16x32_bf16 v[88:91], a[24:27], v[60:63], 0
    ds_read_b64_tr_b16 v[52:53], v7 offset:4096
    v_mfma_f32_16x16x32_bf16 v[88:91], a[8:11], v[56:59], v[88:91]
    ds_read_b64_tr_b16 v[54:55], v7 offset:4608
    v_mfma_f32_16x16x32_bf16 v[84:87], a[4:7], v[56:59], 0
    v_mfma_f32_16x16x32_bf16 v[84:87], a[20:23], v[60:63], v[84:87]
    v_mfma_f32_16x16x32_bf16 v[80:83], a[16:19], v[60:63], 0
    v_mfma_f32_16x16x32_bf16 v[80:83], a[0:3], v[56:59], v[80:83]
    s_waitcnt lgkmcnt(4)
    v_mfma_f32_16x16x32_bf16 v[96:99], a[0:3], v[40:43], 0
    s_add_u32 s61, s68, 16384
    ds_read_b64_tr_b16 v[56:57], v4 offset:8192
    v_mfma_f32_16x16x32_bf16 v[96:99], a[16:19], v[44:47], v[96:99]
    ds_read_b64_tr_b16 v[58:59], v4 offset:8704
    v_mfma_f32_16x16x32_bf16 v[100:103], a[20:23], v[44:47], 0
    ds_read_b64_tr_b16 v[60:61], v4 offset:12288
    v_cvt_pk_bf16_f32 v168, v168, v169
    v_mfma_f32_16x16x32_bf16 v[100:103], a[4:7], v[40:43], v[100:103]
    ds_read_b64_tr_b16 v[62:63], v4 offset:12800
    v_cvt_pk_bf16_f32 v169, v170, v171
    v_mfma_f32_16x16x32_bf16 v[104:107], a[8:11], v[40:43], 0
    buffer_store_dwordx4 v[160:163], v1, s[44:47], s61 offen offset:0 sc1
    v_mfma_f32_16x16x32_bf16 v[104:107], a[24:27], v[44:47], v[104:107]
    v_cvt_pk_bf16_f32 v170, v172, v173
    v_cvt_pk_bf16_f32 v171, v174, v175
    v_mfma_f32_16x16x32_bf16 v[108:111], a[28:31], v[44:47], 0
    v_mfma_f32_16x16x32_bf16 v[108:111], a[12:15], v[40:43], v[108:111]
    s_waitcnt lgkmcnt(4)
    v_mfma_f32_16x16x32_bf16 v[124:127], a[12:15], v[48:51], 0
    ds_read_b64_tr_b16 v[40:41], v5 offset:8192
    v_mfma_f32_16x16x32_bf16 v[124:127], a[28:31], v[52:55], v[124:127]
    ds_read_b64_tr_b16 v[42:43], v5 offset:8704
    v_mfma_f32_16x16x32_bf16 v[120:123], a[24:27], v[52:55], 0
    ds_read_b64_tr_b16 v[44:45], v5 offset:12288
    v_mfma_f32_16x16x32_bf16 v[120:123], a[8:11], v[48:51], v[120:123]
    ds_read_b64_tr_b16 v[46:47], v5 offset:12800
    v_mfma_f32_16x16x32_bf16 v[116:119], a[4:7], v[48:51], 0
    s_add_u32 m0, s62, 81920
    v_mfma_f32_16x16x32_bf16 v[116:119], a[20:23], v[52:55], v[116:119]
    s_bfe_u32 s56, s0, 0x20002
    v_mfma_f32_16x16x32_bf16 v[112:115], a[16:19], v[52:55], 0
    s_mul_i32 s56, s56, 1048576
    v_mfma_f32_16x16x32_bf16 v[112:115], a[0:3], v[48:51], v[112:115]
    s_waitcnt lgkmcnt(4)
    v_mfma_f32_16x16x32_bf16 v[64:67], a[32:35], v[56:59], v[64:67]
    s_add_u32 s56, s56, s66
    ds_read_b64_tr_b16 v[48:49], v6 offset:8192
    v_mfma_f32_16x16x32_bf16 v[64:67], a[48:51], v[60:63], v[64:67]
    s_add_u32 s56, s56, 128
    ds_read_b64_tr_b16 v[50:51], v6 offset:8704
    v_mfma_f32_16x16x32_bf16 v[68:71], a[52:55], v[60:63], v[68:71]
    ds_read_b64_tr_b16 v[52:53], v6 offset:12288
    v_cvt_pk_bf16_f32 v200, v200, v201
    v_mfma_f32_16x16x32_bf16 v[68:71], a[36:39], v[56:59], v[68:71]
    ds_read_b64_tr_b16 v[54:55], v6 offset:12800
    v_cvt_pk_bf16_f32 v201, v202, v203
    v_mfma_f32_16x16x32_bf16 v[72:75], a[40:43], v[56:59], v[72:75]
    buffer_load_dwordx4 v8, s[20:23], s56 offen offset:0 lds
    v_mfma_f32_16x16x32_bf16 v[72:75], a[56:59], v[60:63], v[72:75]
    v_cvt_pk_bf16_f32 v202, v204, v205
    v_cvt_pk_bf16_f32 v203, v206, v207
    v_mfma_f32_16x16x32_bf16 v[76:79], a[60:63], v[60:63], v[76:79]
    v_mfma_f32_16x16x32_bf16 v[76:79], a[44:47], v[56:59], v[76:79]
    s_waitcnt lgkmcnt(4)
    buffer_load_dwordx4 v9, s[20:23], s56 offen offset:1024 lds
    v_mfma_f32_16x16x32_bf16 v[92:95], a[44:47], v[40:43], v[92:95]
    ds_read_b64_tr_b16 v[56:57], v7 offset:8192
    v_mfma_f32_16x16x32_bf16 v[92:95], a[60:63], v[44:47], v[92:95]
    ds_read_b64_tr_b16 v[58:59], v7 offset:8704
    v_mfma_f32_16x16x32_bf16 v[88:91], a[56:59], v[44:47], v[88:91]
    ds_read_b64_tr_b16 v[60:61], v7 offset:12288
    v_mfma_f32_16x16x32_bf16 v[88:91], a[40:43], v[40:43], v[88:91]
    ds_read_b64_tr_b16 v[62:63], v7 offset:12800
    v_mfma_f32_16x16x32_bf16 v[84:87], a[36:39], v[40:43], v[84:87]
    buffer_load_dwordx4 v10, s[20:23], s56 offen offset:2048 lds
    v_mfma_f32_16x16x32_bf16 v[84:87], a[52:55], v[44:47], v[84:87]
    v_mfma_f32_16x16x32_bf16 v[80:83], a[48:51], v[44:47], v[80:83]
    s_waitcnt vmcnt(16) lgkmcnt(0)
    v_cvt_pk_bf16_f32 v176, v176, v177
    v_cvt_pk_bf16_f32 v177, v178, v179
    v_mfma_f32_16x16x32_bf16 v[80:83], a[32:35], v[40:43], v[80:83]
    s_barrier
    buffer_load_dwordx4 v11, s[20:23], s56 offen offset:3072 lds
    v_mfma_f32_16x16x32_bf16 v[96:99], a[32:35], v[48:51], v[96:99]
    ds_read_b64_tr_b16 v[40:41], v4 offset:16384
    v_cvt_pk_bf16_f32 v178, v180, v181
    v_mfma_f32_16x16x32_bf16 v[96:99], a[48:51], v[52:55], v[96:99]
    ds_read_b64_tr_b16 v[42:43], v4 offset:16896
    v_cvt_pk_bf16_f32 v179, v182, v183
    v_mfma_f32_16x16x32_bf16 v[100:103], a[52:55], v[52:55], v[100:103]
    s_add_u32 s61, s68, 16384
    ds_read_b64_tr_b16 v[44:45], v4 offset:20480
    v_mfma_f32_16x16x32_bf16 v[100:103], a[36:39], v[48:51], v[100:103]
    ds_read_b64_tr_b16 v[46:47], v4 offset:20992
    v_mfma_f32_16x16x32_bf16 v[104:107], a[40:43], v[48:51], v[104:107]
    buffer_store_dwordx4 v[168:171], v1, s[44:47], s61 offen offset:1024 sc1
    v_mfma_f32_16x16x32_bf16 v[104:107], a[56:59], v[52:55], v[104:107]
    v_mfma_f32_16x16x32_bf16 v[108:111], a[60:63], v[52:55], v[108:111]
    v_mfma_f32_16x16x32_bf16 v[108:111], a[44:47], v[48:51], v[108:111]
    v_mfma_f32_16x16x32_bf16 v[124:127], a[44:47], v[56:59], v[124:127]
    ds_read_b64_tr_b16 v[48:49], v5 offset:16384
    v_mfma_f32_16x16x32_bf16 v[124:127], a[60:63], v[60:63], v[124:127]
    ds_read_b64_tr_b16 v[50:51], v5 offset:16896
    v_mfma_f32_16x16x32_bf16 v[120:123], a[56:59], v[60:63], v[120:123]
    ds_read_b64_tr_b16 v[52:53], v5 offset:20480
    v_mfma_f32_16x16x32_bf16 v[120:123], a[40:43], v[56:59], v[120:123]
    ds_read_b64_tr_b16 v[54:55], v5 offset:20992
    v_mfma_f32_16x16x32_bf16 v[116:119], a[36:39], v[56:59], v[116:119]
    v_mfma_f32_16x16x32_bf16 v[116:119], a[52:55], v[60:63], v[116:119]
    v_mfma_f32_16x16x32_bf16 v[112:115], a[48:51], v[60:63], v[112:115]
    v_cvt_pk_bf16_f32 v208, v208, v209
    v_cvt_pk_bf16_f32 v209, v210, v211
    v_mfma_f32_16x16x32_bf16 v[112:115], a[32:35], v[56:59], v[112:115]
    s_waitcnt lgkmcnt(4)
    v_cvt_pk_bf16_f32 v210, v212, v213
    v_cvt_pk_bf16_f32 v211, v214, v215
    v_mfma_f32_16x16x32_bf16 v[64:67], a[64:67], v[40:43], v[64:67]
    ds_read_b64_tr_b16 v[56:57], v6 offset:16384
    v_mfma_f32_16x16x32_bf16 v[64:67], a[80:83], v[44:47], v[64:67]
    ds_read_b64_tr_b16 v[58:59], v6 offset:16896
    v_mfma_f32_16x16x32_bf16 v[68:71], a[84:87], v[44:47], v[68:71]
    ds_read_b64_tr_b16 v[60:61], v6 offset:20480
    v_mfma_f32_16x16x32_bf16 v[68:71], a[68:71], v[40:43], v[68:71]
    ds_read_b64_tr_b16 v[62:63], v6 offset:20992
    v_mfma_f32_16x16x32_bf16 v[72:75], a[72:75], v[40:43], v[72:75]
    s_add_u32 m0, s62, 98304
    v_mfma_f32_16x16x32_bf16 v[72:75], a[88:91], v[44:47], v[72:75]
    s_bfe_u32 s56, s0, 0x20004
    v_mfma_f32_16x16x32_bf16 v[76:79], a[92:95], v[44:47], v[76:79]
    s_mul_i32 s56, s56, 1048576
    v_mfma_f32_16x16x32_bf16 v[76:79], a[76:79], v[40:43], v[76:79]
    s_waitcnt lgkmcnt(4)
    v_mfma_f32_16x16x32_bf16 v[92:95], a[76:79], v[48:51], v[92:95]
    s_add_u32 s56, s56, s66
    ds_read_b64_tr_b16 v[40:41], v7 offset:16384
    v_mfma_f32_16x16x32_bf16 v[92:95], a[92:95], v[52:55], v[92:95]
    s_add_u32 s56, s56, 128
    ds_read_b64_tr_b16 v[42:43], v7 offset:16896
    v_mfma_f32_16x16x32_bf16 v[88:91], a[88:91], v[52:55], v[88:91]
    ds_read_b64_tr_b16 v[44:45], v7 offset:20480
    v_cvt_pk_bf16_f32 v184, v184, v185
    v_mfma_f32_16x16x32_bf16 v[88:91], a[72:75], v[48:51], v[88:91]
    ds_read_b64_tr_b16 v[46:47], v7 offset:20992
    v_cvt_pk_bf16_f32 v185, v186, v187
    v_mfma_f32_16x16x32_bf16 v[84:87], a[68:71], v[48:51], v[84:87]
    buffer_load_dwordx4 v8, s[20:23], s56 offen offset:0 lds
    v_mfma_f32_16x16x32_bf16 v[84:87], a[84:87], v[52:55], v[84:87]
    v_cvt_pk_bf16_f32 v186, v188, v189
    v_cvt_pk_bf16_f32 v187, v190, v191
    v_mfma_f32_16x16x32_bf16 v[80:83], a[80:83], v[52:55], v[80:83]
    v_mfma_f32_16x16x32_bf16 v[80:83], a[64:67], v[48:51], v[80:83]
    s_waitcnt lgkmcnt(4)
    buffer_load_dwordx4 v9, s[20:23], s56 offen offset:1024 lds
    v_mfma_f32_16x16x32_bf16 v[96:99], a[64:67], v[56:59], v[96:99]
    ds_read_b64_tr_b16 v[48:49], v4 offset:24576
    v_mfma_f32_16x16x32_bf16 v[96:99], a[80:83], v[60:63], v[96:99]
    ds_read_b64_tr_b16 v[50:51], v4 offset:25088
    v_mfma_f32_16x16x32_bf16 v[100:103], a[84:87], v[60:63], v[100:103]
    ds_read_b64_tr_b16 v[52:53], v4 offset:28672
    v_mfma_f32_16x16x32_bf16 v[100:103], a[68:71], v[56:59], v[100:103]
    ds_read_b64_tr_b16 v[54:55], v4 offset:29184
    v_mfma_f32_16x16x32_bf16 v[104:107], a[72:75], v[56:59], v[104:107]
    s_add_u32 s61, s68, 20480
    buffer_load_dwordx4 v10, s[20:23], s56 offen offset:2048 lds
    v_mfma_f32_16x16x32_bf16 v[104:107], a[88:91], v[60:63], v[104:107]
    v_mfma_f32_16x16x32_bf16 v[108:111], a[92:95], v[60:63], v[108:111]
    v_mfma_f32_16x16x32_bf16 v[108:111], a[76:79], v[56:59], v[108:111]
    s_waitcnt lgkmcnt(4)
    buffer_load_dwordx4 v11, s[20:23], s56 offen offset:3072 lds
    v_mfma_f32_16x16x32_bf16 v[124:127], a[76:79], v[40:43], v[124:127]
    ds_read_b64_tr_b16 v[56:57], v5 offset:24576
    v_mfma_f32_16x16x32_bf16 v[124:127], a[92:95], v[44:47], v[124:127]
    ds_read_b64_tr_b16 v[58:59], v5 offset:25088
    v_mfma_f32_16x16x32_bf16 v[120:123], a[88:91], v[44:47], v[120:123]
    ds_read_b64_tr_b16 v[60:61], v5 offset:28672
    v_cvt_pk_bf16_f32 v216, v216, v217
    v_mfma_f32_16x16x32_bf16 v[120:123], a[72:75], v[40:43], v[120:123]
    ds_read_b64_tr_b16 v[62:63], v5 offset:29184
    v_cvt_pk_bf16_f32 v217, v218, v219
    v_mfma_f32_16x16x32_bf16 v[116:119], a[68:71], v[40:43], v[116:119]
    buffer_store_dwordx4 v[176:179], v1, s[44:47], s61 offen offset:0 sc1
    v_mfma_f32_16x16x32_bf16 v[116:119], a[84:87], v[44:47], v[116:119]
    v_cvt_pk_bf16_f32 v218, v220, v221
    v_cvt_pk_bf16_f32 v219, v222, v223
    v_mfma_f32_16x16x32_bf16 v[112:115], a[80:83], v[44:47], v[112:115]
    v_mfma_f32_16x16x32_bf16 v[112:115], a[64:67], v[40:43], v[112:115]
    s_waitcnt lgkmcnt(4)
    v_mfma_f32_16x16x32_bf16 v[64:67], a[96:99], v[48:51], v[64:67]
    ds_read_b64_tr_b16 v[40:41], v6 offset:24576
    v_mfma_f32_16x16x32_bf16 v[64:67], a[112:115], v[52:55], v[64:67]
    ds_read_b64_tr_b16 v[42:43], v6 offset:25088
    v_mfma_f32_16x16x32_bf16 v[68:71], a[116:119], v[52:55], v[68:71]
    ds_read_b64_tr_b16 v[44:45], v6 offset:28672
    v_mfma_f32_16x16x32_bf16 v[68:71], a[100:103], v[48:51], v[68:71]
    ds_read_b64_tr_b16 v[46:47], v6 offset:29184
    v_mfma_f32_16x16x32_bf16 v[72:75], a[104:107], v[48:51], v[72:75]
    v_mfma_f32_16x16x32_bf16 v[72:75], a[120:123], v[52:55], v[72:75]
    v_mfma_f32_16x16x32_bf16 v[76:79], a[124:127], v[52:55], v[76:79]
    v_mfma_f32_16x16x32_bf16 v[76:79], a[108:111], v[48:51], v[76:79]
    s_waitcnt lgkmcnt(4)
    v_mfma_f32_16x16x32_bf16 v[92:95], a[108:111], v[56:59], v[92:95]
    s_add_u32 m0, s62, 0
    ds_read_b64_tr_b16 v[48:49], v7 offset:24576
    v_mfma_f32_16x16x32_bf16 v[92:95], a[124:127], v[60:63], v[92:95]
    s_add_u32 s56, s1, 0
    ds_read_b64_tr_b16 v[50:51], v7 offset:25088
    v_mfma_f32_16x16x32_bf16 v[88:91], a[120:123], v[60:63], v[88:91]
    s_and_b32 s56, s56, 3
    ds_read_b64_tr_b16 v[52:53], v7 offset:28672
    v_mfma_f32_16x16x32_bf16 v[88:91], a[104:107], v[56:59], v[88:91]
    s_mul_i32 s56, s56, 458752
    ds_read_b64_tr_b16 v[54:55], v7 offset:29184
    v_mfma_f32_16x16x32_bf16 v[84:87], a[100:103], v[56:59], v[84:87]
    s_add_u32 s56, s56, s76
    v_mfma_f32_16x16x32_bf16 v[84:87], a[116:119], v[60:63], v[84:87]
    buffer_load_dwordx4 v30, s[28:31], s56 offen offset:0 lds
    v_mfma_f32_16x16x32_bf16 v[80:83], a[112:115], v[60:63], v[80:83]
    s_waitcnt vmcnt(18) lgkmcnt(0)
    v_mfma_f32_16x16x32_bf16 v[80:83], a[96:99], v[56:59], v[80:83]
    s_barrier
    v_mfma_f32_16x16x32_bf16 v[96:99], a[96:99], v[40:43], v[96:99]
    ds_read_b64_tr_b16 v[56:57], v4 offset:32768
    v_mfma_f32_16x16x32_bf16 v[96:99], a[112:115], v[44:47], v[96:99]
    ds_read_b64_tr_b16 v[58:59], v4 offset:33280
    v_mfma_f32_16x16x32_bf16 v[100:103], a[116:119], v[44:47], v[100:103]
    ds_read_b64_tr_b16 v[60:61], v4 offset:36864
    v_mfma_f32_16x16x32_bf16 v[100:103], a[100:103], v[40:43], v[100:103]
    ds_read_b64_tr_b16 v[62:63], v4 offset:37376
    v_mfma_f32_16x16x32_bf16 v[104:107], a[104:107], v[40:43], v[104:107]
    buffer_load_dwordx4 v31, s[28:31], s56 offen offset:1024 lds
    v_mfma_f32_16x16x32_bf16 v[104:107], a[120:123], v[44:47], v[104:107]
    v_mfma_f32_16x16x32_bf16 v[108:111], a[124:127], v[44:47], v[108:111]
    s_add_u32 s61, s68, 20480
    v_cvt_pk_bf16_f32 v224, v224, v225
    v_cvt_pk_bf16_f32 v225, v226, v227
    v_mfma_f32_16x16x32_bf16 v[108:111], a[108:111], v[40:43], v[108:111]
    buffer_load_dwordx4 v16, s[28:31], s56 offen offset:2048 lds
    v_mfma_f32_16x16x32_bf16 v[124:127], a[108:111], v[48:51], v[124:127]
    ds_read_b64_tr_b16 v[40:41], v5 offset:32768
    v_cvt_pk_bf16_f32 v226, v228, v229
    v_mfma_f32_16x16x32_bf16 v[124:127], a[124:127], v[52:55], v[124:127]
    ds_read_b64_tr_b16 v[42:43], v5 offset:33280
    v_cvt_pk_bf16_f32 v227, v230, v231
    v_mfma_f32_16x16x32_bf16 v[120:123], a[120:123], v[52:55], v[120:123]
    ds_read_b64_tr_b16 v[44:45], v5 offset:36864
    v_mfma_f32_16x16x32_bf16 v[120:123], a[104:107], v[48:51], v[120:123]
    ds_read_b64_tr_b16 v[46:47], v5 offset:37376
    v_mfma_f32_16x16x32_bf16 v[116:119], a[100:103], v[48:51], v[116:119]
    buffer_load_dwordx4 v17, s[28:31], s56 offen offset:3072 lds
    v_mfma_f32_16x16x32_bf16 v[116:119], a[116:119], v[52:55], v[116:119]
    v_mfma_f32_16x16x32_bf16 v[112:115], a[112:115], v[52:55], v[112:115]
    buffer_store_dwordx4 v[184:187], v1, s[44:47], s61 offen offset:1024 sc1
    v_mfma_f32_16x16x32_bf16 v[112:115], a[96:99], v[48:51], v[112:115]
    s_waitcnt lgkmcnt(4)
    v_mfma_f32_16x16x32_bf16 v[64:67], a[128:131], v[56:59], v[64:67]
    ds_read_b64_tr_b16 v[48:49], v6 offset:32768
    v_mfma_f32_16x16x32_bf16 v[64:67], a[144:147], v[60:63], v[64:67]
    ds_read_b64_tr_b16 v[50:51], v6 offset:33280
    v_mfma_f32_16x16x32_bf16 v[68:71], a[148:151], v[60:63], v[68:71]
    ds_read_b64_tr_b16 v[52:53], v6 offset:36864
    v_mfma_f32_16x16x32_bf16 v[68:71], a[132:135], v[56:59], v[68:71]
    ds_read_b64_tr_b16 v[54:55], v6 offset:37376
    v_mfma_f32_16x16x32_bf16 v[72:75], a[136:139], v[56:59], v[72:75]
    v_mfma_f32_16x16x32_bf16 v[72:75], a[152:155], v[60:63], v[72:75]
    v_mfma_f32_16x16x32_bf16 v[76:79], a[156:159], v[60:63], v[76:79]
    v_mfma_f32_16x16x32_bf16 v[76:79], a[140:143], v[56:59], v[76:79]
    s_waitcnt lgkmcnt(4)
    v_mfma_f32_16x16x32_bf16 v[92:95], a[140:143], v[40:43], v[92:95]
    ds_read_b64_tr_b16 v[56:57], v7 offset:32768
    v_mfma_f32_16x16x32_bf16 v[92:95], a[156:159], v[44:47], v[92:95]
    ds_read_b64_tr_b16 v[58:59], v7 offset:33280
    v_mfma_f32_16x16x32_bf16 v[88:91], a[152:155], v[44:47], v[88:91]
    ds_read_b64_tr_b16 v[60:61], v7 offset:36864
    v_mfma_f32_16x16x32_bf16 v[88:91], a[136:139], v[40:43], v[88:91]
    ds_read_b64_tr_b16 v[62:63], v7 offset:37376
    v_mfma_f32_16x16x32_bf16 v[84:87], a[132:135], v[40:43], v[84:87]
    v_mfma_f32_16x16x32_bf16 v[84:87], a[148:151], v[44:47], v[84:87]
    v_mfma_f32_16x16x32_bf16 v[80:83], a[144:147], v[44:47], v[80:83]
    v_mfma_f32_16x16x32_bf16 v[80:83], a[128:131], v[40:43], v[80:83]
    s_waitcnt lgkmcnt(4)
    v_mfma_f32_16x16x32_bf16 v[96:99], a[128:131], v[48:51], v[96:99]
    ds_read_b64_tr_b16 v[40:41], v4 offset:40960
    v_mfma_f32_16x16x32_bf16 v[96:99], a[144:147], v[52:55], v[96:99]
    ds_read_b64_tr_b16 v[42:43], v4 offset:41472
    v_mfma_f32_16x16x32_bf16 v[100:103], a[148:151], v[52:55], v[100:103]
    ds_read_b64_tr_b16 v[44:45], v4 offset:45056
    v_cvt_pk_bf16_f32 v232, v232, v233
    v_mfma_f32_16x16x32_bf16 v[100:103], a[132:135], v[48:51], v[100:103]
    ds_read_b64_tr_b16 v[46:47], v4 offset:45568
    v_cvt_pk_bf16_f32 v233, v234, v235
    v_mfma_f32_16x16x32_bf16 v[104:107], a[136:139], v[48:51], v[104:107]
    s_add_u32 m0, s62, 114688
    v_cvt_pk_bf16_f32 v234, v236, v237
    v_cvt_pk_bf16_f32 v235, v238, v239
    v_mfma_f32_16x16x32_bf16 v[104:107], a[152:155], v[52:55], v[104:107]
K_PG2:
    s_cmp_eq_u32 s100, 1
    s_cbranch_scc1 K_PG6
    s_bfe_u32 s56, s0, 0x20006
    v_mfma_f32_16x16x32_bf16 v[108:111], a[156:159], v[52:55], v[108:111]
    s_mul_i32 s56, s56, 1048576
    v_mfma_f32_16x16x32_bf16 v[108:111], a[140:143], v[48:51], v[108:111]
    s_waitcnt lgkmcnt(4)
    v_mfma_f32_16x16x32_bf16 v[124:127], a[140:143], v[56:59], v[124:127]
    s_add_u32 s56, s56, s66
    ds_read_b64_tr_b16 v[48:49], v5 offset:40960
    v_mfma_f32_16x16x32_bf16 v[124:127], a[156:159], v[60:63], v[124:127]
    s_add_u32 s56, s56, 128
    ds_read_b64_tr_b16 v[50:51], v5 offset:41472
    v_mfma_f32_16x16x32_bf16 v[120:123], a[152:155], v[60:63], v[120:123]
    s_add_u32 s61, s68, 0
    ds_read_b64_tr_b16 v[52:53], v5 offset:45056
    v_mfma_f32_16x16x32_bf16 v[120:123], a[136:139], v[56:59], v[120:123]
    ds_read_b64_tr_b16 v[54:55], v5 offset:45568
    v_mfma_f32_16x16x32_bf16 v[116:119], a[132:135], v[56:59], v[116:119]
    buffer_load_dwordx4 v8, s[20:23], s56 offen offset:0 lds
    v_mfma_f32_16x16x32_bf16 v[116:119], a[148:151], v[60:63], v[116:119]
    v_mfma_f32_16x16x32_bf16 v[112:115], a[144:147], v[60:63], v[112:115]
    v_mfma_f32_16x16x32_bf16 v[112:115], a[128:131], v[56:59], v[112:115]
    s_waitcnt lgkmcnt(4)
    buffer_load_dwordx4 v9, s[20:23], s56 offen offset:1024 lds
    v_mfma_f32_16x16x32_bf16 v[64:67], a[160:163], v[40:43], v[64:67]
    ds_read_b64_tr_b16 v[56:57], v6 offset:40960
    v_mfma_f32_16x16x32_bf16 v[64:67], a[176:179], v[44:47], v[64:67]
    ds_read_b64_tr_b16 v[58:59], v6 offset:41472
    v_mfma_f32_16x16x32_bf16 v[68:71], a[180:183], v[44:47], v[68:71]
    ds_read_b64_tr_b16 v[60:61], v6 offset:45056
    v_mfma_f32_16x16x32_bf16 v[68:71], a[164:167], v[40:43], v[68:71]
    ds_read_b64_tr_b16 v[62:63], v6 offset:45568
    v_mfma_f32_16x16x32_bf16 v[72:75], a[168:171], v[40:43], v[72:75]
    buffer_load_dwordx4 v10, s[20:23], s56 offen offset:2048 lds
    v_mfma_f32_16x16x32_bf16 v[72:75], a[184:187], v[44:47], v[72:75]
    v_mfma_f32_16x16x32_bf16 v[76:79], a[188:191], v[44:47], v[76:79]
    v_mfma_f32_16x16x32_bf16 v[76:79], a[172:175], v[40:43], v[76:79]
    s_waitcnt lgkmcnt(4)
    buffer_load_dwordx4 v11, s[20:23], s56 offen offset:3072 lds
    v_mfma_f32_16x16x32_bf16 v[92:95], a[172:175], v[48:51], v[92:95]
    ds_read_b64_tr_b16 v[40:41], v7 offset:40960
    v_mfma_f32_16x16x32_bf16 v[92:95], a[188:191], v[52:55], v[92:95]
    ds_read_b64_tr_b16 v[42:43], v7 offset:41472
    v_mfma_f32_16x16x32_bf16 v[88:91], a[184:187], v[52:55], v[88:91]
    ds_read_b64_tr_b16 v[44:45], v7 offset:45056
    v_mfma_f32_16x16x32_bf16 v[88:91], a[168:171], v[48:51], v[88:91]
    ds_read_b64_tr_b16 v[46:47], v7 offset:45568
    v_mfma_f32_16x16x32_bf16 v[84:87], a[164:167], v[48:51], v[84:87]
    buffer_store_dwordx4 v[192:195], v1, s[44:47], s61 offen offset:2048 sc1
    v_mfma_f32_16x16x32_bf16 v[84:87], a[180:183], v[52:55], v[84:87]
    v_mfma_f32_16x16x32_bf16 v[80:83], a[176:179], v[52:55], v[80:83]
    s_waitcnt vmcnt(21) lgkmcnt(0)
    v_cvt_pk_bf16_f32 v240, v240, v241
    v_cvt_pk_bf16_f32 v241, v242, v243
    v_mfma_f32_16x16x32_bf16 v[80:83], a[160:163], v[48:51], v[80:83]
    s_barrier
    v_cvt_pk_bf16_f32 v242, v244, v245
    v_cvt_pk_bf16_f32 v243, v246, v247
    v_mfma_f32_16x16x32_bf16 v[96:99], a[160:163], v[56:59], v[96:99]
    ds_read_b64_tr_b16 v[48:49], v4 offset:49152
    v_mfma_f32_16x16x32_bf16 v[96:99], a[176:179], v[60:63], v[96:99]
    ds_read_b64_tr_b16 v[50:51], v4 offset:49664
    v_mfma_f32_16x16x32_bf16 v[100:103], a[180:183], v[60:63], v[100:103]
    ds_read_b64_tr_b16 v[52:53], v4 offset:53248
    v_mfma_f32_16x16x32_bf16 v[100:103], a[164:167], v[56:59], v[100:103]
    ds_read_b64_tr_b16 v[54:55], v4 offset:53760
    v_mfma_f32_16x16x32_bf16 v[104:107], a[168:171], v[56:59], v[104:107]
    v_mfma_f32_16x16x32_bf16 v[104:107], a[184:187], v[60:63], v[104:107]
    v_mfma_f32_16x16x32_bf16 v[108:111], a[188:191], v[60:63], v[108:111]
    v_mfma_f32_16x16x32_bf16 v[108:111], a[172:175], v[56:59], v[108:111]
    v_mfma_f32_16x16x32_bf16 v[124:127], a[172:175], v[40:43], v[124:127]
    ds_read_b64_tr_b16 v[56:57], v5 offset:49152
    v_mfma_f32_16x16x32_bf16 v[124:127], a[188:191], v[44:47], v[124:127]
    ds_read_b64_tr_b16 v[58:59], v5 offset:49664
    v_mfma_f32_16x16x32_bf16 v[120:123], a[184:187], v[44:47], v[120:123]
    ds_read_b64_tr_b16 v[60:61], v5 offset:53248
    v_mfma_f32_16x16x32_bf16 v[120:123], a[168:171], v[40:43], v[120:123]
    ds_read_b64_tr_b16 v[62:63], v5 offset:53760
    v_mfma_f32_16x16x32_bf16 v[116:119], a[164:167], v[40:43], v[116:119]
    s_add_u32 m0, s62, 16384
    v_mfma_f32_16x16x32_bf16 v[116:119], a[180:183], v[44:47], v[116:119]
    s_add_u32 s56, s1, 1
    v_mfma_f32_16x16x32_bf16 v[112:115], a[176:179], v[44:47], v[112:115]
    s_and_b32 s56, s56, 3
    v_mfma_f32_16x16x32_bf16 v[112:115], a[160:163], v[40:43], v[112:115]
    s_waitcnt lgkmcnt(4)
    v_mfma_f32_16x16x32_bf16 v[64:67], a[192:195], v[48:51], v[64:67]
    s_mul_i32 s56, s56, 458752
    ds_read_b64_tr_b16 v[40:41], v6 offset:49152
    v_mfma_f32_16x16x32_bf16 v[64:67], a[208:211], v[52:55], v[64:67]
    s_add_u32 s56, s56, s76
    ds_read_b64_tr_b16 v[42:43], v6 offset:49664
    v_mfma_f32_16x16x32_bf16 v[68:71], a[212:215], v[52:55], v[68:71]
    s_lshl_b32 s59, s63, 1
    ds_read_b64_tr_b16 v[44:45], v6 offset:53248
    v_mfma_f32_16x16x32_bf16 v[68:71], a[196:199], v[48:51], v[68:71]
    s_sub_u32 s59, 15, s59
    ds_read_b64_tr_b16 v[46:47], v6 offset:53760
    v_mfma_f32_16x16x32_bf16 v[72:75], a[200:203], v[48:51], v[72:75]
    s_add_u32 s61, s68, 0
    buffer_load_dwordx4 v30, s[28:31], s56 offen offset:0 lds
    v_mfma_f32_16x16x32_bf16 v[72:75], a[216:219], v[52:55], v[72:75]
    v_and_b32 v12, 1, v0
    v_mul_u32_u24 v12, s59, v12
    v_mfma_f32_16x16x32_bf16 v[76:79], a[220:223], v[52:55], v[76:79]
    v_add_u32 v12, s63, v12
    v_lshlrev_b32 v12, 7, v12
    v_mfma_f32_16x16x32_bf16 v[76:79], a[204:207], v[48:51], v[76:79]
    s_waitcnt lgkmcnt(4)
    buffer_load_dwordx4 v31, s[28:31], s56 offen offset:1024 lds
    v_mfma_f32_16x16x32_bf16 v[92:95], a[204:207], v[56:59], v[92:95]
    s_mov_b32 s96, 0x3903000
    ds_read_b64_tr_b16 v[48:49], v7 offset:49152
    v_mfma_f32_16x16x32_bf16 v[92:95], a[220:223], v[60:63], v[92:95]
    ds_read_b64_tr_b16 v[50:51], v7 offset:49664
    v_mfma_f32_16x16x32_bf16 v[88:91], a[216:219], v[60:63], v[88:91]
    ds_read_b64_tr_b16 v[52:53], v7 offset:53248
    v_cvt_pk_bf16_f32 v248, v248, v249
    v_mfma_f32_16x16x32_bf16 v[88:91], a[200:203], v[56:59], v[88:91]
    ds_read_b64_tr_b16 v[54:55], v7 offset:53760
    v_cvt_pk_bf16_f32 v249, v250, v251
    v_mfma_f32_16x16x32_bf16 v[84:87], a[196:199], v[56:59], v[84:87]
    buffer_load_dwordx4 v16, s[28:31], s56 offen offset:2048 lds
    v_mfma_f32_16x16x32_bf16 v[84:87], a[212:215], v[60:63], v[84:87]
    v_cvt_pk_bf16_f32 v250, v252, v253
    v_cvt_pk_bf16_f32 v251, v254, v255
    v_mfma_f32_16x16x32_bf16 v[80:83], a[208:211], v[60:63], v[80:83]
    v_mfma_f32_16x16x32_bf16 v[80:83], a[192:195], v[56:59], v[80:83]
    s_waitcnt lgkmcnt(4)
    buffer_load_dwordx4 v17, s[28:31], s56 offen offset:3072 lds
    v_mfma_f32_16x16x32_bf16 v[96:99], a[192:195], v[40:43], v[96:99]
    ds_read_b64_tr_b16 v[56:57], v4 offset:57344
    v_mfma_f32_16x16x32_bf16 v[96:99], a[208:211], v[44:47], v[96:99]
    ds_read_b64_tr_b16 v[58:59], v4 offset:57856
    v_mfma_f32_16x16x32_bf16 v[100:103], a[212:215], v[44:47], v[100:103]
    ds_read_b64_tr_b16 v[60:61], v4 offset:61440
    v_mfma_f32_16x16x32_bf16 v[100:103], a[196:199], v[40:43], v[100:103]
    ds_read_b64_tr_b16 v[62:63], v4 offset:61952
    v_mfma_f32_16x16x32_bf16 v[104:107], a[200:203], v[40:43], v[104:107]
    v_xor_b32 v4, 0x10000, v4
    v_mfma_f32_16x16x32_bf16 v[104:107], a[216:219], v[44:47], v[104:107]
    buffer_load_dword v13, v12, s[44:47], s96 offen sc1
    v_mfma_f32_16x16x32_bf16 v[108:111], a[220:223], v[44:47], v[108:111]
    v_mfma_f32_16x16x32_bf16 v[108:111], a[204:207], v[40:43], v[108:111]
    s_waitcnt lgkmcnt(4)
    buffer_store_dwordx4 v[200:203], v1, s[44:47], s61 offen offset:3072 sc1
    v_mfma_f32_16x16x32_bf16 v[124:127], a[204:207], v[48:51], v[124:127]
    ds_read_b64_tr_b16 v[40:41], v5 offset:57344
    v_mfma_f32_16x16x32_bf16 v[124:127], a[220:223], v[52:55], v[124:127]
    ds_read_b64_tr_b16 v[42:43], v5 offset:57856
    v_mfma_f32_16x16x32_bf16 v[120:123], a[216:219], v[52:55], v[120:123]
    ds_read_b64_tr_b16 v[44:45], v5 offset:61440
    v_mfma_f32_16x16x32_bf16 v[120:123], a[200:203], v[48:51], v[120:123]
    ds_read_b64_tr_b16 v[46:47], v5 offset:61952
    v_mfma_f32_16x16x32_bf16 v[116:119], a[196:199], v[48:51], v[116:119]
    v_xor_b32 v5, 0x10000, v5
    v_mfma_f32_16x16x32_bf16 v[116:119], a[212:215], v[52:55], v[116:119]
    v_mfma_f32_16x16x32_bf16 v[112:115], a[208:211], v[52:55], v[112:115]
    v_mfma_f32_16x16x32_bf16 v[112:115], a[192:195], v[48:51], v[112:115]
    s_waitcnt lgkmcnt(4)
    v_mfma_f32_16x16x32_bf16 v[64:67], a[224:227], v[56:59], v[64:67]
    ds_read_b64_tr_b16 v[48:49], v6 offset:57344
    v_mfma_f32_16x16x32_bf16 v[128:131], a[240:243], v[60:63], v[64:67]
    s_add_u32 s61, s68, 4096
    ds_read_b64_tr_b16 v[50:51], v6 offset:57856
    v_mfma_f32_16x16x32_bf16 v[68:71], a[244:247], v[60:63], v[68:71]
    ds_read_b64_tr_b16 v[52:53], v6 offset:61440
    v_mfma_f32_16x16x32_bf16 v[132:135], a[228:231], v[56:59], v[68:71]
    ds_read_b64_tr_b16 v[54:55], v6 offset:61952
    v_mfma_f32_16x16x32_bf16 v[72:75], a[232:235], v[56:59], v[72:75]
    s_add_u32 m0, s62, 32768
    v_xor_b32 v6, 0x10000, v6
    v_mfma_f32_16x16x32_bf16 v[136:139], a[248:251], v[60:63], v[72:75]
    s_add_u32 s56, s1, 2
    buffer_store_dwordx4 v[208:211], v1, s[44:47], s61 offen offset:2048 sc1
    v_mfma_f32_16x16x32_bf16 v[76:79], a[252:255], v[60:63], v[76:79]
    s_and_b32 s56, s56, 3
    v_mfma_f32_16x16x32_bf16 v[140:143], a[236:239], v[56:59], v[76:79]
    s_waitcnt lgkmcnt(4)
    v_mfma_f32_16x16x32_bf16 v[80:83], a[224:227], v[40:43], v[80:83]
    s_mul_i32 s56, s56, 458752
    ds_read_b64_tr_b16 v[56:57], v7 offset:57344
    v_mfma_f32_16x16x32_bf16 v[144:147], a[240:243], v[44:47], v[80:83]
    s_add_u32 s56, s56, s76
    ds_read_b64_tr_b16 v[58:59], v7 offset:57856
    v_mfma_f32_16x16x32_bf16 v[84:87], a[244:247], v[44:47], v[84:87]
    ds_read_b64_tr_b16 v[60:61], v7 offset:61440
    v_mfma_f32_16x16x32_bf16 v[148:151], a[228:231], v[40:43], v[84:87]
    ds_read_b64_tr_b16 v[62:63], v7 offset:61952
    v_mfma_f32_16x16x32_bf16 v[88:91], a[232:235], v[40:43], v[88:91]
    v_xor_b32 v7, 0x10000, v7
    v_mfma_f32_16x16x32_bf16 v[152:155], a[248:251], v[44:47], v[88:91]
    buffer_load_dwordx4 v30, s[28:31], s56 offen offset:0 lds
    v_mfma_f32_16x16x32_bf16 v[92:95], a[252:255], v[44:47], v[92:95]
    s_waitcnt lgkmcnt(0)
    v_mfma_f32_16x16x32_bf16 v[156:159], a[236:239], v[40:43], v[92:95]
    s_barrier
    v_mfma_f32_16x16x32_bf16 v[96:99], a[224:227], v[48:51], v[96:99]
    ds_read_b64_tr_b16 v[40:41], v4 offset:0
    v_mfma_f32_16x16x32_bf16 v[160:163], a[240:243], v[52:55], v[96:99]
    ds_read_b64_tr_b16 v[42:43], v4 offset:512
    v_mfma_f32_16x16x32_bf16 v[100:103], a[244:247], v[52:55], v[100:103]
    ds_read_b64_tr_b16 v[44:45], v4 offset:4096
    v_mfma_f32_16x16x32_bf16 v[164:167], a[228:231], v[48:51], v[100:103]
    ds_read_b64_tr_b16 v[46:47], v4 offset:4608
    v_mfma_f32_16x16x32_bf16 v[104:107], a[232:235], v[48:51], v[104:107]
    buffer_load_dwordx4 v31, s[28:31], s56 offen offset:1024 lds
    v_mfma_f32_16x16x32_bf16 v[168:171], a[248:251], v[52:55], v[104:107]
    v_mfma_f32_16x16x32_bf16 v[108:111], a[252:255], v[52:55], v[108:111]
    v_mfma_f32_16x16x32_bf16 v[172:175], a[236:239], v[48:51], v[108:111]
    buffer_load_dwordx4 v16, s[28:31], s56 offen offset:2048 lds
    v_mfma_f32_16x16x32_bf16 v[112:115], a[224:227], v[56:59], v[112:115]
    ds_read_b64_tr_b16 v[48:49], v5 offset:0
    v_mfma_f32_16x16x32_bf16 v[176:179], a[240:243], v[60:63], v[112:115]
    ds_read_b64_tr_b16 v[50:51], v5 offset:512
    v_mfma_f32_16x16x32_bf16 v[116:119], a[244:247], v[60:63], v[116:119]
    ds_read_b64_tr_b16 v[52:53], v5 offset:4096
    v_mfma_f32_16x16x32_bf16 v[180:183], a[228:231], v[56:59], v[116:119]
    ds_read_b64_tr_b16 v[54:55], v5 offset:4608
    v_mfma_f32_16x16x32_bf16 v[120:123], a[232:235], v[56:59], v[120:123]
    buffer_load_dwordx4 v17, s[28:31], s56 offen offset:3072 lds
    v_mfma_f32_16x16x32_bf16 v[184:187], a[248:251], v[60:63], v[120:123]
    v_mfma_f32_16x16x32_bf16 v[124:127], a[252:255], v[60:63], v[124:127]
    v_mfma_f32_16x16x32_bf16 v[188:191], a[236:239], v[56:59], v[124:127]
    s_waitcnt lgkmcnt(4)
    v_mfma_f32_16x16x32_bf16 v[64:67], a[0:3], v[40:43], 0
    ds_read_b64_tr_b16 v[56:57], v6 offset:0
    v_mfma_f32_16x16x32_bf16 v[64:67], a[16:19], v[44:47], v[64:67]
    ds_read_b64_tr_b16 v[58:59], v6 offset:512
    v_mfma_f32_16x16x32_bf16 v[68:71], a[20:23], v[44:47], 0
    ds_read_b64_tr_b16 v[60:61], v6 offset:4096
    v_mfma_f32_16x16x32_bf16 v[68:71], a[4:7], v[40:43], v[68:71]
    ds_read_b64_tr_b16 v[62:63], v6 offset:4608
    v_mfma_f32_16x16x32_bf16 v[72:75], a[8:11], v[40:43], 0
    v_mfma_f32_16x16x32_bf16 v[72:75], a[24:27], v[44:47], v[72:75]
    s_add_u32 s61, s68, 4096
    v_mfma_f32_16x16x32_bf16 v[76:79], a[28:31], v[44:47], 0
    buffer_store_dwordx4 v[216:219], v1, s[44:47], s61 offen offset:3072 sc1
    v_mfma_f32_16x16x32_bf16 v[76:79], a[12:15], v[40:43], v[76:79]
    s_waitcnt lgkmcnt(4)
    v_cvt_pk_bf16_f32 v128, v128, v129
    v_cvt_pk_bf16_f32 v129, v130, v131
    v_mfma_f32_16x16x32_bf16 v[92:95], a[12:15], v[48:51], 0
    s_add_u32 m0, s62, 49152
    ds_read_b64_tr_b16 v[40:41], v7 offset:0
    v_cvt_pk_bf16_f32 v130, v132, v133
    v_mfma_f32_16x16x32_bf16 v[92:95], a[28:31], v[52:55], v[92:95]
    s_add_u32 s56, s1, 3
    ds_read_b64_tr_b16 v[42:43], v7 offset:512
    v_cvt_pk_bf16_f32 v131, v134, v135
    v_mfma_f32_16x16x32_bf16 v[88:91], a[24:27], v[52:55], 0
    s_and_b32 s56, s56, 3
    ds_read_b64_tr_b16 v[44:45], v7 offset:4096
    v_mfma_f32_16x16x32_bf16 v[88:91], a[8:11], v[48:51], v[88:91]
    s_mul_i32 s56, s56, 458752
    ds_read_b64_tr_b16 v[46:47], v7 offset:4608
    v_mfma_f32_16x16x32_bf16 v[84:87], a[4:7], v[48:51], 0
    s_add_u32 s56, s56, s76
    v_mfma_f32_16x16x32_bf16 v[84:87], a[20:23], v[52:55], v[84:87]
    buffer_load_dwordx4 v30, s[28:31], s56 offen offset:0 lds
    v_mfma_f32_16x16x32_bf16 v[80:83], a[16:19], v[52:55], 0
    v_mfma_f32_16x16x32_bf16 v[80:83], a[0:3], v[48:51], v[80:83]
    s_waitcnt lgkmcnt(4)
    v_mfma_f32_16x16x32_bf16 v[96:99], a[0:3], v[56:59], 0
    ds_read_b64_tr_b16 v[48:49], v4 offset:8192
    v_mfma_f32_16x16x32_bf16 v[96:99], a[16:19], v[60:63], v[96:99]
    ds_read_b64_tr_b16 v[50:51], v4 offset:8704
    v_mfma_f32_16x16x32_bf16 v[100:103], a[20:23], v[60:63], 0
    s_waitcnt vmcnt(8)
    ds_read_b64_tr_b16 v[52:53], v4 offset:12288
    v_cmp_gt_u32 vcc, 16, v13
    v_mfma_f32_16x16x32_bf16 v[100:103], a[4:7], v[56:59], v[100:103]
    s_cbranch_vccnz S1
S1_RET:
    ds_read_b64_tr_b16 v[54:55], v4 offset:12800
    v_mfma_f32_16x16x32_bf16 v[104:107], a[8:11], v[56:59], 0
    s_add_u32 s58, s1, 0
    buffer_load_dwordx4 v31, s[28:31], s56 offen offset:1024 lds
    v_mfma_f32_16x16x32_bf16 v[104:107], a[24:27], v[60:63], v[104:107]
    s_and_b32 s58, s58, 3
    v_mfma_f32_16x16x32_bf16 v[108:111], a[28:31], v[60:63], 0
    s_mul_i32 s58, s58, 8192
    v_mfma_f32_16x16x32_bf16 v[108:111], a[12:15], v[56:59], v[108:111]
    s_waitcnt lgkmcnt(4)
    buffer_load_dwordx4 v16, s[28:31], s56 offen offset:2048 lds
    v_mfma_f32_16x16x32_bf16 v[124:127], a[12:15], v[40:43], 0
    s_add_u32 s57, s58, s73
    ds_read_b64_tr_b16 v[56:57], v5 offset:8192
    v_mfma_f32_16x16x32_bf16 v[124:127], a[28:31], v[44:47], v[124:127]
    s_add_u32 s58, s58, s74
    ds_read_b64_tr_b16 v[58:59], v5 offset:8704
    v_mfma_f32_16x16x32_bf16 v[120:123], a[24:27], v[44:47], 0
    ds_read_b64_tr_b16 v[60:61], v5 offset:12288
    v_mfma_f32_16x16x32_bf16 v[120:123], a[8:11], v[40:43], v[120:123]
    ds_read_b64_tr_b16 v[62:63], v5 offset:12800
    v_mfma_f32_16x16x32_bf16 v[116:119], a[4:7], v[40:43], 0
    buffer_load_dwordx4 v17, s[28:31], s56 offen offset:3072 lds
    v_mfma_f32_16x16x32_bf16 v[116:119], a[20:23], v[44:47], v[116:119]
    v_mfma_f32_16x16x32_bf16 v[112:115], a[16:19], v[44:47], 0
    v_mfma_f32_16x16x32_bf16 v[112:115], a[0:3], v[40:43], v[112:115]
    s_waitcnt lgkmcnt(4)
    v_mfma_f32_16x16x32_bf16 v[64:67], a[32:35], v[48:51], v[64:67]
    ds_read_b64_tr_b16 v[40:41], v6 offset:8192
    v_mfma_f32_16x16x32_bf16 v[64:67], a[48:51], v[52:55], v[64:67]
    ds_read_b64_tr_b16 v[42:43], v6 offset:8704
    v_mfma_f32_16x16x32_bf16 v[68:71], a[52:55], v[52:55], v[68:71]
    ds_read_b64_tr_b16 v[44:45], v6 offset:12288
    v_cvt_pk_bf16_f32 v136, v136, v137
    v_mfma_f32_16x16x32_bf16 v[68:71], a[36:39], v[48:51], v[68:71]
    ds_read_b64_tr_b16 v[46:47], v6 offset:12800
    v_cvt_pk_bf16_f32 v137, v138, v139
    v_mfma_f32_16x16x32_bf16 v[72:75], a[40:43], v[48:51], v[72:75]
    buffer_load_dwordx4 a[0:3], v1, s[44:47], s57 offen offset:0 sc1
    v_mfma_f32_16x16x32_bf16 v[72:75], a[56:59], v[52:55], v[72:75]
    v_cvt_pk_bf16_f32 v138, v140, v141
    v_cvt_pk_bf16_f32 v139, v142, v143
    v_mfma_f32_16x16x32_bf16 v[76:79], a[60:63], v[52:55], v[76:79]
    buffer_load_dwordx4 a[4:7], v1, s[44:47], s57 offen offset:1024 sc1
    v_mfma_f32_16x16x32_bf16 v[76:79], a[44:47], v[48:51], v[76:79]
    s_waitcnt lgkmcnt(4)
    v_mfma_f32_16x16x32_bf16 v[92:95], a[44:47], v[56:59], v[92:95]
    ds_read_b64_tr_b16 v[48:49], v7 offset:8192
    v_mfma_f32_16x16x32_bf16 v[92:95], a[60:63], v[60:63], v[92:95]
    s_add_u32 s61, s68, 16384
    ds_read_b64_tr_b16 v[50:51], v7 offset:8704
    v_mfma_f32_16x16x32_bf16 v[88:91], a[56:59], v[60:63], v[88:91]
    ds_read_b64_tr_b16 v[52:53], v7 offset:12288
    v_mfma_f32_16x16x32_bf16 v[88:91], a[40:43], v[56:59], v[88:91]
    ds_read_b64_tr_b16 v[54:55], v7 offset:12800
    v_mfma_f32_16x16x32_bf16 v[84:87], a[36:39], v[56:59], v[84:87]
    buffer_load_dwordx4 a[8:11], v1, s[44:47], s58 offen offset:0 sc1
    v_mfma_f32_16x16x32_bf16 v[84:87], a[52:55], v[60:63], v[84:87]
    v_mfma_f32_16x16x32_bf16 v[80:83], a[48:51], v[60:63], v[80:83]
    s_waitcnt lgkmcnt(0)
    v_mfma_f32_16x16x32_bf16 v[80:83], a[32:35], v[56:59], v[80:83]
    s_barrier
    buffer_load_dwordx4 a[12:15], v1, s[44:47], s58 offen offset:1024 sc1
    v_mfma_f32_16x16x32_bf16 v[96:99], a[32:35], v[40:43], v[96:99]
    ds_read_b64_tr_b16 v[56:57], v4 offset:16384
    v_mfma_f32_16x16x32_bf16 v[96:99], a[48:51], v[44:47], v[96:99]
    ds_read_b64_tr_b16 v[58:59], v4 offset:16896
    v_mfma_f32_16x16x32_bf16 v[100:103], a[52:55], v[44:47], v[100:103]
    ds_read_b64_tr_b16 v[60:61], v4 offset:20480
    v_mfma_f32_16x16x32_bf16 v[100:103], a[36:39], v[40:43], v[100:103]
    ds_read_b64_tr_b16 v[62:63], v4 offset:20992
    v_mfma_f32_16x16x32_bf16 v[104:107], a[40:43], v[40:43], v[104:107]
    v_mfma_f32_16x16x32_bf16 v[104:107], a[56:59], v[44:47], v[104:107]
    buffer_load_dwordx4 a[16:19], v1, s[44:47], s57 offen offset:2048 sc1
    v_mfma_f32_16x16x32_bf16 v[108:111], a[60:63], v[44:47], v[108:111]
    v_mfma_f32_16x16x32_bf16 v[108:111], a[44:47], v[40:43], v[108:111]
    buffer_store_dwordx4 v[224:227], v1, s[44:47], s61 offen offset:2048 sc1
    v_mfma_f32_16x16x32_bf16 v[124:127], a[44:47], v[48:51], v[124:127]
    ds_read_b64_tr_b16 v[40:41], v5 offset:16384
    v_mfma_f32_16x16x32_bf16 v[124:127], a[60:63], v[52:55], v[124:127]
    ds_read_b64_tr_b16 v[42:43], v5 offset:16896
    v_mfma_f32_16x16x32_bf16 v[120:123], a[56:59], v[52:55], v[120:123]
    ds_read_b64_tr_b16 v[44:45], v5 offset:20480
    v_mfma_f32_16x16x32_bf16 v[120:123], a[40:43], v[48:51], v[120:123]
    ds_read_b64_tr_b16 v[46:47], v5 offset:20992
    v_mfma_f32_16x16x32_bf16 v[116:119], a[36:39], v[48:51], v[116:119]
    buffer_load_dwordx4 a[20:23], v1, s[44:47], s57 offen offset:3072 sc1
    v_mfma_f32_16x16x32_bf16 v[116:119], a[52:55], v[52:55], v[116:119]
    v_mfma_f32_16x16x32_bf16 v[112:115], a[48:51], v[52:55], v[112:115]
    v_cvt_pk_bf16_f32 v144, v144, v145
    v_cvt_pk_bf16_f32 v145, v146, v147
    v_mfma_f32_16x16x32_bf16 v[112:115], a[32:35], v[48:51], v[112:115]
    s_waitcnt lgkmcnt(4)
    buffer_load_dwordx4 a[24:27], v1, s[44:47], s58 offen offset:2048 sc1
    v_mfma_f32_16x16x32_bf16 v[64:67], a[64:67], v[56:59], v[64:67]
    ds_read_b64_tr_b16 v[48:49], v6 offset:16384
    v_cvt_pk_bf16_f32 v146, v148, v149
    v_mfma_f32_16x16x32_bf16 v[64:67], a[80:83], v[60:63], v[64:67]
    ds_read_b64_tr_b16 v[50:51], v6 offset:16896
    v_cvt_pk_bf16_f32 v147, v150, v151
    v_mfma_f32_16x16x32_bf16 v[68:71], a[84:87], v[60:63], v[68:71]
    ds_read_b64_tr_b16 v[52:53], v6 offset:20480
    v_mfma_f32_16x16x32_bf16 v[68:71], a[68:71], v[56:59], v[68:71]
    ds_read_b64_tr_b16 v[54:55], v6 offset:20992
    v_mfma_f32_16x16x32_bf16 v[72:75], a[72:75], v[56:59], v[72:75]
    v_mfma_f32_16x16x32_bf16 v[72:75], a[88:91], v[60:63], v[72:75]
    buffer_load_dwordx4 a[28:31], v1, s[44:47], s58 offen offset:3072 sc1
    v_mfma_f32_16x16x32_bf16 v[76:79], a[92:95], v[60:63], v[76:79]
    s_add_u32 s57, s57, 4096
    v_mfma_f32_16x16x32_bf16 v[76:79], a[76:79], v[56:59], v[76:79]
    s_waitcnt lgkmcnt(4)
    v_mfma_f32_16x16x32_bf16 v[92:95], a[76:79], v[40:43], v[92:95]
    s_add_u32 s58, s58, 4096
    ds_read_b64_tr_b16 v[56:57], v7 offset:16384
    v_mfma_f32_16x16x32_bf16 v[92:95], a[92:95], v[44:47], v[92:95]
    ds_read_b64_tr_b16 v[58:59], v7 offset:16896
    v_mfma_f32_16x16x32_bf16 v[88:91], a[88:91], v[44:47], v[88:91]
    ds_read_b64_tr_b16 v[60:61], v7 offset:20480
    v_mfma_f32_16x16x32_bf16 v[88:91], a[72:75], v[40:43], v[88:91]
    ds_read_b64_tr_b16 v[62:63], v7 offset:20992
    v_mfma_f32_16x16x32_bf16 v[84:87], a[68:71], v[40:43], v[84:87]
    buffer_load_dwordx4 a[32:35], v1, s[44:47], s57 offen offset:0 sc1
    v_mfma_f32_16x16x32_bf16 v[84:87], a[84:87], v[44:47], v[84:87]
    s_add_u32 s61, s68, 16384
    v_mfma_f32_16x16x32_bf16 v[80:83], a[80:83], v[44:47], v[80:83]
    v_mfma_f32_16x16x32_bf16 v[80:83], a[64:67], v[40:43], v[80:83]
    s_waitcnt lgkmcnt(4)
    buffer_load_dwordx4 a[36:39], v1, s[44:47], s57 offen offset:1024 sc1
    v_mfma_f32_16x16x32_bf16 v[96:99], a[64:67], v[48:51], v[96:99]
    ds_read_b64_tr_b16 v[40:41], v4 offset:24576
    v_mfma_f32_16x16x32_bf16 v[96:99], a[80:83], v[52:55], v[96:99]
    ds_read_b64_tr_b16 v[42:43], v4 offset:25088
    v_mfma_f32_16x16x32_bf16 v[100:103], a[84:87], v[52:55], v[100:103]
    ds_read_b64_tr_b16 v[44:45], v4 offset:28672
    v_mfma_f32_16x16x32_bf16 v[100:103], a[68:71], v[48:51], v[100:103]
    ds_read_b64_tr_b16 v[46:47], v4 offset:29184
    v_mfma_f32_16x16x32_bf16 v[104:107], a[72:75], v[48:51], v[104:107]
    v_mfma_f32_16x16x32_bf16 v[104:107], a[88:91], v[52:55], v[104:107]
    buffer_load_dwordx4 a[40:43], v1, s[44:47], s58 offen offset:0 sc1
    v_mfma_f32_16x16x32_bf16 v[108:111], a[92:95], v[52:55], v[108:111]
    v_mfma_f32_16x16x32_bf16 v[108:111], a[76:79], v[48:51], v[108:111]
    s_waitcnt lgkmcnt(4)
    buffer_store_dwordx4 v[232:235], v1, s[44:47], s61 offen offset:3072 sc1
    v_mfma_f32_16x16x32_bf16 v[124:127], a[76:79], v[56:59], v[124:127]
    ds_read_b64_tr_b16 v[48:49], v5 offset:24576
    v_mfma_f32_16x16x32_bf16 v[124:127], a[92:95], v[60:63], v[124:127]
    ds_read_b64_tr_b16 v[50:51], v5 offset:25088
    v_mfma_f32_16x16x32_bf16 v[120:123], a[88:91], v[60:63], v[120:123]
    ds_read_b64_tr_b16 v[52:53], v5 offset:28672
    v_cvt_pk_bf16_f32 v152, v152, v153
    v_mfma_f32_16x16x32_bf16 v[120:123], a[72:75], v[56:59], v[120:123]
    ds_read_b64_tr_b16 v[54:55], v5 offset:29184
    v_cvt_pk_bf16_f32 v153, v154, v155
    v_mfma_f32_16x16x32_bf16 v[116:119], a[68:71], v[56:59], v[116:119]
    buffer_load_dwordx4 a[44:47], v1, s[44:47], s58 offen offset:1024 sc1
    v_mfma_f32_16x16x32_bf16 v[116:119], a[84:87], v[60:63], v[116:119]
    v_cvt_pk_bf16_f32 v154, v156, v157
    v_cvt_pk_bf16_f32 v155, v158, v159
    v_mfma_f32_16x16x32_bf16 v[112:115], a[80:83], v[60:63], v[112:115]
    v_mfma_f32_16x16x32_bf16 v[112:115], a[64:67], v[56:59], v[112:115]
    s_waitcnt lgkmcnt(4)
    buffer_load_dwordx4 a[48:51], v1, s[44:47], s57 offen offset:2048 sc1
    v_mfma_f32_16x16x32_bf16 v[64:67], a[96:99], v[40:43], v[64:67]
    ds_read_b64_tr_b16 v[56:57], v6 offset:24576
    v_mfma_f32_16x16x32_bf16 v[64:67], a[112:115], v[44:47], v[64:67]
    ds_read_b64_tr_b16 v[58:59], v6 offset:25088
    v_mfma_f32_16x16x32_bf16 v[68:71], a[116:119], v[44:47], v[68:71]
    ds_read_b64_tr_b16 v[60:61], v6 offset:28672
    v_mfma_f32_16x16x32_bf16 v[68:71], a[100:103], v[40:43], v[68:71]
    ds_read_b64_tr_b16 v[62:63], v6 offset:29184
    v_mfma_f32_16x16x32_bf16 v[72:75], a[104:107], v[40:43], v[72:75]
    buffer_load_dwordx4 a[52:55], v1, s[44:47], s57 offen offset:3072 sc1
    v_mfma_f32_16x16x32_bf16 v[72:75], a[120:123], v[44:47], v[72:75]
    v_mfma_f32_16x16x32_bf16 v[76:79], a[124:127], v[44:47], v[76:79]
    v_mfma_f32_16x16x32_bf16 v[76:79], a[108:111], v[40:43], v[76:79]
    s_waitcnt lgkmcnt(4)
    v_mfma_f32_16x16x32_bf16 v[92:95], a[108:111], v[48:51], v[92:95]
    ds_read_b64_tr_b16 v[40:41], v7 offset:24576
    v_mfma_f32_16x16x32_bf16 v[92:95], a[124:127], v[52:55], v[92:95]
    ds_read_b64_tr_b16 v[42:43], v7 offset:25088
    v_mfma_f32_16x16x32_bf16 v[88:91], a[120:123], v[52:55], v[88:91]
    ds_read_b64_tr_b16 v[44:45], v7 offset:28672
    v_mfma_f32_16x16x32_bf16 v[88:91], a[104:107], v[48:51], v[88:91]
    ds_read_b64_tr_b16 v[46:47], v7 offset:29184
    v_mfma_f32_16x16x32_bf16 v[84:87], a[100:103], v[48:51], v[84:87]
    buffer_load_dwordx4 a[56:59], v1, s[44:47], s58 offen offset:2048 sc1
    v_mfma_f32_16x16x32_bf16 v[84:87], a[116:119], v[52:55], v[84:87]
    v_mfma_f32_16x16x32_bf16 v[80:83], a[112:115], v[52:55], v[80:83]
    s_waitcnt lgkmcnt(0)
    v_mfma_f32_16x16x32_bf16 v[80:83], a[96:99], v[48:51], v[80:83]
    s_barrier
    buffer_load_dwordx4 a[60:63], v1, s[44:47], s58 offen offset:3072 sc1
    v_mfma_f32_16x16x32_bf16 v[96:99], a[96:99], v[56:59], v[96:99]
    s_add_u32 s58, s1, 1
    ds_read_b64_tr_b16 v[48:49], v4 offset:32768
    v_mfma_f32_16x16x32_bf16 v[96:99], a[112:115], v[60:63], v[96:99]
    s_and_b32 s58, s58, 3
    ds_read_b64_tr_b16 v[50:51], v4 offset:33280
    v_mfma_f32_16x16x32_bf16 v[100:103], a[116:119], v[60:63], v[100:103]
    s_mul_i32 s58, s58, 8192
    ds_read_b64_tr_b16 v[52:53], v4 offset:36864
    v_mfma_f32_16x16x32_bf16 v[100:103], a[100:103], v[56:59], v[100:103]
    s_add_u32 s57, s58, s73
    ds_read_b64_tr_b16 v[54:55], v4 offset:37376
    v_mfma_f32_16x16x32_bf16 v[104:107], a[104:107], v[56:59], v[104:107]
    s_add_u32 s58, s58, s74
    v_mfma_f32_16x16x32_bf16 v[104:107], a[120:123], v[60:63], v[104:107]
    s_add_u32 s61, s68, 20480
    buffer_load_dwordx4 a[64:67], v1, s[44:47], s57 offen offset:0 sc1
    v_mfma_f32_16x16x32_bf16 v[108:111], a[124:127], v[60:63], v[108:111]
    v_cvt_pk_bf16_f32 v160, v160, v161
    v_cvt_pk_bf16_f32 v161, v162, v163
    v_mfma_f32_16x16x32_bf16 v[108:111], a[108:111], v[56:59], v[108:111]
    buffer_store_dwordx4 v[240:243], v1, s[44:47], s61 offen offset:2048 sc1
    v_mfma_f32_16x16x32_bf16 v[124:127], a[108:111], v[40:43], v[124:127]
    ds_read_b64_tr_b16 v[56:57], v5 offset:32768
    v_cvt_pk_bf16_f32 v162, v164, v165
    v_mfma_f32_16x16x32_bf16 v[124:127], a[124:127], v[44:47], v[124:127]
    ds_read_b64_tr_b16 v[58:59], v5 offset:33280
    v_cvt_pk_bf16_f32 v163, v166, v167
    v_mfma_f32_16x16x32_bf16 v[120:123], a[120:123], v[44:47], v[120:123]
    ds_read_b64_tr_b16 v[60:61], v5 offset:36864
    v_mfma_f32_16x16x32_bf16 v[120:123], a[104:107], v[40:43], v[120:123]
    ds_read_b64_tr_b16 v[62:63], v5 offset:37376
    v_mfma_f32_16x16x32_bf16 v[116:119], a[100:103], v[40:43], v[116:119]
    buffer_load_dwordx4 a[68:71], v1, s[44:47], s57 offen offset:1024 sc1
    v_mfma_f32_16x16x32_bf16 v[116:119], a[116:119], v[44:47], v[116:119]
    v_mfma_f32_16x16x32_bf16 v[112:115], a[112:115], v[44:47], v[112:115]
    v_mfma_f32_16x16x32_bf16 v[112:115], a[96:99], v[40:43], v[112:115]
    s_waitcnt lgkmcnt(4)
    buffer_load_dwordx4 a[72:75], v1, s[44:47], s58 offen offset:0 sc1
    v_mfma_f32_16x16x32_bf16 v[64:67], a[128:131], v[48:51], v[64:67]
    ds_read_b64_tr_b16 v[40:41], v6 offset:32768
    v_mfma_f32_16x16x32_bf16 v[64:67], a[144:147], v[52:55], v[64:67]
    ds_read_b64_tr_b16 v[42:43], v6 offset:33280
    v_mfma_f32_16x16x32_bf16 v[68:71], a[148:151], v[52:55], v[68:71]
    ds_read_b64_tr_b16 v[44:45], v6 offset:36864
    v_mfma_f32_16x16x32_bf16 v[68:71], a[132:135], v[48:51], v[68:71]
    ds_read_b64_tr_b16 v[46:47], v6 offset:37376
    v_mfma_f32_16x16x32_bf16 v[72:75], a[136:139], v[48:51], v[72:75]
    buffer_load_dwordx4 a[76:79], v1, s[44:47], s58 offen offset:1024 sc1
    v_mfma_f32_16x16x32_bf16 v[72:75], a[152:155], v[52:55], v[72:75]
    v_mfma_f32_16x16x32_bf16 v[76:79], a[156:159], v[52:55], v[76:79]
    v_mfma_f32_16x16x32_bf16 v[76:79], a[140:143], v[48:51], v[76:79]
    s_waitcnt lgkmcnt(4)
    v_mfma_f32_16x16x32_bf16 v[92:95], a[140:143], v[56:59], v[92:95]
    ds_read_b64_tr_b16 v[48:49], v7 offset:32768
    v_mfma_f32_16x16x32_bf16 v[92:95], a[156:159], v[60:63], v[92:95]
    ds_read_b64_tr_b16 v[50:51], v7 offset:33280
    v_mfma_f32_16x16x32_bf16 v[88:91], a[152:155], v[60:63], v[88:91]
    ds_read_b64_tr_b16 v[52:53], v7 offset:36864
    v_mfma_f32_16x16x32_bf16 v[88:91], a[136:139], v[56:59], v[88:91]
    ds_read_b64_tr_b16 v[54:55], v7 offset:37376
    v_mfma_f32_16x16x32_bf16 v[84:87], a[132:135], v[56:59], v[84:87]
    buffer_load_dwordx4 a[80:83], v1, s[44:47], s57 offen offset:2048 sc1
    v_mfma_f32_16x16x32_bf16 v[84:87], a[148:151], v[60:63], v[84:87]
    v_mfma_f32_16x16x32_bf16 v[80:83], a[144:147], v[60:63], v[80:83]
    v_mfma_f32_16x16x32_bf16 v[80:83], a[128:131], v[56:59], v[80:83]
    s_waitcnt lgkmcnt(4)
    buffer_load_dwordx4 a[84:87], v1, s[44:47], s57 offen offset:3072 sc1
    v_mfma_f32_16x16x32_bf16 v[96:99], a[128:131], v[40:43], v[96:99]
    ds_read_b64_tr_b16 v[56:57], v4 offset:40960
    v_mfma_f32_16x16x32_bf16 v[96:99], a[144:147], v[44:47], v[96:99]
    ds_read_b64_tr_b16 v[58:59], v4 offset:41472
    v_mfma_f32_16x16x32_bf16 v[100:103], a[148:151], v[44:47], v[100:103]
    ds_read_b64_tr_b16 v[60:61], v4 offset:45056
    v_cvt_pk_bf16_f32 v168, v168, v169
    v_mfma_f32_16x16x32_bf16 v[100:103], a[132:135], v[40:43], v[100:103]
K_PG3:
    s_cmp_eq_u32 s100, 1
    s_cbranch_scc1 K_PG7
    ds_read_b64_tr_b16 v[62:63], v4 offset:45568
    v_cvt_pk_bf16_f32 v169, v170, v171
    v_mfma_f32_16x16x32_bf16 v[104:107], a[136:139], v[40:43], v[104:107]
    buffer_load_dwordx4 a[88:91], v1, s[44:47], s58 offen offset:2048 sc1
    v_mfma_f32_16x16x32_bf16 v[104:107], a[152:155], v[44:47], v[104:107]
    s_add_u32 s61, s68, 20480
    v_cvt_pk_bf16_f32 v170, v172, v173
    v_cvt_pk_bf16_f32 v171, v174, v175
    v_mfma_f32_16x16x32_bf16 v[108:111], a[156:159], v[44:47], v[108:111]
    buffer_store_dwordx4 v[248:251], v1, s[44:47], s61 offen offset:3072 sc1
    v_mfma_f32_16x16x32_bf16 v[108:111], a[140:143], v[40:43], v[108:111]
    s_waitcnt lgkmcnt(4)
    v_mfma_f32_16x16x32_bf16 v[124:127], a[140:143], v[48:51], v[124:127]
    ds_read_b64_tr_b16 v[40:41], v5 offset:40960
    v_mfma_f32_16x16x32_bf16 v[124:127], a[156:159], v[52:55], v[124:127]
    ds_read_b64_tr_b16 v[42:43], v5 offset:41472
    v_mfma_f32_16x16x32_bf16 v[120:123], a[152:155], v[52:55], v[120:123]
    ds_read_b64_tr_b16 v[44:45], v5 offset:45056
    v_mfma_f32_16x16x32_bf16 v[120:123], a[136:139], v[48:51], v[120:123]
    ds_read_b64_tr_b16 v[46:47], v5 offset:45568
    v_mfma_f32_16x16x32_bf16 v[116:119], a[132:135], v[48:51], v[116:119]
    buffer_load_dwordx4 a[92:95], v1, s[44:47], s58 offen offset:3072 sc1
    v_mfma_f32_16x16x32_bf16 v[116:119], a[148:151], v[52:55], v[116:119]
    s_add_u32 s57, s57, 4096
    v_mfma_f32_16x16x32_bf16 v[112:115], a[144:147], v[52:55], v[112:115]
    s_add_u32 s58, s58, 4096
    v_mfma_f32_16x16x32_bf16 v[112:115], a[128:131], v[48:51], v[112:115]
    s_waitcnt lgkmcnt(4)
    buffer_load_dwordx4 a[96:99], v1, s[44:47], s57 offen offset:0 sc1
    v_mfma_f32_16x16x32_bf16 v[64:67], a[160:163], v[56:59], v[64:67]
    ds_read_b64_tr_b16 v[48:49], v6 offset:40960
    v_mfma_f32_16x16x32_bf16 v[64:67], a[176:179], v[60:63], v[64:67]
    ds_read_b64_tr_b16 v[50:51], v6 offset:41472
    v_mfma_f32_16x16x32_bf16 v[68:71], a[180:183], v[60:63], v[68:71]
    ds_read_b64_tr_b16 v[52:53], v6 offset:45056
    v_mfma_f32_16x16x32_bf16 v[68:71], a[164:167], v[56:59], v[68:71]
    ds_read_b64_tr_b16 v[54:55], v6 offset:45568
    v_mfma_f32_16x16x32_bf16 v[72:75], a[168:171], v[56:59], v[72:75]
    buffer_load_dwordx4 a[100:103], v1, s[44:47], s57 offen offset:1024 sc1
    v_mfma_f32_16x16x32_bf16 v[72:75], a[184:187], v[60:63], v[72:75]
    v_mfma_f32_16x16x32_bf16 v[76:79], a[188:191], v[60:63], v[76:79]
    v_mfma_f32_16x16x32_bf16 v[76:79], a[172:175], v[56:59], v[76:79]
    s_waitcnt lgkmcnt(4)
    v_mfma_f32_16x16x32_bf16 v[92:95], a[172:175], v[40:43], v[92:95]
    ds_read_b64_tr_b16 v[56:57], v7 offset:40960
    v_mfma_f32_16x16x32_bf16 v[92:95], a[188:191], v[44:47], v[92:95]
    ds_read_b64_tr_b16 v[58:59], v7 offset:41472
    v_mfma_f32_16x16x32_bf16 v[88:91], a[184:187], v[44:47], v[88:91]
    ds_read_b64_tr_b16 v[60:61], v7 offset:45056
    v_mfma_f32_16x16x32_bf16 v[88:91], a[168:171], v[40:43], v[88:91]
    ds_read_b64_tr_b16 v[62:63], v7 offset:45568
    v_mfma_f32_16x16x32_bf16 v[84:87], a[164:167], v[40:43], v[84:87]
    buffer_load_dwordx4 a[104:107], v1, s[44:47], s58 offen offset:0 sc1
    v_mfma_f32_16x16x32_bf16 v[84:87], a[180:183], v[44:47], v[84:87]
    v_mfma_f32_16x16x32_bf16 v[80:83], a[176:179], v[44:47], v[80:83]
    s_waitcnt lgkmcnt(0)
    v_cvt_pk_bf16_f32 v176, v176, v177
    v_cvt_pk_bf16_f32 v177, v178, v179
    v_mfma_f32_16x16x32_bf16 v[80:83], a[160:163], v[40:43], v[80:83]
    s_barrier
    buffer_load_dwordx4 a[108:111], v1, s[44:47], s58 offen offset:1024 sc1
    v_mfma_f32_16x16x32_bf16 v[96:99], a[160:163], v[48:51], v[96:99]
    ds_read_b64_tr_b16 v[40:41], v4 offset:49152
    v_cvt_pk_bf16_f32 v178, v180, v181
    v_mfma_f32_16x16x32_bf16 v[96:99], a[176:179], v[52:55], v[96:99]
    ds_read_b64_tr_b16 v[42:43], v4 offset:49664
    v_cvt_pk_bf16_f32 v179, v182, v183
    v_mfma_f32_16x16x32_bf16 v[100:103], a[180:183], v[52:55], v[100:103]
    ds_read_b64_tr_b16 v[44:45], v4 offset:53248
    v_mfma_f32_16x16x32_bf16 v[100:103], a[164:167], v[48:51], v[100:103]
    ds_read_b64_tr_b16 v[46:47], v4 offset:53760
    v_mfma_f32_16x16x32_bf16 v[104:107], a[168:171], v[48:51], v[104:107]
    buffer_load_dwordx4 a[112:115], v1, s[44:47], s57 offen offset:2048 sc1
    v_mfma_f32_16x16x32_bf16 v[104:107], a[184:187], v[52:55], v[104:107]
    v_mfma_f32_16x16x32_bf16 v[108:111], a[188:191], v[52:55], v[108:111]
    v_mfma_f32_16x16x32_bf16 v[108:111], a[172:175], v[48:51], v[108:111]
    v_mfma_f32_16x16x32_bf16 v[124:127], a[172:175], v[56:59], v[124:127]
    ds_read_b64_tr_b16 v[48:49], v5 offset:49152
    v_mfma_f32_16x16x32_bf16 v[124:127], a[188:191], v[60:63], v[124:127]
    ds_read_b64_tr_b16 v[50:51], v5 offset:49664
    v_mfma_f32_16x16x32_bf16 v[120:123], a[184:187], v[60:63], v[120:123]
    ds_read_b64_tr_b16 v[52:53], v5 offset:53248
    v_mfma_f32_16x16x32_bf16 v[120:123], a[168:171], v[56:59], v[120:123]
    ds_read_b64_tr_b16 v[54:55], v5 offset:53760
    v_mfma_f32_16x16x32_bf16 v[116:119], a[164:167], v[56:59], v[116:119]
    buffer_load_dwordx4 a[116:119], v1, s[44:47], s57 offen offset:3072 sc1
    v_mfma_f32_16x16x32_bf16 v[116:119], a[180:183], v[60:63], v[116:119]
    v_mfma_f32_16x16x32_bf16 v[112:115], a[176:179], v[60:63], v[112:115]
    v_mfma_f32_16x16x32_bf16 v[112:115], a[160:163], v[56:59], v[112:115]
    s_waitcnt lgkmcnt(4)
    buffer_load_dwordx4 a[120:123], v1, s[44:47], s58 offen offset:2048 sc1
    v_mfma_f32_16x16x32_bf16 v[64:67], a[192:195], v[40:43], v[64:67]
    s_add_u32 s61, s68, 8192
    ds_read_b64_tr_b16 v[56:57], v6 offset:49152
    v_mfma_f32_16x16x32_bf16 v[64:67], a[208:211], v[44:47], v[64:67]
    ds_read_b64_tr_b16 v[58:59], v6 offset:49664
    v_mfma_f32_16x16x32_bf16 v[68:71], a[212:215], v[44:47], v[68:71]
    ds_read_b64_tr_b16 v[60:61], v6 offset:53248
    v_mfma_f32_16x16x32_bf16 v[68:71], a[196:199], v[40:43], v[68:71]
    ds_read_b64_tr_b16 v[62:63], v6 offset:53760
    v_mfma_f32_16x16x32_bf16 v[72:75], a[200:203], v[40:43], v[72:75]
    buffer_load_dwordx4 a[124:127], v1, s[44:47], s58 offen offset:3072 sc1
    v_mfma_f32_16x16x32_bf16 v[72:75], a[216:219], v[44:47], v[72:75]
    s_add_u32 s58, s1, 2
    v_mfma_f32_16x16x32_bf16 v[76:79], a[220:223], v[44:47], v[76:79]
    s_and_b32 s58, s58, 3
    buffer_store_dwordx4 v[128:131], v1, s[44:47], s61 offen offset:0 sc1
    v_mfma_f32_16x16x32_bf16 v[76:79], a[204:207], v[40:43], v[76:79]
    s_waitcnt lgkmcnt(4)
    v_mfma_f32_16x16x32_bf16 v[92:95], a[204:207], v[48:51], v[92:95]
    s_mul_i32 s58, s58, 8192
    ds_read_b64_tr_b16 v[40:41], v7 offset:49152
    v_mfma_f32_16x16x32_bf16 v[92:95], a[220:223], v[52:55], v[92:95]
    s_add_u32 s57, s58, s73
    ds_read_b64_tr_b16 v[42:43], v7 offset:49664
    v_mfma_f32_16x16x32_bf16 v[88:91], a[216:219], v[52:55], v[88:91]
    s_add_u32 s58, s58, s74
    ds_read_b64_tr_b16 v[44:45], v7 offset:53248
    v_cvt_pk_bf16_f32 v184, v184, v185
    v_mfma_f32_16x16x32_bf16 v[88:91], a[200:203], v[48:51], v[88:91]
    ds_read_b64_tr_b16 v[46:47], v7 offset:53760
    v_cvt_pk_bf16_f32 v185, v186, v187
    v_mfma_f32_16x16x32_bf16 v[84:87], a[196:199], v[48:51], v[84:87]
    buffer_load_dwordx4 a[128:131], v1, s[44:47], s57 offen offset:0 sc1
    v_mfma_f32_16x16x32_bf16 v[84:87], a[212:215], v[52:55], v[84:87]
    v_cvt_pk_bf16_f32 v186, v188, v189
    v_cvt_pk_bf16_f32 v187, v190, v191
    v_mfma_f32_16x16x32_bf16 v[80:83], a[208:211], v[52:55], v[80:83]
    buffer_load_dwordx4 a[132:135], v1, s[44:47], s57 offen offset:1024 sc1
    v_mfma_f32_16x16x32_bf16 v[80:83], a[192:195], v[48:51], v[80:83]
    s_waitcnt lgkmcnt(4)
    v_mfma_f32_16x16x32_bf16 v[96:99], a[192:195], v[56:59], v[96:99]
    ds_read_b64_tr_b16 v[48:49], v4 offset:57344
    v_mfma_f32_16x16x32_bf16 v[96:99], a[208:211], v[60:63], v[96:99]
    ds_read_b64_tr_b16 v[50:51], v4 offset:57856
    v_mfma_f32_16x16x32_bf16 v[100:103], a[212:215], v[60:63], v[100:103]
    ds_read_b64_tr_b16 v[52:53], v4 offset:61440
    v_mfma_f32_16x16x32_bf16 v[100:103], a[196:199], v[56:59], v[100:103]
    ds_read_b64_tr_b16 v[54:55], v4 offset:61952
    v_mfma_f32_16x16x32_bf16 v[104:107], a[200:203], v[56:59], v[104:107]
    v_xor_b32 v4, 0x10000, v4
    v_mfma_f32_16x16x32_bf16 v[104:107], a[216:219], v[60:63], v[104:107]
    buffer_load_dwordx4 a[136:139], v1, s[44:47], s58 offen offset:0 sc1
    v_mfma_f32_16x16x32_bf16 v[108:111], a[220:223], v[60:63], v[108:111]
    v_mfma_f32_16x16x32_bf16 v[108:111], a[204:207], v[56:59], v[108:111]
    s_waitcnt lgkmcnt(4)
    v_mfma_f32_16x16x32_bf16 v[124:127], a[204:207], v[40:43], v[124:127]
    ds_read_b64_tr_b16 v[56:57], v5 offset:57344
    v_mfma_f32_16x16x32_bf16 v[124:127], a[220:223], v[44:47], v[124:127]
    ds_read_b64_tr_b16 v[58:59], v5 offset:57856
    v_mfma_f32_16x16x32_bf16 v[120:123], a[216:219], v[44:47], v[120:123]
    ds_read_b64_tr_b16 v[60:61], v5 offset:61440
    v_mfma_f32_16x16x32_bf16 v[120:123], a[200:203], v[40:43], v[120:123]
    ds_read_b64_tr_b16 v[62:63], v5 offset:61952
    v_mfma_f32_16x16x32_bf16 v[116:119], a[196:199], v[40:43], v[116:119]
    v_xor_b32 v5, 0x10000, v5
    v_mfma_f32_16x16x32_bf16 v[116:119], a[212:215], v[44:47], v[116:119]
    buffer_load_dwordx4 a[140:143], v1, s[44:47], s58 offen offset:1024 sc1
    v_mfma_f32_16x16x32_bf16 v[112:115], a[208:211], v[44:47], v[112:115]
    v_mfma_f32_16x16x32_bf16 v[112:115], a[192:195], v[40:43], v[112:115]
    s_waitcnt lgkmcnt(4)
    buffer_load_dwordx4 a[144:147], v1, s[44:47], s57 offen offset:2048 sc1
    v_mfma_f32_16x16x32_bf16 v[64:67], a[224:227], v[48:51], v[64:67]
    ds_read_b64_tr_b16 v[40:41], v6 offset:57344
    v_mfma_f32_16x16x32_bf16 v[192:195], a[240:243], v[52:55], v[64:67]
    ds_read_b64_tr_b16 v[42:43], v6 offset:57856
    v_mfma_f32_16x16x32_bf16 v[68:71], a[244:247], v[52:55], v[68:71]
    s_add_u32 s61, s68, 24576
    ds_read_b64_tr_b16 v[44:45], v6 offset:61440
    v_mfma_f32_16x16x32_bf16 v[196:199], a[228:231], v[48:51], v[68:71]
    ds_read_b64_tr_b16 v[46:47], v6 offset:61952
    v_mfma_f32_16x16x32_bf16 v[72:75], a[232:235], v[48:51], v[72:75]
    v_xor_b32 v6, 0x10000, v6
    v_mfma_f32_16x16x32_bf16 v[200:203], a[248:251], v[52:55], v[72:75]
    buffer_load_dwordx4 a[148:151], v1, s[44:47], s57 offen offset:3072 sc1
    v_mfma_f32_16x16x32_bf16 v[76:79], a[252:255], v[52:55], v[76:79]
    v_mfma_f32_16x16x32_bf16 v[204:207], a[236:239], v[48:51], v[76:79]
    s_waitcnt lgkmcnt(4)
    buffer_store_dwordx4 v[136:139], v1, s[44:47], s61 offen offset:0 sc1
    v_mfma_f32_16x16x32_bf16 v[80:83], a[224:227], v[56:59], v[80:83]
    ds_read_b64_tr_b16 v[48:49], v7 offset:57344
    v_mfma_f32_16x16x32_bf16 v[208:211], a[240:243], v[60:63], v[80:83]
    ds_read_b64_tr_b16 v[50:51], v7 offset:57856
    v_mfma_f32_16x16x32_bf16 v[84:87], a[244:247], v[60:63], v[84:87]
    ds_read_b64_tr_b16 v[52:53], v7 offset:61440
    v_mfma_f32_16x16x32_bf16 v[212:215], a[228:231], v[56:59], v[84:87]
    ds_read_b64_tr_b16 v[54:55], v7 offset:61952
    v_mfma_f32_16x16x32_bf16 v[88:91], a[232:235], v[56:59], v[88:91]
    v_xor_b32 v7, 0x10000, v7
    v_mfma_f32_16x16x32_bf16 v[216:219], a[248:251], v[60:63], v[88:91]
    buffer_load_dwordx4 a[152:155], v1, s[44:47], s58 offen offset:2048 sc1
    v_mfma_f32_16x16x32_bf16 v[92:95], a[252:255], v[60:63], v[92:95]
    s_waitcnt lgkmcnt(0)
    v_mfma_f32_16x16x32_bf16 v[220:223], a[236:239], v[56:59], v[92:95]
    s_barrier
    buffer_load_dwordx4 a[156:159], v1, s[44:47], s58 offen offset:3072 sc1
    v_mfma_f32_16x16x32_bf16 v[96:99], a[224:227], v[40:43], v[96:99]
    s_add_u32 s57, s57, 4096
    ds_read_b64_tr_b16 v[56:57], v4 offset:0
    v_mfma_f32_16x16x32_bf16 v[224:227], a[240:243], v[44:47], v[96:99]
    s_add_u32 s58, s58, 4096
    ds_read_b64_tr_b16 v[58:59], v4 offset:512
    v_mfma_f32_16x16x32_bf16 v[100:103], a[244:247], v[44:47], v[100:103]
    ds_read_b64_tr_b16 v[60:61], v4 offset:4096
    v_mfma_f32_16x16x32_bf16 v[228:231], a[228:231], v[40:43], v[100:103]
    ds_read_b64_tr_b16 v[62:63], v4 offset:4608
    v_mfma_f32_16x16x32_bf16 v[104:107], a[232:235], v[40:43], v[104:107]
    buffer_load_dwordx4 a[160:163], v1, s[44:47], s57 offen offset:0 sc1
    v_mfma_f32_16x16x32_bf16 v[232:235], a[248:251], v[44:47], v[104:107]
    v_mfma_f32_16x16x32_bf16 v[108:111], a[252:255], v[44:47], v[108:111]
    v_mfma_f32_16x16x32_bf16 v[236:239], a[236:239], v[40:43], v[108:111]
    v_mfma_f32_16x16x32_bf16 v[112:115], a[224:227], v[48:51], v[112:115]
    ds_read_b64_tr_b16 v[40:41], v5 offset:0
    v_mfma_f32_16x16x32_bf16 v[240:243], a[240:243], v[52:55], v[112:115]
    ds_read_b64_tr_b16 v[42:43], v5 offset:512
    v_mfma_f32_16x16x32_bf16 v[116:119], a[244:247], v[52:55], v[116:119]
    ds_read_b64_tr_b16 v[44:45], v5 offset:4096
    v_mfma_f32_16x16x32_bf16 v[244:247], a[228:231], v[48:51], v[116:119]
    ds_read_b64_tr_b16 v[46:47], v5 offset:4608
    v_mfma_f32_16x16x32_bf16 v[120:123], a[232:235], v[48:51], v[120:123]
    buffer_load_dwordx4 a[164:167], v1, s[44:47], s57 offen offset:1024 sc1
    v_mfma_f32_16x16x32_bf16 v[248:251], a[248:251], v[52:55], v[120:123]
    v_mfma_f32_16x16x32_bf16 v[124:127], a[252:255], v[52:55], v[124:127]
    buffer_load_dwordx4 a[168:171], v1, s[44:47], s58 offen offset:0 sc1
    v_mfma_f32_16x16x32_bf16 v[252:255], a[236:239], v[48:51], v[124:127]
    s_waitcnt vmcnt(48) lgkmcnt(4)
    v_mfma_f32_16x16x32_bf16 v[64:67], v[56:59], a[0:3], 0
    s_waitcnt vmcnt(44)
    ds_read_b64_tr_b16 v[48:49], v6 offset:0
    v_mfma_f32_16x16x32_bf16 v[64:67], v[60:63], a[16:19], v[64:67]
    s_waitcnt vmcnt(42)
    ds_read_b64_tr_b16 v[50:51], v6 offset:512
    v_mfma_f32_16x16x32_bf16 v[68:71], v[60:63], a[20:23], 0
    ds_read_b64_tr_b16 v[52:53], v6 offset:4096
    v_mfma_f32_16x16x32_bf16 v[68:71], v[56:59], a[4:7], v[68:71]
    ds_read_b64_tr_b16 v[54:55], v6 offset:4608
    v_mfma_f32_16x16x32_bf16 v[72:75], v[56:59], a[8:11], 0
    s_waitcnt vmcnt(41)
    s_add_u32 s61, s68, 8192
    buffer_load_dwordx4 a[172:175], v1, s[44:47], s58 offen offset:1024 sc1
    v_mfma_f32_16x16x32_bf16 v[72:75], v[60:63], a[24:27], v[72:75]
    s_waitcnt vmcnt(41)
    v_mfma_f32_16x16x32_bf16 v[76:79], v[60:63], a[28:31], 0
    buffer_store_dwordx4 v[144:147], v1, s[44:47], s61 offen offset:1024 sc1
    v_mfma_f32_16x16x32_bf16 v[76:79], v[56:59], a[12:15], v[76:79]
    s_waitcnt lgkmcnt(4)
    v_cvt_pk_bf16_f32 v192, v192, v193
    v_cvt_pk_bf16_f32 v193, v194, v195
    v_mfma_f32_16x16x32_bf16 v[92:95], v[40:43], a[12:15], 0
    ds_read_b64_tr_b16 v[56:57], v7 offset:0
    v_cvt_pk_bf16_f32 v194, v196, v197
    v_mfma_f32_16x16x32_bf16 v[92:95], v[44:47], a[28:31], v[92:95]
    ds_read_b64_tr_b16 v[58:59], v7 offset:512
    v_cvt_pk_bf16_f32 v195, v198, v199
    v_mfma_f32_16x16x32_bf16 v[88:91], v[44:47], a[24:27], 0
    ds_read_b64_tr_b16 v[60:61], v7 offset:4096
    v_lshrrev_b32 v36, 4, v0
    v_mfma_f32_16x16x32_bf16 v[88:91], v[40:43], a[8:11], v[88:91]
    ds_read_b64_tr_b16 v[62:63], v7 offset:4608
    v_and_b32 v37, 15, v0
    v_mfma_f32_16x16x32_bf16 v[84:87], v[40:43], a[4:7], 0
    buffer_load_dwordx4 a[176:179], v1, s[44:47], s57 offen offset:2048 sc1
    v_mfma_f32_16x16x32_bf16 v[84:87], v[44:47], a[20:23], v[84:87]
    v_lshlrev_b32 v38, 1, v36
    v_xor_b32 v37, v37, v38
    v_mfma_f32_16x16x32_bf16 v[80:83], v[44:47], a[16:19], 0
    buffer_load_dwordx4 a[180:183], v1, s[44:47], s57 offen offset:3072 sc1
    v_mfma_f32_16x16x32_bf16 v[80:83], v[40:43], a[0:3], v[80:83]
    s_waitcnt lgkmcnt(4)
    v_lshlrev_b32 v37, 4, v37
    v_lshl_add_u32 v18, v36, 10, v37
    v_mfma_f32_16x16x32_bf16 v[96:99], v[48:51], a[0:3], 0
    s_sub_u32 s60, 183, s101
    ds_read_b64_tr_b16 v[40:41], v4 offset:8192
    v_mfma_f32_16x16x32_bf16 v[96:99], v[52:55], a[16:19], v[96:99]
    s_and_b32 s60, s60, 0x40000000
    ds_read_b64_tr_b16 v[42:43], v4 offset:8704
    v_mfma_f32_16x16x32_bf16 v[100:103], v[52:55], a[20:23], 0
    ds_read_b64_tr_b16 v[44:45], v4 offset:12288
    v_or_b32 v18, s60, v18
    v_mfma_f32_16x16x32_bf16 v[100:103], v[48:51], a[4:7], v[100:103]
    ds_read_b64_tr_b16 v[46:47], v4 offset:12800
    v_xor_b32 v19, 128, v18
    v_mfma_f32_16x16x32_bf16 v[104:107], v[48:51], a[8:11], 0
    buffer_load_dwordx4 a[184:187], v1, s[44:47], s58 offen offset:2048 sc1
    v_mfma_f32_16x16x32_bf16 v[104:107], v[52:55], a[24:27], v[104:107]
    v_lshrrev_b32 v36, 2, v0
    v_and_b32 v37, 7, v36
    v_mfma_f32_16x16x32_bf16 v[108:111], v[52:55], a[28:31], 0
    v_lshlrev_b32 v36, 8, v36
    v_lshl_add_u32 v36, v37, 5, v36
    v_mfma_f32_16x16x32_bf16 v[108:111], v[48:51], a[12:15], v[108:111]
    s_waitcnt lgkmcnt(4)
    v_and_b32 v37, 3, v0
    v_lshlrev_b32 v37, 4, v37
    v_mfma_f32_16x16x32_bf16 v[124:127], v[56:59], a[12:15], 0
    ds_read_b64_tr_b16 v[48:49], v5 offset:8192
    v_xor_b32 v36, v37, v36
    v_mfma_f32_16x16x32_bf16 v[124:127], v[60:63], a[28:31], v[124:127]
    s_lshl_b32 s52, s3, 13
    ds_read_b64_tr_b16 v[50:51], v5 offset:8704
    v_mfma_f32_16x16x32_bf16 v[120:123], v[60:63], a[24:27], 0
    s_add_u32 s52, s52, 131072
    ds_read_b64_tr_b16 v[52:53], v5 offset:12288
    v_mfma_f32_16x16x32_bf16 v[120:123], v[56:59], a[8:11], v[120:123]
    ds_read_b64_tr_b16 v[54:55], v5 offset:12800
    v_add_u32 v32, s52, v36
    v_mfma_f32_16x16x32_bf16 v[116:119], v[56:59], a[4:7], 0
    buffer_load_dwordx4 a[188:191], v1, s[44:47], s58 offen offset:3072 sc1
    v_mfma_f32_16x16x32_bf16 v[116:119], v[60:63], a[20:23], v[116:119]
    s_add_u32 s58, s1, 3
    v_mfma_f32_16x16x32_bf16 v[112:115], v[60:63], a[16:19], 0
    s_and_b32 s58, s58, 3
    v_mfma_f32_16x16x32_bf16 v[112:115], v[56:59], a[0:3], v[112:115]
    s_waitcnt vmcnt(45) lgkmcnt(4)
    v_mfma_f32_16x16x32_bf16 v[64:67], v[40:43], a[32:35], v[64:67]
    s_waitcnt vmcnt(40)
    s_mul_i32 s58, s58, 8192
    ds_read_b64_tr_b16 v[56:57], v6 offset:8192
    v_mfma_f32_16x16x32_bf16 v[64:67], v[44:47], a[48:51], v[64:67]
    s_waitcnt vmcnt(39)
    s_add_u32 s57, s58, s73
    ds_read_b64_tr_b16 v[58:59], v6 offset:8704
    v_mfma_f32_16x16x32_bf16 v[68:71], v[44:47], a[52:55], v[68:71]
    s_add_u32 s58, s58, s74
    ds_read_b64_tr_b16 v[60:61], v6 offset:12288
    v_cvt_pk_bf16_f32 v200, v200, v201
    v_mfma_f32_16x16x32_bf16 v[68:71], v[40:43], a[36:39], v[68:71]
    ds_read_b64_tr_b16 v[62:63], v6 offset:12800
    v_cvt_pk_bf16_f32 v201, v202, v203
    v_mfma_f32_16x16x32_bf16 v[72:75], v[40:43], a[40:43], v[72:75]
    s_waitcnt vmcnt(38)
    buffer_load_dwordx4 a[192:195], v1, s[44:47], s57 offen offset:0 sc1
    v_mfma_f32_16x16x32_bf16 v[72:75], v[44:47], a[56:59], v[72:75]
    s_waitcnt vmcnt(38)
    v_cvt_pk_bf16_f32 v202, v204, v205
    v_cvt_pk_bf16_f32 v203, v206, v207
    v_mfma_f32_16x16x32_bf16 v[76:79], v[44:47], a[60:63], v[76:79]
    s_add_u32 s61, s68, 24576
    buffer_load_dwordx4 a[196:199], v1, s[44:47], s57 offen offset:1024 sc1
    v_mfma_f32_16x16x32_bf16 v[76:79], v[40:43], a[44:47], v[76:79]
    s_waitcnt lgkmcnt(4)
    v_mfma_f32_16x16x32_bf16 v[92:95], v[48:51], a[44:47], v[92:95]
    ds_read_b64_tr_b16 v[40:41], v7 offset:8192
    v_mfma_f32_16x16x32_bf16 v[92:95], v[52:55], a[60:63], v[92:95]
    ds_read_b64_tr_b16 v[42:43], v7 offset:8704
    v_mfma_f32_16x16x32_bf16 v[88:91], v[52:55], a[56:59], v[88:91]
    ds_read_b64_tr_b16 v[44:45], v7 offset:12288
    v_mfma_f32_16x16x32_bf16 v[88:91], v[48:51], a[40:43], v[88:91]
    ds_read_b64_tr_b16 v[46:47], v7 offset:12800
    v_mfma_f32_16x16x32_bf16 v[84:87], v[48:51], a[36:39], v[84:87]
    buffer_load_dwordx4 a[200:203], v1, s[44:47], s58 offen offset:0 sc1
    v_mfma_f32_16x16x32_bf16 v[84:87], v[52:55], a[52:55], v[84:87]
    v_mfma_f32_16x16x32_bf16 v[80:83], v[52:55], a[48:51], v[80:83]
    s_waitcnt lgkmcnt(0)
    buffer_load_dwordx4 a[204:207], v1, s[44:47], s58 offen offset:1024 sc1
    v_mfma_f32_16x16x32_bf16 v[80:83], v[48:51], a[32:35], v[80:83]
    s_barrier
    v_mfma_f32_16x16x32_bf16 v[96:99], v[56:59], a[32:35], v[96:99]
    ds_read_b64_tr_b16 v[48:49], v4 offset:16384
    v_mfma_f32_16x16x32_bf16 v[96:99], v[60:63], a[48:51], v[96:99]
    ds_read_b64_tr_b16 v[50:51], v4 offset:16896
    v_mfma_f32_16x16x32_bf16 v[100:103], v[60:63], a[52:55], v[100:103]
    ds_read_b64_tr_b16 v[52:53], v4 offset:20480
    v_mfma_f32_16x16x32_bf16 v[100:103], v[56:59], a[36:39], v[100:103]
    ds_read_b64_tr_b16 v[54:55], v4 offset:20992
    v_mfma_f32_16x16x32_bf16 v[104:107], v[56:59], a[40:43], v[104:107]
    buffer_load_dwordx4 a[208:211], v1, s[44:47], s57 offen offset:2048 sc1
    v_mfma_f32_16x16x32_bf16 v[104:107], v[60:63], a[56:59], v[104:107]
    v_mfma_f32_16x16x32_bf16 v[108:111], v[60:63], a[60:63], v[108:111]
    buffer_store_dwordx4 v[152:155], v1, s[44:47], s61 offen offset:1024 sc1
    v_mfma_f32_16x16x32_bf16 v[108:111], v[56:59], a[44:47], v[108:111]
    v_mfma_f32_16x16x32_bf16 v[124:127], v[40:43], a[44:47], v[124:127]
    ds_read_b64_tr_b16 v[56:57], v5 offset:16384
    v_mfma_f32_16x16x32_bf16 v[124:127], v[44:47], a[60:63], v[124:127]
    ds_read_b64_tr_b16 v[58:59], v5 offset:16896
    v_mfma_f32_16x16x32_bf16 v[120:123], v[44:47], a[56:59], v[120:123]
    ds_read_b64_tr_b16 v[60:61], v5 offset:20480
    v_mfma_f32_16x16x32_bf16 v[120:123], v[40:43], a[40:43], v[120:123]
    ds_read_b64_tr_b16 v[62:63], v5 offset:20992
    v_mfma_f32_16x16x32_bf16 v[116:119], v[40:43], a[36:39], v[116:119]
    buffer_load_dwordx4 a[212:215], v1, s[44:47], s57 offen offset:3072 sc1
    v_mfma_f32_16x16x32_bf16 v[116:119], v[44:47], a[52:55], v[116:119]
    v_mfma_f32_16x16x32_bf16 v[112:115], v[44:47], a[48:51], v[112:115]
    buffer_load_dwordx4 a[216:219], v1, s[44:47], s58 offen offset:2048 sc1
    v_mfma_f32_16x16x32_bf16 v[112:115], v[40:43], a[32:35], v[112:115]
    s_waitcnt vmcnt(44) lgkmcnt(4)
    v_cvt_pk_bf16_f32 v208, v208, v209
    v_cvt_pk_bf16_f32 v209, v210, v211
    v_mfma_f32_16x16x32_bf16 v[64:67], v[48:51], a[64:67], v[64:67]
    s_waitcnt vmcnt(39)
    ds_read_b64_tr_b16 v[40:41], v6 offset:16384
    v_cvt_pk_bf16_f32 v210, v212, v213
    v_mfma_f32_16x16x32_bf16 v[64:67], v[52:55], a[80:83], v[64:67]
    s_waitcnt vmcnt(38)
    ds_read_b64_tr_b16 v[42:43], v6 offset:16896
    v_cvt_pk_bf16_f32 v211, v214, v215
    v_mfma_f32_16x16x32_bf16 v[68:71], v[52:55], a[84:87], v[68:71]
    ds_read_b64_tr_b16 v[44:45], v6 offset:20480
    v_mfma_f32_16x16x32_bf16 v[68:71], v[48:51], a[68:71], v[68:71]
    ds_read_b64_tr_b16 v[46:47], v6 offset:20992
    v_mfma_f32_16x16x32_bf16 v[72:75], v[48:51], a[72:75], v[72:75]
    s_waitcnt vmcnt(37)
    buffer_load_dwordx4 a[220:223], v1, s[44:47], s58 offen offset:3072 sc1
    v_mfma_f32_16x16x32_bf16 v[72:75], v[52:55], a[88:91], v[72:75]
    s_waitcnt vmcnt(36)
    s_add_u32 s57, s57, 4096
    v_mfma_f32_16x16x32_bf16 v[76:79], v[52:55], a[92:95], v[76:79]
    s_add_u32 s58, s58, 4096
    v_mfma_f32_16x16x32_bf16 v[76:79], v[48:51], a[76:79], v[76:79]
    s_waitcnt lgkmcnt(4)
    v_mfma_f32_16x16x32_bf16 v[92:95], v[56:59], a[76:79], v[92:95]
    s_add_u32 s61, s68, 8192
    ds_read_b64_tr_b16 v[48:49], v7 offset:16384
    v_mfma_f32_16x16x32_bf16 v[92:95], v[60:63], a[92:95], v[92:95]
    ds_read_b64_tr_b16 v[50:51], v7 offset:16896
    v_mfma_f32_16x16x32_bf16 v[88:91], v[60:63], a[88:91], v[88:91]
    ds_read_b64_tr_b16 v[52:53], v7 offset:20480
    v_mfma_f32_16x16x32_bf16 v[88:91], v[56:59], a[72:75], v[88:91]
    ds_read_b64_tr_b16 v[54:55], v7 offset:20992
    v_mfma_f32_16x16x32_bf16 v[84:87], v[56:59], a[68:71], v[84:87]
    buffer_load_dwordx4 a[224:227], v1, s[44:47], s57 offen offset:0 sc1
    v_mfma_f32_16x16x32_bf16 v[84:87], v[60:63], a[84:87], v[84:87]
    v_mfma_f32_16x16x32_bf16 v[80:83], v[60:63], a[80:83], v[80:83]
    buffer_load_dwordx4 a[228:231], v1, s[44:47], s57 offen offset:1024 sc1
    v_mfma_f32_16x16x32_bf16 v[80:83], v[56:59], a[64:67], v[80:83]
    s_waitcnt lgkmcnt(4)
    v_mfma_f32_16x16x32_bf16 v[96:99], v[40:43], a[64:67], v[96:99]
    ds_read_b64_tr_b16 v[56:57], v4 offset:24576
    v_mfma_f32_16x16x32_bf16 v[96:99], v[44:47], a[80:83], v[96:99]
    ds_read_b64_tr_b16 v[58:59], v4 offset:25088
    v_mfma_f32_16x16x32_bf16 v[100:103], v[44:47], a[84:87], v[100:103]
    ds_read_b64_tr_b16 v[60:61], v4 offset:28672
    v_mfma_f32_16x16x32_bf16 v[100:103], v[40:43], a[68:71], v[100:103]
    ds_read_b64_tr_b16 v[62:63], v4 offset:29184
    v_mfma_f32_16x16x32_bf16 v[104:107], v[40:43], a[72:75], v[104:107]
    buffer_load_dwordx4 a[232:235], v1, s[44:47], s58 offen offset:0 sc1
    v_mfma_f32_16x16x32_bf16 v[104:107], v[44:47], a[88:91], v[104:107]
    v_mfma_f32_16x16x32_bf16 v[108:111], v[44:47], a[92:95], v[108:111]
    buffer_store_dwordx4 v[160:163], v1, s[44:47], s61 offen offset:2048 sc1
    v_mfma_f32_16x16x32_bf16 v[108:111], v[40:43], a[76:79], v[108:111]
    s_waitcnt lgkmcnt(4)
    v_mfma_f32_16x16x32_bf16 v[124:127], v[48:51], a[76:79], v[124:127]
    ds_read_b64_tr_b16 v[40:41], v5 offset:24576
    v_mfma_f32_16x16x32_bf16 v[124:127], v[52:55], a[92:95], v[124:127]
    ds_read_b64_tr_b16 v[42:43], v5 offset:25088
    v_mfma_f32_16x16x32_bf16 v[120:123], v[52:55], a[88:91], v[120:123]
    ds_read_b64_tr_b16 v[44:45], v5 offset:28672
    v_cvt_pk_bf16_f32 v216, v216, v217
    v_mfma_f32_16x16x32_bf16 v[120:123], v[48:51], a[72:75], v[120:123]
    ds_read_b64_tr_b16 v[46:47], v5 offset:29184
    v_cvt_pk_bf16_f32 v217, v218, v219
    v_mfma_f32_16x16x32_bf16 v[116:119], v[48:51], a[68:71], v[116:119]
    buffer_load_dwordx4 a[236:239], v1, s[44:47], s58 offen offset:1024 sc1
    v_mfma_f32_16x16x32_bf16 v[116:119], v[52:55], a[84:87], v[116:119]
    v_cvt_pk_bf16_f32 v218, v220, v221
    v_cvt_pk_bf16_f32 v219, v222, v223
    v_mfma_f32_16x16x32_bf16 v[112:115], v[52:55], a[80:83], v[112:115]
    buffer_load_dwordx4 a[240:243], v1, s[44:47], s57 offen offset:2048 sc1
    v_mfma_f32_16x16x32_bf16 v[112:115], v[48:51], a[64:67], v[112:115]
    s_waitcnt vmcnt(41) lgkmcnt(4)
    v_mfma_f32_16x16x32_bf16 v[64:67], v[56:59], a[96:99], v[64:67]
    s_waitcnt vmcnt(37)
    ds_read_b64_tr_b16 v[48:49], v6 offset:24576
    v_mfma_f32_16x16x32_bf16 v[64:67], v[60:63], a[112:115], v[64:67]
    s_waitcnt vmcnt(36)
    ds_read_b64_tr_b16 v[50:51], v6 offset:25088
    v_mfma_f32_16x16x32_bf16 v[68:71], v[60:63], a[116:119], v[68:71]
    ds_read_b64_tr_b16 v[52:53], v6 offset:28672
    v_mfma_f32_16x16x32_bf16 v[68:71], v[56:59], a[100:103], v[68:71]
    ds_read_b64_tr_b16 v[54:55], v6 offset:29184
    v_mfma_f32_16x16x32_bf16 v[72:75], v[56:59], a[104:107], v[72:75]
    s_waitcnt vmcnt(35)
    buffer_load_dwordx4 a[244:247], v1, s[44:47], s57 offen offset:3072 sc1
    v_mfma_f32_16x16x32_bf16 v[72:75], v[60:63], a[120:123], v[72:75]
    s_waitcnt vmcnt(35)
    v_mfma_f32_16x16x32_bf16 v[76:79], v[60:63], a[124:127], v[76:79]
    v_mfma_f32_16x16x32_bf16 v[76:79], v[56:59], a[108:111], v[76:79]
    s_waitcnt lgkmcnt(4)
    v_mfma_f32_16x16x32_bf16 v[92:95], v[40:43], a[108:111], v[92:95]
    ds_read_b64_tr_b16 v[56:57], v7 offset:24576
    v_mfma_f32_16x16x32_bf16 v[92:95], v[44:47], a[124:127], v[92:95]
    ds_read_b64_tr_b16 v[58:59], v7 offset:25088
    v_mfma_f32_16x16x32_bf16 v[88:91], v[44:47], a[120:123], v[88:91]
    s_add_u32 s61, s68, 24576
    ds_read_b64_tr_b16 v[60:61], v7 offset:28672
    v_mfma_f32_16x16x32_bf16 v[88:91], v[40:43], a[104:107], v[88:91]
    ds_read_b64_tr_b16 v[62:63], v7 offset:29184
    v_mfma_f32_16x16x32_bf16 v[84:87], v[40:43], a[100:103], v[84:87]
    buffer_load_dwordx4 a[248:251], v1, s[44:47], s58 offen offset:2048 sc1
    v_mfma_f32_16x16x32_bf16 v[84:87], v[44:47], a[116:119], v[84:87]
    v_mfma_f32_16x16x32_bf16 v[80:83], v[44:47], a[112:115], v[80:83]
    s_waitcnt lgkmcnt(0)
    buffer_load_dwordx4 a[252:255], v1, s[44:47], s58 offen offset:3072 sc1
    v_mfma_f32_16x16x32_bf16 v[80:83], v[40:43], a[96:99], v[80:83]
    s_barrier
    v_mfma_f32_16x16x32_bf16 v[96:99], v[48:51], a[96:99], v[96:99]
    ds_read_b64_tr_b16 v[40:41], v4 offset:32768
    v_mfma_f32_16x16x32_bf16 v[96:99], v[52:55], a[112:115], v[96:99]
    ds_read_b64_tr_b16 v[42:43], v4 offset:33280
    v_mfma_f32_16x16x32_bf16 v[100:103], v[52:55], a[116:119], v[100:103]
    ds_read_b64_tr_b16 v[44:45], v4 offset:36864
    v_mfma_f32_16x16x32_bf16 v[100:103], v[48:51], a[100:103], v[100:103]
    ds_read_b64_tr_b16 v[46:47], v4 offset:37376
    v_mfma_f32_16x16x32_bf16 v[104:107], v[48:51], a[104:107], v[104:107]
    buffer_store_dwordx4 v[168:171], v1, s[44:47], s61 offen offset:2048 sc1
    v_mfma_f32_16x16x32_bf16 v[104:107], v[52:55], a[120:123], v[104:107]
    v_mfma_f32_16x16x32_bf16 v[108:111], v[52:55], a[124:127], v[108:111]
    v_cvt_pk_bf16_f32 v224, v224, v225
    v_cvt_pk_bf16_f32 v225, v226, v227
    v_mfma_f32_16x16x32_bf16 v[108:111], v[48:51], a[108:111], v[108:111]
    v_cvt_pk_bf16_f32 v226, v228, v229
    v_cvt_pk_bf16_f32 v227, v230, v231
    v_mfma_f32_16x16x32_bf16 v[124:127], v[56:59], a[108:111], v[124:127]
    ds_read_b64_tr_b16 v[48:49], v5 offset:32768
    v_mfma_f32_16x16x32_bf16 v[124:127], v[60:63], a[124:127], v[124:127]
    ds_read_b64_tr_b16 v[50:51], v5 offset:33280
    v_mfma_f32_16x16x32_bf16 v[120:123], v[60:63], a[120:123], v[120:123]
    ds_read_b64_tr_b16 v[52:53], v5 offset:36864
    v_mfma_f32_16x16x32_bf16 v[120:123], v[56:59], a[104:107], v[120:123]
    ds_read_b64_tr_b16 v[54:55], v5 offset:37376
    v_mfma_f32_16x16x32_bf16 v[116:119], v[56:59], a[100:103], v[116:119]
    v_mfma_f32_16x16x32_bf16 v[116:119], v[60:63], a[116:119], v[116:119]
    v_mfma_f32_16x16x32_bf16 v[112:115], v[60:63], a[112:115], v[112:115]
    s_add_u32 m0, s62, 65536
    v_mfma_f32_16x16x32_bf16 v[112:115], v[56:59], a[96:99], v[112:115]
    s_waitcnt vmcnt(36) lgkmcnt(4)
    v_mfma_f32_16x16x32_bf16 v[64:67], v[40:43], a[128:131], v[64:67]
    s_waitcnt vmcnt(32)
    s_add_u32 s56, s1, 0
    ds_read_b64_tr_b16 v[56:57], v6 offset:32768
    v_mfma_f32_16x16x32_bf16 v[64:67], v[44:47], a[144:147], v[64:67]
    s_waitcnt vmcnt(31)
    s_and_b32 s56, s56, 3
    ds_read_b64_tr_b16 v[58:59], v6 offset:33280
    v_mfma_f32_16x16x32_bf16 v[68:71], v[44:47], a[148:151], v[68:71]
    s_mul_i32 s56, s56, 458752
    ds_read_b64_tr_b16 v[60:61], v6 offset:36864
    v_mfma_f32_16x16x32_bf16 v[68:71], v[40:43], a[132:135], v[68:71]
    s_add_u32 s56, s56, s76
    ds_read_b64_tr_b16 v[62:63], v6 offset:37376
    v_mfma_f32_16x16x32_bf16 v[72:75], v[40:43], a[136:139], v[72:75]
    s_waitcnt vmcnt(29)
    buffer_load_dwordx4 v30, s[32:35], s56 offen offset:0 lds
    v_mfma_f32_16x16x32_bf16 v[72:75], v[44:47], a[152:155], v[72:75]
    s_waitcnt vmcnt(29)
    v_mfma_f32_16x16x32_bf16 v[76:79], v[44:47], a[156:159], v[76:79]
    v_mfma_f32_16x16x32_bf16 v[76:79], v[40:43], a[140:143], v[76:79]
    s_waitcnt lgkmcnt(4)
    buffer_load_dwordx4 v31, s[32:35], s56 offen offset:1024 lds
    v_mfma_f32_16x16x32_bf16 v[92:95], v[48:51], a[140:143], v[92:95]
K_PG4:
    s_cmp_eq_u32 s100, 1
    s_cbranch_scc1 K_PG8
    ds_read_b64_tr_b16 v[40:41], v7 offset:32768
    v_mfma_f32_16x16x32_bf16 v[92:95], v[52:55], a[156:159], v[92:95]
    ds_read_b64_tr_b16 v[42:43], v7 offset:33280
    v_mfma_f32_16x16x32_bf16 v[88:91], v[52:55], a[152:155], v[88:91]
    ds_read_b64_tr_b16 v[44:45], v7 offset:36864
    v_mfma_f32_16x16x32_bf16 v[88:91], v[48:51], a[136:139], v[88:91]
    ds_read_b64_tr_b16 v[46:47], v7 offset:37376
    v_mfma_f32_16x16x32_bf16 v[84:87], v[48:51], a[132:135], v[84:87]
    s_add_u32 s61, s68, 8192
    buffer_load_dwordx4 v16, s[32:35], s56 offen offset:2048 lds
    v_mfma_f32_16x16x32_bf16 v[84:87], v[52:55], a[148:151], v[84:87]
    v_mfma_f32_16x16x32_bf16 v[80:83], v[52:55], a[144:147], v[80:83]
    v_mfma_f32_16x16x32_bf16 v[80:83], v[48:51], a[128:131], v[80:83]
    s_waitcnt lgkmcnt(4)
    buffer_load_dwordx4 v17, s[32:35], s56 offen offset:3072 lds
    v_mfma_f32_16x16x32_bf16 v[96:99], v[56:59], a[128:131], v[96:99]
    ds_read_b64_tr_b16 v[48:49], v4 offset:40960
    v_mfma_f32_16x16x32_bf16 v[96:99], v[60:63], a[144:147], v[96:99]
    ds_read_b64_tr_b16 v[50:51], v4 offset:41472
    v_mfma_f32_16x16x32_bf16 v[100:103], v[60:63], a[148:151], v[100:103]
    ds_read_b64_tr_b16 v[52:53], v4 offset:45056
    v_cvt_pk_bf16_f32 v232, v232, v233
    v_mfma_f32_16x16x32_bf16 v[100:103], v[56:59], a[132:135], v[100:103]
    ds_read_b64_tr_b16 v[54:55], v4 offset:45568
    v_cvt_pk_bf16_f32 v233, v234, v235
    v_mfma_f32_16x16x32_bf16 v[104:107], v[56:59], a[136:139], v[104:107]
    buffer_store_dwordx4 v[176:179], v1, s[44:47], s61 offen offset:3072 sc1
    v_mfma_f32_16x16x32_bf16 v[104:107], v[60:63], a[152:155], v[104:107]
    v_cvt_pk_bf16_f32 v234, v236, v237
    v_cvt_pk_bf16_f32 v235, v238, v239
    v_mfma_f32_16x16x32_bf16 v[108:111], v[60:63], a[156:159], v[108:111]
    v_mfma_f32_16x16x32_bf16 v[108:111], v[56:59], a[140:143], v[108:111]
    s_waitcnt lgkmcnt(4)
    v_mfma_f32_16x16x32_bf16 v[124:127], v[40:43], a[140:143], v[124:127]
    ds_read_b64_tr_b16 v[56:57], v5 offset:40960
    v_mfma_f32_16x16x32_bf16 v[124:127], v[44:47], a[156:159], v[124:127]
    ds_read_b64_tr_b16 v[58:59], v5 offset:41472
    v_mfma_f32_16x16x32_bf16 v[120:123], v[44:47], a[152:155], v[120:123]
    ds_read_b64_tr_b16 v[60:61], v5 offset:45056
    v_mfma_f32_16x16x32_bf16 v[120:123], v[40:43], a[136:139], v[120:123]
    ds_read_b64_tr_b16 v[62:63], v5 offset:45568
    v_mfma_f32_16x16x32_bf16 v[116:119], v[40:43], a[132:135], v[116:119]
    v_mfma_f32_16x16x32_bf16 v[116:119], v[44:47], a[148:151], v[116:119]
    v_mfma_f32_16x16x32_bf16 v[112:115], v[44:47], a[144:147], v[112:115]
    v_mfma_f32_16x16x32_bf16 v[112:115], v[40:43], a[128:131], v[112:115]
    s_waitcnt vmcnt(32) lgkmcnt(4)
    v_mfma_f32_16x16x32_bf16 v[64:67], v[48:51], a[160:163], v[64:67]
    s_waitcnt vmcnt(27)
    ds_read_b64_tr_b16 v[40:41], v6 offset:40960
    v_mfma_f32_16x16x32_bf16 v[64:67], v[52:55], a[176:179], v[64:67]
    s_waitcnt vmcnt(26)
    ds_read_b64_tr_b16 v[42:43], v6 offset:41472
    v_mfma_f32_16x16x32_bf16 v[68:71], v[52:55], a[180:183], v[68:71]
    ds_read_b64_tr_b16 v[44:45], v6 offset:45056
    v_mfma_f32_16x16x32_bf16 v[68:71], v[48:51], a[164:167], v[68:71]
    ds_read_b64_tr_b16 v[46:47], v6 offset:45568
    v_mfma_f32_16x16x32_bf16 v[72:75], v[48:51], a[168:171], v[72:75]
    s_waitcnt vmcnt(25)
    v_mfma_f32_16x16x32_bf16 v[72:75], v[52:55], a[184:187], v[72:75]
    s_waitcnt vmcnt(24)
    v_mfma_f32_16x16x32_bf16 v[76:79], v[52:55], a[188:191], v[76:79]
    v_mfma_f32_16x16x32_bf16 v[76:79], v[48:51], a[172:175], v[76:79]
    s_waitcnt lgkmcnt(4)
    v_mfma_f32_16x16x32_bf16 v[92:95], v[56:59], a[172:175], v[92:95]
    ds_read_b64_tr_b16 v[48:49], v7 offset:40960
    v_mfma_f32_16x16x32_bf16 v[92:95], v[60:63], a[188:191], v[92:95]
    ds_read_b64_tr_b16 v[50:51], v7 offset:41472
    v_mfma_f32_16x16x32_bf16 v[88:91], v[60:63], a[184:187], v[88:91]
    ds_read_b64_tr_b16 v[52:53], v7 offset:45056
    v_mfma_f32_16x16x32_bf16 v[88:91], v[56:59], a[168:171], v[88:91]
    ds_read_b64_tr_b16 v[54:55], v7 offset:45568
    v_mfma_f32_16x16x32_bf16 v[84:87], v[56:59], a[164:167], v[84:87]
    v_mfma_f32_16x16x32_bf16 v[84:87], v[60:63], a[180:183], v[84:87]
    v_mfma_f32_16x16x32_bf16 v[80:83], v[60:63], a[176:179], v[80:83]
    s_waitcnt lgkmcnt(0)
    v_cvt_pk_bf16_f32 v240, v240, v241
    v_cvt_pk_bf16_f32 v241, v242, v243
    v_mfma_f32_16x16x32_bf16 v[80:83], v[56:59], a[160:163], v[80:83]
    s_barrier
    v_cvt_pk_bf16_f32 v242, v244, v245
    v_cvt_pk_bf16_f32 v243, v246, v247
    v_mfma_f32_16x16x32_bf16 v[96:99], v[40:43], a[160:163], v[96:99]
    s_add_u32 m0, s62, 81920
    ds_read_b64_tr_b16 v[56:57], v4 offset:49152
    v_mfma_f32_16x16x32_bf16 v[96:99], v[44:47], a[176:179], v[96:99]
    s_add_u32 s56, s1, 1
    ds_read_b64_tr_b16 v[58:59], v4 offset:49664
    v_mfma_f32_16x16x32_bf16 v[100:103], v[44:47], a[180:183], v[100:103]
    s_and_b32 s56, s56, 3
    ds_read_b64_tr_b16 v[60:61], v4 offset:53248
    v_mfma_f32_16x16x32_bf16 v[100:103], v[40:43], a[164:167], v[100:103]
    s_mul_i32 s56, s56, 458752
    ds_read_b64_tr_b16 v[62:63], v4 offset:53760
    v_mfma_f32_16x16x32_bf16 v[104:107], v[40:43], a[168:171], v[104:107]
    s_add_u32 s56, s56, s76
    v_mfma_f32_16x16x32_bf16 v[104:107], v[44:47], a[184:187], v[104:107]
    s_add_u32 s61, s68, 24576
    buffer_load_dwordx4 v30, s[32:35], s56 offen offset:0 lds
    v_mfma_f32_16x16x32_bf16 v[108:111], v[44:47], a[188:191], v[108:111]
    v_mfma_f32_16x16x32_bf16 v[108:111], v[40:43], a[172:175], v[108:111]
    buffer_store_dwordx4 v[184:187], v1, s[44:47], s61 offen offset:3072 sc1
    v_mfma_f32_16x16x32_bf16 v[124:127], v[48:51], a[172:175], v[124:127]
    ds_read_b64_tr_b16 v[40:41], v5 offset:49152
    v_mfma_f32_16x16x32_bf16 v[124:127], v[52:55], a[188:191], v[124:127]
    ds_read_b64_tr_b16 v[42:43], v5 offset:49664
    v_mfma_f32_16x16x32_bf16 v[120:123], v[52:55], a[184:187], v[120:123]
    ds_read_b64_tr_b16 v[44:45], v5 offset:53248
    v_mfma_f32_16x16x32_bf16 v[120:123], v[48:51], a[168:171], v[120:123]
    ds_read_b64_tr_b16 v[46:47], v5 offset:53760
    v_mfma_f32_16x16x32_bf16 v[116:119], v[48:51], a[164:167], v[116:119]
    buffer_load_dwordx4 v31, s[32:35], s56 offen offset:1024 lds
    v_mfma_f32_16x16x32_bf16 v[116:119], v[52:55], a[180:183], v[116:119]
    v_mfma_f32_16x16x32_bf16 v[112:115], v[52:55], a[176:179], v[112:115]
    v_mfma_f32_16x16x32_bf16 v[112:115], v[48:51], a[160:163], v[112:115]
    s_waitcnt vmcnt(26) lgkmcnt(4)
    buffer_load_dwordx4 v16, s[32:35], s56 offen offset:2048 lds
    v_mfma_f32_16x16x32_bf16 v[64:67], v[56:59], a[192:195], v[64:67]
    s_waitcnt vmcnt(23)
    ds_read_b64_tr_b16 v[48:49], v6 offset:49152
    v_mfma_f32_16x16x32_bf16 v[64:67], v[60:63], a[208:211], v[64:67]
    s_waitcnt vmcnt(21)
    ds_read_b64_tr_b16 v[50:51], v6 offset:49664
    v_mfma_f32_16x16x32_bf16 v[68:71], v[60:63], a[212:215], v[68:71]
    ds_read_b64_tr_b16 v[52:53], v6 offset:53248
    v_mfma_f32_16x16x32_bf16 v[68:71], v[56:59], a[196:199], v[68:71]
    ds_read_b64_tr_b16 v[54:55], v6 offset:53760
    v_mfma_f32_16x16x32_bf16 v[72:75], v[56:59], a[200:203], v[72:75]
    s_waitcnt vmcnt(20)
    buffer_load_dwordx4 v17, s[32:35], s56 offen offset:3072 lds
    v_mfma_f32_16x16x32_bf16 v[72:75], v[60:63], a[216:219], v[72:75]
    s_waitcnt vmcnt(20)
    v_mfma_f32_16x16x32_bf16 v[76:79], v[60:63], a[220:223], v[76:79]
    v_mfma_f32_16x16x32_bf16 v[76:79], v[56:59], a[204:207], v[76:79]
    s_waitcnt lgkmcnt(4)
    v_mfma_f32_16x16x32_bf16 v[92:95], v[40:43], a[204:207], v[92:95]
    ds_read_b64_tr_b16 v[56:57], v7 offset:49152
    v_mfma_f32_16x16x32_bf16 v[92:95], v[44:47], a[220:223], v[92:95]
    ds_read_b64_tr_b16 v[58:59], v7 offset:49664
    v_mfma_f32_16x16x32_bf16 v[88:91], v[44:47], a[216:219], v[88:91]
    ds_read_b64_tr_b16 v[60:61], v7 offset:53248
    v_cvt_pk_bf16_f32 v248, v248, v249
    v_mfma_f32_16x16x32_bf16 v[88:91], v[40:43], a[200:203], v[88:91]
    ds_read_b64_tr_b16 v[62:63], v7 offset:53760
    v_cvt_pk_bf16_f32 v249, v250, v251
    v_mfma_f32_16x16x32_bf16 v[84:87], v[40:43], a[196:199], v[84:87]
    v_cvt_pk_bf16_f32 v250, v252, v253
    v_cvt_pk_bf16_f32 v251, v254, v255
    v_mfma_f32_16x16x32_bf16 v[84:87], v[44:47], a[212:215], v[84:87]
    v_mfma_f32_16x16x32_bf16 v[80:83], v[44:47], a[208:211], v[80:83]
    v_mfma_f32_16x16x32_bf16 v[80:83], v[40:43], a[192:195], v[80:83]
    s_waitcnt lgkmcnt(4)
    v_mfma_f32_16x16x32_bf16 v[96:99], v[48:51], a[192:195], v[96:99]
    ds_read_b64_tr_b16 v[40:41], v4 offset:57344
    v_mfma_f32_16x16x32_bf16 v[96:99], v[52:55], a[208:211], v[96:99]
    ds_read_b64_tr_b16 v[42:43], v4 offset:57856
    v_mfma_f32_16x16x32_bf16 v[100:103], v[52:55], a[212:215], v[100:103]
    ds_read_b64_tr_b16 v[44:45], v4 offset:61440
    v_mfma_f32_16x16x32_bf16 v[100:103], v[48:51], a[196:199], v[100:103]
    s_add_u32 s61, s68, 12288
    ds_read_b64_tr_b16 v[46:47], v4 offset:61952
    v_mfma_f32_16x16x32_bf16 v[104:107], v[48:51], a[200:203], v[104:107]
    v_xor_b32 v4, 0x10000, v4
    v_mfma_f32_16x16x32_bf16 v[104:107], v[52:55], a[216:219], v[104:107]
    buffer_store_dwordx4 v[192:195], v1, s[44:47], s61 offen offset:0 sc1
    v_mfma_f32_16x16x32_bf16 v[108:111], v[52:55], a[220:223], v[108:111]
    v_mfma_f32_16x16x32_bf16 v[108:111], v[48:51], a[204:207], v[108:111]
    s_waitcnt lgkmcnt(4)
    v_mfma_f32_16x16x32_bf16 v[124:127], v[56:59], a[204:207], v[124:127]
    ds_read_b64_tr_b16 v[48:49], v5 offset:57344
    v_mfma_f32_16x16x32_bf16 v[124:127], v[60:63], a[220:223], v[124:127]
    ds_read_b64_tr_b16 v[50:51], v5 offset:57856
    v_mfma_f32_16x16x32_bf16 v[120:123], v[60:63], a[216:219], v[120:123]
    ds_read_b64_tr_b16 v[52:53], v5 offset:61440
    v_mfma_f32_16x16x32_bf16 v[120:123], v[56:59], a[200:203], v[120:123]
    ds_read_b64_tr_b16 v[54:55], v5 offset:61952
    v_mfma_f32_16x16x32_bf16 v[116:119], v[56:59], a[196:199], v[116:119]
    v_xor_b32 v5, 0x10000, v5
    v_mfma_f32_16x16x32_bf16 v[116:119], v[60:63], a[212:215], v[116:119]
    v_mfma_f32_16x16x32_bf16 v[112:115], v[60:63], a[208:211], v[112:115]
    v_mfma_f32_16x16x32_bf16 v[112:115], v[56:59], a[192:195], v[112:115]
    s_waitcnt vmcnt(20) lgkmcnt(4)
    v_mfma_f32_16x16x32_bf16 v[64:67], v[40:43], a[224:227], v[64:67]
    s_waitcnt vmcnt(15)
    ds_read_b64_tr_b16 v[56:57], v6 offset:57344
    v_mfma_f32_16x16x32_bf16 v[128:131], v[44:47], a[240:243], v[64:67]
    s_waitcnt vmcnt(14)
    ds_read_b64_tr_b16 v[58:59], v6 offset:57856
    v_mfma_f32_16x16x32_bf16 v[68:71], v[44:47], a[244:247], v[68:71]
    s_add_u32 m0, s62, 98304
    ds_read_b64_tr_b16 v[60:61], v6 offset:61440
    v_mfma_f32_16x16x32_bf16 v[144:147], v[40:43], a[228:231], v[68:71]
    s_add_u32 s56, s1, 2
    ds_read_b64_tr_b16 v[62:63], v6 offset:61952
    v_mfma_f32_16x16x32_bf16 v[72:75], v[40:43], a[232:235], v[72:75]
    s_waitcnt vmcnt(13)
    s_and_b32 s56, s56, 3
    v_xor_b32 v6, 0x10000, v6
    v_mfma_f32_16x16x32_bf16 v[160:163], v[44:47], a[248:251], v[72:75]
    s_waitcnt vmcnt(12)
    s_mul_i32 s56, s56, 458752
    v_mfma_f32_16x16x32_bf16 v[76:79], v[44:47], a[252:255], v[76:79]
    s_add_u32 s56, s56, s76
    v_mfma_f32_16x16x32_bf16 v[176:179], v[40:43], a[236:239], v[76:79]
    s_waitcnt lgkmcnt(4)
    buffer_load_dwordx4 v30, s[32:35], s56 offen offset:0 lds
    v_mfma_f32_16x16x32_bf16 v[80:83], v[48:51], a[224:227], v[80:83]
    ds_read_b64_tr_b16 v[40:41], v7 offset:57344
    v_mfma_f32_16x16x32_bf16 v[132:135], v[52:55], a[240:243], v[80:83]
    ds_read_b64_tr_b16 v[42:43], v7 offset:57856
    v_mfma_f32_16x16x32_bf16 v[84:87], v[52:55], a[244:247], v[84:87]
    ds_read_b64_tr_b16 v[44:45], v7 offset:61440
    v_mul_f32 v20, v128, v128
    v_mfma_f32_16x16x32_bf16 v[148:151], v[48:51], a[228:231], v[84:87]
    ds_read_b64_tr_b16 v[46:47], v7 offset:61952
    v_fmaak_f32 v20, v20, v3, 0xc1906ebb
    v_mfma_f32_16x16x32_bf16 v[88:91], v[48:51], a[232:235], v[88:91]
    v_xor_b32 v7, 0x10000, v7
    v_mul_f32 v20, v20, v128
    v_mfma_f32_16x16x32_bf16 v[164:167], v[52:55], a[248:251], v[88:91]
    buffer_load_dwordx4 v31, s[32:35], s56 offen offset:1024 lds
    v_mfma_f32_16x16x32_bf16 v[92:95], v[52:55], a[252:255], v[92:95]
    s_waitcnt vmcnt(9) lgkmcnt(0)
    v_exp_f32 v20, v20
    v_mfma_f32_16x16x32_bf16 v[180:183], v[48:51], a[236:239], v[92:95]
    s_barrier
    v_fma_f32 v20, v20, s71, s71
    v_mfma_f32_16x16x32_bf16 v[96:99], v[56:59], a[224:227], v[96:99]
    ds_read_b64_tr_b16 v[48:49], v4 offset:0
    v_mfma_f32_16x16x32_bf16 v[136:139], v[60:63], a[240:243], v[96:99]
    ds_read_b64_tr_b16 v[50:51], v4 offset:512
    v_mul_f32 v21, v129, v129
    v_mfma_f32_16x16x32_bf16 v[100:103], v[60:63], a[244:247], v[100:103]
    ds_read_b64_tr_b16 v[52:53], v4 offset:4096
    v_fmaak_f32 v21, v21, v3, 0xc1906ebb
    v_mfma_f32_16x16x32_bf16 v[152:155], v[56:59], a[228:231], v[100:103]
    s_add_u32 s61, s68, 28672
    ds_read_b64_tr_b16 v[54:55], v4 offset:4608
    v_mul_f32 v21, v21, v129
    v_mfma_f32_16x16x32_bf16 v[104:107], v[56:59], a[232:235], v[104:107]
    buffer_load_dwordx4 v16, s[32:35], s56 offen offset:2048 lds
    v_mfma_f32_16x16x32_bf16 v[168:171], v[60:63], a[248:251], v[104:107]
    v_rcp_f32 v20, v20
    v_mfma_f32_16x16x32_bf16 v[108:111], v[60:63], a[252:255], v[108:111]
    v_mul_f32 v128, v20, v128
    v_mfma_f32_16x16x32_bf16 v[184:187], v[56:59], a[236:239], v[108:111]
    buffer_load_dwordx4 v17, s[32:35], s56 offen offset:3072 lds
    v_mfma_f32_16x16x32_bf16 v[112:115], v[40:43], a[224:227], v[112:115]
    s_add_u32 m0, s52, 0
    ds_read_b64_tr_b16 v[56:57], v5 offset:0
    v_mfma_f32_16x16x32_bf16 v[140:143], v[44:47], a[240:243], v[112:115]
    s_add_u32 s56, s79, 0
    ds_read_b64_tr_b16 v[58:59], v5 offset:512
    v_mul_f32 v22, v130, v130
    v_mfma_f32_16x16x32_bf16 v[116:119], v[44:47], a[244:247], v[116:119]
    ds_read_b64_tr_b16 v[60:61], v5 offset:4096
    v_fmaak_f32 v22, v22, v3, 0xc1906ebb
    v_mfma_f32_16x16x32_bf16 v[156:159], v[40:43], a[228:231], v[116:119]
    ds_read_b64_tr_b16 v[62:63], v5 offset:4608
    v_mul_f32 v22, v22, v130
    v_mfma_f32_16x16x32_bf16 v[120:123], v[40:43], a[232:235], v[120:123]
    buffer_load_dwordx4 v18, s[24:27], s56 offen lds
    v_mfma_f32_16x16x32_bf16 v[172:175], v[44:47], a[248:251], v[120:123]
    v_exp_f32 v21, v21
    v_mfma_f32_16x16x32_bf16 v[124:127], v[44:47], a[252:255], v[124:127]
    buffer_store_dwordx4 v[200:203], v1, s[44:47], s61 offen offset:0 sc1
    v_mfma_f32_16x16x32_bf16 v[188:191], v[40:43], a[236:239], v[124:127]
    s_waitcnt lgkmcnt(4)
    v_fma_f32 v21, v21, s71, s71
    v_mfma_f32_16x16x32_bf16 v[64:67], v[48:51], a[0:3], 0
    ds_read_b64_tr_b16 v[40:41], v6 offset:0
    v_mfma_f32_16x16x32_bf16 v[64:67], v[52:55], a[16:19], v[64:67]
    ds_read_b64_tr_b16 v[42:43], v6 offset:512
    v_mul_f32 v23, v131, v131
    v_mfma_f32_16x16x32_bf16 v[68:71], v[52:55], a[20:23], 0
    ds_read_b64_tr_b16 v[44:45], v6 offset:4096
    v_fmaak_f32 v23, v23, v3, 0xc1906ebb
    v_mfma_f32_16x16x32_bf16 v[68:71], v[48:51], a[4:7], v[68:71]
    ds_read_b64_tr_b16 v[46:47], v6 offset:4608
    v_mul_f32 v23, v23, v131
    v_mfma_f32_16x16x32_bf16 v[72:75], v[48:51], a[8:11], 0
    v_rcp_f32 v21, v21
    v_mfma_f32_16x16x32_bf16 v[72:75], v[52:55], a[24:27], v[72:75]
    v_mul_f32 v129, v21, v129
    v_mfma_f32_16x16x32_bf16 v[76:79], v[52:55], a[28:31], 0
    v_exp_f32 v22, v22
    v_mfma_f32_16x16x32_bf16 v[76:79], v[48:51], a[12:15], v[76:79]
    s_waitcnt lgkmcnt(4)
    v_fma_f32 v22, v22, s71, s71
    v_mfma_f32_16x16x32_bf16 v[92:95], v[56:59], a[12:15], 0
    ds_read_b64_tr_b16 v[48:49], v7 offset:0
    v_mul_f32 v24, v144, v144
    v_mfma_f32_16x16x32_bf16 v[92:95], v[60:63], a[28:31], v[92:95]
    ds_read_b64_tr_b16 v[50:51], v7 offset:512
    v_fmaak_f32 v24, v24, v3, 0xc1906ebb
    v_mfma_f32_16x16x32_bf16 v[88:91], v[60:63], a[24:27], 0
    ds_read_b64_tr_b16 v[52:53], v7 offset:4096
    v_mul_f32 v24, v24, v144
    v_mfma_f32_16x16x32_bf16 v[88:91], v[56:59], a[8:11], v[88:91]
    ds_read_b64_tr_b16 v[54:55], v7 offset:4608
    v_mfma_f32_16x16x32_bf16 v[84:87], v[56:59], a[4:7], 0
    v_rcp_f32 v22, v22
    v_mfma_f32_16x16x32_bf16 v[84:87], v[60:63], a[20:23], v[84:87]
    v_mul_f32 v130, v22, v130
    v_mfma_f32_16x16x32_bf16 v[80:83], v[60:63], a[16:19], 0
    v_exp_f32 v23, v23
    v_mfma_f32_16x16x32_bf16 v[80:83], v[56:59], a[0:3], v[80:83]
    s_waitcnt lgkmcnt(4)
    v_fma_f32 v23, v23, s71, s71
    v_mfma_f32_16x16x32_bf16 v[96:99], v[40:43], a[0:3], 0
    ds_read_b64_tr_b16 v[56:57], v4 offset:8192
    v_mul_f32 v25, v145, v145
    v_mfma_f32_16x16x32_bf16 v[96:99], v[44:47], a[16:19], v[96:99]
    ds_read_b64_tr_b16 v[58:59], v4 offset:8704
    v_rcp_f32 v23, v23
    v_mfma_f32_16x16x32_bf16 v[100:103], v[44:47], a[20:23], 0
    ds_read_b64_tr_b16 v[60:61], v4 offset:12288
    v_mul_f32 v131, v23, v131
    v_mfma_f32_16x16x32_bf16 v[100:103], v[40:43], a[4:7], v[100:103]
    s_add_u32 s61, s68, 12288
    ds_read_b64_tr_b16 v[62:63], v4 offset:12800
    v_fmaak_f32 v25, v25, v3, 0xc1906ebb
    v_mfma_f32_16x16x32_bf16 v[104:107], v[40:43], a[8:11], 0
    s_add_u32 m0, s62, 114688
    buffer_store_dwordx4 v[208:211], v1, s[44:47], s61 offen offset:1024 sc1
    v_mfma_f32_16x16x32_bf16 v[104:107], v[44:47], a[24:27], v[104:107]
    s_add_u32 s56, s1, 3
    v_exp_f32 v24, v24
    v_mfma_f32_16x16x32_bf16 v[108:111], v[44:47], a[28:31], 0
    s_and_b32 s56, s56, 3
    v_fma_f32 v24, v24, s71, s71
    v_mul_f32 v25, v25, v145
    v_mfma_f32_16x16x32_bf16 v[108:111], v[40:43], a[12:15], v[108:111]
    s_waitcnt lgkmcnt(4)
    v_rcp_f32 v24, v24
    v_mfma_f32_16x16x32_bf16 v[124:127], v[48:51], a[12:15], 0
    s_mul_i32 s56, s56, 458752
    ds_read_b64_tr_b16 v[40:41], v5 offset:8192
    v_mul_f32 v144, v24, v144
    v_mfma_f32_16x16x32_bf16 v[124:127], v[52:55], a[28:31], v[124:127]
    s_add_u32 s56, s56, s76
    ds_read_b64_tr_b16 v[42:43], v5 offset:8704
    v_mul_f32 v26, v146, v146
    v_mfma_f32_16x16x32_bf16 v[120:123], v[52:55], a[24:27], 0
    ds_read_b64_tr_b16 v[44:45], v5 offset:12288
    v_fmaak_f32 v26, v26, v3, 0xc1906ebb
    v_mfma_f32_16x16x32_bf16 v[120:123], v[48:51], a[8:11], v[120:123]
    ds_read_b64_tr_b16 v[46:47], v5 offset:12800
    v_mul_f32 v26, v26, v146
    v_mfma_f32_16x16x32_bf16 v[116:119], v[48:51], a[4:7], 0
    buffer_load_dwordx4 v30, s[32:35], s56 offen offset:0 lds
    v_mfma_f32_16x16x32_bf16 v[116:119], v[52:55], a[20:23], v[116:119]
    v_exp_f32 v25, v25
    v_mfma_f32_16x16x32_bf16 v[112:115], v[52:55], a[16:19], 0
    v_fma_f32 v25, v25, s71, s71
    v_mfma_f32_16x16x32_bf16 v[112:115], v[48:51], a[0:3], v[112:115]
    s_waitcnt lgkmcnt(4)
    buffer_load_dwordx4 v31, s[32:35], s56 offen offset:1024 lds
    v_mfma_f32_16x16x32_bf16 v[64:67], v[56:59], a[32:35], v[64:67]
    ds_read_b64_tr_b16 v[48:49], v6 offset:8192
    v_mul_f32 v27, v147, v147
    v_mfma_f32_16x16x32_bf16 v[64:67], v[60:63], a[48:51], v[64:67]
    ds_read_b64_tr_b16 v[50:51], v6 offset:8704
    v_fmaak_f32 v27, v27, v3, 0xc1906ebb
    v_mfma_f32_16x16x32_bf16 v[68:71], v[60:63], a[52:55], v[68:71]
    ds_read_b64_tr_b16 v[52:53], v6 offset:12288
    v_mul_f32 v27, v27, v147
    v_mfma_f32_16x16x32_bf16 v[68:71], v[56:59], a[36:39], v[68:71]
    ds_read_b64_tr_b16 v[54:55], v6 offset:12800
    v_mfma_f32_16x16x32_bf16 v[72:75], v[56:59], a[40:43], v[72:75]
    buffer_load_dwordx4 v16, s[32:35], s56 offen offset:2048 lds
    v_mfma_f32_16x16x32_bf16 v[72:75], v[60:63], a[56:59], v[72:75]
    v_rcp_f32 v25, v25
    v_mfma_f32_16x16x32_bf16 v[76:79], v[60:63], a[60:63], v[76:79]
    v_mul_f32 v145, v25, v145
    v_mfma_f32_16x16x32_bf16 v[76:79], v[56:59], a[44:47], v[76:79]
    s_waitcnt lgkmcnt(4)
    buffer_load_dwordx4 v17, s[32:35], s56 offen offset:3072 lds
    v_mfma_f32_16x16x32_bf16 v[92:95], v[40:43], a[44:47], v[92:95]
    s_add_u32 m0, s52, 1024
    ds_read_b64_tr_b16 v[56:57], v7 offset:8192
    v_mul_f32 v20, v160, v160
    v_mfma_f32_16x16x32_bf16 v[92:95], v[44:47], a[60:63], v[92:95]
    s_add_u32 s56, s79, 4096
    ds_read_b64_tr_b16 v[58:59], v7 offset:8704
    v_exp_f32 v26, v26
    v_mfma_f32_16x16x32_bf16 v[88:91], v[44:47], a[56:59], v[88:91]
    ds_read_b64_tr_b16 v[60:61], v7 offset:12288
    v_fma_f32 v26, v26, s71, s71
    v_mfma_f32_16x16x32_bf16 v[88:91], v[40:43], a[40:43], v[88:91]
    ds_read_b64_tr_b16 v[62:63], v7 offset:12800
    v_fmaak_f32 v20, v20, v3, 0xc1906ebb
    v_mfma_f32_16x16x32_bf16 v[84:87], v[40:43], a[36:39], v[84:87]
    buffer_load_dwordx4 v19, s[24:27], s56 offen lds
    v_mfma_f32_16x16x32_bf16 v[84:87], v[44:47], a[52:55], v[84:87]
    v_rcp_f32 v26, v26
    v_mfma_f32_16x16x32_bf16 v[80:83], v[44:47], a[48:51], v[80:83]
    s_waitcnt vmcnt(13) lgkmcnt(0)
    v_mul_f32 v146, v26, v146
    v_mul_f32 v20, v20, v160
    v_mfma_f32_16x16x32_bf16 v[80:83], v[40:43], a[32:35], v[80:83]
    s_barrier
    v_exp_f32 v27, v27
    v_mfma_f32_16x16x32_bf16 v[96:99], v[48:51], a[32:35], v[96:99]
    ds_read_b64_tr_b16 v[40:41], v4 offset:16384
    v_fma_f32 v27, v27, s71, s71
    v_mfma_f32_16x16x32_bf16 v[96:99], v[52:55], a[48:51], v[96:99]
    ds_read_b64_tr_b16 v[42:43], v4 offset:16896
    v_mul_f32 v21, v161, v161
    v_mfma_f32_16x16x32_bf16 v[100:103], v[52:55], a[52:55], v[100:103]
    ds_read_b64_tr_b16 v[44:45], v4 offset:20480
    v_fmaak_f32 v21, v21, v3, 0xc1906ebb
    v_mfma_f32_16x16x32_bf16 v[100:103], v[48:51], a[36:39], v[100:103]
    s_add_u32 s61, s68, 28672
    ds_read_b64_tr_b16 v[46:47], v4 offset:20992
    v_mul_f32 v21, v21, v161
    v_mfma_f32_16x16x32_bf16 v[104:107], v[48:51], a[40:43], v[104:107]
    buffer_store_dwordx4 v[216:219], v1, s[44:47], s61 offen offset:1024 sc1
    v_mfma_f32_16x16x32_bf16 v[104:107], v[52:55], a[56:59], v[104:107]
    v_rcp_f32 v27, v27
    v_mfma_f32_16x16x32_bf16 v[108:111], v[52:55], a[60:63], v[108:111]
    v_mul_f32 v147, v27, v147
    v_mfma_f32_16x16x32_bf16 v[108:111], v[48:51], a[44:47], v[108:111]
    v_exp_f32 v20, v20
    v_mfma_f32_16x16x32_bf16 v[124:127], v[56:59], a[44:47], v[124:127]
    ds_read_b64_tr_b16 v[48:49], v5 offset:16384
    v_fma_f32 v20, v20, s71, s71
    v_mfma_f32_16x16x32_bf16 v[124:127], v[60:63], a[60:63], v[124:127]
    ds_read_b64_tr_b16 v[50:51], v5 offset:16896
    v_mul_f32 v22, v162, v162
    v_mfma_f32_16x16x32_bf16 v[120:123], v[60:63], a[56:59], v[120:123]
    ds_read_b64_tr_b16 v[52:53], v5 offset:20480
    v_fmaak_f32 v22, v22, v3, 0xc1906ebb
    v_mfma_f32_16x16x32_bf16 v[120:123], v[56:59], a[40:43], v[120:123]
    ds_read_b64_tr_b16 v[54:55], v5 offset:20992
    v_mul_f32 v22, v22, v162
    v_mfma_f32_16x16x32_bf16 v[116:119], v[56:59], a[36:39], v[116:119]
    v_rcp_f32 v20, v20
    v_mfma_f32_16x16x32_bf16 v[116:119], v[60:63], a[52:55], v[116:119]
    v_mul_f32 v160, v20, v160
    v_mfma_f32_16x16x32_bf16 v[112:115], v[60:63], a[48:51], v[112:115]
    v_exp_f32 v21, v21
    v_mfma_f32_16x16x32_bf16 v[112:115], v[56:59], a[32:35], v[112:115]
    s_waitcnt lgkmcnt(4)
    v_fma_f32 v21, v21, s71, s71
    v_mul_f32 v23, v163, v163
    v_mfma_f32_16x16x32_bf16 v[64:67], v[40:43], a[64:67], v[64:67]
    ds_read_b64_tr_b16 v[56:57], v6 offset:16384
    v_fmaak_f32 v23, v23, v3, 0xc1906ebb
    v_mfma_f32_16x16x32_bf16 v[64:67], v[44:47], a[80:83], v[64:67]
    ds_read_b64_tr_b16 v[58:59], v6 offset:16896
    v_rcp_f32 v21, v21
    v_mfma_f32_16x16x32_bf16 v[68:71], v[44:47], a[84:87], v[68:71]
    ds_read_b64_tr_b16 v[60:61], v6 offset:20480
    v_mul_f32 v161, v21, v161
    v_mfma_f32_16x16x32_bf16 v[68:71], v[40:43], a[68:71], v[68:71]
    ds_read_b64_tr_b16 v[62:63], v6 offset:20992
    v_mul_f32 v23, v23, v163
    v_mfma_f32_16x16x32_bf16 v[72:75], v[40:43], a[72:75], v[72:75]
    v_exp_f32 v22, v22
    v_mfma_f32_16x16x32_bf16 v[72:75], v[44:47], a[88:91], v[72:75]
    v_fma_f32 v22, v22, s71, s71
    v_mfma_f32_16x16x32_bf16 v[76:79], v[44:47], a[92:95], v[76:79]
    s_add_u32 m0, s62, 0
    v_rcp_f32 v22, v22
    v_mfma_f32_16x16x32_bf16 v[76:79], v[40:43], a[76:79], v[76:79]
    s_waitcnt lgkmcnt(4)
    v_mul_f32 v162, v22, v162
    v_mul_f32 v24, v176, v176
    v_mfma_f32_16x16x32_bf16 v[92:95], v[48:51], a[76:79], v[92:95]
    s_add_u32 s56, s1, 0
    ds_read_b64_tr_b16 v[40:41], v7 offset:16384
    v_fmaak_f32 v24, v24, v3, 0xc1906ebb
    v_mfma_f32_16x16x32_bf16 v[92:95], v[52:55], a[92:95], v[92:95]
    s_and_b32 s56, s56, 3
    ds_read_b64_tr_b16 v[42:43], v7 offset:16896
    v_mul_f32 v24, v24, v176
    v_mfma_f32_16x16x32_bf16 v[88:91], v[52:55], a[88:91], v[88:91]
    s_mul_i32 s56, s56, 1048576
    ds_read_b64_tr_b16 v[44:45], v7 offset:20480
    v_mfma_f32_16x16x32_bf16 v[88:91], v[48:51], a[72:75], v[88:91]
    s_add_u32 s56, s56, s75
    ds_read_b64_tr_b16 v[46:47], v7 offset:20992
    v_mfma_f32_16x16x32_bf16 v[84:87], v[48:51], a[68:71], v[84:87]
    buffer_load_dwordx4 v8, s[12:15], s56 offen offset:0 lds
    v_mfma_f32_16x16x32_bf16 v[84:87], v[52:55], a[84:87], v[84:87]
    v_exp_f32 v23, v23
    v_mfma_f32_16x16x32_bf16 v[80:83], v[52:55], a[80:83], v[80:83]
    v_fma_f32 v23, v23, s71, s71
    v_mul_f32 v25, v177, v177
    v_mfma_f32_16x16x32_bf16 v[80:83], v[48:51], a[64:67], v[80:83]
    s_waitcnt lgkmcnt(4)
    buffer_load_dwordx4 v9, s[12:15], s56 offen offset:1024 lds
    v_mfma_f32_16x16x32_bf16 v[96:99], v[56:59], a[64:67], v[96:99]
    ds_read_b64_tr_b16 v[48:49], v4 offset:24576
    v_fmaak_f32 v25, v25, v3, 0xc1906ebb
    v_mfma_f32_16x16x32_bf16 v[96:99], v[60:63], a[80:83], v[96:99]
    ds_read_b64_tr_b16 v[50:51], v4 offset:25088
    v_mul_f32 v25, v25, v177
    v_mfma_f32_16x16x32_bf16 v[100:103], v[60:63], a[84:87], v[100:103]
    ds_read_b64_tr_b16 v[52:53], v4 offset:28672
    v_mfma_f32_16x16x32_bf16 v[100:103], v[56:59], a[68:71], v[100:103]
    s_add_u32 s61, s68, 12288
    ds_read_b64_tr_b16 v[54:55], v4 offset:29184
    v_mfma_f32_16x16x32_bf16 v[104:107], v[56:59], a[72:75], v[104:107]
    buffer_load_dwordx4 v10, s[12:15], s56 offen offset:2048 lds
    v_mfma_f32_16x16x32_bf16 v[104:107], v[60:63], a[88:91], v[104:107]
    v_rcp_f32 v23, v23
    v_mfma_f32_16x16x32_bf16 v[108:111], v[60:63], a[92:95], v[108:111]
    v_mul_f32 v163, v23, v163
    v_mul_f32 v26, v178, v178
    v_mfma_f32_16x16x32_bf16 v[108:111], v[56:59], a[76:79], v[108:111]
    s_waitcnt lgkmcnt(4)
    buffer_load_dwordx4 v11, s[12:15], s56 offen offset:3072 lds
    v_mfma_f32_16x16x32_bf16 v[124:127], v[40:43], a[76:79], v[124:127]
    s_add_u32 m0, s52, 2048
    ds_read_b64_tr_b16 v[56:57], v5 offset:24576
    v_fmaak_f32 v26, v26, v3, 0xc1906ebb
    v_mfma_f32_16x16x32_bf16 v[124:127], v[44:47], a[92:95], v[124:127]
    s_add_u32 s56, s79, 8192
    ds_read_b64_tr_b16 v[58:59], v5 offset:25088
    v_exp_f32 v24, v24
    v_mfma_f32_16x16x32_bf16 v[120:123], v[44:47], a[88:91], v[120:123]
    ds_read_b64_tr_b16 v[60:61], v5 offset:28672
    v_fma_f32 v24, v24, s71, s71
    v_mfma_f32_16x16x32_bf16 v[120:123], v[40:43], a[72:75], v[120:123]
    ds_read_b64_tr_b16 v[62:63], v5 offset:29184
    v_mul_f32 v26, v26, v178
    v_mfma_f32_16x16x32_bf16 v[116:119], v[40:43], a[68:71], v[116:119]
    buffer_load_dwordx4 v18, s[24:27], s56 offen lds
    v_mfma_f32_16x16x32_bf16 v[116:119], v[44:47], a[84:87], v[116:119]
    v_rcp_f32 v24, v24
    v_mfma_f32_16x16x32_bf16 v[112:115], v[44:47], a[80:83], v[112:115]
    buffer_store_dwordx4 v[224:227], v1, s[44:47], s61 offen offset:2048 sc1
    v_mfma_f32_16x16x32_bf16 v[112:115], v[40:43], a[64:67], v[112:115]
    s_waitcnt lgkmcnt(4)
    v_mul_f32 v176, v24, v176
    v_mul_f32 v27, v179, v179
    v_mfma_f32_16x16x32_bf16 v[64:67], v[48:51], a[96:99], v[64:67]
    ds_read_b64_tr_b16 v[40:41], v6 offset:24576
    v_fmaak_f32 v27, v27, v3, 0xc1906ebb
    v_mfma_f32_16x16x32_bf16 v[64:67], v[52:55], a[112:115], v[64:67]
    ds_read_b64_tr_b16 v[42:43], v6 offset:25088
    v_mul_f32 v27, v27, v179
    v_mfma_f32_16x16x32_bf16 v[68:71], v[52:55], a[116:119], v[68:71]
    ds_read_b64_tr_b16 v[44:45], v6 offset:28672
    v_mfma_f32_16x16x32_bf16 v[68:71], v[48:51], a[100:103], v[68:71]
    ds_read_b64_tr_b16 v[46:47], v6 offset:29184
    v_mfma_f32_16x16x32_bf16 v[72:75], v[48:51], a[104:107], v[72:75]
    v_exp_f32 v25, v25
    v_mfma_f32_16x16x32_bf16 v[72:75], v[52:55], a[120:123], v[72:75]
    v_fma_f32 v25, v25, s71, s71
    v_mul_f32 v20, v132, v132
    v_mfma_f32_16x16x32_bf16 v[76:79], v[52:55], a[124:127], v[76:79]
    v_rcp_f32 v25, v25
    v_mfma_f32_16x16x32_bf16 v[76:79], v[48:51], a[108:111], v[76:79]
    s_waitcnt lgkmcnt(4)
    v_mul_f32 v177, v25, v177
    v_fmaak_f32 v20, v20, v3, 0xc1906ebb
    v_mfma_f32_16x16x32_bf16 v[92:95], v[56:59], a[108:111], v[92:95]
    ds_read_b64_tr_b16 v[48:49], v7 offset:24576
    v_mul_f32 v20, v20, v132
    v_mfma_f32_16x16x32_bf16 v[92:95], v[60:63], a[124:127], v[92:95]
    ds_read_b64_tr_b16 v[50:51], v7 offset:25088
    v_mfma_f32_16x16x32_bf16 v[88:91], v[60:63], a[120:123], v[88:91]
    ds_read_b64_tr_b16 v[52:53], v7 offset:28672
    v_mfma_f32_16x16x32_bf16 v[88:91], v[56:59], a[104:107], v[88:91]
    ds_read_b64_tr_b16 v[54:55], v7 offset:29184
    v_mfma_f32_16x16x32_bf16 v[84:87], v[56:59], a[100:103], v[84:87]
    v_exp_f32 v26, v26
    v_mfma_f32_16x16x32_bf16 v[84:87], v[60:63], a[116:119], v[84:87]
    v_fma_f32 v26, v26, s71, s71
    v_mul_f32 v21, v133, v133
    v_mfma_f32_16x16x32_bf16 v[80:83], v[60:63], a[112:115], v[80:83]
    s_waitcnt vmcnt(15) lgkmcnt(0)
    v_rcp_f32 v26, v26
    v_mfma_f32_16x16x32_bf16 v[80:83], v[56:59], a[96:99], v[80:83]
    s_barrier
    v_mul_f32 v178, v26, v178
    v_fmaak_f32 v21, v21, v3, 0xc1906ebb
    v_mfma_f32_16x16x32_bf16 v[96:99], v[40:43], a[96:99], v[96:99]
K_PG5:
    s_cmp_eq_u32 s100, 1
    s_cbranch_scc1 K_PG9
    ds_read_b64_tr_b16 v[56:57], v4 offset:32768
    v_mul_f32 v21, v21, v133
    v_mfma_f32_16x16x32_bf16 v[96:99], v[44:47], a[112:115], v[96:99]
    ds_read_b64_tr_b16 v[58:59], v4 offset:33280
    v_exp_f32 v27, v27
    v_mfma_f32_16x16x32_bf16 v[100:103], v[44:47], a[116:119], v[100:103]
    ds_read_b64_tr_b16 v[60:61], v4 offset:36864
    v_fma_f32 v27, v27, s71, s71
    v_mfma_f32_16x16x32_bf16 v[100:103], v[40:43], a[100:103], v[100:103]
    s_add_u32 s61, s68, 28672
    ds_read_b64_tr_b16 v[62:63], v4 offset:37376
    v_mfma_f32_16x16x32_bf16 v[104:107], v[40:43], a[104:107], v[104:107]
    buffer_store_dwordx4 v[232:235], v1, s[44:47], s61 offen offset:2048 sc1
    v_mfma_f32_16x16x32_bf16 v[104:107], v[44:47], a[120:123], v[104:107]
    v_rcp_f32 v27, v27
    v_mfma_f32_16x16x32_bf16 v[108:111], v[44:47], a[124:127], v[108:111]
    v_mul_f32 v179, v27, v179
    v_mul_f32 v22, v134, v134
    v_mfma_f32_16x16x32_bf16 v[108:111], v[40:43], a[108:111], v[108:111]
    v_exp_f32 v20, v20
    v_mfma_f32_16x16x32_bf16 v[124:127], v[48:51], a[108:111], v[124:127]
    ds_read_b64_tr_b16 v[40:41], v5 offset:32768
    v_fma_f32 v20, v20, s71, s71
    v_mfma_f32_16x16x32_bf16 v[124:127], v[52:55], a[124:127], v[124:127]
    ds_read_b64_tr_b16 v[42:43], v5 offset:33280
    v_fmaak_f32 v22, v22, v3, 0xc1906ebb
    v_mfma_f32_16x16x32_bf16 v[120:123], v[52:55], a[120:123], v[120:123]
    ds_read_b64_tr_b16 v[44:45], v5 offset:36864
    v_mul_f32 v22, v22, v134
    v_mfma_f32_16x16x32_bf16 v[120:123], v[48:51], a[104:107], v[120:123]
    ds_read_b64_tr_b16 v[46:47], v5 offset:37376
    v_mfma_f32_16x16x32_bf16 v[116:119], v[48:51], a[100:103], v[116:119]
    v_rcp_f32 v20, v20
    v_mfma_f32_16x16x32_bf16 v[116:119], v[52:55], a[116:119], v[116:119]
    s_add_u32 m0, s62, 16384
    v_mul_f32 v132, v20, v132
    v_mul_f32 v23, v135, v135
    v_mfma_f32_16x16x32_bf16 v[112:115], v[52:55], a[112:115], v[112:115]
    s_add_u32 s56, s1, 1
    v_exp_f32 v21, v21
    v_mfma_f32_16x16x32_bf16 v[112:115], v[48:51], a[96:99], v[112:115]
    s_waitcnt lgkmcnt(4)
    v_fma_f32 v21, v21, s71, s71
    v_fmaak_f32 v23, v23, v3, 0xc1906ebb
    v_mfma_f32_16x16x32_bf16 v[64:67], v[56:59], a[128:131], v[64:67]
    s_and_b32 s56, s56, 3
    ds_read_b64_tr_b16 v[48:49], v6 offset:32768
    v_mul_f32 v23, v23, v135
    v_mfma_f32_16x16x32_bf16 v[64:67], v[60:63], a[144:147], v[64:67]
    s_mul_i32 s56, s56, 1048576
    ds_read_b64_tr_b16 v[50:51], v6 offset:33280
    v_mfma_f32_16x16x32_bf16 v[68:71], v[60:63], a[148:151], v[68:71]
    s_add_u32 s56, s56, s75
    ds_read_b64_tr_b16 v[52:53], v6 offset:36864
    v_mfma_f32_16x16x32_bf16 v[68:71], v[56:59], a[132:135], v[68:71]
    ds_read_b64_tr_b16 v[54:55], v6 offset:37376
    v_mfma_f32_16x16x32_bf16 v[72:75], v[56:59], a[136:139], v[72:75]
    buffer_load_dwordx4 v8, s[12:15], s56 offen offset:0 lds
    v_mfma_f32_16x16x32_bf16 v[72:75], v[60:63], a[152:155], v[72:75]
    v_rcp_f32 v21, v21
    v_mfma_f32_16x16x32_bf16 v[76:79], v[60:63], a[156:159], v[76:79]
    v_mul_f32 v133, v21, v133
    v_mul_f32 v24, v148, v148
    v_mfma_f32_16x16x32_bf16 v[76:79], v[56:59], a[140:143], v[76:79]
    s_waitcnt lgkmcnt(4)
    buffer_load_dwordx4 v9, s[12:15], s56 offen offset:1024 lds
    v_mfma_f32_16x16x32_bf16 v[92:95], v[40:43], a[140:143], v[92:95]
    ds_read_b64_tr_b16 v[56:57], v7 offset:32768
    v_fmaak_f32 v24, v24, v3, 0xc1906ebb
    v_mfma_f32_16x16x32_bf16 v[92:95], v[44:47], a[156:159], v[92:95]
    ds_read_b64_tr_b16 v[58:59], v7 offset:33280
    v_exp_f32 v22, v22
    v_mfma_f32_16x16x32_bf16 v[88:91], v[44:47], a[152:155], v[88:91]
    ds_read_b64_tr_b16 v[60:61], v7 offset:36864
    v_fma_f32 v22, v22, s71, s71
    v_mfma_f32_16x16x32_bf16 v[88:91], v[40:43], a[136:139], v[88:91]
    ds_read_b64_tr_b16 v[62:63], v7 offset:37376
    v_mul_f32 v24, v24, v148
    v_mfma_f32_16x16x32_bf16 v[84:87], v[40:43], a[132:135], v[84:87]
    buffer_load_dwordx4 v10, s[12:15], s56 offen offset:2048 lds
    v_mfma_f32_16x16x32_bf16 v[84:87], v[44:47], a[148:151], v[84:87]
    v_rcp_f32 v22, v22
    v_mfma_f32_16x16x32_bf16 v[80:83], v[44:47], a[144:147], v[80:83]
    v_mul_f32 v134, v22, v134
    v_mul_f32 v25, v149, v149
    v_mfma_f32_16x16x32_bf16 v[80:83], v[40:43], a[128:131], v[80:83]
    s_waitcnt lgkmcnt(4)
    buffer_load_dwordx4 v11, s[12:15], s56 offen offset:3072 lds
    v_mfma_f32_16x16x32_bf16 v[96:99], v[48:51], a[128:131], v[96:99]
    s_add_u32 m0, s52, 3072
    ds_read_b64_tr_b16 v[40:41], v4 offset:40960
    v_fmaak_f32 v25, v25, v3, 0xc1906ebb
    v_mfma_f32_16x16x32_bf16 v[96:99], v[52:55], a[144:147], v[96:99]
    s_add_u32 s56, s79, 12288
    ds_read_b64_tr_b16 v[42:43], v4 offset:41472
    v_mul_f32 v25, v25, v149
    v_mfma_f32_16x16x32_bf16 v[100:103], v[52:55], a[148:151], v[100:103]
    ds_read_b64_tr_b16 v[44:45], v4 offset:45056
    v_mfma_f32_16x16x32_bf16 v[100:103], v[48:51], a[132:135], v[100:103]
    s_add_u32 s61, s68, 12288
    ds_read_b64_tr_b16 v[46:47], v4 offset:45568
    v_mul_f32 v26, v150, v150
    v_mfma_f32_16x16x32_bf16 v[104:107], v[48:51], a[136:139], v[104:107]
    buffer_load_dwordx4 v19, s[24:27], s56 offen lds
    v_mfma_f32_16x16x32_bf16 v[104:107], v[52:55], a[152:155], v[104:107]
    v_exp_f32 v23, v23
    v_mfma_f32_16x16x32_bf16 v[108:111], v[52:55], a[156:159], v[108:111]
    buffer_store_dwordx4 v[240:243], v1, s[44:47], s61 offen offset:3072 sc1
    v_mfma_f32_16x16x32_bf16 v[108:111], v[48:51], a[140:143], v[108:111]
    s_waitcnt lgkmcnt(4)
    v_fma_f32 v23, v23, s71, s71
    v_fmaak_f32 v26, v26, v3, 0xc1906ebb
    v_mfma_f32_16x16x32_bf16 v[124:127], v[56:59], a[140:143], v[124:127]
    ds_read_b64_tr_b16 v[48:49], v5 offset:40960
    v_mul_f32 v26, v26, v150
    v_mfma_f32_16x16x32_bf16 v[124:127], v[60:63], a[156:159], v[124:127]
    ds_read_b64_tr_b16 v[50:51], v5 offset:41472
    v_mfma_f32_16x16x32_bf16 v[120:123], v[60:63], a[152:155], v[120:123]
    ds_read_b64_tr_b16 v[52:53], v5 offset:45056
    v_mfma_f32_16x16x32_bf16 v[120:123], v[56:59], a[136:139], v[120:123]
    ds_read_b64_tr_b16 v[54:55], v5 offset:45568
    v_mul_f32 v27, v151, v151
    v_mfma_f32_16x16x32_bf16 v[116:119], v[56:59], a[132:135], v[116:119]
    v_rcp_f32 v23, v23
    v_mfma_f32_16x16x32_bf16 v[116:119], v[60:63], a[148:151], v[116:119]
    v_mul_f32 v135, v23, v135
    v_fmaak_f32 v27, v27, v3, 0xc1906ebb
    v_mfma_f32_16x16x32_bf16 v[112:115], v[60:63], a[144:147], v[112:115]
    v_exp_f32 v24, v24
    v_mfma_f32_16x16x32_bf16 v[112:115], v[56:59], a[128:131], v[112:115]
    s_waitcnt lgkmcnt(4)
    v_fma_f32 v24, v24, s71, s71
    v_mul_f32 v27, v27, v151
    v_mfma_f32_16x16x32_bf16 v[64:67], v[40:43], a[160:163], v[64:67]
    ds_read_b64_tr_b16 v[56:57], v6 offset:40960
    v_mfma_f32_16x16x32_bf16 v[64:67], v[44:47], a[176:179], v[64:67]
    ds_read_b64_tr_b16 v[58:59], v6 offset:41472
    v_rcp_f32 v24, v24
    v_mfma_f32_16x16x32_bf16 v[68:71], v[44:47], a[180:183], v[68:71]
    ds_read_b64_tr_b16 v[60:61], v6 offset:45056
    v_mul_f32 v148, v24, v148
    v_mfma_f32_16x16x32_bf16 v[68:71], v[40:43], a[164:167], v[68:71]
    ds_read_b64_tr_b16 v[62:63], v6 offset:45568
    v_mul_f32 v20, v164, v164
    v_mfma_f32_16x16x32_bf16 v[72:75], v[40:43], a[168:171], v[72:75]
    v_exp_f32 v25, v25
    v_mfma_f32_16x16x32_bf16 v[72:75], v[44:47], a[184:187], v[72:75]
    v_fma_f32 v25, v25, s71, s71
    v_fmaak_f32 v20, v20, v3, 0xc1906ebb
    v_mfma_f32_16x16x32_bf16 v[76:79], v[44:47], a[188:191], v[76:79]
    v_rcp_f32 v25, v25
    v_mfma_f32_16x16x32_bf16 v[76:79], v[40:43], a[172:175], v[76:79]
    s_waitcnt lgkmcnt(4)
    v_mul_f32 v149, v25, v149
    v_mul_f32 v20, v20, v164
    v_mfma_f32_16x16x32_bf16 v[92:95], v[48:51], a[172:175], v[92:95]
    ds_read_b64_tr_b16 v[40:41], v7 offset:40960
    v_mfma_f32_16x16x32_bf16 v[92:95], v[52:55], a[188:191], v[92:95]
    ds_read_b64_tr_b16 v[42:43], v7 offset:41472
    v_mfma_f32_16x16x32_bf16 v[88:91], v[52:55], a[184:187], v[88:91]
    ds_read_b64_tr_b16 v[44:45], v7 offset:45056
    v_mul_f32 v21, v165, v165
    v_mfma_f32_16x16x32_bf16 v[88:91], v[48:51], a[168:171], v[88:91]
    ds_read_b64_tr_b16 v[46:47], v7 offset:45568
    v_fmaak_f32 v21, v21, v3, 0xc1906ebb
    v_mfma_f32_16x16x32_bf16 v[84:87], v[48:51], a[164:167], v[84:87]
    v_exp_f32 v26, v26
    v_mfma_f32_16x16x32_bf16 v[84:87], v[52:55], a[180:183], v[84:87]
    v_fma_f32 v26, v26, s71, s71
    v_mul_f32 v21, v21, v165
    v_mfma_f32_16x16x32_bf16 v[80:83], v[52:55], a[176:179], v[80:83]
    s_waitcnt vmcnt(15) lgkmcnt(0)
    v_rcp_f32 v26, v26
    v_mfma_f32_16x16x32_bf16 v[80:83], v[48:51], a[160:163], v[80:83]
    s_barrier
    v_mul_f32 v150, v26, v150
    v_mfma_f32_16x16x32_bf16 v[96:99], v[56:59], a[160:163], v[96:99]
    ds_read_b64_tr_b16 v[48:49], v4 offset:49152
    v_mfma_f32_16x16x32_bf16 v[96:99], v[60:63], a[176:179], v[96:99]
    ds_read_b64_tr_b16 v[50:51], v4 offset:49664
    v_mfma_f32_16x16x32_bf16 v[100:103], v[60:63], a[180:183], v[100:103]
    ds_read_b64_tr_b16 v[52:53], v4 offset:53248
    v_mul_f32 v22, v166, v166
    v_mfma_f32_16x16x32_bf16 v[100:103], v[56:59], a[164:167], v[100:103]
    s_add_u32 s61, s68, 28672
    ds_read_b64_tr_b16 v[54:55], v4 offset:53760
    v_fmaak_f32 v22, v22, v3, 0xc1906ebb
    v_mfma_f32_16x16x32_bf16 v[104:107], v[56:59], a[168:171], v[104:107]
    buffer_store_dwordx4 v[248:251], v1, s[44:47], s61 offen offset:3072 sc1
    v_mfma_f32_16x16x32_bf16 v[104:107], v[60:63], a[184:187], v[104:107]
    v_exp_f32 v27, v27
    v_mfma_f32_16x16x32_bf16 v[108:111], v[60:63], a[188:191], v[108:111]
    s_lshr_b32 s67, s64, 3
    v_fma_f32 v27, v27, s71, s71
    v_mul_f32 v22, v22, v166
    v_mfma_f32_16x16x32_bf16 v[108:111], v[56:59], a[172:175], v[108:111]
    s_bfe_u32 s59, s64, 0x10002
    v_rcp_f32 v27, v27
    v_mfma_f32_16x16x32_bf16 v[124:127], v[40:43], a[172:175], v[124:127]
    s_lshl_b32 s59, s59, 3
    ds_read_b64_tr_b16 v[56:57], v5 offset:49152
    v_mul_f32 v151, v27, v151
    v_mfma_f32_16x16x32_bf16 v[124:127], v[44:47], a[188:191], v[124:127]
    s_add_u32 m0, s62, 32768
    ds_read_b64_tr_b16 v[58:59], v5 offset:49664
    v_exp_f32 v20, v20
    v_mfma_f32_16x16x32_bf16 v[120:123], v[44:47], a[184:187], v[120:123]
    s_add_u32 s56, s1, 2
    ds_read_b64_tr_b16 v[60:61], v5 offset:53248
    v_fma_f32 v20, v20, s71, s71
    v_mfma_f32_16x16x32_bf16 v[120:123], v[40:43], a[168:171], v[120:123]
    s_and_b32 s56, s56, 3
    ds_read_b64_tr_b16 v[62:63], v5 offset:53760
    v_mul_f32 v23, v167, v167
    v_mfma_f32_16x16x32_bf16 v[116:119], v[40:43], a[164:167], v[116:119]
    s_mul_i32 s56, s56, 1048576
    v_rcp_f32 v20, v20
    v_mfma_f32_16x16x32_bf16 v[116:119], v[44:47], a[180:183], v[116:119]
    s_add_u32 s56, s56, s75
    v_mul_f32 v164, v20, v164
    v_fmaak_f32 v23, v23, v3, 0xc1906ebb
    v_mfma_f32_16x16x32_bf16 v[112:115], v[44:47], a[176:179], v[112:115]
    s_add_u32 s59, s59, s63
    buffer_load_dwordx4 v8, s[12:15], s56 offen offset:0 lds
    v_mfma_f32_16x16x32_bf16 v[112:115], v[40:43], a[160:163], v[112:115]
    s_waitcnt lgkmcnt(4)
    v_exp_f32 v21, v21
    v_mfma_f32_16x16x32_bf16 v[64:67], v[48:51], a[192:195], v[64:67]
    s_lshl_b32 s59, s59, 2
    ds_read_b64_tr_b16 v[40:41], v6 offset:49152
    v_fma_f32 v21, v21, s71, s71
    v_mfma_f32_16x16x32_bf16 v[64:67], v[52:55], a[208:211], v[64:67]
    s_and_b32 s60, s64, 3
    ds_read_b64_tr_b16 v[42:43], v6 offset:49664
    v_mul_f32 v23, v23, v167
    v_mfma_f32_16x16x32_bf16 v[68:71], v[52:55], a[212:215], v[68:71]
    s_add_u32 s59, s59, s60
    ds_read_b64_tr_b16 v[44:45], v6 offset:53248
    v_mul_f32 v24, v180, v180
    v_mfma_f32_16x16x32_bf16 v[68:71], v[48:51], a[196:199], v[68:71]
    s_lshl_b32 s59, s59, 4
    ds_read_b64_tr_b16 v[46:47], v6 offset:53760
    v_fmaak_f32 v24, v24, v3, 0xc1906ebb
    v_mfma_f32_16x16x32_bf16 v[72:75], v[48:51], a[200:203], v[72:75]
    s_add_u32 s59, s59, s3
    buffer_load_dwordx4 v9, s[12:15], s56 offen offset:1024 lds
    v_mfma_f32_16x16x32_bf16 v[72:75], v[52:55], a[216:219], v[72:75]
    s_mul_i32 s68, s59, 6144
    v_rcp_f32 v21, v21
    v_mfma_f32_16x16x32_bf16 v[76:79], v[52:55], a[220:223], v[76:79]
    s_add_u32 s68, s68, 0x4000000
    v_mul_f32 v165, v21, v165
    v_mul_f32 v24, v24, v180
    v_mfma_f32_16x16x32_bf16 v[76:79], v[48:51], a[204:207], v[76:79]
    s_waitcnt lgkmcnt(4)
    buffer_load_dwordx4 v10, s[12:15], s56 offen offset:2048 lds
    v_mfma_f32_16x16x32_bf16 v[92:95], v[56:59], a[204:207], v[92:95]
    s_mul_i32 s59, s67, 24576
    ds_read_b64_tr_b16 v[48:49], v7 offset:49152
    v_mfma_f32_16x16x32_bf16 v[92:95], v[60:63], a[220:223], v[92:95]
    s_add_u32 s70, s59, s68
    ds_read_b64_tr_b16 v[50:51], v7 offset:49664
    v_mul_f32 v25, v181, v181
    v_mfma_f32_16x16x32_bf16 v[88:91], v[60:63], a[216:219], v[88:91]
    ds_read_b64_tr_b16 v[52:53], v7 offset:53248
    v_fmaak_f32 v25, v25, v3, 0xc1906ebb
    v_mfma_f32_16x16x32_bf16 v[88:91], v[56:59], a[200:203], v[88:91]
    ds_read_b64_tr_b16 v[54:55], v7 offset:53760
    v_mul_f32 v25, v25, v181
    v_mfma_f32_16x16x32_bf16 v[84:87], v[56:59], a[196:199], v[84:87]
    buffer_load_dwordx4 v11, s[12:15], s56 offen offset:3072 lds
    v_mfma_f32_16x16x32_bf16 v[84:87], v[60:63], a[212:215], v[84:87]
    s_add_u32 m0, s52, 4096
    v_exp_f32 v22, v22
    v_mfma_f32_16x16x32_bf16 v[80:83], v[60:63], a[208:211], v[80:83]
    s_add_u32 s56, s79, 16384
    v_fma_f32 v22, v22, s71, s71
    v_mfma_f32_16x16x32_bf16 v[80:83], v[56:59], a[192:195], v[80:83]
    s_waitcnt lgkmcnt(4)
    buffer_load_dwordx4 v18, s[24:27], s56 offen lds
    v_mfma_f32_16x16x32_bf16 v[96:99], v[40:43], a[192:195], v[96:99]
    ds_read_b64_tr_b16 v[56:57], v4 offset:57344
    v_mfma_f32_16x16x32_bf16 v[96:99], v[44:47], a[208:211], v[96:99]
    ds_read_b64_tr_b16 v[58:59], v4 offset:57856
    v_rcp_f32 v22, v22
    v_mfma_f32_16x16x32_bf16 v[100:103], v[44:47], a[212:215], v[100:103]
    ds_read_b64_tr_b16 v[60:61], v4 offset:61440
    v_mul_f32 v166, v22, v166
    v_mfma_f32_16x16x32_bf16 v[100:103], v[40:43], a[196:199], v[100:103]
    ds_read_b64_tr_b16 v[62:63], v4 offset:61952
    v_mul_f32 v26, v182, v182
    v_mfma_f32_16x16x32_bf16 v[104:107], v[40:43], a[200:203], v[104:107]
    v_xor_b32 v4, 0x10000, v4
    v_fmaak_f32 v26, v26, v3, 0xc1906ebb
    v_mfma_f32_16x16x32_bf16 v[104:107], v[44:47], a[216:219], v[104:107]
    v_exp_f32 v23, v23
    v_mfma_f32_16x16x32_bf16 v[108:111], v[44:47], a[220:223], v[108:111]
    v_fma_f32 v23, v23, s71, s71
    v_mul_f32 v26, v26, v182
    v_mfma_f32_16x16x32_bf16 v[108:111], v[40:43], a[204:207], v[108:111]
    s_waitcnt lgkmcnt(4)
    v_rcp_f32 v23, v23
    v_mfma_f32_16x16x32_bf16 v[124:127], v[48:51], a[204:207], v[124:127]
    ds_read_b64_tr_b16 v[40:41], v5 offset:57344
    v_mul_f32 v167, v23, v167
    v_mfma_f32_16x16x32_bf16 v[124:127], v[52:55], a[220:223], v[124:127]
    ds_read_b64_tr_b16 v[42:43], v5 offset:57856
    v_mul_f32 v27, v183, v183
    v_mfma_f32_16x16x32_bf16 v[120:123], v[52:55], a[216:219], v[120:123]
    ds_read_b64_tr_b16 v[44:45], v5 offset:61440
    v_fmaak_f32 v27, v27, v3, 0xc1906ebb
    v_mfma_f32_16x16x32_bf16 v[120:123], v[48:51], a[200:203], v[120:123]
    ds_read_b64_tr_b16 v[46:47], v5 offset:61952
    v_mul_f32 v27, v27, v183
    v_mfma_f32_16x16x32_bf16 v[116:119], v[48:51], a[196:199], v[116:119]
    v_xor_b32 v5, 0x10000, v5
    v_mfma_f32_16x16x32_bf16 v[116:119], v[52:55], a[212:215], v[116:119]
    v_exp_f32 v24, v24
    v_mfma_f32_16x16x32_bf16 v[112:115], v[52:55], a[208:211], v[112:115]
    v_fma_f32 v24, v24, s71, s71
    v_mfma_f32_16x16x32_bf16 v[112:115], v[48:51], a[192:195], v[112:115]
    s_waitcnt lgkmcnt(4)
    v_rcp_f32 v24, v24
    v_mfma_f32_16x16x32_bf16 v[64:67], v[56:59], a[224:227], v[64:67]
    ds_read_b64_tr_b16 v[48:49], v6 offset:57344
    v_mul_f32 v180, v24, v180
    v_mfma_f32_16x16x32_bf16 v[192:195], v[60:63], a[240:243], v[64:67]
    ds_read_b64_tr_b16 v[50:51], v6 offset:57856
    v_mul_f32 v20, v136, v136
    v_mfma_f32_16x16x32_bf16 v[68:71], v[60:63], a[244:247], v[68:71]
    ds_read_b64_tr_b16 v[52:53], v6 offset:61440
    v_fmaak_f32 v20, v20, v3, 0xc1906ebb
    v_mfma_f32_16x16x32_bf16 v[208:211], v[56:59], a[228:231], v[68:71]
    ds_read_b64_tr_b16 v[54:55], v6 offset:61952
    v_mul_f32 v20, v20, v136
    v_mfma_f32_16x16x32_bf16 v[72:75], v[56:59], a[232:235], v[72:75]
    v_xor_b32 v6, 0x10000, v6
    v_mfma_f32_16x16x32_bf16 v[224:227], v[60:63], a[248:251], v[72:75]
    v_exp_f32 v25, v25
    v_mfma_f32_16x16x32_bf16 v[76:79], v[60:63], a[252:255], v[76:79]
    v_fma_f32 v25, v25, s71, s71
    v_mfma_f32_16x16x32_bf16 v[240:243], v[56:59], a[236:239], v[76:79]
    s_waitcnt lgkmcnt(4)
    v_rcp_f32 v25, v25
    v_mfma_f32_16x16x32_bf16 v[80:83], v[40:43], a[224:227], v[80:83]
    ds_read_b64_tr_b16 v[56:57], v7 offset:57344
    v_mul_f32 v181, v25, v181
    v_mfma_f32_16x16x32_bf16 v[196:199], v[44:47], a[240:243], v[80:83]
    ds_read_b64_tr_b16 v[58:59], v7 offset:57856
    v_exp_f32 v26, v26
    v_mfma_f32_16x16x32_bf16 v[84:87], v[44:47], a[244:247], v[84:87]
    ds_read_b64_tr_b16 v[60:61], v7 offset:61440
    v_fma_f32 v26, v26, s71, s71
    v_mfma_f32_16x16x32_bf16 v[212:215], v[40:43], a[228:231], v[84:87]
    ds_read_b64_tr_b16 v[62:63], v7 offset:61952
    v_mul_f32 v21, v137, v137
    v_mfma_f32_16x16x32_bf16 v[88:91], v[40:43], a[232:235], v[88:91]
    v_xor_b32 v7, 0x10000, v7
    v_fmaak_f32 v21, v21, v3, 0xc1906ebb
    v_mfma_f32_16x16x32_bf16 v[228:231], v[44:47], a[248:251], v[88:91]
    v_rcp_f32 v26, v26
    v_mfma_f32_16x16x32_bf16 v[92:95], v[44:47], a[252:255], v[92:95]
    s_waitcnt vmcnt(15) lgkmcnt(0)
    v_mul_f32 v182, v26, v182
    v_mul_f32 v21, v21, v137
    v_mfma_f32_16x16x32_bf16 v[244:247], v[40:43], a[236:239], v[92:95]
    s_barrier
    v_exp_f32 v27, v27
    v_mfma_f32_16x16x32_bf16 v[96:99], v[48:51], a[224:227], v[96:99]
    ds_read_b64_tr_b16 v[40:41], v4 offset:0
    v_fma_f32 v27, v27, s71, s71
    v_mfma_f32_16x16x32_bf16 v[200:203], v[52:55], a[240:243], v[96:99]
    ds_read_b64_tr_b16 v[42:43], v4 offset:512
    v_mul_f32 v22, v138, v138
    v_mfma_f32_16x16x32_bf16 v[100:103], v[52:55], a[244:247], v[100:103]
    ds_read_b64_tr_b16 v[44:45], v4 offset:4096
    v_fmaak_f32 v22, v22, v3, 0xc1906ebb
    v_mfma_f32_16x16x32_bf16 v[216:219], v[48:51], a[228:231], v[100:103]
    ds_read_b64_tr_b16 v[46:47], v4 offset:4608
    v_mul_f32 v22, v22, v138
    v_mfma_f32_16x16x32_bf16 v[104:107], v[48:51], a[232:235], v[104:107]
    v_rcp_f32 v27, v27
    v_mfma_f32_16x16x32_bf16 v[232:235], v[52:55], a[248:251], v[104:107]
    s_add_u32 m0, s62, 49152
    v_mul_f32 v183, v27, v183
    v_mul_f32 v192, v128, v192
    v_mfma_f32_16x16x32_bf16 v[108:111], v[52:55], a[252:255], v[108:111]
    s_add_u32 s56, s1, 3
    v_exp_f32 v20, v20
    v_mfma_f32_16x16x32_bf16 v[248:251], v[48:51], a[236:239], v[108:111]
    s_and_b32 s56, s56, 3
    v_fma_f32 v20, v20, s71, s71
    v_mul_f32 v23, v139, v139
    v_mfma_f32_16x16x32_bf16 v[112:115], v[56:59], a[224:227], v[112:115]
    s_mul_i32 s56, s56, 1048576
    ds_read_b64_tr_b16 v[48:49], v5 offset:0
    v_fmaak_f32 v23, v23, v3, 0xc1906ebb
    v_mfma_f32_16x16x32_bf16 v[204:207], v[60:63], a[240:243], v[112:115]
    s_add_u32 s56, s56, s75
    ds_read_b64_tr_b16 v[50:51], v5 offset:512
    v_mul_f32 v23, v23, v139
    v_mfma_f32_16x16x32_bf16 v[116:119], v[60:63], a[244:247], v[116:119]
    ds_read_b64_tr_b16 v[52:53], v5 offset:4096
    v_mul_f32 v193, v129, v193
    v_mfma_f32_16x16x32_bf16 v[220:223], v[56:59], a[228:231], v[116:119]
    ds_read_b64_tr_b16 v[54:55], v5 offset:4608
    v_mul_f32 v194, v130, v194
    v_mfma_f32_16x16x32_bf16 v[120:123], v[56:59], a[232:235], v[120:123]
    buffer_load_dwordx4 v8, s[12:15], s56 offen offset:0 lds
    v_mfma_f32_16x16x32_bf16 v[236:239], v[60:63], a[248:251], v[120:123]
    v_rcp_f32 v20, v20
    v_mfma_f32_16x16x32_bf16 v[124:127], v[60:63], a[252:255], v[124:127]
    v_mul_f32 v136, v20, v136
    v_mul_f32 v195, v131, v195
    v_mfma_f32_16x16x32_bf16 v[252:255], v[56:59], a[236:239], v[124:127]
    s_waitcnt lgkmcnt(4)
    buffer_load_dwordx4 v9, s[12:15], s56 offen offset:1024 lds
    v_mfma_f32_16x16x32_bf16 v[64:67], v[40:43], a[0:3], 0
    ds_read_b64_tr_b16 v[56:57], v6 offset:0
    v_mul_f32 v24, v152, v152
    v_mfma_f32_16x16x32_bf16 v[64:67], v[44:47], a[16:19], v[64:67]
    ds_read_b64_tr_b16 v[58:59], v6 offset:512
    v_exp_f32 v21, v21
    v_mfma_f32_16x16x32_bf16 v[68:71], v[44:47], a[20:23], 0
    ds_read_b64_tr_b16 v[60:61], v6 offset:4096
    v_fma_f32 v21, v21, s71, s71
    v_mfma_f32_16x16x32_bf16 v[68:71], v[40:43], a[4:7], v[68:71]
    ds_read_b64_tr_b16 v[62:63], v6 offset:4608
    v_fmaak_f32 v24, v24, v3, 0xc1906ebb
    v_mfma_f32_16x16x32_bf16 v[72:75], v[40:43], a[8:11], 0
    buffer_load_dwordx4 v10, s[12:15], s56 offen offset:2048 lds
    v_mfma_f32_16x16x32_bf16 v[72:75], v[44:47], a[24:27], v[72:75]
    v_rcp_f32 v21, v21
    v_mfma_f32_16x16x32_bf16 v[76:79], v[44:47], a[28:31], 0
    v_mul_f32 v137, v21, v137
    v_mul_f32 v24, v24, v152
    v_mfma_f32_16x16x32_bf16 v[76:79], v[40:43], a[12:15], v[76:79]
    s_waitcnt lgkmcnt(4)
    buffer_load_dwordx4 v11, s[12:15], s56 offen offset:3072 lds
    v_mfma_f32_16x16x32_bf16 v[92:95], v[48:51], a[12:15], 0
    s_add_u32 m0, s52, 5120
    ds_read_b64_tr_b16 v[40:41], v7 offset:0
    v_mul_f32 v25, v153, v153
    v_mfma_f32_16x16x32_bf16 v[92:95], v[52:55], a[28:31], v[92:95]
    s_add_u32 s56, s79, 20480
    ds_read_b64_tr_b16 v[42:43], v7 offset:512
    v_fmaak_f32 v25, v25, v3, 0xc1906ebb
    v_mfma_f32_16x16x32_bf16 v[88:91], v[52:55], a[24:27], 0
    ds_read_b64_tr_b16 v[44:45], v7 offset:4096
    v_mul_f32 v25, v25, v153
    v_mfma_f32_16x16x32_bf16 v[88:91], v[48:51], a[8:11], v[88:91]
    ds_read_b64_tr_b16 v[46:47], v7 offset:4608
    v_mul_f32 v208, v144, v208
    v_mfma_f32_16x16x32_bf16 v[84:87], v[48:51], a[4:7], 0
    buffer_load_dwordx4 v19, s[24:27], s56 offen lds
    v_mfma_f32_16x16x32_bf16 v[84:87], v[52:55], a[20:23], v[84:87]
    v_exp_f32 v22, v22
    v_mfma_f32_16x16x32_bf16 v[80:83], v[52:55], a[16:19], 0
    v_fma_f32 v22, v22, s71, s71
    v_mul_f32 v26, v154, v154
    v_mfma_f32_16x16x32_bf16 v[80:83], v[48:51], a[0:3], v[80:83]
    s_waitcnt lgkmcnt(4)
    v_rcp_f32 v22, v22
    v_mfma_f32_16x16x32_bf16 v[96:99], v[56:59], a[0:3], 0
    ds_read_b64_tr_b16 v[48:49], v4 offset:8192
    v_mul_f32 v138, v22, v138
    v_mfma_f32_16x16x32_bf16 v[96:99], v[60:63], a[16:19], v[96:99]
    ds_read_b64_tr_b16 v[50:51], v4 offset:8704
    v_fmaak_f32 v26, v26, v3, 0xc1906ebb
    v_mfma_f32_16x16x32_bf16 v[100:103], v[60:63], a[20:23], 0
    ds_read_b64_tr_b16 v[52:53], v4 offset:12288
    v_mul_f32 v26, v26, v154
    v_mfma_f32_16x16x32_bf16 v[100:103], v[56:59], a[4:7], v[100:103]
    ds_read_b64_tr_b16 v[54:55], v4 offset:12800
    v_mul_f32 v209, v145, v209
    v_mfma_f32_16x16x32_bf16 v[104:107], v[56:59], a[8:11], 0
    v_exp_f32 v23, v23
    v_mfma_f32_16x16x32_bf16 v[104:107], v[60:63], a[24:27], v[104:107]
    v_fma_f32 v23, v23, s71, s71
    v_mul_f32 v210, v146, v210
    v_mfma_f32_16x16x32_bf16 v[108:111], v[60:63], a[28:31], 0
    v_rcp_f32 v23, v23
    v_mfma_f32_16x16x32_bf16 v[108:111], v[56:59], a[12:15], v[108:111]
    s_waitcnt lgkmcnt(4)
    v_mul_f32 v139, v23, v139
    v_mul_f32 v27, v155, v155
    v_mfma_f32_16x16x32_bf16 v[124:127], v[40:43], a[12:15], 0
    ds_read_b64_tr_b16 v[56:57], v5 offset:8192
    v_fmaak_f32 v27, v27, v3, 0xc1906ebb
    v_mfma_f32_16x16x32_bf16 v[124:127], v[44:47], a[28:31], v[124:127]
    ds_read_b64_tr_b16 v[58:59], v5 offset:8704
    v_exp_f32 v24, v24
    v_mfma_f32_16x16x32_bf16 v[120:123], v[44:47], a[24:27], 0
    ds_read_b64_tr_b16 v[60:61], v5 offset:12288
    v_fma_f32 v24, v24, s71, s71
    v_mfma_f32_16x16x32_bf16 v[120:123], v[40:43], a[8:11], v[120:123]
    ds_read_b64_tr_b16 v[62:63], v5 offset:12800
    v_mul_f32 v27, v27, v155
    v_mfma_f32_16x16x32_bf16 v[116:119], v[40:43], a[4:7], 0
    v_rcp_f32 v24, v24
    v_mfma_f32_16x16x32_bf16 v[116:119], v[44:47], a[20:23], v[116:119]
    v_mul_f32 v152, v24, v152
    v_mul_f32 v211, v147, v211
    v_mfma_f32_16x16x32_bf16 v[112:115], v[44:47], a[16:19], 0
    v_exp_f32 v25, v25
    v_mfma_f32_16x16x32_bf16 v[112:115], v[40:43], a[0:3], v[112:115]
    s_waitcnt lgkmcnt(4)
    v_fma_f32 v25, v25, s71, s71
    v_mul_f32 v20, v168, v168
    v_mfma_f32_16x16x32_bf16 v[64:67], v[48:51], a[32:35], v[64:67]
    ds_read_b64_tr_b16 v[40:41], v6 offset:8192
    v_fmaak_f32 v20, v20, v3, 0xc1906ebb
    v_mfma_f32_16x16x32_bf16 v[64:67], v[52:55], a[48:51], v[64:67]
    ds_read_b64_tr_b16 v[42:43], v6 offset:8704
    v_mul_f32 v20, v20, v168
    v_mfma_f32_16x16x32_bf16 v[68:71], v[52:55], a[52:55], v[68:71]
    ds_read_b64_tr_b16 v[44:45], v6 offset:12288
    v_mul_f32 v224, v160, v224
    v_mfma_f32_16x16x32_bf16 v[68:71], v[48:51], a[36:39], v[68:71]
    ds_read_b64_tr_b16 v[46:47], v6 offset:12800
    v_mul_f32 v225, v161, v225
    v_mfma_f32_16x16x32_bf16 v[72:75], v[48:51], a[40:43], v[72:75]
    v_rcp_f32 v25, v25
    v_mfma_f32_16x16x32_bf16 v[72:75], v[52:55], a[56:59], v[72:75]
    v_mul_f32 v153, v25, v153
    v_mul_f32 v21, v169, v169
    v_mfma_f32_16x16x32_bf16 v[76:79], v[52:55], a[60:63], v[76:79]
    v_exp_f32 v26, v26
    v_mfma_f32_16x16x32_bf16 v[76:79], v[48:51], a[44:47], v[76:79]
    s_waitcnt lgkmcnt(4)
    v_fma_f32 v26, v26, s71, s71
    v_fmaak_f32 v21, v21, v3, 0xc1906ebb
    v_mfma_f32_16x16x32_bf16 v[92:95], v[56:59], a[44:47], v[92:95]
    ds_read_b64_tr_b16 v[48:49], v7 offset:8192
    v_mul_f32 v21, v21, v169
    v_mfma_f32_16x16x32_bf16 v[92:95], v[60:63], a[60:63], v[92:95]
    ds_read_b64_tr_b16 v[50:51], v7 offset:8704
    v_mul_f32 v226, v162, v226
    v_mfma_f32_16x16x32_bf16 v[88:91], v[60:63], a[56:59], v[88:91]
    ds_read_b64_tr_b16 v[52:53], v7 offset:12288
    v_mul_f32 v227, v163, v227
    v_mfma_f32_16x16x32_bf16 v[88:91], v[56:59], a[40:43], v[88:91]
    ds_read_b64_tr_b16 v[54:55], v7 offset:12800
    v_mul_f32 v240, v176, v240
    v_mfma_f32_16x16x32_bf16 v[84:87], v[56:59], a[36:39], v[84:87]
    v_rcp_f32 v26, v26
    v_mfma_f32_16x16x32_bf16 v[84:87], v[60:63], a[52:55], v[84:87]
    s_add_u32 m0, s52, 6144
    v_mul_f32 v154, v26, v154
    v_mul_f32 v22, v170, v170
    v_mfma_f32_16x16x32_bf16 v[80:83], v[60:63], a[48:51], v[80:83]
    s_waitcnt vmcnt(10) lgkmcnt(0)
    v_exp_f32 v27, v27
    v_mfma_f32_16x16x32_bf16 v[80:83], v[56:59], a[32:35], v[80:83]
    s_barrier
    v_fma_f32 v27, v27, s71, s71
    v_fmaak_f32 v22, v22, v3, 0xc1906ebb
    v_mfma_f32_16x16x32_bf16 v[96:99], v[40:43], a[32:35], v[96:99]
    s_add_u32 s56, s79, 24576
    ds_read_b64_tr_b16 v[56:57], v4 offset:16384
    v_mul_f32 v22, v22, v170
    v_mfma_f32_16x16x32_bf16 v[96:99], v[44:47], a[48:51], v[96:99]
    s_mov_b32 s96, s72
    ds_read_b64_tr_b16 v[58:59], v4 offset:16896
    v_rcp_f32 v27, v27
    v_mfma_f32_16x16x32_bf16 v[100:103], v[44:47], a[52:55], v[100:103]
    ds_read_b64_tr_b16 v[60:61], v4 offset:20480
    v_mov_b32 v13, 1
    v_mfma_f32_16x16x32_bf16 v[100:103], v[40:43], a[36:39], v[100:103]
    ds_read_b64_tr_b16 v[62:63], v4 offset:20992
    v_mul_f32 v155, v27, v155
    v_mfma_f32_16x16x32_bf16 v[104:107], v[40:43], a[40:43], v[104:107]
    buffer_load_dwordx4 v18, s[24:27], s56 offen lds
    v_mfma_f32_16x16x32_bf16 v[104:107], v[44:47], a[56:59], v[104:107]
    s_add_u32 m0, s62, 65536
    v_exp_f32 v20, v20
    v_mfma_f32_16x16x32_bf16 v[108:111], v[44:47], a[60:63], v[108:111]
    s_add_u32 s56, s1, 0
    v_fma_f32 v20, v20, s71, s71
    v_mul_f32 v23, v171, v171
    v_mfma_f32_16x16x32_bf16 v[108:111], v[40:43], a[44:47], v[108:111]
    s_and_b32 s56, s56, 3
    v_rcp_f32 v20, v20
    v_mfma_f32_16x16x32_bf16 v[124:127], v[48:51], a[44:47], v[124:127]
    s_mul_i32 s56, s56, 1048576
    ds_read_b64_tr_b16 v[40:41], v5 offset:16384
    v_mul_f32 v168, v20, v168
    v_mfma_f32_16x16x32_bf16 v[124:127], v[52:55], a[60:63], v[124:127]
    s_add_u32 s56, s56, s75
    ds_read_b64_tr_b16 v[42:43], v5 offset:16896
    v_fmaak_f32 v23, v23, v3, 0xc1906ebb
    v_mfma_f32_16x16x32_bf16 v[120:123], v[52:55], a[56:59], v[120:123]
    s_add_u32 s56, s56, 128
    ds_read_b64_tr_b16 v[44:45], v5 offset:20480
    v_mul_f32 v23, v23, v171
    v_mfma_f32_16x16x32_bf16 v[120:123], v[48:51], a[40:43], v[120:123]
    ds_read_b64_tr_b16 v[46:47], v5 offset:20992
    v_mul_f32 v241, v177, v241
    v_mfma_f32_16x16x32_bf16 v[116:119], v[48:51], a[36:39], v[116:119]
    buffer_load_dwordx4 v8, s[12:15], s56 offen offset:0 lds
    v_mfma_f32_16x16x32_bf16 v[116:119], v[52:55], a[52:55], v[116:119]
    v_exp_f32 v21, v21
    v_mfma_f32_16x16x32_bf16 v[112:115], v[52:55], a[48:51], v[112:115]
    v_fma_f32 v21, v21, s71, s71
    v_mul_f32 v24, v184, v184
    v_mfma_f32_16x16x32_bf16 v[112:115], v[48:51], a[32:35], v[112:115]
    s_waitcnt lgkmcnt(4)
    buffer_load_dwordx4 v9, s[12:15], s56 offen offset:1024 lds
    v_mfma_f32_16x16x32_bf16 v[64:67], v[56:59], a[64:67], v[64:67]
K_PG6:
    s_cmp_eq_u32 s100, 1
    s_cbranch_scc1 K_PG10
    ds_read_b64_tr_b16 v[48:49], v6 offset:16384
    v_fmaak_f32 v24, v24, v3, 0xc1906ebb
    v_mfma_f32_16x16x32_bf16 v[64:67], v[60:63], a[80:83], v[64:67]
    ds_read_b64_tr_b16 v[50:51], v6 offset:16896
    v_mul_f32 v24, v24, v184
    v_mfma_f32_16x16x32_bf16 v[68:71], v[60:63], a[84:87], v[68:71]
    ds_read_b64_tr_b16 v[52:53], v6 offset:20480
    v_mul_f32 v242, v178, v242
    v_mfma_f32_16x16x32_bf16 v[68:71], v[56:59], a[68:71], v[68:71]
    s_lshl_b32 s72, s3, 13
    ds_read_b64_tr_b16 v[54:55], v6 offset:20992
    v_mul_f32 v243, v179, v243
    v_mfma_f32_16x16x32_bf16 v[72:75], v[56:59], a[72:75], v[72:75]
    buffer_load_dwordx4 v10, s[12:15], s56 offen offset:2048 lds
    v_mfma_f32_16x16x32_bf16 v[72:75], v[60:63], a[88:91], v[72:75]
    v_rcp_f32 v21, v21
    v_mfma_f32_16x16x32_bf16 v[76:79], v[60:63], a[92:95], v[76:79]
    v_mul_f32 v169, v21, v169
    v_mul_f32 v25, v185, v185
    v_mfma_f32_16x16x32_bf16 v[76:79], v[56:59], a[76:79], v[76:79]
    s_waitcnt lgkmcnt(4)
    buffer_load_dwordx4 v11, s[12:15], s56 offen offset:3072 lds
    v_mfma_f32_16x16x32_bf16 v[92:95], v[40:43], a[76:79], v[92:95]
    ds_read_b64_tr_b16 v[56:57], v7 offset:16384
    v_fmaak_f32 v25, v25, v3, 0xc1906ebb
    v_mfma_f32_16x16x32_bf16 v[92:95], v[44:47], a[92:95], v[92:95]
    ds_read_b64_tr_b16 v[58:59], v7 offset:16896
    v_exp_f32 v22, v22
    v_mfma_f32_16x16x32_bf16 v[88:91], v[44:47], a[88:91], v[88:91]
    ds_read_b64_tr_b16 v[60:61], v7 offset:20480
    v_fma_f32 v22, v22, s71, s71
    v_mfma_f32_16x16x32_bf16 v[88:91], v[40:43], a[72:75], v[88:91]
    ds_read_b64_tr_b16 v[62:63], v7 offset:20992
    v_mul_f32 v25, v25, v185
    v_mfma_f32_16x16x32_bf16 v[84:87], v[40:43], a[68:71], v[84:87]
    buffer_atomic_add v13, v14, s[44:47], s96 offen
    v_mfma_f32_16x16x32_bf16 v[84:87], v[44:47], a[84:87], v[84:87]
    v_rcp_f32 v22, v22
    v_mfma_f32_16x16x32_bf16 v[80:83], v[44:47], a[80:83], v[80:83]
    v_mul_f32 v170, v22, v170
    v_mul_f32 v26, v186, v186
    v_mfma_f32_16x16x32_bf16 v[80:83], v[40:43], a[64:67], v[80:83]
    s_waitcnt lgkmcnt(4)
    v_exp_f32 v23, v23
    v_mfma_f32_16x16x32_bf16 v[96:99], v[48:51], a[64:67], v[96:99]
    ds_read_b64_tr_b16 v[40:41], v4 offset:24576
    v_fma_f32 v23, v23, s71, s71
    v_mfma_f32_16x16x32_bf16 v[96:99], v[52:55], a[80:83], v[96:99]
    ds_read_b64_tr_b16 v[42:43], v4 offset:25088
    v_fmaak_f32 v26, v26, v3, 0xc1906ebb
    v_mfma_f32_16x16x32_bf16 v[100:103], v[52:55], a[84:87], v[100:103]
    ds_read_b64_tr_b16 v[44:45], v4 offset:28672
    v_mul_f32 v26, v26, v186
    v_mfma_f32_16x16x32_bf16 v[100:103], v[48:51], a[68:71], v[100:103]
    ds_read_b64_tr_b16 v[46:47], v4 offset:29184
    v_mul_f32 v27, v187, v187
    v_mfma_f32_16x16x32_bf16 v[104:107], v[48:51], a[72:75], v[104:107]
    v_rcp_f32 v23, v23
    v_mfma_f32_16x16x32_bf16 v[104:107], v[52:55], a[88:91], v[104:107]
    v_mul_f32 v171, v23, v171
    v_fmaak_f32 v27, v27, v3, 0xc1906ebb
    v_mfma_f32_16x16x32_bf16 v[108:111], v[52:55], a[92:95], v[108:111]
    v_exp_f32 v24, v24
    v_mfma_f32_16x16x32_bf16 v[108:111], v[48:51], a[76:79], v[108:111]
    s_waitcnt lgkmcnt(4)
    v_fma_f32 v24, v24, s71, s71
    v_mul_f32 v27, v27, v187
    v_mfma_f32_16x16x32_bf16 v[124:127], v[56:59], a[76:79], v[124:127]
    ds_read_b64_tr_b16 v[48:49], v5 offset:24576
    v_mul_f32 v196, v132, v196
    v_mfma_f32_16x16x32_bf16 v[124:127], v[60:63], a[92:95], v[124:127]
    ds_read_b64_tr_b16 v[50:51], v5 offset:25088
    v_mul_f32 v197, v133, v197
    v_mfma_f32_16x16x32_bf16 v[120:123], v[60:63], a[88:91], v[120:123]
    ds_read_b64_tr_b16 v[52:53], v5 offset:28672
    v_mul_f32 v198, v134, v198
    v_mfma_f32_16x16x32_bf16 v[120:123], v[56:59], a[72:75], v[120:123]
    ds_read_b64_tr_b16 v[54:55], v5 offset:29184
    v_mul_f32 v20, v140, v140
    v_mfma_f32_16x16x32_bf16 v[116:119], v[56:59], a[68:71], v[116:119]
    v_rcp_f32 v24, v24
    v_mfma_f32_16x16x32_bf16 v[116:119], v[60:63], a[84:87], v[116:119]
    v_mul_f32 v184, v24, v184
    v_fmaak_f32 v20, v20, v3, 0xc1906ebb
    v_mfma_f32_16x16x32_bf16 v[112:115], v[60:63], a[80:83], v[112:115]
    v_exp_f32 v25, v25
    v_mfma_f32_16x16x32_bf16 v[112:115], v[56:59], a[64:67], v[112:115]
    s_waitcnt lgkmcnt(4)
    v_fma_f32 v25, v25, s71, s71
    v_mul_f32 v20, v20, v140
    v_mfma_f32_16x16x32_bf16 v[64:67], v[40:43], a[96:99], v[64:67]
    s_add_u32 m0, s52, 7168
    ds_read_b64_tr_b16 v[56:57], v6 offset:24576
    v_mul_f32 v199, v135, v199
    v_mfma_f32_16x16x32_bf16 v[64:67], v[44:47], a[112:115], v[64:67]
    s_add_u32 s56, s79, 28672
    ds_read_b64_tr_b16 v[58:59], v6 offset:25088
    v_rcp_f32 v25, v25
    v_mfma_f32_16x16x32_bf16 v[68:71], v[44:47], a[116:119], v[68:71]
    ds_read_b64_tr_b16 v[60:61], v6 offset:28672
    v_mul_f32 v185, v25, v185
    v_mfma_f32_16x16x32_bf16 v[68:71], v[40:43], a[100:103], v[68:71]
    ds_read_b64_tr_b16 v[62:63], v6 offset:29184
    v_mul_f32 v21, v141, v141
    v_mfma_f32_16x16x32_bf16 v[72:75], v[40:43], a[104:107], v[72:75]
    buffer_load_dwordx4 v19, s[24:27], s56 offen lds
    v_mfma_f32_16x16x32_bf16 v[72:75], v[44:47], a[120:123], v[72:75]
    v_exp_f32 v26, v26
    v_mfma_f32_16x16x32_bf16 v[76:79], v[44:47], a[124:127], v[76:79]
    v_fma_f32 v26, v26, s71, s71
    v_fmaak_f32 v21, v21, v3, 0xc1906ebb
    v_mfma_f32_16x16x32_bf16 v[76:79], v[40:43], a[108:111], v[76:79]
    s_waitcnt lgkmcnt(4)
    v_rcp_f32 v26, v26
    v_mfma_f32_16x16x32_bf16 v[92:95], v[48:51], a[108:111], v[92:95]
    ds_read_b64_tr_b16 v[40:41], v7 offset:24576
    v_mul_f32 v186, v26, v186
    v_mfma_f32_16x16x32_bf16 v[92:95], v[52:55], a[124:127], v[92:95]
    ds_read_b64_tr_b16 v[42:43], v7 offset:25088
    v_mul_f32 v21, v21, v141
    v_mfma_f32_16x16x32_bf16 v[88:91], v[52:55], a[120:123], v[88:91]
    ds_read_b64_tr_b16 v[44:45], v7 offset:28672
    v_mul_f32 v212, v148, v212
    v_mfma_f32_16x16x32_bf16 v[88:91], v[48:51], a[104:107], v[88:91]
    ds_read_b64_tr_b16 v[46:47], v7 offset:29184
    v_mul_f32 v22, v142, v142
    v_mfma_f32_16x16x32_bf16 v[84:87], v[48:51], a[100:103], v[84:87]
    v_exp_f32 v27, v27
    v_mfma_f32_16x16x32_bf16 v[84:87], v[52:55], a[116:119], v[84:87]
    s_add_u32 m0, s62, 81920
    v_fma_f32 v27, v27, s71, s71
    v_fmaak_f32 v22, v22, v3, 0xc1906ebb
    v_mfma_f32_16x16x32_bf16 v[80:83], v[52:55], a[112:115], v[80:83]
    s_waitcnt vmcnt(13) lgkmcnt(0)
    v_rcp_f32 v27, v27
    v_mfma_f32_16x16x32_bf16 v[80:83], v[48:51], a[96:99], v[80:83]
    s_barrier
    v_mul_f32 v187, v27, v187
    v_mul_f32 v22, v22, v142
    v_mfma_f32_16x16x32_bf16 v[96:99], v[56:59], a[96:99], v[96:99]
    s_add_u32 s56, s1, 1
    ds_read_b64_tr_b16 v[48:49], v4 offset:32768
    v_mul_f32 v213, v149, v213
    v_mfma_f32_16x16x32_bf16 v[96:99], v[60:63], a[112:115], v[96:99]
    s_and_b32 s56, s56, 3
    ds_read_b64_tr_b16 v[50:51], v4 offset:33280
    v_mul_f32 v214, v150, v214
    v_mfma_f32_16x16x32_bf16 v[100:103], v[60:63], a[116:119], v[100:103]
    s_mul_i32 s56, s56, 1048576
    ds_read_b64_tr_b16 v[52:53], v4 offset:36864
    v_mul_f32 v23, v143, v143
    v_mfma_f32_16x16x32_bf16 v[100:103], v[56:59], a[100:103], v[100:103]
    s_add_u32 s56, s56, s75
    ds_read_b64_tr_b16 v[54:55], v4 offset:37376
    v_fmaak_f32 v23, v23, v3, 0xc1906ebb
    v_mfma_f32_16x16x32_bf16 v[104:107], v[56:59], a[104:107], v[104:107]
    s_add_u32 s56, s56, 128
    v_exp_f32 v20, v20
    v_mfma_f32_16x16x32_bf16 v[104:107], v[60:63], a[120:123], v[104:107]
    buffer_load_dwordx4 v8, s[12:15], s56 offen offset:0 lds
    v_mfma_f32_16x16x32_bf16 v[108:111], v[60:63], a[124:127], v[108:111]
    v_fma_f32 v20, v20, s71, s71
    v_mul_f32 v23, v23, v143
    v_mfma_f32_16x16x32_bf16 v[108:111], v[56:59], a[108:111], v[108:111]
    v_rcp_f32 v20, v20
    v_mfma_f32_16x16x32_bf16 v[124:127], v[40:43], a[108:111], v[124:127]
    ds_read_b64_tr_b16 v[56:57], v5 offset:32768
    v_mul_f32 v140, v20, v140
    v_mfma_f32_16x16x32_bf16 v[124:127], v[44:47], a[124:127], v[124:127]
    ds_read_b64_tr_b16 v[58:59], v5 offset:33280
    v_exp_f32 v21, v21
    v_mfma_f32_16x16x32_bf16 v[120:123], v[44:47], a[120:123], v[120:123]
    ds_read_b64_tr_b16 v[60:61], v5 offset:36864
    v_fma_f32 v21, v21, s71, s71
    v_mfma_f32_16x16x32_bf16 v[120:123], v[40:43], a[104:107], v[120:123]
    ds_read_b64_tr_b16 v[62:63], v5 offset:37376
    v_mul_f32 v24, v156, v156
    v_mfma_f32_16x16x32_bf16 v[116:119], v[40:43], a[100:103], v[116:119]
    buffer_load_dwordx4 v9, s[12:15], s56 offen offset:1024 lds
    v_mfma_f32_16x16x32_bf16 v[116:119], v[44:47], a[116:119], v[116:119]
    v_rcp_f32 v21, v21
    v_mfma_f32_16x16x32_bf16 v[112:115], v[44:47], a[112:115], v[112:115]
    v_mul_f32 v141, v21, v141
    v_fmaak_f32 v24, v24, v3, 0xc1906ebb
    v_mfma_f32_16x16x32_bf16 v[112:115], v[40:43], a[96:99], v[112:115]
    s_waitcnt lgkmcnt(4)
    buffer_load_dwordx4 v10, s[12:15], s56 offen offset:2048 lds
    v_mfma_f32_16x16x32_bf16 v[64:67], v[48:51], a[128:131], v[64:67]
    ds_read_b64_tr_b16 v[40:41], v6 offset:32768
    v_mul_f32 v24, v24, v156
    v_mfma_f32_16x16x32_bf16 v[64:67], v[52:55], a[144:147], v[64:67]
    ds_read_b64_tr_b16 v[42:43], v6 offset:33280
    v_mul_f32 v215, v151, v215
    v_mfma_f32_16x16x32_bf16 v[68:71], v[52:55], a[148:151], v[68:71]
    ds_read_b64_tr_b16 v[44:45], v6 offset:36864
    v_mul_f32 v25, v157, v157
    v_mfma_f32_16x16x32_bf16 v[68:71], v[48:51], a[132:135], v[68:71]
    ds_read_b64_tr_b16 v[46:47], v6 offset:37376
    v_fmaak_f32 v25, v25, v3, 0xc1906ebb
    v_mfma_f32_16x16x32_bf16 v[72:75], v[48:51], a[136:139], v[72:75]
    buffer_load_dwordx4 v11, s[12:15], s56 offen offset:3072 lds
    v_mfma_f32_16x16x32_bf16 v[72:75], v[52:55], a[152:155], v[72:75]
    v_exp_f32 v22, v22
    v_mfma_f32_16x16x32_bf16 v[76:79], v[52:55], a[156:159], v[76:79]
    v_fma_f32 v22, v22, s71, s71
    v_mul_f32 v25, v25, v157
    v_mfma_f32_16x16x32_bf16 v[76:79], v[48:51], a[140:143], v[76:79]
    s_waitcnt lgkmcnt(4)
    v_rcp_f32 v22, v22
    v_mfma_f32_16x16x32_bf16 v[92:95], v[56:59], a[140:143], v[92:95]
    ds_read_b64_tr_b16 v[48:49], v7 offset:32768
    v_mul_f32 v142, v22, v142
    v_mfma_f32_16x16x32_bf16 v[92:95], v[60:63], a[156:159], v[92:95]
    ds_read_b64_tr_b16 v[50:51], v7 offset:33280
    v_mul_f32 v26, v158, v158
    v_mfma_f32_16x16x32_bf16 v[88:91], v[60:63], a[152:155], v[88:91]
    ds_read_b64_tr_b16 v[52:53], v7 offset:36864
    v_fmaak_f32 v26, v26, v3, 0xc1906ebb
    v_mfma_f32_16x16x32_bf16 v[88:91], v[56:59], a[136:139], v[88:91]
    ds_read_b64_tr_b16 v[54:55], v7 offset:37376
    v_mul_f32 v26, v26, v158
    v_mfma_f32_16x16x32_bf16 v[84:87], v[56:59], a[132:135], v[84:87]
    v_exp_f32 v23, v23
    v_mfma_f32_16x16x32_bf16 v[84:87], v[60:63], a[148:151], v[84:87]
    v_fma_f32 v23, v23, s71, s71
    v_mul_f32 v228, v164, v228
    v_mfma_f32_16x16x32_bf16 v[80:83], v[60:63], a[144:147], v[80:83]
    v_rcp_f32 v23, v23
    v_mfma_f32_16x16x32_bf16 v[80:83], v[56:59], a[128:131], v[80:83]
    s_waitcnt lgkmcnt(4)
    v_mul_f32 v143, v23, v143
    v_mul_f32 v229, v165, v229
    v_mfma_f32_16x16x32_bf16 v[96:99], v[40:43], a[128:131], v[96:99]
    ds_read_b64_tr_b16 v[56:57], v4 offset:40960
    v_mul_f32 v230, v166, v230
    v_mfma_f32_16x16x32_bf16 v[96:99], v[44:47], a[144:147], v[96:99]
    ds_read_b64_tr_b16 v[58:59], v4 offset:41472
    v_exp_f32 v24, v24
    v_mfma_f32_16x16x32_bf16 v[100:103], v[44:47], a[148:151], v[100:103]
    ds_read_b64_tr_b16 v[60:61], v4 offset:45056
    v_fma_f32 v24, v24, s71, s71
    v_mfma_f32_16x16x32_bf16 v[100:103], v[40:43], a[132:135], v[100:103]
    ds_read_b64_tr_b16 v[62:63], v4 offset:45568
    v_mul_f32 v27, v159, v159
    v_mfma_f32_16x16x32_bf16 v[104:107], v[40:43], a[136:139], v[104:107]
    v_rcp_f32 v24, v24
    v_mfma_f32_16x16x32_bf16 v[104:107], v[44:47], a[152:155], v[104:107]
    v_mul_f32 v156, v24, v156
    v_fmaak_f32 v27, v27, v3, 0xc1906ebb
    v_mfma_f32_16x16x32_bf16 v[108:111], v[44:47], a[156:159], v[108:111]
    v_exp_f32 v25, v25
    v_mfma_f32_16x16x32_bf16 v[108:111], v[40:43], a[140:143], v[108:111]
    s_waitcnt lgkmcnt(4)
    v_fma_f32 v25, v25, s71, s71
    v_mul_f32 v27, v27, v159
    v_mfma_f32_16x16x32_bf16 v[124:127], v[48:51], a[140:143], v[124:127]
    ds_read_b64_tr_b16 v[40:41], v5 offset:40960
    v_mul_f32 v231, v167, v231
    v_mfma_f32_16x16x32_bf16 v[124:127], v[52:55], a[156:159], v[124:127]
    ds_read_b64_tr_b16 v[42:43], v5 offset:41472
    v_mul_f32 v20, v172, v172
    v_mfma_f32_16x16x32_bf16 v[120:123], v[52:55], a[152:155], v[120:123]
    ds_read_b64_tr_b16 v[44:45], v5 offset:45056
    v_fmaak_f32 v20, v20, v3, 0xc1906ebb
    v_mfma_f32_16x16x32_bf16 v[120:123], v[48:51], a[136:139], v[120:123]
    ds_read_b64_tr_b16 v[46:47], v5 offset:45568
    v_mul_f32 v20, v20, v172
    v_mfma_f32_16x16x32_bf16 v[116:119], v[48:51], a[132:135], v[116:119]
    v_rcp_f32 v25, v25
    v_mfma_f32_16x16x32_bf16 v[116:119], v[52:55], a[148:151], v[116:119]
    v_mul_f32 v157, v25, v157
    v_mul_f32 v244, v180, v244
    v_mfma_f32_16x16x32_bf16 v[112:115], v[52:55], a[144:147], v[112:115]
    v_exp_f32 v26, v26
    v_mfma_f32_16x16x32_bf16 v[112:115], v[48:51], a[128:131], v[112:115]
    s_waitcnt lgkmcnt(4)
    v_fma_f32 v26, v26, s71, s71
    v_mul_f32 v245, v181, v245
    v_mfma_f32_16x16x32_bf16 v[64:67], v[56:59], a[160:163], v[64:67]
    ds_read_b64_tr_b16 v[48:49], v6 offset:40960
    v_mul_f32 v21, v173, v173
    v_mfma_f32_16x16x32_bf16 v[64:67], v[60:63], a[176:179], v[64:67]
    ds_read_b64_tr_b16 v[50:51], v6 offset:41472
    v_fmaak_f32 v21, v21, v3, 0xc1906ebb
    v_mfma_f32_16x16x32_bf16 v[68:71], v[60:63], a[180:183], v[68:71]
    ds_read_b64_tr_b16 v[52:53], v6 offset:45056
    v_mul_f32 v21, v21, v173
    v_mfma_f32_16x16x32_bf16 v[68:71], v[56:59], a[164:167], v[68:71]
    ds_read_b64_tr_b16 v[54:55], v6 offset:45568
    v_mul_f32 v246, v182, v246
    v_mfma_f32_16x16x32_bf16 v[72:75], v[56:59], a[168:171], v[72:75]
    v_rcp_f32 v26, v26
    v_mfma_f32_16x16x32_bf16 v[72:75], v[60:63], a[184:187], v[72:75]
    v_mul_f32 v158, v26, v158
    v_mul_f32 v247, v183, v247
    v_mfma_f32_16x16x32_bf16 v[76:79], v[60:63], a[188:191], v[76:79]
    v_exp_f32 v27, v27
    v_mfma_f32_16x16x32_bf16 v[76:79], v[56:59], a[172:175], v[76:79]
    s_waitcnt lgkmcnt(4)
    v_fma_f32 v27, v27, s71, s71
    v_mul_f32 v200, v136, v200
    v_mfma_f32_16x16x32_bf16 v[92:95], v[40:43], a[172:175], v[92:95]
    ds_read_b64_tr_b16 v[56:57], v7 offset:40960
    v_mul_f32 v22, v174, v174
    v_mfma_f32_16x16x32_bf16 v[92:95], v[44:47], a[188:191], v[92:95]
    s_add_u32 m0, s62, 98304
    ds_read_b64_tr_b16 v[58:59], v7 offset:41472
    v_rcp_f32 v27, v27
    v_mfma_f32_16x16x32_bf16 v[88:91], v[44:47], a[184:187], v[88:91]
    s_add_u32 s56, s1, 2
    ds_read_b64_tr_b16 v[60:61], v7 offset:45056
    v_mul_f32 v159, v27, v159
    v_mfma_f32_16x16x32_bf16 v[88:91], v[40:43], a[168:171], v[88:91]
    s_and_b32 s56, s56, 3
    ds_read_b64_tr_b16 v[62:63], v7 offset:45568
    v_fmaak_f32 v22, v22, v3, 0xc1906ebb
    v_mfma_f32_16x16x32_bf16 v[84:87], v[40:43], a[164:167], v[84:87]
    s_mul_i32 s56, s56, 1048576
    v_exp_f32 v20, v20
    v_mfma_f32_16x16x32_bf16 v[84:87], v[44:47], a[180:183], v[84:87]
    s_add_u32 s56, s56, s75
    v_fma_f32 v20, v20, s71, s71
    v_mul_f32 v22, v22, v174
    v_mfma_f32_16x16x32_bf16 v[80:83], v[44:47], a[176:179], v[80:83]
    s_waitcnt vmcnt(12) lgkmcnt(0)
    v_rcp_f32 v20, v20
    v_mfma_f32_16x16x32_bf16 v[80:83], v[40:43], a[160:163], v[80:83]
    s_barrier
    v_mul_f32 v172, v20, v172
    v_mul_f32 v201, v137, v201
    v_mfma_f32_16x16x32_bf16 v[96:99], v[48:51], a[160:163], v[96:99]
    s_add_u32 s56, s56, 128
    ds_read_b64_tr_b16 v[40:41], v4 offset:49152
    v_mul_f32 v23, v175, v175
    v_mfma_f32_16x16x32_bf16 v[96:99], v[52:55], a[176:179], v[96:99]
    ds_read_b64_tr_b16 v[42:43], v4 offset:49664
    v_fmaak_f32 v23, v23, v3, 0xc1906ebb
    v_mfma_f32_16x16x32_bf16 v[100:103], v[52:55], a[180:183], v[100:103]
    ds_read_b64_tr_b16 v[44:45], v4 offset:53248
    v_mul_f32 v23, v23, v175
    v_mfma_f32_16x16x32_bf16 v[100:103], v[48:51], a[164:167], v[100:103]
    ds_read_b64_tr_b16 v[46:47], v4 offset:53760
    v_mul_f32 v202, v138, v202
    v_mfma_f32_16x16x32_bf16 v[104:107], v[48:51], a[168:171], v[104:107]
    buffer_load_dwordx4 v8, s[12:15], s56 offen offset:0 lds
    v_mfma_f32_16x16x32_bf16 v[104:107], v[52:55], a[184:187], v[104:107]
    v_exp_f32 v21, v21
    v_mfma_f32_16x16x32_bf16 v[108:111], v[52:55], a[188:191], v[108:111]
    v_fma_f32 v21, v21, s71, s71
    v_mul_f32 v203, v139, v203
    v_mfma_f32_16x16x32_bf16 v[108:111], v[48:51], a[172:175], v[108:111]
    buffer_load_dwordx4 v9, s[12:15], s56 offen offset:1024 lds
    v_mfma_f32_16x16x32_bf16 v[124:127], v[56:59], a[172:175], v[124:127]
    ds_read_b64_tr_b16 v[48:49], v5 offset:49152
    v_mul_f32 v24, v188, v188
    v_mfma_f32_16x16x32_bf16 v[124:127], v[60:63], a[188:191], v[124:127]
    ds_read_b64_tr_b16 v[50:51], v5 offset:49664
    v_fmaak_f32 v24, v24, v3, 0xc1906ebb
    v_mfma_f32_16x16x32_bf16 v[120:123], v[60:63], a[184:187], v[120:123]
    ds_read_b64_tr_b16 v[52:53], v5 offset:53248
    v_mul_f32 v24, v24, v188
    v_mfma_f32_16x16x32_bf16 v[120:123], v[56:59], a[168:171], v[120:123]
    ds_read_b64_tr_b16 v[54:55], v5 offset:53760
    v_mul_f32 v216, v152, v216
    v_mfma_f32_16x16x32_bf16 v[116:119], v[56:59], a[164:167], v[116:119]
    buffer_load_dwordx4 v10, s[12:15], s56 offen offset:2048 lds
    v_mfma_f32_16x16x32_bf16 v[116:119], v[60:63], a[180:183], v[116:119]
    v_rcp_f32 v21, v21
    v_mfma_f32_16x16x32_bf16 v[112:115], v[60:63], a[176:179], v[112:115]
    v_mul_f32 v173, v21, v173
    v_mul_f32 v217, v153, v217
    v_mfma_f32_16x16x32_bf16 v[112:115], v[56:59], a[160:163], v[112:115]
    s_waitcnt lgkmcnt(4)
    buffer_load_dwordx4 v11, s[12:15], s56 offen offset:3072 lds
    v_mfma_f32_16x16x32_bf16 v[64:67], v[40:43], a[192:195], v[64:67]
    ds_read_b64_tr_b16 v[56:57], v6 offset:49152
    v_mul_f32 v25, v189, v189
    v_mfma_f32_16x16x32_bf16 v[64:67], v[44:47], a[208:211], v[64:67]
    ds_read_b64_tr_b16 v[58:59], v6 offset:49664
    v_exp_f32 v22, v22
    v_mfma_f32_16x16x32_bf16 v[68:71], v[44:47], a[212:215], v[68:71]
    ds_read_b64_tr_b16 v[60:61], v6 offset:53248
    v_fma_f32 v22, v22, s71, s71
    v_mfma_f32_16x16x32_bf16 v[68:71], v[40:43], a[196:199], v[68:71]
    ds_read_b64_tr_b16 v[62:63], v6 offset:53760
    v_fmaak_f32 v25, v25, v3, 0xc1906ebb
    v_mfma_f32_16x16x32_bf16 v[72:75], v[40:43], a[200:203], v[72:75]
    v_rcp_f32 v22, v22
    v_mfma_f32_16x16x32_bf16 v[72:75], v[44:47], a[216:219], v[72:75]
    v_mul_f32 v174, v22, v174
    v_mul_f32 v25, v25, v189
    v_mfma_f32_16x16x32_bf16 v[76:79], v[44:47], a[220:223], v[76:79]
    v_exp_f32 v23, v23
    v_mfma_f32_16x16x32_bf16 v[76:79], v[40:43], a[204:207], v[76:79]
    s_waitcnt lgkmcnt(4)
    v_fma_f32 v23, v23, s71, s71
    v_mul_f32 v26, v190, v190
    v_mfma_f32_16x16x32_bf16 v[92:95], v[48:51], a[204:207], v[92:95]
    ds_read_b64_tr_b16 v[40:41], v7 offset:49152
    v_fmaak_f32 v26, v26, v3, 0xc1906ebb
    v_mfma_f32_16x16x32_bf16 v[92:95], v[52:55], a[220:223], v[92:95]
    ds_read_b64_tr_b16 v[42:43], v7 offset:49664
    v_mul_f32 v26, v26, v190
    v_mfma_f32_16x16x32_bf16 v[88:91], v[52:55], a[216:219], v[88:91]
    ds_read_b64_tr_b16 v[44:45], v7 offset:53248
    v_mul_f32 v218, v154, v218
    v_mfma_f32_16x16x32_bf16 v[88:91], v[48:51], a[200:203], v[88:91]
    ds_read_b64_tr_b16 v[46:47], v7 offset:53760
    v_mul_f32 v219, v155, v219
    v_mfma_f32_16x16x32_bf16 v[84:87], v[48:51], a[196:199], v[84:87]
    v_rcp_f32 v23, v23
    v_mfma_f32_16x16x32_bf16 v[84:87], v[52:55], a[212:215], v[84:87]
    v_mul_f32 v175, v23, v175
    v_mul_f32 v232, v168, v232
    v_mfma_f32_16x16x32_bf16 v[80:83], v[52:55], a[208:211], v[80:83]
    v_exp_f32 v24, v24
    v_mfma_f32_16x16x32_bf16 v[80:83], v[48:51], a[192:195], v[80:83]
    s_waitcnt lgkmcnt(4)
    v_fma_f32 v24, v24, s71, s71
    v_mul_f32 v27, v191, v191
    v_mfma_f32_16x16x32_bf16 v[96:99], v[56:59], a[192:195], v[96:99]
    ds_read_b64_tr_b16 v[48:49], v4 offset:57344
    v_fmaak_f32 v27, v27, v3, 0xc1906ebb
    v_mfma_f32_16x16x32_bf16 v[96:99], v[60:63], a[208:211], v[96:99]
    ds_read_b64_tr_b16 v[50:51], v4 offset:57856
    v_mul_f32 v27, v27, v191
    v_mfma_f32_16x16x32_bf16 v[100:103], v[60:63], a[212:215], v[100:103]
    ds_read_b64_tr_b16 v[52:53], v4 offset:61440
    v_mul_f32 v233, v169, v233
    v_mfma_f32_16x16x32_bf16 v[100:103], v[56:59], a[196:199], v[100:103]
    ds_read_b64_tr_b16 v[54:55], v4 offset:61952
    v_mul_f32 v234, v170, v234
    v_mfma_f32_16x16x32_bf16 v[104:107], v[56:59], a[200:203], v[104:107]
    v_xor_b32 v4, 0x10000, v4
    v_mul_f32 v235, v171, v235
    v_mfma_f32_16x16x32_bf16 v[104:107], v[60:63], a[216:219], v[104:107]
    v_rcp_f32 v24, v24
    v_mfma_f32_16x16x32_bf16 v[108:111], v[60:63], a[220:223], v[108:111]
    v_mul_f32 v188, v24, v188
    v_mul_f32 v248, v184, v248
    v_mfma_f32_16x16x32_bf16 v[108:111], v[56:59], a[204:207], v[108:111]
    s_waitcnt lgkmcnt(4)
    v_exp_f32 v25, v25
    v_mfma_f32_16x16x32_bf16 v[124:127], v[40:43], a[204:207], v[124:127]
    ds_read_b64_tr_b16 v[56:57], v5 offset:57344
    v_fma_f32 v25, v25, s71, s71
    v_mfma_f32_16x16x32_bf16 v[124:127], v[44:47], a[220:223], v[124:127]
    ds_read_b64_tr_b16 v[58:59], v5 offset:57856
    v_rcp_f32 v25, v25
    v_mfma_f32_16x16x32_bf16 v[120:123], v[44:47], a[216:219], v[120:123]
    ds_read_b64_tr_b16 v[60:61], v5 offset:61440
    v_mul_f32 v189, v25, v189
    v_mfma_f32_16x16x32_bf16 v[120:123], v[40:43], a[200:203], v[120:123]
    ds_read_b64_tr_b16 v[62:63], v5 offset:61952
    v_mul_f32 v249, v185, v249
    v_mfma_f32_16x16x32_bf16 v[116:119], v[40:43], a[196:199], v[116:119]
    v_xor_b32 v5, 0x10000, v5
    v_mul_f32 v250, v186, v250
    v_mfma_f32_16x16x32_bf16 v[116:119], v[44:47], a[212:215], v[116:119]
    v_exp_f32 v26, v26
    v_mfma_f32_16x16x32_bf16 v[112:115], v[44:47], a[208:211], v[112:115]
    v_fma_f32 v26, v26, s71, s71
    v_mul_f32 v251, v187, v251
    v_mfma_f32_16x16x32_bf16 v[112:115], v[40:43], a[192:195], v[112:115]
    s_waitcnt lgkmcnt(4)
    v_rcp_f32 v26, v26
    v_mfma_f32_16x16x32_bf16 v[64:67], v[48:51], a[224:227], v[64:67]
    ds_read_b64_tr_b16 v[40:41], v6 offset:57344
    v_mul_f32 v190, v26, v190
    v_mfma_f32_16x16x32_bf16 v[128:131], v[52:55], a[240:243], v[64:67]
    ds_read_b64_tr_b16 v[42:43], v6 offset:57856
    v_mul_f32 v204, v140, v204
    v_mfma_f32_16x16x32_bf16 v[68:71], v[52:55], a[244:247], v[68:71]
    ds_read_b64_tr_b16 v[44:45], v6 offset:61440
    v_mul_f32 v205, v141, v205
    v_mfma_f32_16x16x32_bf16 v[144:147], v[48:51], a[228:231], v[68:71]
    ds_read_b64_tr_b16 v[46:47], v6 offset:61952
    v_mul_f32 v206, v142, v206
    v_mfma_f32_16x16x32_bf16 v[72:75], v[48:51], a[232:235], v[72:75]
    v_xor_b32 v6, 0x10000, v6
    v_mul_f32 v207, v143, v207
    v_mfma_f32_16x16x32_bf16 v[160:163], v[52:55], a[248:251], v[72:75]
    s_add_u32 m0, s62, 114688
    v_exp_f32 v27, v27
    v_mfma_f32_16x16x32_bf16 v[76:79], v[52:55], a[252:255], v[76:79]
    s_add_u32 s56, s1, 3
    v_fma_f32 v27, v27, s71, s71
    v_mul_f32 v220, v156, v220
    v_mfma_f32_16x16x32_bf16 v[176:179], v[48:51], a[236:239], v[76:79]
    s_waitcnt lgkmcnt(4)
    v_rcp_f32 v27, v27
    v_mfma_f32_16x16x32_bf16 v[80:83], v[56:59], a[224:227], v[80:83]
    s_and_b32 s56, s56, 3
    ds_read_b64_tr_b16 v[48:49], v7 offset:57344
    v_mul_f32 v191, v27, v191
    v_mfma_f32_16x16x32_bf16 v[132:135], v[60:63], a[240:243], v[80:83]
    s_mul_i32 s56, s56, 1048576
    ds_read_b64_tr_b16 v[50:51], v7 offset:57856
    v_mul_f32 v221, v157, v221
    v_mfma_f32_16x16x32_bf16 v[84:87], v[60:63], a[244:247], v[84:87]
    s_add_u32 s56, s56, s75
    ds_read_b64_tr_b16 v[52:53], v7 offset:61440
    v_mul_f32 v222, v158, v222
    v_mfma_f32_16x16x32_bf16 v[148:151], v[56:59], a[228:231], v[84:87]
    s_add_u32 s56, s56, 128
    ds_read_b64_tr_b16 v[54:55], v7 offset:61952
    v_mul_f32 v223, v159, v223
    v_mfma_f32_16x16x32_bf16 v[88:91], v[56:59], a[232:235], v[88:91]
    v_xor_b32 v7, 0x10000, v7
    v_mul_f32 v236, v172, v236
    v_mfma_f32_16x16x32_bf16 v[164:167], v[60:63], a[248:251], v[88:91]
    buffer_load_dwordx4 v8, s[12:15], s56 offen offset:0 lds
    v_mfma_f32_16x16x32_bf16 v[92:95], v[60:63], a[252:255], v[92:95]
    s_waitcnt vmcnt(11) lgkmcnt(0)
    v_mul_f32 v237, v173, v237
    v_mul_f32 v238, v174, v238
    v_mfma_f32_16x16x32_bf16 v[180:183], v[56:59], a[236:239], v[92:95]
    s_barrier
    v_mul_f32 v239, v175, v239
    v_mul_f32 v252, v188, v252
    v_mfma_f32_16x16x32_bf16 v[96:99], v[40:43], a[224:227], v[96:99]
    s_add_u32 s61, s77, 0
    ds_read_b64_tr_b16 v[56:57], v4 offset:0
    v_mul_f32 v253, v189, v253
    v_mfma_f32_16x16x32_bf16 v[136:139], v[44:47], a[240:243], v[96:99]
    ds_read_b64_tr_b16 v[58:59], v4 offset:512
    v_mul_f32 v254, v190, v254
    v_mul_f32 v255, v191, v255
    v_mfma_f32_16x16x32_bf16 v[100:103], v[44:47], a[244:247], v[100:103]
    ds_read_b64_tr_b16 v[60:61], v4 offset:4096
    v_cvt_pk_bf16_f32 v192, v192, v193
    v_mfma_f32_16x16x32_bf16 v[152:155], v[40:43], a[228:231], v[100:103]
    ds_read_b64_tr_b16 v[62:63], v4 offset:4608
    v_cvt_pk_bf16_f32 v193, v194, v195
    v_mfma_f32_16x16x32_bf16 v[104:107], v[40:43], a[232:235], v[104:107]
    s_lshl_b32 s96, s64, 7
    buffer_load_dwordx4 v9, s[12:15], s56 offen offset:1024 lds
    v_mfma_f32_16x16x32_bf16 v[168:171], v[44:47], a[248:251], v[104:107]
    s_add_u32 s96, s96, 0x3900000
    v_cvt_pk_bf16_f32 v194, v196, v197
    v_cvt_pk_bf16_f32 v195, v198, v199
    v_mfma_f32_16x16x32_bf16 v[108:111], v[44:47], a[252:255], v[108:111]
    v_mov_b32 v12, 0
    v_cvt_pk_bf16_f32 v208, v208, v209
    v_mfma_f32_16x16x32_bf16 v[184:187], v[40:43], a[236:239], v[108:111]
    buffer_load_dwordx4 v10, s[12:15], s56 offen offset:2048 lds
    v_mfma_f32_16x16x32_bf16 v[112:115], v[48:51], a[224:227], v[112:115]
    ds_read_b64_tr_b16 v[40:41], v5 offset:0
    v_cvt_pk_bf16_f32 v209, v210, v211
    v_mfma_f32_16x16x32_bf16 v[140:143], v[52:55], a[240:243], v[112:115]
    ds_read_b64_tr_b16 v[42:43], v5 offset:512
    v_cvt_pk_bf16_f32 v210, v212, v213
    v_mfma_f32_16x16x32_bf16 v[116:119], v[52:55], a[244:247], v[116:119]
    ds_read_b64_tr_b16 v[44:45], v5 offset:4096
    v_cvt_pk_bf16_f32 v211, v214, v215
    v_mfma_f32_16x16x32_bf16 v[156:159], v[48:51], a[228:231], v[116:119]
    ds_read_b64_tr_b16 v[46:47], v5 offset:4608
    v_cvt_pk_bf16_f32 v224, v224, v225
    v_mfma_f32_16x16x32_bf16 v[120:123], v[48:51], a[232:235], v[120:123]
    buffer_load_dwordx4 v11, s[12:15], s56 offen offset:3072 lds
    v_mfma_f32_16x16x32_bf16 v[172:175], v[52:55], a[248:251], v[120:123]
    v_cvt_pk_bf16_f32 v225, v226, v227
    v_cvt_pk_bf16_f32 v226, v228, v229
    v_mfma_f32_16x16x32_bf16 v[124:127], v[52:55], a[252:255], v[124:127]
    buffer_load_dword v13, v12, s[44:47], s96 offen sc1
    v_mfma_f32_16x16x32_bf16 v[188:191], v[48:51], a[236:239], v[124:127]
    s_waitcnt lgkmcnt(4)
    v_cvt_pk_bf16_f32 v227, v230, v231
    v_cvt_pk_bf16_f32 v240, v240, v241
    v_mfma_f32_16x16x32_bf16 v[64:67], v[56:59], a[0:3], 0
    ds_read_b64_tr_b16 v[48:49], v6 offset:0
    v_cvt_pk_bf16_f32 v241, v242, v243
    v_mfma_f32_16x16x32_bf16 v[64:67], v[60:63], a[16:19], v[64:67]
    ds_read_b64_tr_b16 v[50:51], v6 offset:512
    v_cvt_pk_bf16_f32 v242, v244, v245
    v_mfma_f32_16x16x32_bf16 v[68:71], v[60:63], a[20:23], 0
    ds_read_b64_tr_b16 v[52:53], v6 offset:4096
    v_cvt_pk_bf16_f32 v243, v246, v247
    v_mfma_f32_16x16x32_bf16 v[68:71], v[56:59], a[4:7], v[68:71]
    ds_read_b64_tr_b16 v[54:55], v6 offset:4608
    v_mfma_f32_16x16x32_bf16 v[72:75], v[56:59], a[8:11], 0
    buffer_store_dwordx4 v[192:195], v28, s[44:47], s61 offen offset:0 sc1
    v_mfma_f32_16x16x32_bf16 v[72:75], v[60:63], a[24:27], v[72:75]
    s_add_u32 s61, s77, 0
    v_mfma_f32_16x16x32_bf16 v[76:79], v[60:63], a[28:31], 0
    buffer_store_dwordx4 v[208:211], v28, s[44:47], s61 offen offset:1024 sc1
    v_mfma_f32_16x16x32_bf16 v[76:79], v[56:59], a[12:15], v[76:79]
    s_waitcnt lgkmcnt(4)
    v_mfma_f32_16x16x32_bf16 v[92:95], v[40:43], a[12:15], 0
    s_add_u32 s61, s78, 0
    ds_read_b64_tr_b16 v[56:57], v7 offset:0
    v_xor_b32 v33, 64, v32
    v_mfma_f32_16x16x32_bf16 v[92:95], v[44:47], a[28:31], v[92:95]
    ds_read_b64_tr_b16 v[58:59], v7 offset:512
    v_xor_b32 v34, 128, v32
    v_mfma_f32_16x16x32_bf16 v[88:91], v[44:47], a[24:27], 0
    s_bfe_u32 s57, s64, 0x10002
    ds_read_b64_tr_b16 v[60:61], v7 offset:4096
    v_xor_b32 v35, 192, v32
    v_mfma_f32_16x16x32_bf16 v[88:91], v[40:43], a[8:11], v[88:91]
    s_lshl_b32 s57, s57, 3
    ds_read_b64_tr_b16 v[62:63], v7 offset:4608
    v_and_b32 v37, 15, v0
    v_mfma_f32_16x16x32_bf16 v[84:87], v[40:43], a[4:7], 0
    s_add_u32 s57, s57, s63
    buffer_store_dwordx4 v[224:227], v28, s[44:47], s61 offen offset:0 sc1
    v_mfma_f32_16x16x32_bf16 v[84:87], v[44:47], a[20:23], v[84:87]
    s_add_u32 s61, s78, 0
    v_and_b32 v38, 48, v0
    v_lshl_add_u32 v36, v37, 10, v38
    v_mfma_f32_16x16x32_bf16 v[80:83], v[44:47], a[16:19], 0
K_PG7:
    s_cmp_eq_u32 s100, 1
    s_cbranch_scc1 K_PG11
    s_and_b32 s58, s64, 3
    buffer_store_dwordx4 v[240:243], v28, s[44:47], s61 offen offset:1024 sc1
    v_mfma_f32_16x16x32_bf16 v[80:83], v[40:43], a[0:3], v[80:83]
    s_waitcnt lgkmcnt(4)
    v_mfma_f32_16x16x32_bf16 v[96:99], v[48:51], a[0:3], 0
    s_add_u32 s61, s77, 4096
    ds_read_b64_tr_b16 v[40:41], v4 offset:8192
    v_mfma_f32_16x16x32_bf16 v[96:99], v[52:55], a[16:19], v[96:99]
    s_lshr_b32 s60, s3, 1
    ds_read_b64_tr_b16 v[42:43], v4 offset:8704
    v_mfma_f32_16x16x32_bf16 v[100:103], v[52:55], a[20:23], 0
    s_sub_u32 s59, s58, s57
    ds_read_b64_tr_b16 v[44:45], v4 offset:12288
    v_mfma_f32_16x16x32_bf16 v[100:103], v[48:51], a[4:7], v[100:103]
    s_mul_i32 s59, s59, s60
    ds_read_b64_tr_b16 v[46:47], v4 offset:12800
    v_mfma_f32_16x16x32_bf16 v[104:107], v[48:51], a[8:11], 0
    s_add_u32 s59, s59, s57
    v_cvt_pk_bf16_f32 v200, v200, v201
    v_cvt_pk_bf16_f32 v201, v202, v203
    v_mfma_f32_16x16x32_bf16 v[104:107], v[52:55], a[24:27], v[104:107]
    s_lshl_b32 s59, s59, 1
    v_cvt_pk_bf16_f32 v202, v204, v205
    v_cvt_pk_bf16_f32 v203, v206, v207
    v_mfma_f32_16x16x32_bf16 v[108:111], v[52:55], a[28:31], 0
    s_and_b32 s84, s3, 1
    buffer_store_dwordx4 v[200:203], v28, s[44:47], s61 offen offset:0 sc1
    v_mfma_f32_16x16x32_bf16 v[108:111], v[48:51], a[12:15], v[108:111]
    s_waitcnt lgkmcnt(4)
    v_mfma_f32_16x16x32_bf16 v[124:127], v[56:59], a[12:15], 0
    s_add_u32 s59, s59, s84
    ds_read_b64_tr_b16 v[48:49], v5 offset:8192
    v_mfma_f32_16x16x32_bf16 v[124:127], v[60:63], a[28:31], v[124:127]
    s_mul_i32 s59, s59, 753664
    ds_read_b64_tr_b16 v[50:51], v5 offset:8704
    v_mfma_f32_16x16x32_bf16 v[120:123], v[60:63], a[24:27], 0
    s_mul_i32 s65, s60, 0x1800000
    ds_read_b64_tr_b16 v[52:53], v5 offset:12288
    v_mfma_f32_16x16x32_bf16 v[120:123], v[56:59], a[8:11], v[120:123]
    s_add_u32 s59, s59, s65
    ds_read_b64_tr_b16 v[54:55], v5 offset:12800
    v_mfma_f32_16x16x32_bf16 v[116:119], v[56:59], a[4:7], 0
    s_add_u32 s59, s59, 0x21ff000
    v_mfma_f32_16x16x32_bf16 v[116:119], v[60:63], a[20:23], v[116:119]
    s_mul_i32 s65, s67, 57344
    v_mfma_f32_16x16x32_bf16 v[112:115], v[60:63], a[16:19], 0
    s_add_u32 s65, s65, s59
    v_mfma_f32_16x16x32_bf16 v[112:115], v[56:59], a[0:3], v[112:115]
    s_waitcnt lgkmcnt(4)
    v_mfma_f32_16x16x32_bf16 v[64:67], v[40:43], a[32:35], v[64:67]
    s_lshl_b32 s66, s67, 17
    ds_read_b64_tr_b16 v[56:57], v6 offset:8192
    v_mfma_f32_16x16x32_bf16 v[64:67], v[44:47], a[48:51], v[64:67]
    s_add_u32 s66, s66, s59
    ds_read_b64_tr_b16 v[58:59], v6 offset:8704
    v_mfma_f32_16x16x32_bf16 v[68:71], v[44:47], a[52:55], v[68:71]
    s_add_u32 s66, s66, 229376
    ds_read_b64_tr_b16 v[60:61], v6 offset:12288
    v_cvt_pk_bf16_f32 v128, v128, v129
    v_mfma_f32_16x16x32_bf16 v[68:71], v[40:43], a[36:39], v[68:71]
    s_lshl_b32 s0, s58, 1
    ds_read_b64_tr_b16 v[62:63], v6 offset:12800
    v_cvt_pk_bf16_f32 v129, v130, v131
    v_mfma_f32_16x16x32_bf16 v[72:75], v[40:43], a[40:43], v[72:75]
    s_add_u32 s0, s0, s84
    v_cvt_pk_bf16_f32 v130, v132, v133
    v_cvt_pk_bf16_f32 v131, v134, v135
    v_mfma_f32_16x16x32_bf16 v[72:75], v[44:47], a[56:59], v[72:75]
    s_mul_i32 s0, s0, 753664
    v_accvgpr_write_b32 a0, v128
    v_accvgpr_write_b32 a1, v129
    v_mfma_f32_16x16x32_bf16 v[76:79], v[44:47], a[60:63], v[76:79]
    s_mul_i32 s59, s67, 57344
    v_accvgpr_write_b32 a2, v130
    v_accvgpr_write_b32 a3, v131
    v_mfma_f32_16x16x32_bf16 v[76:79], v[40:43], a[44:47], v[76:79]
    s_waitcnt lgkmcnt(4)
    v_mov_b32 v128, 0
    v_mov_b32 v129, 0
    v_mfma_f32_16x16x32_bf16 v[92:95], v[48:51], a[44:47], v[92:95]
    s_add_u32 s0, s0, s59
    ds_read_b64_tr_b16 v[40:41], v7 offset:8192
    v_mov_b32 v130, 0
    v_mfma_f32_16x16x32_bf16 v[92:95], v[52:55], a[60:63], v[92:95]
    s_add_u32 s0, s0, 0x3a00000
    ds_read_b64_tr_b16 v[42:43], v7 offset:8704
    v_mov_b32 v131, 0
    v_mfma_f32_16x16x32_bf16 v[88:91], v[52:55], a[56:59], v[88:91]
    s_lshl_b32 s1, s57, 1
    ds_read_b64_tr_b16 v[44:45], v7 offset:12288
    v_mov_b32 v132, 0
    v_mfma_f32_16x16x32_bf16 v[88:91], v[48:51], a[40:43], v[88:91]
    s_add_u32 s1, s1, s60
    ds_read_b64_tr_b16 v[46:47], v7 offset:12800
    v_mov_b32 v133, 0
    v_mfma_f32_16x16x32_bf16 v[84:87], v[48:51], a[36:39], v[84:87]
    s_mul_i32 s1, s1, 753664
    v_mov_b32 v134, 0
    v_mov_b32 v135, 0
    v_mfma_f32_16x16x32_bf16 v[84:87], v[52:55], a[52:55], v[84:87]
    s_add_u32 s61, s77, 4096
    v_cvt_pk_bf16_f32 v136, v136, v137
    v_cvt_pk_bf16_f32 v137, v138, v139
    v_mfma_f32_16x16x32_bf16 v[80:83], v[52:55], a[48:51], v[80:83]
    s_waitcnt vmcnt(14) lgkmcnt(0)
    v_cvt_pk_bf16_f32 v138, v140, v141
    v_cvt_pk_bf16_f32 v139, v142, v143
    v_mfma_f32_16x16x32_bf16 v[80:83], v[48:51], a[32:35], v[80:83]
    s_barrier
    v_accvgpr_write_b32 a4, v136
    v_accvgpr_write_b32 a5, v137
    v_mfma_f32_16x16x32_bf16 v[96:99], v[56:59], a[32:35], v[96:99]
    s_add_u32 s1, s1, s59
    ds_read_b64_tr_b16 v[48:49], v4 offset:16384
    v_cvt_pk_bf16_f32 v216, v216, v217
    v_mfma_f32_16x16x32_bf16 v[96:99], v[60:63], a[48:51], v[96:99]
    s_add_u32 s1, s1, 0x2200000
    ds_read_b64_tr_b16 v[50:51], v4 offset:16896
    v_cvt_pk_bf16_f32 v217, v218, v219
    v_mfma_f32_16x16x32_bf16 v[100:103], v[60:63], a[52:55], v[100:103]
    s_sub_u32 s79, 1, s60
    ds_read_b64_tr_b16 v[52:53], v4 offset:20480
    v_cvt_pk_bf16_f32 v218, v220, v221
    v_mfma_f32_16x16x32_bf16 v[100:103], v[56:59], a[36:39], v[100:103]
    s_mul_i32 s79, s79, s67
    ds_read_b64_tr_b16 v[54:55], v4 offset:20992
    v_cvt_pk_bf16_f32 v219, v222, v223
    v_mfma_f32_16x16x32_bf16 v[104:107], v[56:59], a[40:43], v[104:107]
    s_add_u32 s53, s60, 4
    buffer_store_dwordx4 v[216:219], v28, s[44:47], s61 offen offset:1024 sc1
    v_mfma_f32_16x16x32_bf16 v[104:107], v[60:63], a[56:59], v[104:107]
    s_lshl_b32 s53, s53, 13
    v_accvgpr_write_b32 a6, v138
    v_accvgpr_write_b32 a7, v139
    v_mfma_f32_16x16x32_bf16 v[108:111], v[60:63], a[60:63], v[108:111]
    s_add_u32 s54, s84, 6
    v_mov_b32 v136, 0
    v_mov_b32 v137, 0
    v_mfma_f32_16x16x32_bf16 v[108:111], v[56:59], a[44:47], v[108:111]
    s_lshl_b32 s54, s54, 13
    v_mov_b32 v138, 0
    v_mov_b32 v139, 0
    v_mfma_f32_16x16x32_bf16 v[124:127], v[40:43], a[44:47], v[124:127]
    s_lshl_b32 s69, s57, 1
    ds_read_b64_tr_b16 v[56:57], v5 offset:16384
    v_mov_b32 v140, 0
    v_mfma_f32_16x16x32_bf16 v[124:127], v[44:47], a[60:63], v[124:127]
    s_add_u32 s69, s69, s60
    ds_read_b64_tr_b16 v[58:59], v5 offset:16896
    v_mov_b32 v141, 0
    v_mfma_f32_16x16x32_bf16 v[120:123], v[44:47], a[56:59], v[120:123]
    s_lshl_b32 s69, s69, 2
    ds_read_b64_tr_b16 v[60:61], v5 offset:20480
    v_mov_b32 v142, 0
    v_mfma_f32_16x16x32_bf16 v[120:123], v[40:43], a[40:43], v[120:123]
    s_add_u32 s69, s69, s67
    ds_read_b64_tr_b16 v[62:63], v5 offset:20992
    v_mov_b32 v143, 0
    v_mfma_f32_16x16x32_bf16 v[116:119], v[40:43], a[36:39], v[116:119]
    s_waitcnt vmcnt(6)
    s_lshl_b32 s69, s69, 14
    v_cmp_gt_u32 vcc, 8, v13
    v_cvt_pk_bf16_f32 v144, v144, v145
    v_mfma_f32_16x16x32_bf16 v[116:119], v[44:47], a[52:55], v[116:119]
    s_cbranch_vccnz S2
S2_RET:
    v_cvt_pk_bf16_f32 v145, v146, v147
    v_cvt_pk_bf16_f32 v146, v148, v149
    v_mfma_f32_16x16x32_bf16 v[112:115], v[44:47], a[48:51], v[112:115]
    s_lshl_b32 s59, s58, 1
    v_cvt_pk_bf16_f32 v147, v150, v151
    v_mfma_f32_16x16x32_bf16 v[112:115], v[40:43], a[32:35], v[112:115]
    s_waitcnt lgkmcnt(4)
    v_accvgpr_write_b32 a8, v144
    v_accvgpr_write_b32 a9, v145
    v_mfma_f32_16x16x32_bf16 v[64:67], v[48:51], a[64:67], v[64:67]
    s_add_u32 s59, s59, s84
    ds_read_b64_tr_b16 v[40:41], v6 offset:16384
    v_accvgpr_write_b32 a10, v146
    v_mfma_f32_16x16x32_bf16 v[64:67], v[52:55], a[80:83], v[64:67]
    s_lshl_b32 s59, s59, 7
    ds_read_b64_tr_b16 v[42:43], v6 offset:16896
    v_accvgpr_write_b32 a11, v147
    v_mfma_f32_16x16x32_bf16 v[68:71], v[52:55], a[84:87], v[68:71]
    s_add_u32 s69, s69, s59
    ds_read_b64_tr_b16 v[44:45], v6 offset:20480
    v_mov_b32 v144, 0
    v_mfma_f32_16x16x32_bf16 v[68:71], v[48:51], a[68:71], v[68:71]
    s_sub_u32 s60, 15, s57
    ds_read_b64_tr_b16 v[46:47], v6 offset:20992
    v_mov_b32 v145, 0
    v_mfma_f32_16x16x32_bf16 v[72:75], v[48:51], a[72:75], v[72:75]
    s_add_u32 m0, s62, 0
    v_mov_b32 v146, 0
    v_mov_b32 v147, 0
    v_mfma_f32_16x16x32_bf16 v[72:75], v[52:55], a[88:91], v[72:75]
    s_add_u32 s56, s62, 0
    v_mov_b32 v148, 0
    v_mov_b32 v149, 0
    v_mfma_f32_16x16x32_bf16 v[76:79], v[52:55], a[92:95], v[76:79]
    s_min_u32 s59, s57, s60
    buffer_load_dwordx4 v1, s[48:51], s56 offen offset:0 sc1 lds
    v_mfma_f32_16x16x32_bf16 v[76:79], v[48:51], a[76:79], v[76:79]
    s_waitcnt lgkmcnt(4)
    v_mov_b32 v150, 0
    v_mov_b32 v151, 0
    v_mfma_f32_16x16x32_bf16 v[92:95], v[56:59], a[76:79], v[92:95]
    s_add_u32 s61, s78, 4096
    ds_read_b64_tr_b16 v[48:49], v7 offset:16384
    v_cvt_pk_bf16_f32 v152, v152, v153
    v_mfma_f32_16x16x32_bf16 v[92:95], v[60:63], a[92:95], v[92:95]
    s_lshl_b32 s59, s59, 2
    ds_read_b64_tr_b16 v[50:51], v7 offset:16896
    v_cvt_pk_bf16_f32 v153, v154, v155
    v_mfma_f32_16x16x32_bf16 v[88:91], v[60:63], a[88:91], v[88:91]
    s_add_u32 s59, s59, s67
    ds_read_b64_tr_b16 v[52:53], v7 offset:20480
    v_cvt_pk_bf16_f32 v154, v156, v157
    v_mfma_f32_16x16x32_bf16 v[88:91], v[56:59], a[72:75], v[88:91]
    s_lshl_b32 s59, s59, 7
    ds_read_b64_tr_b16 v[54:55], v7 offset:20992
    v_cvt_pk_bf16_f32 v155, v158, v159
    v_mfma_f32_16x16x32_bf16 v[84:87], v[56:59], a[68:71], v[84:87]
    s_add_u32 s71, s59, 0x3902000
    buffer_load_dwordx4 v1, s[48:51], s56 offen offset:1024 sc1 lds
    v_mfma_f32_16x16x32_bf16 v[84:87], v[60:63], a[84:87], v[84:87]
    s_mov_b32 s76, 0xff800000
    v_cvt_pk_bf16_f32 v232, v232, v233
    v_cvt_pk_bf16_f32 v233, v234, v235
    v_mfma_f32_16x16x32_bf16 v[80:83], v[60:63], a[80:83], v[80:83]
    v_cvt_pk_bf16_f32 v234, v236, v237
    v_cvt_pk_bf16_f32 v235, v238, v239
    v_mfma_f32_16x16x32_bf16 v[80:83], v[56:59], a[64:67], v[80:83]
    s_waitcnt lgkmcnt(4)
    buffer_load_dwordx4 v1, s[48:51], s56 offen offset:2048 sc1 lds
    v_mfma_f32_16x16x32_bf16 v[96:99], v[40:43], a[64:67], v[96:99]
    ds_read_b64_tr_b16 v[56:57], v4 offset:24576
    v_accvgpr_write_b32 a12, v152
    v_mfma_f32_16x16x32_bf16 v[96:99], v[44:47], a[80:83], v[96:99]
    ds_read_b64_tr_b16 v[58:59], v4 offset:25088
    v_accvgpr_write_b32 a13, v153
    v_mfma_f32_16x16x32_bf16 v[100:103], v[44:47], a[84:87], v[100:103]
    ds_read_b64_tr_b16 v[60:61], v4 offset:28672
    v_accvgpr_write_b32 a14, v154
    v_mfma_f32_16x16x32_bf16 v[100:103], v[40:43], a[68:71], v[100:103]
    ds_read_b64_tr_b16 v[62:63], v4 offset:29184
    v_accvgpr_write_b32 a15, v155
    v_mfma_f32_16x16x32_bf16 v[104:107], v[40:43], a[72:75], v[104:107]
    buffer_load_dwordx4 v1, s[48:51], s56 offen offset:3072 sc1 lds
    v_mfma_f32_16x16x32_bf16 v[104:107], v[44:47], a[88:91], v[104:107]
    v_mov_b32 v152, 0
    v_mov_b32 v153, 0
    v_mfma_f32_16x16x32_bf16 v[108:111], v[44:47], a[92:95], v[108:111]
    buffer_store_dwordx4 v[232:235], v28, s[44:47], s61 offen offset:0 sc1
    v_mfma_f32_16x16x32_bf16 v[108:111], v[40:43], a[76:79], v[108:111]
    s_waitcnt lgkmcnt(4)
    v_mov_b32 v154, 0
    v_mov_b32 v155, 0
    v_mfma_f32_16x16x32_bf16 v[124:127], v[48:51], a[76:79], v[124:127]
    s_add_u32 m0, s62, 16384
    ds_read_b64_tr_b16 v[40:41], v5 offset:24576
    v_mov_b32 v156, 0
    v_mfma_f32_16x16x32_bf16 v[124:127], v[52:55], a[92:95], v[124:127]
    s_add_u32 s56, s62, 16384
    ds_read_b64_tr_b16 v[42:43], v5 offset:25088
    v_mov_b32 v157, 0
    v_mfma_f32_16x16x32_bf16 v[120:123], v[52:55], a[88:91], v[120:123]
    ds_read_b64_tr_b16 v[44:45], v5 offset:28672
    v_mov_b32 v158, 0
    v_mfma_f32_16x16x32_bf16 v[120:123], v[48:51], a[72:75], v[120:123]
    ds_read_b64_tr_b16 v[46:47], v5 offset:29184
    v_mov_b32 v159, 0
    v_mfma_f32_16x16x32_bf16 v[116:119], v[48:51], a[68:71], v[116:119]
    buffer_load_dwordx4 v1, s[48:51], s56 offen offset:0 sc1 lds
    v_mfma_f32_16x16x32_bf16 v[116:119], v[52:55], a[84:87], v[116:119]
    v_cvt_pk_bf16_f32 v160, v160, v161
    v_cvt_pk_bf16_f32 v161, v162, v163
    v_mfma_f32_16x16x32_bf16 v[112:115], v[52:55], a[80:83], v[112:115]
    v_cvt_pk_bf16_f32 v162, v164, v165
    v_cvt_pk_bf16_f32 v163, v166, v167
    v_mfma_f32_16x16x32_bf16 v[112:115], v[48:51], a[64:67], v[112:115]
    s_waitcnt lgkmcnt(4)
    buffer_load_dwordx4 v1, s[48:51], s56 offen offset:1024 sc1 lds
    v_mfma_f32_16x16x32_bf16 v[64:67], v[56:59], a[96:99], v[64:67]
    ds_read_b64_tr_b16 v[48:49], v6 offset:24576
    v_accvgpr_write_b32 a16, v160
    v_mfma_f32_16x16x32_bf16 v[64:67], v[60:63], a[112:115], v[64:67]
    ds_read_b64_tr_b16 v[50:51], v6 offset:25088
    v_accvgpr_write_b32 a17, v161
    v_mfma_f32_16x16x32_bf16 v[68:71], v[60:63], a[116:119], v[68:71]
    ds_read_b64_tr_b16 v[52:53], v6 offset:28672
    v_accvgpr_write_b32 a18, v162
    v_mfma_f32_16x16x32_bf16 v[68:71], v[56:59], a[100:103], v[68:71]
    ds_read_b64_tr_b16 v[54:55], v6 offset:29184
    v_accvgpr_write_b32 a19, v163
    v_mfma_f32_16x16x32_bf16 v[72:75], v[56:59], a[104:107], v[72:75]
    buffer_load_dwordx4 v1, s[48:51], s56 offen offset:2048 sc1 lds
    v_mfma_f32_16x16x32_bf16 v[72:75], v[60:63], a[120:123], v[72:75]
    s_add_u32 s61, s78, 4096
    v_mov_b32 v160, 0
    v_mov_b32 v161, 0
    v_mfma_f32_16x16x32_bf16 v[76:79], v[60:63], a[124:127], v[76:79]
    v_mov_b32 v162, 0
    v_mov_b32 v163, 0
    v_mfma_f32_16x16x32_bf16 v[76:79], v[56:59], a[108:111], v[76:79]
    s_waitcnt lgkmcnt(4)
    buffer_load_dwordx4 v1, s[48:51], s56 offen offset:3072 sc1 lds
    v_mfma_f32_16x16x32_bf16 v[92:95], v[40:43], a[108:111], v[92:95]
    ds_read_b64_tr_b16 v[56:57], v7 offset:24576
    v_cvt_pk_bf16_f32 v248, v248, v249
    v_mfma_f32_16x16x32_bf16 v[92:95], v[44:47], a[124:127], v[92:95]
    ds_read_b64_tr_b16 v[58:59], v7 offset:25088
    v_cvt_pk_bf16_f32 v249, v250, v251
    v_mfma_f32_16x16x32_bf16 v[88:91], v[44:47], a[120:123], v[88:91]
    ds_read_b64_tr_b16 v[60:61], v7 offset:28672
    v_cvt_pk_bf16_f32 v250, v252, v253
    v_mfma_f32_16x16x32_bf16 v[88:91], v[40:43], a[104:107], v[88:91]
    ds_read_b64_tr_b16 v[62:63], v7 offset:29184
    v_cvt_pk_bf16_f32 v251, v254, v255
    v_mfma_f32_16x16x32_bf16 v[84:87], v[40:43], a[100:103], v[84:87]
    s_add_u32 m0, s62, 32768
    buffer_store_dwordx4 v[248:251], v28, s[44:47], s61 offen offset:1024 sc1
    v_mfma_f32_16x16x32_bf16 v[84:87], v[44:47], a[116:119], v[84:87]
    s_add_u32 s56, s62, 32768
    v_mov_b32 v164, 0
    v_mov_b32 v165, 0
    v_mfma_f32_16x16x32_bf16 v[80:83], v[44:47], a[112:115], v[80:83]
    s_waitcnt lgkmcnt(0)
    buffer_load_dwordx4 v1, s[48:51], s56 offen offset:0 sc1 lds
    v_mfma_f32_16x16x32_bf16 v[80:83], v[40:43], a[96:99], v[80:83]
    s_barrier
    v_mov_b32 v166, 0
    v_mov_b32 v167, 0
    v_mfma_f32_16x16x32_bf16 v[96:99], v[48:51], a[96:99], v[96:99]
    ds_read_b64_tr_b16 v[40:41], v4 offset:32768
    v_cvt_pk_bf16_f32 v168, v168, v169
    v_mfma_f32_16x16x32_bf16 v[96:99], v[52:55], a[112:115], v[96:99]
    ds_read_b64_tr_b16 v[42:43], v4 offset:33280
    v_cvt_pk_bf16_f32 v169, v170, v171
    v_mfma_f32_16x16x32_bf16 v[100:103], v[52:55], a[116:119], v[100:103]
    ds_read_b64_tr_b16 v[44:45], v4 offset:36864
    v_cvt_pk_bf16_f32 v170, v172, v173
    v_mfma_f32_16x16x32_bf16 v[100:103], v[48:51], a[100:103], v[100:103]
    ds_read_b64_tr_b16 v[46:47], v4 offset:37376
    v_cvt_pk_bf16_f32 v171, v174, v175
    v_mfma_f32_16x16x32_bf16 v[104:107], v[48:51], a[104:107], v[104:107]
    buffer_load_dwordx4 v1, s[48:51], s56 offen offset:1024 sc1 lds
    v_mfma_f32_16x16x32_bf16 v[104:107], v[52:55], a[120:123], v[104:107]
    v_accvgpr_write_b32 a20, v168
    v_accvgpr_write_b32 a21, v169
    v_mfma_f32_16x16x32_bf16 v[108:111], v[52:55], a[124:127], v[108:111]
    v_accvgpr_write_b32 a22, v170
    v_accvgpr_write_b32 a23, v171
    v_mfma_f32_16x16x32_bf16 v[108:111], v[48:51], a[108:111], v[108:111]
    buffer_load_dwordx4 v1, s[48:51], s56 offen offset:2048 sc1 lds
    v_mfma_f32_16x16x32_bf16 v[124:127], v[56:59], a[108:111], v[124:127]
    ds_read_b64_tr_b16 v[48:49], v5 offset:32768
    v_mov_b32 v168, 0
    v_mfma_f32_16x16x32_bf16 v[124:127], v[60:63], a[124:127], v[124:127]
    ds_read_b64_tr_b16 v[50:51], v5 offset:33280
    v_mov_b32 v169, 0
    v_mfma_f32_16x16x32_bf16 v[120:123], v[60:63], a[120:123], v[120:123]
    ds_read_b64_tr_b16 v[52:53], v5 offset:36864
    v_mov_b32 v170, 0
    v_mfma_f32_16x16x32_bf16 v[120:123], v[56:59], a[104:107], v[120:123]
    ds_read_b64_tr_b16 v[54:55], v5 offset:37376
    v_mov_b32 v171, 0
    v_mfma_f32_16x16x32_bf16 v[116:119], v[56:59], a[100:103], v[116:119]
    buffer_load_dwordx4 v1, s[48:51], s56 offen offset:3072 sc1 lds
    v_mfma_f32_16x16x32_bf16 v[116:119], v[60:63], a[116:119], v[116:119]
    v_mov_b32 v172, 0
    v_mov_b32 v173, 0
    v_mfma_f32_16x16x32_bf16 v[112:115], v[60:63], a[112:115], v[112:115]
    v_mov_b32 v174, 0
    v_mov_b32 v175, 0
    v_mfma_f32_16x16x32_bf16 v[112:115], v[56:59], a[96:99], v[112:115]
    s_waitcnt lgkmcnt(4)
    v_cvt_pk_bf16_f32 v176, v176, v177
    v_cvt_pk_bf16_f32 v177, v178, v179
    v_mfma_f32_16x16x32_bf16 v[64:67], v[40:43], a[128:131], v[64:67]
    s_add_u32 m0, s62, 49152
    ds_read_b64_tr_b16 v[56:57], v6 offset:32768
    v_cvt_pk_bf16_f32 v178, v180, v181
    v_mfma_f32_16x16x32_bf16 v[64:67], v[44:47], a[144:147], v[64:67]
    s_add_u32 s56, s83, 0
    ds_read_b64_tr_b16 v[58:59], v6 offset:33280
    v_cvt_pk_bf16_f32 v179, v182, v183
    v_mfma_f32_16x16x32_bf16 v[68:71], v[44:47], a[148:151], v[68:71]
    ds_read_b64_tr_b16 v[60:61], v6 offset:36864
    v_accvgpr_write_b32 a24, v176
    v_mfma_f32_16x16x32_bf16 v[68:71], v[40:43], a[132:135], v[68:71]
    ds_read_b64_tr_b16 v[62:63], v6 offset:37376
    v_accvgpr_write_b32 a25, v177
    v_mfma_f32_16x16x32_bf16 v[72:75], v[40:43], a[136:139], v[72:75]
    buffer_load_dwordx4 v1, s[48:51], s56 offen offset:0 sc1 lds
    v_mfma_f32_16x16x32_bf16 v[72:75], v[44:47], a[152:155], v[72:75]
    v_accvgpr_write_b32 a26, v178
    v_accvgpr_write_b32 a27, v179
    v_mfma_f32_16x16x32_bf16 v[76:79], v[44:47], a[156:159], v[76:79]
    v_mov_b32 v176, 0
    v_mov_b32 v177, 0
    v_mfma_f32_16x16x32_bf16 v[76:79], v[40:43], a[140:143], v[76:79]
    s_waitcnt lgkmcnt(4)
    buffer_load_dwordx4 v1, s[48:51], s56 offen offset:1024 sc1 lds
    v_mfma_f32_16x16x32_bf16 v[92:95], v[48:51], a[140:143], v[92:95]
    ds_read_b64_tr_b16 v[40:41], v7 offset:32768
    v_mov_b32 v178, 0
    v_mfma_f32_16x16x32_bf16 v[92:95], v[52:55], a[156:159], v[92:95]
    ds_read_b64_tr_b16 v[42:43], v7 offset:33280
    v_mov_b32 v179, 0
    v_mfma_f32_16x16x32_bf16 v[88:91], v[52:55], a[152:155], v[88:91]
    ds_read_b64_tr_b16 v[44:45], v7 offset:36864
    v_mov_b32 v180, 0
    v_mfma_f32_16x16x32_bf16 v[88:91], v[48:51], a[136:139], v[88:91]
    ds_read_b64_tr_b16 v[46:47], v7 offset:37376
    v_mov_b32 v181, 0
    v_mfma_f32_16x16x32_bf16 v[84:87], v[48:51], a[132:135], v[84:87]
    buffer_load_dwordx4 v1, s[48:51], s56 offen offset:2048 sc1 lds
    v_mfma_f32_16x16x32_bf16 v[84:87], v[52:55], a[148:151], v[84:87]
    v_mov_b32 v182, 0
    v_mov_b32 v183, 0
    v_mfma_f32_16x16x32_bf16 v[80:83], v[52:55], a[144:147], v[80:83]
    v_cvt_pk_bf16_f32 v184, v184, v185
    v_cvt_pk_bf16_f32 v185, v186, v187
    v_mfma_f32_16x16x32_bf16 v[80:83], v[48:51], a[128:131], v[80:83]
    s_waitcnt lgkmcnt(4)
    buffer_load_dwordx4 v1, s[48:51], s56 offen offset:3072 sc1 lds
    v_mfma_f32_16x16x32_bf16 v[96:99], v[56:59], a[128:131], v[96:99]
    ds_read_b64_tr_b16 v[48:49], v4 offset:40960
    v_cvt_pk_bf16_f32 v186, v188, v189
    v_mfma_f32_16x16x32_bf16 v[96:99], v[60:63], a[144:147], v[96:99]
    ds_read_b64_tr_b16 v[50:51], v4 offset:41472
    v_cvt_pk_bf16_f32 v187, v190, v191
    v_mfma_f32_16x16x32_bf16 v[100:103], v[60:63], a[148:151], v[100:103]
    ds_read_b64_tr_b16 v[52:53], v4 offset:45056
    v_accvgpr_write_b32 a28, v184
    v_mfma_f32_16x16x32_bf16 v[100:103], v[56:59], a[132:135], v[100:103]
    ds_read_b64_tr_b16 v[54:55], v4 offset:45568
    v_accvgpr_write_b32 a29, v185
    v_mfma_f32_16x16x32_bf16 v[104:107], v[56:59], a[136:139], v[104:107]
    s_add_u32 m0, s62, 65536
    v_accvgpr_write_b32 a30, v186
    v_accvgpr_write_b32 a31, v187
    v_mfma_f32_16x16x32_bf16 v[104:107], v[60:63], a[152:155], v[104:107]
    s_add_u32 s56, s83, 16384
    v_mov_b32 v184, 0
    v_mov_b32 v185, 0
    v_mfma_f32_16x16x32_bf16 v[108:111], v[60:63], a[156:159], v[108:111]
    buffer_load_dwordx4 v1, s[48:51], s56 offen offset:0 sc1 lds
    v_mfma_f32_16x16x32_bf16 v[108:111], v[56:59], a[140:143], v[108:111]
    s_waitcnt lgkmcnt(4)
    v_mov_b32 v186, 0
    v_mov_b32 v187, 0
    v_mfma_f32_16x16x32_bf16 v[124:127], v[40:43], a[140:143], v[124:127]
    ds_read_b64_tr_b16 v[56:57], v5 offset:40960
    v_mov_b32 v188, 0
    v_mfma_f32_16x16x32_bf16 v[124:127], v[44:47], a[156:159], v[124:127]
    ds_read_b64_tr_b16 v[58:59], v5 offset:41472
    v_mov_b32 v189, 0
    v_mfma_f32_16x16x32_bf16 v[120:123], v[44:47], a[152:155], v[120:123]
    ds_read_b64_tr_b16 v[60:61], v5 offset:45056
    v_mov_b32 v190, 0
    v_mfma_f32_16x16x32_bf16 v[120:123], v[40:43], a[136:139], v[120:123]
    ds_read_b64_tr_b16 v[62:63], v5 offset:45568
    v_mov_b32 v191, 0
    v_mfma_f32_16x16x32_bf16 v[116:119], v[40:43], a[132:135], v[116:119]
    buffer_load_dwordx4 v1, s[48:51], s56 offen offset:1024 sc1 lds
    v_mfma_f32_16x16x32_bf16 v[116:119], v[44:47], a[148:151], v[116:119]
    v_lshrrev_b32 v29, 4, v0
    v_xor_b32 v29, v29, v0
    v_mfma_f32_16x16x32_bf16 v[112:115], v[44:47], a[144:147], v[112:115]
    v_bfe_u32 v29, v29, 1, 1
    v_add_u32 v29, -1, v29
    v_mfma_f32_16x16x32_bf16 v[112:115], v[40:43], a[128:131], v[112:115]
    s_waitcnt lgkmcnt(4)
    buffer_load_dwordx4 v1, s[48:51], s56 offen offset:2048 sc1 lds
    v_mfma_f32_16x16x32_bf16 v[64:67], v[48:51], a[160:163], v[64:67]
    ds_read_b64_tr_b16 v[40:41], v6 offset:40960
    v_and_b32 v29, 0x3f803f80, v29
    v_mfma_f32_16x16x32_bf16 v[64:67], v[52:55], a[176:179], v[64:67]
    ds_read_b64_tr_b16 v[42:43], v6 offset:41472
    v_and_b32 v8, 1, v0
    v_mfma_f32_16x16x32_bf16 v[68:71], v[52:55], a[180:183], v[68:71]
    ds_read_b64_tr_b16 v[44:45], v6 offset:45056
    v_mul_u32_u24 v8, 0xaaaa, v8
    v_mfma_f32_16x16x32_bf16 v[68:71], v[48:51], a[164:167], v[68:71]
    ds_read_b64_tr_b16 v[46:47], v6 offset:45568
    v_add_u32 v8, 0x4444, v8
    v_mfma_f32_16x16x32_bf16 v[72:75], v[48:51], a[168:171], v[72:75]
    buffer_load_dwordx4 v1, s[48:51], s56 offen offset:3072 sc1 lds
    v_mfma_f32_16x16x32_bf16 v[72:75], v[52:55], a[184:187], v[72:75]
    v_accvgpr_write_b32 a96, v29
    v_accvgpr_write_b32 a97, v29
    v_mfma_f32_16x16x32_bf16 v[76:79], v[52:55], a[188:191], v[76:79]
    v_accvgpr_write_b32 a98, v29
    v_accvgpr_write_b32 a99, v29
    v_mfma_f32_16x16x32_bf16 v[76:79], v[48:51], a[172:175], v[76:79]
    s_waitcnt lgkmcnt(4)
    v_accvgpr_write_b32 a100, 0
    v_accvgpr_write_b32 a101, 0
    v_mfma_f32_16x16x32_bf16 v[92:95], v[56:59], a[172:175], v[92:95]
    s_add_u32 m0, s62, 81920
    ds_read_b64_tr_b16 v[48:49], v7 offset:40960
    v_accvgpr_write_b32 a102, 0
    v_mfma_f32_16x16x32_bf16 v[92:95], v[60:63], a[188:191], v[92:95]
    s_add_u32 s56, s83, 32768
    ds_read_b64_tr_b16 v[50:51], v7 offset:41472
    v_accvgpr_write_b32 a103, 0
    v_mfma_f32_16x16x32_bf16 v[88:91], v[60:63], a[184:187], v[88:91]
    s_lshl_b32 s96, s63, 7
    ds_read_b64_tr_b16 v[52:53], v7 offset:45056
    v_accvgpr_write_b32 a104, 0
    v_mfma_f32_16x16x32_bf16 v[88:91], v[56:59], a[168:171], v[88:91]
    s_add_u32 s96, s96, 0x3901000
    ds_read_b64_tr_b16 v[54:55], v7 offset:45568
    v_accvgpr_write_b32 a105, 0
    v_mfma_f32_16x16x32_bf16 v[84:87], v[56:59], a[164:167], v[84:87]
    buffer_load_dwordx4 v1, s[48:51], s56 offen offset:0 sc1 lds
    v_mfma_f32_16x16x32_bf16 v[84:87], v[60:63], a[180:183], v[84:87]
    v_accvgpr_write_b32 a106, 0
    v_accvgpr_write_b32 a107, 0
    v_mfma_f32_16x16x32_bf16 v[80:83], v[60:63], a[176:179], v[80:83]
    s_waitcnt vmcnt(14) lgkmcnt(0)
    v_accvgpr_write_b32 a108, 0
    v_accvgpr_write_b32 a109, 0
    v_mfma_f32_16x16x32_bf16 v[80:83], v[56:59], a[160:163], v[80:83]
    s_barrier
    buffer_load_dwordx4 v1, s[48:51], s56 offen offset:1024 sc1 lds
    v_mfma_f32_16x16x32_bf16 v[96:99], v[40:43], a[160:163], v[96:99]
    ds_read_b64_tr_b16 v[56:57], v4 offset:49152
    v_accvgpr_write_b32 a110, 0
    v_mfma_f32_16x16x32_bf16 v[96:99], v[44:47], a[176:179], v[96:99]
    ds_read_b64_tr_b16 v[58:59], v4 offset:49664
    v_accvgpr_write_b32 a111, 0
    v_mfma_f32_16x16x32_bf16 v[100:103], v[44:47], a[180:183], v[100:103]
    ds_read_b64_tr_b16 v[60:61], v4 offset:53248
    v_accvgpr_write_b32 a112, 0
    v_mfma_f32_16x16x32_bf16 v[100:103], v[40:43], a[164:167], v[100:103]
    ds_read_b64_tr_b16 v[62:63], v4 offset:53760
    v_accvgpr_write_b32 a113, 0
    v_mfma_f32_16x16x32_bf16 v[104:107], v[40:43], a[168:171], v[104:107]
    buffer_load_dwordx4 v1, s[48:51], s56 offen offset:2048 sc1 lds
    v_mfma_f32_16x16x32_bf16 v[104:107], v[44:47], a[184:187], v[104:107]
    v_accvgpr_write_b32 a114, 0
    v_accvgpr_write_b32 a115, 0
    v_mfma_f32_16x16x32_bf16 v[108:111], v[44:47], a[188:191], v[108:111]
    v_accvgpr_write_b32 a116, -1
    v_accvgpr_write_b32 a117, -1
    v_mfma_f32_16x16x32_bf16 v[108:111], v[40:43], a[172:175], v[108:111]
    buffer_load_dwordx4 v1, s[48:51], s56 offen offset:3072 sc1 lds
    v_mfma_f32_16x16x32_bf16 v[124:127], v[48:51], a[172:175], v[124:127]
    ds_read_b64_tr_b16 v[40:41], v5 offset:49152
    v_accvgpr_write_b32 a118, -1
    v_mfma_f32_16x16x32_bf16 v[124:127], v[52:55], a[188:191], v[124:127]
    ds_read_b64_tr_b16 v[42:43], v5 offset:49664
    v_accvgpr_write_b32 a119, -1
    v_mfma_f32_16x16x32_bf16 v[120:123], v[52:55], a[184:187], v[120:123]
    ds_read_b64_tr_b16 v[44:45], v5 offset:53248
    v_mov_b32 v16, 0
    v_mfma_f32_16x16x32_bf16 v[120:123], v[48:51], a[168:171], v[120:123]
    ds_read_b64_tr_b16 v[46:47], v5 offset:53760
    v_mov_b32 v17, 0
    v_mfma_f32_16x16x32_bf16 v[116:119], v[48:51], a[164:167], v[116:119]
    s_add_u32 m0, s62, 98304
    v_mov_b32 v18, 0
    v_mov_b32 v19, 0
    v_mfma_f32_16x16x32_bf16 v[116:119], v[52:55], a[180:183], v[116:119]
    s_add_u32 s56, s83, 49152
    v_mov_b32 v20, 0
    v_mov_b32 v21, 0
    v_mfma_f32_16x16x32_bf16 v[112:115], v[52:55], a[176:179], v[112:115]
    buffer_load_dwordx4 v1, s[48:51], s56 offen offset:0 sc1 lds
    v_mfma_f32_16x16x32_bf16 v[112:115], v[48:51], a[160:163], v[112:115]
    s_waitcnt lgkmcnt(4)
    v_mov_b32 v22, 0
    v_mov_b32 v23, 0
    v_mfma_f32_16x16x32_bf16 v[64:67], v[56:59], a[192:195], v[64:67]
    ds_read_b64_tr_b16 v[48:49], v6 offset:49152
    v_mov_b32 v24, 0
    v_mfma_f32_16x16x32_bf16 v[64:67], v[60:63], a[208:211], v[64:67]
    ds_read_b64_tr_b16 v[50:51], v6 offset:49664
    v_mov_b32 v25, 0
    v_mfma_f32_16x16x32_bf16 v[68:71], v[60:63], a[212:215], v[68:71]
K_PG8:
    s_cmp_eq_u32 s100, 1
    s_cbranch_scc1 K_PG12
    ds_read_b64_tr_b16 v[52:53], v6 offset:53248
    v_mov_b32 v26, 0
    v_mfma_f32_16x16x32_bf16 v[68:71], v[56:59], a[196:199], v[68:71]
    ds_read_b64_tr_b16 v[54:55], v6 offset:53760
    v_mov_b32 v27, 0
    v_mfma_f32_16x16x32_bf16 v[72:75], v[56:59], a[200:203], v[72:75]
    buffer_load_dwordx4 v1, s[48:51], s56 offen offset:1024 sc1 lds
    v_mfma_f32_16x16x32_bf16 v[72:75], v[60:63], a[216:219], v[72:75]
    v_mov_b32 v28, 0
    v_mov_b32 v29, 0
    v_mfma_f32_16x16x32_bf16 v[76:79], v[60:63], a[220:223], v[76:79]
    ds_read_b128 a[32:35], v1 offset:0
    v_mov_b32 v30, 0
    v_mfma_f32_16x16x32_bf16 v[76:79], v[56:59], a[204:207], v[76:79]
    s_waitcnt lgkmcnt(5)
    buffer_load_dwordx4 v1, s[48:51], s56 offen offset:2048 sc1 lds
    v_mfma_f32_16x16x32_bf16 v[92:95], v[40:43], a[204:207], v[92:95]
    ds_read_b64_tr_b16 v[56:57], v7 offset:49152
    ds_read_b128 a[36:39], v1 offset:1024
    v_mfma_f32_16x16x32_bf16 v[92:95], v[44:47], a[220:223], v[92:95]
    ds_read_b64_tr_b16 v[58:59], v7 offset:49664
    ds_read_b128 a[40:43], v1 offset:2048
    v_mfma_f32_16x16x32_bf16 v[88:91], v[44:47], a[216:219], v[88:91]
    ds_read_b64_tr_b16 v[60:61], v7 offset:53248
    ds_read_b128 a[44:47], v1 offset:3072
    v_mfma_f32_16x16x32_bf16 v[88:91], v[40:43], a[200:203], v[88:91]
    ds_read_b64_tr_b16 v[62:63], v7 offset:53760
    ds_read_b128 a[48:51], v1 offset:4096
    v_mfma_f32_16x16x32_bf16 v[84:87], v[40:43], a[196:199], v[84:87]
    buffer_load_dwordx4 v1, s[48:51], s56 offen offset:3072 sc1 lds
    v_mfma_f32_16x16x32_bf16 v[84:87], v[44:47], a[212:215], v[84:87]
    ds_read_b128 a[52:55], v1 offset:5120
    v_mov_b32 v31, 0
    v_mfma_f32_16x16x32_bf16 v[80:83], v[44:47], a[208:211], v[80:83]
    s_waitcnt lgkmcnt(10)
    ds_read_b128 a[56:59], v1 offset:6144
    ds_read_b64_tr_b16 a[128:129], v32 offset:0
    v_mfma_f32_16x16x32_bf16 v[80:83], v[40:43], a[192:195], v[80:83]
    ds_read_b128 a[60:63], v1 offset:7168
    ds_read_b64_tr_b16 a[130:131], v32 offset:4096
    v_mfma_f32_16x16x32_bf16 v[96:99], v[48:51], a[192:195], v[96:99]
    s_waitcnt lgkmcnt(10)
    ds_read_b64_tr_b16 v[40:41], v4 offset:57344
    ds_read_b64_tr_b16 a[132:133], v32 offset:8
    v_mfma_f32_16x16x32_bf16 v[96:99], v[52:55], a[208:211], v[96:99]
    ds_read_b64_tr_b16 v[42:43], v4 offset:57856
    ds_read_b64_tr_b16 a[134:135], v32 offset:4104
    v_mfma_f32_16x16x32_bf16 v[100:103], v[52:55], a[212:215], v[100:103]
    s_waitcnt lgkmcnt(10)
    ds_read_b64_tr_b16 v[44:45], v4 offset:61440
    ds_read_b64_tr_b16 a[136:137], v33 offset:0
    v_mfma_f32_16x16x32_bf16 v[100:103], v[48:51], a[196:199], v[100:103]
    ds_read_b64_tr_b16 v[46:47], v4 offset:61952
    ds_read_b64_tr_b16 a[138:139], v33 offset:4096
    v_mfma_f32_16x16x32_bf16 v[104:107], v[48:51], a[200:203], v[104:107]
    ds_read_b64_tr_b16 a[140:141], v33 offset:8
    v_mov_b32 v13, 4
    v_mfma_f32_16x16x32_bf16 v[104:107], v[52:55], a[216:219], v[104:107]
    s_waitcnt lgkmcnt(11)
    ds_read_b64_tr_b16 a[142:143], v33 offset:4104
    v_add_u32 v2, 49152, v1
    v_mfma_f32_16x16x32_bf16 v[108:111], v[52:55], a[220:223], v[108:111]
    ds_read_b64_tr_b16 a[144:145], v34 offset:0
    v_add_u32 v3, 32768, v1
    v_mfma_f32_16x16x32_bf16 v[108:111], v[48:51], a[204:207], v[108:111]
    ds_read_b64_tr_b16 a[146:147], v34 offset:4096
    v_mfma_f32_16x16x32_bf16 v[124:127], v[56:59], a[204:207], v[124:127]
    s_waitcnt lgkmcnt(10)
    s_sub_u32 s59, 183, s101
    ds_read_b64_tr_b16 v[48:49], v5 offset:57344
    ds_read_b64_tr_b16 a[148:149], v34 offset:8
    v_mfma_f32_16x16x32_bf16 v[124:127], v[60:63], a[220:223], v[124:127]
    s_and_b32 s59, s59, 0x40000000
    ds_read_b64_tr_b16 v[50:51], v5 offset:57856
    ds_read_b64_tr_b16 a[150:151], v34 offset:4104
    v_mfma_f32_16x16x32_bf16 v[120:123], v[60:63], a[216:219], v[120:123]
    s_waitcnt lgkmcnt(10)
    ds_read_b64_tr_b16 v[52:53], v5 offset:61440
    ds_read_b64_tr_b16 a[152:153], v35 offset:0
    v_mfma_f32_16x16x32_bf16 v[120:123], v[56:59], a[200:203], v[120:123]
    ds_read_b64_tr_b16 v[54:55], v5 offset:61952
    ds_read_b64_tr_b16 a[154:155], v35 offset:4096
    v_mfma_f32_16x16x32_bf16 v[116:119], v[56:59], a[196:199], v[116:119]
    ds_read_b64_tr_b16 a[156:157], v35 offset:8
    v_or_b32 v12, s59, v1
    v_mfma_f32_16x16x32_bf16 v[116:119], v[60:63], a[212:215], v[116:119]
    s_waitcnt lgkmcnt(11)
    s_add_u32 s60, s70, 4096
    ds_read_b64_tr_b16 a[158:159], v35 offset:4104
    v_mfma_f32_16x16x32_bf16 v[112:115], v[60:63], a[208:211], v[112:115]
    s_add_u32 s59, s80, 753664
    buffer_load_dwordx4 a[120:123], v36, s[4:7], s69 offen offset:0
    v_mfma_f32_16x16x32_bf16 v[112:115], v[56:59], a[192:195], v[112:115]
    v_mfma_f32_16x16x32_bf16 v[64:67], v[40:43], a[224:227], v[64:67]
    s_mov_b32 s77, 0x57800000
    ds_read_b64_tr_b16 v[56:57], v6 offset:57344
    v_mfma_f32_16x16x32_bf16 v[192:195], v[44:47], a[240:243], v[64:67]
    s_mov_b32 s73, 49152
    ds_read_b64_tr_b16 v[58:59], v6 offset:57856
    v_mfma_f32_16x16x32_bf16 v[68:71], v[44:47], a[244:247], v[68:71]
    s_mov_b32 s74, s62
    ds_read_b64_tr_b16 v[60:61], v6 offset:61440
    v_mfma_f32_16x16x32_bf16 v[208:211], v[40:43], a[228:231], v[68:71]
    s_waitcnt lgkmcnt(11)
    s_mov_b32 s75, s85
    ds_read_b64_tr_b16 v[62:63], v6 offset:61952
    v_mfma_f32_16x16x32_bf16 v[72:75], v[40:43], a[232:235], v[72:75]
    buffer_load_dwordx4 a[124:127], v36, s[4:7], s69 offen offset:64
    v_mfma_f32_16x16x32_bf16 v[224:227], v[44:47], a[248:251], v[72:75]
    v_mfma_f32_16x16x32_bf16 v[76:79], v[44:47], a[252:255], v[76:79]
    v_mfma_f32_16x16x32_bf16 v[240:243], v[40:43], a[236:239], v[76:79]
    s_waitcnt lgkmcnt(7)
    v_mfma_f32_16x16x32_bf16 v[80:83], v[48:51], a[224:227], v[80:83]
    ds_read_b64_tr_b16 v[40:41], v7 offset:57344
    v_mov_b32 v64, 0
    v_mfma_f32_16x16x32_bf16 v[196:199], v[52:55], a[240:243], v[80:83]
    ds_read_b64_tr_b16 v[42:43], v7 offset:57856
    v_mov_b32 v65, 0
    v_mfma_f32_16x16x32_bf16 v[84:87], v[52:55], a[244:247], v[84:87]
    ds_read_b64_tr_b16 v[44:45], v7 offset:61440
    v_mov_b32 v66, 0
    v_mfma_f32_16x16x32_bf16 v[212:215], v[48:51], a[228:231], v[84:87]
    ds_read_b64_tr_b16 v[46:47], v7 offset:61952
    v_mov_b32 v67, 0
    v_mfma_f32_16x16x32_bf16 v[88:91], v[48:51], a[232:235], v[88:91]
    v_mov_b32 v68, 0
    v_mov_b32 v69, 0
    v_mfma_f32_16x16x32_bf16 v[228:231], v[52:55], a[248:251], v[88:91]
    v_mov_b32 v70, 0
    v_mov_b32 v71, 0
    v_mfma_f32_16x16x32_bf16 v[92:95], v[52:55], a[252:255], v[92:95]
    s_waitcnt vmcnt(22) lgkmcnt(0)
    v_cvt_pk_bf16_f32 v192, v192, v193
    v_cvt_pk_bf16_f32 v193, v194, v195
    v_mfma_f32_16x16x32_bf16 v[244:247], v[48:51], a[236:239], v[92:95]
    s_barrier
    v_cvt_pk_bf16_f32 v194, v196, v197
    v_mfma_f32_16x16x32_bf16 v[96:99], v[56:59], a[224:227], v[96:99]
    s_add_u32 m0, s62, 114688
    v_cvt_pk_bf16_f32 v195, v198, v199
    v_cvt_pk_bf16_f32 v208, v208, v209
    v_mfma_f32_16x16x32_bf16 v[200:203], v[60:63], a[240:243], v[96:99]
    s_add_u32 s56, s83, 65536
    v_cvt_pk_bf16_f32 v209, v210, v211
    v_cvt_pk_bf16_f32 v210, v212, v213
    v_mfma_f32_16x16x32_bf16 v[100:103], v[60:63], a[244:247], v[100:103]
    buffer_load_dwordx4 v1, s[48:51], s56 offen offset:0 sc1 lds
    v_mfma_f32_16x16x32_bf16 v[216:219], v[56:59], a[228:231], v[100:103]
    v_cvt_pk_bf16_f32 v211, v214, v215
    v_cvt_pk_bf16_f32 v224, v224, v225
    v_mfma_f32_16x16x32_bf16 v[104:107], v[56:59], a[232:235], v[104:107]
    v_cvt_pk_bf16_f32 v225, v226, v227
    v_cvt_pk_bf16_f32 v226, v228, v229
    v_mfma_f32_16x16x32_bf16 v[232:235], v[60:63], a[248:251], v[104:107]
    buffer_load_dwordx4 v1, s[48:51], s56 offen offset:1024 sc1 lds
    v_mfma_f32_16x16x32_bf16 v[108:111], v[60:63], a[252:255], v[108:111]
    v_cvt_pk_bf16_f32 v227, v230, v231
    v_cvt_pk_bf16_f32 v240, v240, v241
    v_mfma_f32_16x16x32_bf16 v[248:251], v[56:59], a[236:239], v[108:111]
    v_cvt_pk_bf16_f32 v241, v242, v243
    v_cvt_pk_bf16_f32 v242, v244, v245
    v_mfma_f32_16x16x32_bf16 v[112:115], v[40:43], a[224:227], v[112:115]
    buffer_load_dwordx4 v1, s[48:51], s56 offen offset:2048 sc1 lds
    v_mfma_f32_16x16x32_bf16 v[204:207], v[44:47], a[240:243], v[112:115]
    v_cvt_pk_bf16_f32 v243, v246, v247
    v_mov_b32 v72, 0
    v_mfma_f32_16x16x32_bf16 v[116:119], v[44:47], a[244:247], v[116:119]
    v_mov_b32 v73, 0
    v_mov_b32 v74, 0
    v_mfma_f32_16x16x32_bf16 v[220:223], v[40:43], a[228:231], v[116:119]
    buffer_load_dwordx4 v1, s[48:51], s56 offen offset:3072 sc1 lds
    v_mfma_f32_16x16x32_bf16 v[120:123], v[40:43], a[232:235], v[120:123]
    s_cmp_eq_u32 s85, 0
    s_cbranch_scc1 K_NM0
K_NM0_RET:
    v_mov_b32 v75, 0
    v_mov_b32 v76, 0
    v_mfma_f32_16x16x32_bf16 v[236:239], v[44:47], a[248:251], v[120:123]
    v_mov_b32 v77, 0
    v_mov_b32 v78, 0
    v_mfma_f32_16x16x32_bf16 v[124:127], v[44:47], a[252:255], v[124:127]
    v_cvt_pk_bf16_f32 v200, v200, v201
    v_cvt_pk_bf16_f32 v201, v202, v203
    v_mfma_f32_16x16x32_bf16 v[252:255], v[40:43], a[236:239], v[124:127]
    v_cvt_pk_bf16_f32 v202, v204, v205
    v_cvt_pk_bf16_f32 v203, v206, v207
    v_mfma_f32_16x16x32_bf16 v[196:199], a[32:35], a[0:3], 0
    v_cvt_pk_bf16_f32 v216, v216, v217
    v_cvt_pk_bf16_f32 v217, v218, v219
    v_mfma_f32_16x16x32_bf16 v[196:199], a[36:39], a[4:7], v[196:199]
    v_cvt_pk_bf16_f32 v218, v220, v221
    v_cvt_pk_bf16_f32 v219, v222, v223
    v_mfma_f32_16x16x32_bf16 v[196:199], a[40:43], v[192:195], v[196:199]
    s_add_u32 s83, s83, 65536
    v_cvt_pk_bf16_f32 v232, v232, v233
    v_cvt_pk_bf16_f32 v233, v234, v235
    v_mfma_f32_16x16x32_bf16 v[212:215], a[32:35], a[8:11], 0
    v_cvt_pk_bf16_f32 v234, v236, v237
    v_cvt_pk_bf16_f32 v235, v238, v239
    v_mfma_f32_16x16x32_bf16 v[212:215], a[36:39], a[12:15], v[212:215]
    v_cvt_pk_bf16_f32 v248, v248, v249
    v_cvt_pk_bf16_f32 v249, v250, v251
    v_mfma_f32_16x16x32_bf16 v[212:215], a[40:43], v[208:211], v[212:215]
    v_cvt_pk_bf16_f32 v250, v252, v253
    v_cvt_pk_bf16_f32 v251, v254, v255
    v_mfma_f32_16x16x32_bf16 v[196:199], a[44:47], v[200:203], v[196:199]
    buffer_atomic_add v13, v14, s[44:47], s96 offen
    v_mfma_f32_16x16x32_bf16 v[212:215], a[44:47], v[216:219], v[212:215]
    v_mov_b32 v79, 0
    v_mov_b32 v80, 0
    v_mfma_f32_16x16x32_bf16 v[204:207], a[48:51], a[0:3], 0
    v_mov_b32 v81, 0
    v_mov_b32 v82, 0
    v_mfma_f32_16x16x32_bf16 v[204:207], a[52:55], a[4:7], v[204:207]
    v_mov_b32 v83, 0
    v_mov_b32 v84, 0
    v_mfma_f32_16x16x32_bf16 v[204:207], a[56:59], v[192:195], v[204:207]
    v_mov_b32 v85, 0
    v_mov_b32 v86, 0
    v_mfma_f32_16x16x32_bf16 v[204:207], a[60:63], v[200:203], v[204:207]
    v_mov_b32 v87, 0
    v_mov_b32 v88, 0
    v_mfma_f32_16x16x32_bf16 v[220:223], a[48:51], a[8:11], 0
    v_mov_b32 v89, 0
    v_mov_b32 v90, 0
    v_mfma_f32_16x16x32_bf16 v[220:223], a[52:55], a[12:15], v[220:223]
    v_mov_b32 v91, 0
    v_mov_b32 v92, 0
    v_mfma_f32_16x16x32_bf16 v[220:223], a[56:59], v[208:211], v[220:223]
    v_mov_b32 v93, 0
    v_mov_b32 v94, 0
    v_mfma_f32_16x16x32_bf16 v[220:223], a[60:63], v[216:219], v[220:223]
    v_mov_b32 v95, 0
    v_mov_b32 v96, 0
    v_mfma_f32_16x16x32_bf16 v[228:231], a[32:35], a[16:19], v[16:19]
    v_mov_b32 v97, 0
    v_mov_b32 v98, 0
    v_mfma_f32_16x16x32_bf16 v[228:231], a[36:39], a[20:23], v[228:231]
    v_mov_b32 v99, 0
    v_mfma_f32_16x16x32_bf16 v[228:231], a[40:43], v[224:227], v[228:231]
    v_mfma_f32_16x16x32_bf16 v[228:231], a[44:47], v[232:235], v[228:231]
    v_max3_f32 v9, v196, v197, v198
    v_max3_f32 v11, v199, v204, v205
    v_max3_f32 v9, v9, v206, v207
    v_mfma_f32_16x16x32_bf16 v[244:247], a[32:35], a[24:27], v[20:23]
    v_max_f32 v9, v9, v11
    v_max3_f32 v10, v212, v213, v214
    v_max3_f32 v44, v215, v220, v221
    v_mfma_f32_16x16x32_bf16 v[244:247], a[36:39], a[28:31], v[244:247]
    v_max3_f32 v10, v10, v222, v223
    v_max_f32 v10, v10, v44
    v_mov_b32 v11, v9
    v_mfma_f32_16x16x32_bf16 v[244:247], a[40:43], v[240:243], v[244:247]
    v_mov_b32 v44, v10
    v_mfma_f32_16x16x32_bf16 v[244:247], a[44:47], v[248:251], v[244:247]
    v_permlane16_swap_b32 v9, v11
    v_permlane16_swap_b32 v10, v44
    v_max_f32 v9, v9, v11
    v_mfma_f32_16x16x32_bf16 v[236:239], a[48:51], a[16:19], v[24:27]
    ds_read_b128 a[32:35], v1 offset:16384
    v_max_f32 v10, v10, v44
    v_mov_b32 v11, v9
    v_mfma_f32_16x16x32_bf16 v[236:239], a[52:55], a[20:23], v[236:239]
    ds_read_b128 a[36:39], v1 offset:17408
    v_mov_b32 v44, v10
    v_mfma_f32_16x16x32_bf16 v[236:239], a[56:59], v[224:227], v[236:239]
    ds_read_b128 a[40:43], v1 offset:18432
    v_permlane32_swap_b32 v9, v11
    v_permlane32_swap_b32 v10, v44
    v_mfma_f32_16x16x32_bf16 v[236:239], a[60:63], v[232:235], v[236:239]
    ds_read_b128 a[44:47], v1 offset:19456
    v_max_f32 v9, v9, v11
    v_max_f32 v10, v10, v44
    v_mfma_f32_16x16x32_bf16 v[252:255], a[48:51], a[24:27], v[28:31]
    ds_read_b128 a[48:51], v1 offset:20480
    v_sub_f32 v196, v196, v9
    v_sub_f32 v197, v197, v9
    v_mfma_f32_16x16x32_bf16 v[252:255], a[52:55], a[28:31], v[252:255]
    ds_read_b128 a[52:55], v1 offset:21504
    v_sub_f32 v198, v198, v9
    v_sub_f32 v199, v199, v9
    v_mfma_f32_16x16x32_bf16 v[252:255], a[56:59], v[240:243], v[252:255]
    ds_read_b128 a[56:59], v1 offset:22528
    v_sub_f32 v204, v204, v9
    v_sub_f32 v205, v205, v9
    v_mfma_f32_16x16x32_bf16 v[252:255], a[60:63], v[248:251], v[252:255]
    ds_read_b128 a[60:63], v1 offset:23552
    v_sub_f32 v206, v206, v9
    v_sub_f32 v207, v207, v9
    v_mfma_f32_16x16x32_bf16 v[100:103], a[100:103], a[100:103], 0
    v_mfma_f32_16x16x32_bf16 v[104:107], a[100:103], a[100:103], 0
    v_pk_add_f32 v[212:213], v[212:213], v[10:11] op_sel_hi:[1,0] neg_lo:[0,1] neg_hi:[0,1]
    v_pk_add_f32 v[214:215], v[214:215], v[10:11] op_sel_hi:[1,0] neg_lo:[0,1] neg_hi:[0,1]
    v_pk_add_f32 v[220:221], v[220:221], v[10:11] op_sel_hi:[1,0] neg_lo:[0,1] neg_hi:[0,1]
    v_pk_add_f32 v[222:223], v[222:223], v[10:11] op_sel_hi:[1,0] neg_lo:[0,1] neg_hi:[0,1]
    v_pk_mul_f32 v[48:49], v[8:9], -1.0 op_sel:[1,0] op_sel_hi:[1,0]
    v_pk_mul_f32 v[50:51], v[8:9], -1.0 op_sel:[1,0] op_sel_hi:[1,0]
    v_pk_mul_f32 v[56:57], v[8:9], -1.0 op_sel:[1,0] op_sel_hi:[1,0]
    v_pk_mul_f32 v[58:59], v[8:9], -1.0 op_sel:[1,0] op_sel_hi:[1,0]
    v_pk_mul_f32 v[52:53], v[10:11], -1.0 op_sel_hi:[0,0]
    v_pk_mul_f32 v[54:55], v[10:11], -1.0 op_sel_hi:[0,0]
    v_pk_mul_f32 v[60:61], v[10:11], -1.0 op_sel_hi:[0,0]
    v_pk_mul_f32 v[62:63], v[10:11], -1.0 op_sel_hi:[0,0]
    v_exp_f32 v4, v196
    v_max3_f32 v40, v228, v229, v230
    v_mfma_f32_16x16x32_bf16 v[108:111], a[100:103], a[100:103], 0
    v_exp_f32 v5, v197
    v_max3_f32 v42, v231, v236, v237
    v_cvt_pk_bf16_f32 v32, v4, v5
    v_exp_f32 v6, v198
    v_max3_f32 v40, v40, v238, v239
    v_mfma_f32_16x16x32_bf16 v[112:115], a[100:103], a[100:103], 0
    v_exp_f32 v7, v199
    v_max_f32 v40, v40, v42
    v_cvt_pk_bf16_f32 v33, v6, v7
    v_exp_f32 v4, v204
    v_max3_f32 v41, v244, v245, v246
    v_mfma_f32_16x16x32_bf16 v[116:119], a[100:103], a[100:103], 0
    v_exp_f32 v5, v205
    v_max3_f32 v43, v247, v252, v253
    v_cvt_pk_bf16_f32 v34, v4, v5
    v_exp_f32 v6, v206
    v_max3_f32 v41, v41, v254, v255
    v_mfma_f32_16x16x32_bf16 v[120:123], a[100:103], a[100:103], 0
    v_exp_f32 v7, v207
    v_max_f32 v41, v41, v43
    v_cvt_pk_bf16_f32 v35, v6, v7
    v_exp_f32 v4, v212
    v_mov_b32 v42, v40
    v_mfma_f32_16x16x32_bf16 v[124:127], a[100:103], a[100:103], 0
    v_exp_f32 v5, v213
    v_mov_b32 v43, v41
    v_cvt_pk_bf16_f32 v36, v4, v5
    v_exp_f32 v6, v214
    v_permlane16_swap_b32 v40, v42
    v_exp_f32 v7, v215
    v_permlane16_swap_b32 v41, v43
    v_cvt_pk_bf16_f32 v37, v6, v7
    v_exp_f32 v4, v220
    v_max_f32 v40, v40, v42
    v_exp_f32 v5, v221
    v_max_f32 v41, v41, v43
    v_cvt_pk_bf16_f32 v38, v4, v5
    v_exp_f32 v6, v222
    v_mov_b32 v42, v40
    v_exp_f32 v7, v223
    v_mov_b32 v43, v41
    v_cvt_pk_bf16_f32 v39, v6, v7
    s_nop 0
    v_permlane32_swap_b32 v40, v42
    v_permlane32_swap_b32 v41, v43
    v_max_f32 v40, v40, v42
    v_max_f32 v41, v41, v43
    v_pk_add_f32 v[228:229], v[228:229], v[40:41] op_sel_hi:[1,0] neg_lo:[0,1] neg_hi:[0,1]
    v_pk_add_f32 v[230:231], v[230:231], v[40:41] op_sel_hi:[1,0] neg_lo:[0,1] neg_hi:[0,1]
    v_pk_add_f32 v[236:237], v[236:237], v[40:41] op_sel_hi:[1,0] neg_lo:[0,1] neg_hi:[0,1]
    v_pk_add_f32 v[238:239], v[238:239], v[40:41] op_sel_hi:[1,0] neg_lo:[0,1] neg_hi:[0,1]
    v_pk_add_f32 v[244:245], v[244:245], v[40:41] op_sel:[0,1] op_sel_hi:[1,1] neg_lo:[0,1] neg_hi:[0,1]
    v_pk_add_f32 v[246:247], v[246:247], v[40:41] op_sel:[0,1] op_sel_hi:[1,1] neg_lo:[0,1] neg_hi:[0,1]
    v_pk_add_f32 v[252:253], v[252:253], v[40:41] op_sel:[0,1] op_sel_hi:[1,1] neg_lo:[0,1] neg_hi:[0,1]
    v_pk_add_f32 v[254:255], v[254:255], v[40:41] op_sel:[0,1] op_sel_hi:[1,1] neg_lo:[0,1] neg_hi:[0,1]
    v_pk_mul_f32 v[16:17], v[40:41], -1.0 op_sel_hi:[0,0]
    v_pk_mul_f32 v[18:19], v[40:41], -1.0 op_sel_hi:[0,0]
    v_pk_mul_f32 v[24:25], v[40:41], -1.0 op_sel_hi:[0,0]
    v_pk_mul_f32 v[26:27], v[40:41], -1.0 op_sel_hi:[0,0]
    v_pk_mul_f32 v[20:21], v[40:41], -1.0 op_sel:[1,0] op_sel_hi:[1,0]
    v_pk_mul_f32 v[22:23], v[40:41], -1.0 op_sel:[1,0] op_sel_hi:[1,0]
    v_pk_mul_f32 v[28:29], v[40:41], -1.0 op_sel:[1,0] op_sel_hi:[1,0]
    v_pk_mul_f32 v[30:31], v[40:41], -1.0 op_sel:[1,0] op_sel_hi:[1,0]
    s_waitcnt vmcnt(15) lgkmcnt(0)
    s_sub_u32 s75, s75, 1
    s_cbranch_scc1 K_TB
    s_cmp_eq_u32 s75, 0
    s_cbranch_scc1 K_DLAST
.p2align 5
K_DUAL:
    v_mfma_f32_16x16x32_bf16 v[196:199], a[32:35], a[0:3], v[48:51]
    s_barrier
    v_mfma_f32_16x16x32_bf16 v[196:199], a[36:39], a[4:7], v[196:199]
    s_mov_b32 m0, s74
    v_exp_f32 v4, v228
    v_mfma_f32_16x16x32_bf16 v[196:199], a[40:43], v[192:195], v[196:199]
    s_add_u32 s74, s74, 16384
    ds_read_b128 a[64:67], v2 offset:8192
    v_mfma_f32_16x16x32_bf16 v[196:199], a[44:47], v[200:203], v[196:199]
    s_and_b32 s74, s74, 0x1ffff
    v_exp_f32 v5, v229
    v_mfma_f32_16x16x32_bf16 v[212:215], a[44:47], v[216:219], v[52:55]
    s_add_u32 s83, s83, 16384
    ds_read_b128 a[68:71], v2 offset:9216
    v_cvt_pk_bf16_f32 v40, v4, v5
    v_mfma_f32_16x16x32_bf16 v[212:215], a[40:43], v[208:211], v[212:215]
    v_exp_f32 v6, v230
    v_mfma_f32_16x16x32_bf16 v[212:215], a[36:39], a[12:15], v[212:215]
    ds_read_b128 a[72:75], v2 offset:10240
    v_mfma_f32_16x16x32_bf16 v[212:215], a[32:35], a[8:11], v[212:215]
    s_waitcnt lgkmcnt(3)
    v_exp_f32 v7, v231
    v_mfma_f32_16x16x32_bf16 v[220:223], a[48:51], a[8:11], v[60:63]
    ds_read_b128 a[76:79], v2 offset:11264
    v_cvt_pk_bf16_f32 v41, v6, v7
    v_mfma_f32_16x16x32_bf16 v[220:223], a[52:55], a[12:15], v[220:223]
    v_exp_f32 v4, v236
    v_mfma_f32_16x16x32_bf16 v[220:223], a[56:59], v[208:211], v[220:223]
    ds_read_b128 a[80:83], v2 offset:12288
    ds_read_b128 a[84:87], v2 offset:13312
    v_mfma_f32_16x16x32_bf16 v[220:223], a[60:63], v[216:219], v[220:223]
    v_exp_f32 v5, v237
    v_mfma_f32_16x16x32_bf16 v[204:207], a[60:63], v[200:203], v[56:59]
    ds_read_b128 a[88:91], v2 offset:14336
    v_cvt_pk_bf16_f32 v42, v4, v5
    v_mfma_f32_16x16x32_bf16 v[204:207], a[56:59], v[192:195], v[204:207]
    v_exp_f32 v6, v238
    v_mfma_f32_16x16x32_bf16 v[204:207], a[52:55], a[4:7], v[204:207]
    ds_read_b128 a[92:95], v2 offset:15360
    v_mfma_f32_16x16x32_bf16 v[204:207], a[48:51], a[0:3], v[204:207]
    v_exp_f32 v7, v239
    v_smfmac_f32_16x16x64_bf16 a[100:103], a[96:99], v[32:39], v8
    s_waitcnt lgkmcnt(4)
    v_cvt_pk_bf16_f32 v43, v6, v7
    v_mfma_f32_16x16x32_bf16 v[128:131], a[64:67], v[32:35], v[128:131]
    v_exp_f32 v4, v244
    v_mfma_f32_16x16x32_bf16 v[160:163], a[64:67], v[36:39], v[160:163]
    buffer_load_dwordx4 v1, s[48:51], s83 offen offset:0 sc1 lds
    v_mfma_f32_16x16x32_bf16 v[132:135], a[68:71], v[32:35], v[132:135]
    v_exp_f32 v5, v245
    v_mfma_f32_16x16x32_bf16 v[164:167], a[68:71], v[36:39], v[164:167]
    v_cvt_pk_bf16_f32 v44, v4, v5
    v_mfma_f32_16x16x32_bf16 v[136:139], a[72:75], v[32:35], v[136:139]
    v_exp_f32 v6, v246
    v_mfma_f32_16x16x32_bf16 v[168:171], a[72:75], v[36:39], v[168:171]
    buffer_load_dwordx4 v1, s[48:51], s83 offen offset:1024 sc1 lds
    v_mfma_f32_16x16x32_bf16 v[140:143], a[76:79], v[32:35], v[140:143]
    v_exp_f32 v7, v247
    v_mfma_f32_16x16x32_bf16 v[172:175], a[76:79], v[36:39], v[172:175]
    s_waitcnt lgkmcnt(0)
    v_cvt_pk_bf16_f32 v45, v6, v7
    v_mfma_f32_16x16x32_bf16 v[144:147], a[80:83], v[32:35], v[144:147]
    v_exp_f32 v4, v252
    v_mfma_f32_16x16x32_bf16 v[176:179], a[80:83], v[36:39], v[176:179]
    buffer_load_dwordx4 v1, s[48:51], s83 offen offset:2048 sc1 lds
    v_mfma_f32_16x16x32_bf16 v[148:151], a[84:87], v[32:35], v[148:151]
    v_exp_f32 v5, v253
    v_mfma_f32_16x16x32_bf16 v[180:183], a[84:87], v[36:39], v[180:183]
    v_cvt_pk_bf16_f32 v46, v4, v5
    v_mfma_f32_16x16x32_bf16 v[152:155], a[88:91], v[32:35], v[152:155]
    v_exp_f32 v6, v254
    v_mfma_f32_16x16x32_bf16 v[184:187], a[88:91], v[36:39], v[184:187]
    buffer_load_dwordx4 v1, s[48:51], s83 offen offset:3072 sc1 lds
    v_mfma_f32_16x16x32_bf16 v[156:159], a[92:95], v[32:35], v[156:159]
    v_exp_f32 v7, v255
    v_mfma_f32_16x16x32_bf16 v[188:191], a[92:95], v[36:39], v[188:191]
    v_cvt_pk_bf16_f32 v47, v6, v7
    v_mfma_f32_16x16x32_bf16 v[228:231], a[32:35], a[16:19], v[16:19]
    v_exp_f32 v4, v196
    v_mfma_f32_16x16x32_bf16 v[228:231], a[36:39], a[20:23], v[228:231]
    v_exp_f32 v5, v197
    v_mfma_f32_16x16x32_bf16 v[228:231], a[40:43], v[224:227], v[228:231]
    v_cvt_pk_bf16_f32 v32, v4, v5
    v_mfma_f32_16x16x32_bf16 v[228:231], a[44:47], v[232:235], v[228:231]
    v_exp_f32 v6, v198
    v_mfma_f32_16x16x32_bf16 v[244:247], a[44:47], v[248:251], v[20:23]
    v_exp_f32 v7, v199
    v_mfma_f32_16x16x32_bf16 v[244:247], a[40:43], v[240:243], v[244:247]
    v_cvt_pk_bf16_f32 v33, v6, v7
    v_mfma_f32_16x16x32_bf16 v[244:247], a[36:39], a[28:31], v[244:247]
    v_exp_f32 v4, v204
    v_mfma_f32_16x16x32_bf16 v[244:247], a[32:35], a[24:27], v[244:247]
    v_exp_f32 v5, v205
    v_mfma_f32_16x16x32_bf16 v[252:255], a[48:51], a[24:27], v[28:31]
    ds_read_b128 a[32:35], v3 offset:0
    v_cvt_pk_bf16_f32 v34, v4, v5
    v_mfma_f32_16x16x32_bf16 v[252:255], a[52:55], a[28:31], v[252:255]
    v_exp_f32 v6, v206
    v_mfma_f32_16x16x32_bf16 v[252:255], a[56:59], v[240:243], v[252:255]
    v_exp_f32 v7, v207
    v_mfma_f32_16x16x32_bf16 v[252:255], a[60:63], v[248:251], v[252:255]
    ds_read_b128 a[36:39], v3 offset:1024
    v_cvt_pk_bf16_f32 v35, v6, v7
    v_mfma_f32_16x16x32_bf16 v[236:239], a[60:63], v[232:235], v[24:27]
    v_exp_f32 v4, v212
    v_mfma_f32_16x16x32_bf16 v[236:239], a[56:59], v[224:227], v[236:239]
    v_exp_f32 v5, v213
    v_mfma_f32_16x16x32_bf16 v[236:239], a[52:55], a[20:23], v[236:239]
    ds_read_b128 a[40:43], v3 offset:2048
    v_cvt_pk_bf16_f32 v36, v4, v5
    v_mfma_f32_16x16x32_bf16 v[236:239], a[48:51], a[16:19], v[236:239]
    v_exp_f32 v6, v214
    v_smfmac_f32_16x16x64_bf16 a[108:111], a[96:99], v[40:47], v8
    ds_read_b128 a[44:47], v3 offset:3072
    v_mfma_f32_16x16x32_bf16 v[64:67], a[64:67], v[40:43], v[64:67]
    v_exp_f32 v7, v215
    v_mfma_f32_16x16x32_bf16 v[96:99], a[64:67], v[44:47], v[96:99]
    ds_read_b128 a[48:51], v3 offset:4096
    v_cvt_pk_bf16_f32 v37, v6, v7
    v_mfma_f32_16x16x32_bf16 v[68:71], a[68:71], v[40:43], v[68:71]
    v_exp_f32 v4, v220
    v_mfma_f32_16x16x32_bf16 v[100:103], a[68:71], v[44:47], v[100:103]
    v_exp_f32 v5, v221
    v_mfma_f32_16x16x32_bf16 v[72:75], a[72:75], v[40:43], v[72:75]
    ds_read_b128 a[52:55], v3 offset:5120
    v_cvt_pk_bf16_f32 v38, v4, v5
    v_mfma_f32_16x16x32_bf16 v[104:107], a[72:75], v[44:47], v[104:107]
    v_exp_f32 v6, v222
    v_mfma_f32_16x16x32_bf16 v[76:79], a[76:79], v[40:43], v[76:79]
    v_exp_f32 v7, v223
    v_mfma_f32_16x16x32_bf16 v[108:111], a[76:79], v[44:47], v[108:111]
    ds_read_b128 a[56:59], v3 offset:6144
    v_cvt_pk_bf16_f32 v39, v6, v7
    v_mfma_f32_16x16x32_bf16 v[80:83], a[80:83], v[40:43], v[80:83]
    ds_read_b128 a[60:63], v3 offset:7168
    v_mfma_f32_16x16x32_bf16 v[112:115], a[80:83], v[44:47], v[112:115]
    v_mfma_f32_16x16x32_bf16 v[84:87], a[84:87], v[40:43], v[84:87]
    s_add_u32 s73, s73, 16384
    v_mfma_f32_16x16x32_bf16 v[116:119], a[84:87], v[44:47], v[116:119]
    s_and_b32 s73, s73, 0x1ffff
    v_mfma_f32_16x16x32_bf16 v[88:91], a[88:91], v[40:43], v[88:91]
    s_sub_u32 s75, s75, 1
    v_mfma_f32_16x16x32_bf16 v[120:123], a[88:91], v[44:47], v[120:123]
    s_cmp_lg_u32 s75, 0
    v_mov_b32 v3, v2
    v_add_u32 v2, s73, v1
    v_mfma_f32_16x16x32_bf16 v[92:95], a[92:95], v[40:43], v[92:95]
    v_mfma_f32_16x16x32_bf16 v[124:127], a[92:95], v[44:47], v[124:127]
    s_waitcnt vmcnt(12) lgkmcnt(4)
    s_cbranch_scc1 K_DUAL
K_DLAST:
    v_mfma_f32_16x16x32_bf16 v[196:199], a[32:35], a[0:3], v[48:51]
    s_barrier
    v_mfma_f32_16x16x32_bf16 v[196:199], a[36:39], a[4:7], v[196:199]
    s_mov_b32 m0, s74
    v_exp_f32 v4, v228
    v_mfma_f32_16x16x32_bf16 v[196:199], a[40:43], v[192:195], v[196:199]
    s_add_u32 s74, s74, 16384
    ds_read_b128 a[64:67], v2 offset:8192
    v_mov_b32 v24, s76
    v_mfma_f32_16x16x32_bf16 v[196:199], a[44:47], v[200:203], v[196:199]
    s_and_b32 s74, s74, 0x1ffff
    v_exp_f32 v5, v229
    v_mfma_f32_16x16x32_bf16 v[212:215], a[44:47], v[216:219], v[52:55]
    s_add_u32 s83, s83, 16384
    ds_read_b128 a[68:71], v2 offset:9216
    v_cvt_pk_bf16_f32 v40, v4, v5
    v_mfma_f32_16x16x32_bf16 v[212:215], a[40:43], v[208:211], v[212:215]
    v_exp_f32 v6, v230
    v_mfma_f32_16x16x32_bf16 v[212:215], a[36:39], a[12:15], v[212:215]
    ds_read_b128 a[72:75], v2 offset:10240
    v_cndmask_b32 v16, v16, v24, s[88:89]
    v_mfma_f32_16x16x32_bf16 v[212:215], a[32:35], a[8:11], v[212:215]
    s_waitcnt lgkmcnt(3)
    v_exp_f32 v7, v231
    v_mfma_f32_16x16x32_bf16 v[220:223], a[48:51], a[8:11], v[60:63]
    ds_read_b128 a[76:79], v2 offset:11264
    v_cvt_pk_bf16_f32 v41, v6, v7
    v_mfma_f32_16x16x32_bf16 v[220:223], a[52:55], a[12:15], v[220:223]
    v_exp_f32 v4, v236
    v_mfma_f32_16x16x32_bf16 v[220:223], a[56:59], v[208:211], v[220:223]
    ds_read_b128 a[80:83], v2 offset:12288
    ds_read_b128 a[84:87], v2 offset:13312
    v_mfma_f32_16x16x32_bf16 v[220:223], a[60:63], v[216:219], v[220:223]
    v_exp_f32 v5, v237
    v_mfma_f32_16x16x32_bf16 v[204:207], a[60:63], v[200:203], v[56:59]
    ds_read_b128 a[88:91], v2 offset:14336
    v_cvt_pk_bf16_f32 v42, v4, v5
    v_mfma_f32_16x16x32_bf16 v[204:207], a[56:59], v[192:195], v[204:207]
    v_exp_f32 v6, v238
    v_mfma_f32_16x16x32_bf16 v[204:207], a[52:55], a[4:7], v[204:207]
    ds_read_b128 a[92:95], v2 offset:15360
    v_cndmask_b32 v17, v17, v24, s[90:91]
    v_mfma_f32_16x16x32_bf16 v[204:207], a[48:51], a[0:3], v[204:207]
    v_exp_f32 v7, v239
    v_smfmac_f32_16x16x64_bf16 a[100:103], a[96:99], v[32:39], v8
    s_waitcnt lgkmcnt(4)
    v_cvt_pk_bf16_f32 v43, v6, v7
    v_mfma_f32_16x16x32_bf16 v[128:131], a[64:67], v[32:35], v[128:131]
    v_exp_f32 v4, v244
    v_mfma_f32_16x16x32_bf16 v[160:163], a[64:67], v[36:39], v[160:163]
    buffer_load_dwordx4 v1, s[48:51], s83 offen offset:0 sc1 lds
    v_cndmask_b32 v18, v18, v24, s[92:93]
    v_mfma_f32_16x16x32_bf16 v[132:135], a[68:71], v[32:35], v[132:135]
    v_exp_f32 v5, v245
    v_mfma_f32_16x16x32_bf16 v[164:167], a[68:71], v[36:39], v[164:167]
    v_cvt_pk_bf16_f32 v44, v4, v5
    v_cndmask_b32 v19, v19, v24, s[94:95]
    v_mfma_f32_16x16x32_bf16 v[136:139], a[72:75], v[32:35], v[136:139]
    v_exp_f32 v6, v246
    v_mfma_f32_16x16x32_bf16 v[168:171], a[72:75], v[36:39], v[168:171]
    buffer_load_dwordx4 v1, s[48:51], s83 offen offset:1024 sc1 lds
    v_cndmask_b32 v28, v28, v24, s[88:89]
    v_mfma_f32_16x16x32_bf16 v[140:143], a[76:79], v[32:35], v[140:143]
    v_exp_f32 v7, v247
    v_mfma_f32_16x16x32_bf16 v[172:175], a[76:79], v[36:39], v[172:175]
    s_waitcnt lgkmcnt(0)
    v_cvt_pk_bf16_f32 v45, v6, v7
    v_cndmask_b32 v29, v29, v24, s[90:91]
    v_mfma_f32_16x16x32_bf16 v[144:147], a[80:83], v[32:35], v[144:147]
    v_exp_f32 v4, v252
    v_mfma_f32_16x16x32_bf16 v[176:179], a[80:83], v[36:39], v[176:179]
    buffer_load_dwordx4 v1, s[48:51], s83 offen offset:2048 sc1 lds
    v_cndmask_b32 v30, v30, v24, s[92:93]
    v_mfma_f32_16x16x32_bf16 v[148:151], a[84:87], v[32:35], v[148:151]
    v_exp_f32 v5, v253
    v_mfma_f32_16x16x32_bf16 v[180:183], a[84:87], v[36:39], v[180:183]
    v_cvt_pk_bf16_f32 v46, v4, v5
    v_cndmask_b32 v31, v31, v24, s[94:95]
    v_mfma_f32_16x16x32_bf16 v[152:155], a[88:91], v[32:35], v[152:155]
K_PG9:
    s_cmp_eq_u32 s100, 1
    s_cbranch_scc1 K_PG13
    v_exp_f32 v6, v254
    v_mfma_f32_16x16x32_bf16 v[184:187], a[88:91], v[36:39], v[184:187]
    buffer_load_dwordx4 v1, s[48:51], s83 offen offset:3072 sc1 lds
    v_mfma_f32_16x16x32_bf16 v[156:159], a[92:95], v[32:35], v[156:159]
    v_exp_f32 v7, v255
    v_mfma_f32_16x16x32_bf16 v[188:191], a[92:95], v[36:39], v[188:191]
    v_cvt_pk_bf16_f32 v47, v6, v7
    v_mfma_f32_16x16x32_bf16 v[228:231], a[32:35], a[16:19], v[16:19]
    v_exp_f32 v4, v196
    v_mfma_f32_16x16x32_bf16 v[228:231], a[36:39], a[20:23], v[228:231]
    v_exp_f32 v5, v197
    v_mfma_f32_16x16x32_bf16 v[228:231], a[40:43], v[224:227], v[228:231]
    v_cvt_pk_bf16_f32 v32, v4, v5
    v_mfma_f32_16x16x32_bf16 v[228:231], a[44:47], v[232:235], v[228:231]
    v_exp_f32 v6, v198
    v_mfma_f32_16x16x32_bf16 v[244:247], a[44:47], v[248:251], v[20:23]
    v_exp_f32 v7, v199
    v_mfma_f32_16x16x32_bf16 v[244:247], a[40:43], v[240:243], v[244:247]
    v_cvt_pk_bf16_f32 v33, v6, v7
    v_mfma_f32_16x16x32_bf16 v[244:247], a[36:39], a[28:31], v[244:247]
    v_exp_f32 v4, v204
    v_mfma_f32_16x16x32_bf16 v[244:247], a[32:35], a[24:27], v[244:247]
    v_exp_f32 v5, v205
    v_mfma_f32_16x16x32_bf16 v[252:255], a[48:51], a[24:27], v[28:31]
    ds_read_b128 a[32:35], v3 offset:0
    v_cvt_pk_bf16_f32 v34, v4, v5
    v_mfma_f32_16x16x32_bf16 v[252:255], a[52:55], a[28:31], v[252:255]
    v_exp_f32 v6, v206
    v_mfma_f32_16x16x32_bf16 v[252:255], a[56:59], v[240:243], v[252:255]
    v_exp_f32 v7, v207
    v_mfma_f32_16x16x32_bf16 v[252:255], a[60:63], v[248:251], v[252:255]
    ds_read_b128 a[36:39], v3 offset:1024
    v_cvt_pk_bf16_f32 v35, v6, v7
    v_mfma_f32_16x16x32_bf16 v[236:239], a[60:63], v[232:235], v[24:27]
    v_exp_f32 v4, v212
    v_mfma_f32_16x16x32_bf16 v[236:239], a[56:59], v[224:227], v[236:239]
    v_exp_f32 v5, v213
    v_mfma_f32_16x16x32_bf16 v[236:239], a[52:55], a[20:23], v[236:239]
    ds_read_b128 a[40:43], v3 offset:2048
    v_cvt_pk_bf16_f32 v36, v4, v5
    v_mfma_f32_16x16x32_bf16 v[236:239], a[48:51], a[16:19], v[236:239]
    v_exp_f32 v6, v214
    v_smfmac_f32_16x16x64_bf16 a[108:111], a[96:99], v[40:47], v8
    ds_read_b128 a[44:47], v3 offset:3072
    v_mfma_f32_16x16x32_bf16 v[64:67], a[64:67], v[40:43], v[64:67]
    v_exp_f32 v7, v215
    v_mfma_f32_16x16x32_bf16 v[96:99], a[64:67], v[44:47], v[96:99]
    ds_read_b128 a[48:51], v3 offset:4096
    v_cvt_pk_bf16_f32 v37, v6, v7
    v_mfma_f32_16x16x32_bf16 v[68:71], a[68:71], v[40:43], v[68:71]
    v_exp_f32 v4, v220
    v_mfma_f32_16x16x32_bf16 v[100:103], a[68:71], v[44:47], v[100:103]
    v_exp_f32 v5, v221
    v_mfma_f32_16x16x32_bf16 v[72:75], a[72:75], v[40:43], v[72:75]
    ds_read_b128 a[52:55], v3 offset:5120
    v_cvt_pk_bf16_f32 v38, v4, v5
    v_mfma_f32_16x16x32_bf16 v[104:107], a[72:75], v[44:47], v[104:107]
    v_exp_f32 v6, v222
    v_mfma_f32_16x16x32_bf16 v[76:79], a[76:79], v[40:43], v[76:79]
    v_exp_f32 v7, v223
    v_mfma_f32_16x16x32_bf16 v[108:111], a[76:79], v[44:47], v[108:111]
    ds_read_b128 a[56:59], v3 offset:6144
    v_cvt_pk_bf16_f32 v39, v6, v7
    v_mfma_f32_16x16x32_bf16 v[80:83], a[80:83], v[40:43], v[80:83]
    ds_read_b128 a[60:63], v3 offset:7168
    v_mfma_f32_16x16x32_bf16 v[112:115], a[80:83], v[44:47], v[112:115]
    v_mfma_f32_16x16x32_bf16 v[84:87], a[84:87], v[40:43], v[84:87]
    s_add_u32 s73, s73, 16384
    v_mfma_f32_16x16x32_bf16 v[116:119], a[84:87], v[44:47], v[116:119]
    s_and_b32 s73, s73, 0x1ffff
    v_mfma_f32_16x16x32_bf16 v[88:91], a[88:91], v[40:43], v[88:91]
    v_mfma_f32_16x16x32_bf16 v[120:123], a[88:91], v[44:47], v[120:123]
    v_mov_b32 v3, v2
    v_add_u32 v2, s73, v1
    v_mfma_f32_16x16x32_bf16 v[92:95], a[92:95], v[40:43], v[92:95]
    v_mfma_f32_16x16x32_bf16 v[124:127], a[92:95], v[44:47], v[124:127]
    s_waitcnt vmcnt(12) lgkmcnt(4)
K_TB:
    v_mfma_f32_16x16x32_bf16 v[196:199], a[32:35], a[0:3], v[48:51]
    s_barrier
    ds_read_b128 a[64:67], v2 offset:8192
    v_mfma_f32_16x16x32_bf16 v[196:199], a[36:39], a[4:7], v[196:199]
    s_mov_b32 m0, s74
    v_exp_f32 v4, v228
    v_mfma_f32_16x16x32_bf16 v[196:199], a[40:43], v[192:195], v[196:199]
    s_add_u32 s74, s74, 16384
    ds_read_b128 a[68:71], v2 offset:9216
    ds_read_b128 a[72:75], v2 offset:10240
    v_mfma_f32_16x16x32_bf16 v[196:199], a[44:47], v[200:203], v[196:199]
    s_and_b32 s74, s74, 0x1ffff
    v_exp_f32 v5, v229
    v_mfma_f32_16x16x32_bf16 v[212:215], a[44:47], v[216:219], v[52:55]
    s_add_u32 s83, s83, 16384
    ds_read_b128 a[76:79], v2 offset:11264
    v_cvt_pk_bf16_f32 v40, v4, v5
    v_mfma_f32_16x16x32_bf16 v[212:215], a[40:43], v[208:211], v[212:215]
    s_add_u32 s56, s67, 0
    v_exp_f32 v6, v230
    v_mfma_f32_16x16x32_bf16 v[212:215], a[36:39], a[12:15], v[212:215]
    s_and_b32 s56, s56, 3
    ds_read_b128 a[80:83], v2 offset:12288
    buffer_load_dwordx4 v1, s[48:51], s83 offen offset:0 sc1 lds
    v_mfma_f32_16x16x32_bf16 v[212:215], a[32:35], a[8:11], v[212:215]
    s_waitcnt lgkmcnt(5)
    v_exp_f32 v7, v231
    v_mfma_f32_16x16x32_bf16 v[220:223], a[48:51], a[8:11], v[60:63]
    ds_read_b128 a[84:87], v2 offset:13312
    v_cvt_pk_bf16_f32 v41, v6, v7
    v_lshl_add_u32 v25, s56, 10, v1
    v_mfma_f32_16x16x32_bf16 v[220:223], a[52:55], a[12:15], v[220:223]
    s_add_u32 s56, s67, 1
    buffer_store_dwordx4 a[128:131], v12, s[44:47], s80 offen offset:0 sc1
    v_mfma_f32_16x16x32_bf16 v[220:223], a[56:59], v[208:211], v[220:223]
    s_and_b32 s56, s56, 3
    ds_read_b128 a[88:91], v2 offset:14336
    ds_read_b128 a[92:95], v2 offset:15360
    v_mfma_f32_16x16x32_bf16 v[220:223], a[60:63], v[216:219], v[220:223]
    buffer_store_dwordx4 a[132:135], v12, s[44:47], s80 offen offset:1024 sc1
    v_lshl_add_u32 v26, s56, 10, v1
    v_mfma_f32_16x16x32_bf16 v[204:207], a[60:63], v[200:203], v[56:59]
    s_add_u32 s56, s67, 2
    ds_read_b128 a[32:35], v3 offset:0
    v_mov_b32 v42, 0
    v_mfma_f32_16x16x32_bf16 v[204:207], a[56:59], v[192:195], v[204:207]
    s_and_b32 s56, s56, 3
    buffer_store_dwordx4 a[136:139], v12, s[44:47], s80 offen offset:2048 sc1
    v_mfma_f32_16x16x32_bf16 v[204:207], a[52:55], a[4:7], v[204:207]
    buffer_load_dwordx4 v1, s[48:51], s83 offen offset:1024 sc1 lds
    v_lshl_add_u32 v27, s56, 10, v1
    v_mfma_f32_16x16x32_bf16 v[204:207], a[48:51], a[0:3], v[204:207]
    s_add_u32 s56, s67, 3
    buffer_store_dwordx4 a[140:143], v12, s[44:47], s80 offen offset:3072 sc1
    v_smfmac_f32_16x16x64_bf16 a[100:103], a[96:99], v[32:39], v8
    s_waitcnt lgkmcnt(5)
    v_mov_b32 v43, 0
    v_mfma_f32_16x16x32_bf16 v[128:131], a[64:67], v[32:35], v[128:131]
    s_and_b32 s56, s56, 3
    v_exp_f32 v4, v244
    v_mfma_f32_16x16x32_bf16 v[160:163], a[64:67], v[36:39], v[160:163]
    ds_read_b128 a[36:39], v3 offset:1024
    ds_read_b128 a[40:43], v3 offset:2048
    v_lshl_add_u32 v28, s56, 10, v1
    v_mfma_f32_16x16x32_bf16 v[132:135], a[68:71], v[32:35], v[132:135]
    s_add_u32 s57, s1, 4096
    v_exp_f32 v5, v245
    v_mfma_f32_16x16x32_bf16 v[164:167], a[68:71], v[36:39], v[164:167]
    s_add_u32 s61, s0, 4096
    ds_read_b128 a[44:47], v3 offset:3072
    buffer_store_dwordx4 a[144:147], v12, s[44:47], s59 offen offset:0 sc1
    v_cvt_pk_bf16_f32 v44, v4, v5
    v_mfma_f32_16x16x32_bf16 v[136:139], a[72:75], v[32:35], v[136:139]
    s_lshl_b32 s56, s63, 2
    v_exp_f32 v6, v246
    v_mfma_f32_16x16x32_bf16 v[168:171], a[72:75], v[36:39], v[168:171]
    s_sub_u32 s75, 28, s56
    buffer_load_dwordx4 v1, s[48:51], s83 offen offset:2048 sc1 lds
    v_mfma_f32_16x16x32_bf16 v[140:143], a[76:79], v[32:35], v[140:143]
    v_exp_f32 v7, v247
    v_mfma_f32_16x16x32_bf16 v[172:175], a[76:79], v[36:39], v[172:175]
    s_waitcnt lgkmcnt(4)
    ds_read_b128 a[48:51], v3 offset:4096
    v_cvt_pk_bf16_f32 v45, v6, v7
    v_min_u32 v29, 1, v0
    v_mfma_f32_16x16x32_bf16 v[144:147], a[80:83], v[32:35], v[144:147]
    v_exp_f32 v4, v252
    v_mfma_f32_16x16x32_bf16 v[176:179], a[80:83], v[36:39], v[176:179]
    ds_read_b128 a[52:55], v3 offset:5120
    ds_read_b128 a[56:59], v3 offset:6144
    v_mov_b32 v13, 1
    v_mfma_f32_16x16x32_bf16 v[148:151], a[84:87], v[32:35], v[148:151]
    v_exp_f32 v5, v253
    v_mfma_f32_16x16x32_bf16 v[180:183], a[84:87], v[36:39], v[180:183]
    ds_read_b128 a[60:63], v3 offset:7168
    v_cvt_pk_bf16_f32 v46, v4, v5
    v_mfma_f32_16x16x32_bf16 v[152:155], a[88:91], v[32:35], v[152:155]
    v_exp_f32 v6, v254
    v_mfma_f32_16x16x32_bf16 v[184:187], a[88:91], v[36:39], v[184:187]
    buffer_load_dwordx4 v1, s[48:51], s83 offen offset:3072 sc1 lds
    v_mfma_f32_16x16x32_bf16 v[156:159], a[92:95], v[32:35], v[156:159]
    v_exp_f32 v7, v255
    v_mfma_f32_16x16x32_bf16 v[188:191], a[92:95], v[36:39], v[188:191]
    s_waitcnt lgkmcnt(4)
    buffer_store_dwordx4 a[148:151], v12, s[44:47], s59 offen offset:1024 sc1
    v_cvt_pk_bf16_f32 v47, v6, v7
    v_mfma_f32_16x16x32_bf16 v[228:231], a[32:35], a[0:3], v[48:51]
    buffer_store_dwordx4 a[152:155], v12, s[44:47], s59 offen offset:2048 sc1
    v_mfma_f32_16x16x32_bf16 v[228:231], a[36:39], a[4:7], v[228:231]
    v_exp_f32 v4, v196
    v_mfma_f32_16x16x32_bf16 v[228:231], a[40:43], v[192:195], v[228:231]
    s_add_u32 s56, s79, 0
    buffer_store_dwordx4 a[156:159], v12, s[44:47], s59 offen offset:3072 sc1
    v_add_u32 v20, s53, v1
    v_add_u32 v21, s54, v1
    v_mfma_f32_16x16x32_bf16 v[228:231], a[44:47], v[200:203], v[228:231]
    s_and_b32 s56, s56, 3
    v_exp_f32 v5, v197
    v_mfma_f32_16x16x32_bf16 v[244:247], a[44:47], v[216:219], v[52:55]
    s_add_u32 s56, s56, 4
    v_cvt_pk_bf16_f32 v32, v4, v5
    v_add_u32 v22, 0x10000, v20
    v_add_u32 v23, 0x10000, v21
    v_mfma_f32_16x16x32_bf16 v[244:247], a[40:43], v[208:211], v[244:247]
    v_exp_f32 v6, v198
    v_mfma_f32_16x16x32_bf16 v[244:247], a[36:39], a[12:15], v[244:247]
    buffer_store_dwordx4 a[116:119], v1, s[44:47], s70 offen offset:0 sc1
    v_lshl_add_u32 v16, s56, 10, v1
    v_min_u32 v30, 13, v0
    v_mfma_f32_16x16x32_bf16 v[244:247], a[32:35], a[8:11], v[244:247]
    s_waitcnt lgkmcnt(0)
    v_exp_f32 v7, v199
    v_mfma_f32_16x16x32_bf16 v[252:255], a[48:51], a[8:11], v[60:63]
    s_add_u32 s56, s79, 1
    ds_read_b128 a[32:35], v2 offset:0
    v_cvt_pk_bf16_f32 v33, v6, v7
    v_lshlrev_b32 v30, 7, v30
    v_mfma_f32_16x16x32_bf16 v[252:255], a[52:55], a[12:15], v[252:255]
    s_and_b32 s56, s56, 3
    v_exp_f32 v4, v204
    v_mfma_f32_16x16x32_bf16 v[252:255], a[56:59], v[208:211], v[252:255]
    s_add_u32 s56, s56, 3
    buffer_store_dwordx4 a[116:119], v1, s[44:47], s70 offen offset:1024 sc1
    v_lshlrev_b32 v29, 30, v29
    v_mfma_f32_16x16x32_bf16 v[252:255], a[60:63], v[216:219], v[252:255]
    v_exp_f32 v5, v205
    v_mfma_f32_16x16x32_bf16 v[236:239], a[60:63], v[200:203], v[56:59]
    ds_read_b128 a[36:39], v2 offset:1024
    v_cvt_pk_bf16_f32 v34, v4, v5
    v_lshl_add_u32 v17, s56, 10, v1
    v_mfma_f32_16x16x32_bf16 v[236:239], a[56:59], v[192:195], v[236:239]
    s_add_u32 s56, s79, 2
    v_exp_f32 v6, v206
    v_mfma_f32_16x16x32_bf16 v[236:239], a[52:55], a[4:7], v[236:239]
    s_and_b32 s56, s56, 3
    buffer_store_dwordx4 a[116:119], v1, s[44:47], s70 offen offset:2048 sc1
    v_mfma_f32_16x16x32_bf16 v[236:239], a[48:51], a[0:3], v[236:239]
    s_add_u32 s56, s56, 2
    v_exp_f32 v7, v207
    v_smfmac_f32_16x16x64_bf16 a[108:111], a[96:99], v[40:47], v8
    v_cvt_pk_bf16_f32 v35, v6, v7
    v_lshl_add_u32 v18, s56, 10, v1
    v_mfma_f32_16x16x32_bf16 v[64:67], a[64:67], v[40:43], v[64:67]
    s_add_u32 s56, s79, 3
    v_exp_f32 v4, v212
    v_mfma_f32_16x16x32_bf16 v[96:99], a[64:67], v[44:47], v[96:99]
    s_and_b32 s56, s56, 3
    buffer_store_dwordx4 a[116:119], v1, s[44:47], s70 offen offset:3072 sc1
    v_mfma_f32_16x16x32_bf16 v[68:71], a[68:71], v[40:43], v[68:71]
    s_add_u32 s56, s56, 1
    v_exp_f32 v5, v213
    v_mfma_f32_16x16x32_bf16 v[100:103], a[68:71], v[44:47], v[100:103]
    ds_read_b128 a[40:43], v2 offset:2048
    v_cvt_pk_bf16_f32 v36, v4, v5
    v_lshl_add_u32 v19, s56, 10, v1
    v_mfma_f32_16x16x32_bf16 v[72:75], a[72:75], v[40:43], v[72:75]
    v_exp_f32 v6, v214
    v_mfma_f32_16x16x32_bf16 v[104:107], a[72:75], v[44:47], v[104:107]
    buffer_store_dwordx4 a[116:119], v1, s[44:47], s60 offen offset:0 sc1
    v_mfma_f32_16x16x32_bf16 v[76:79], a[76:79], v[40:43], v[76:79]
    v_exp_f32 v7, v215
    v_mfma_f32_16x16x32_bf16 v[108:111], a[76:79], v[44:47], v[108:111]
    ds_read_b128 a[44:47], v2 offset:3072
    v_cvt_pk_bf16_f32 v37, v6, v7
    v_mfma_f32_16x16x32_bf16 v[80:83], a[80:83], v[40:43], v[80:83]
    v_exp_f32 v4, v220
    v_mfma_f32_16x16x32_bf16 v[112:115], a[80:83], v[44:47], v[112:115]
    buffer_store_dwordx4 a[116:119], v1, s[44:47], s60 offen offset:1024 sc1
    v_mfma_f32_16x16x32_bf16 v[84:87], a[84:87], v[40:43], v[84:87]
    s_add_u32 s73, s73, 16384
    v_exp_f32 v5, v221
    v_mfma_f32_16x16x32_bf16 v[116:119], a[84:87], v[44:47], v[116:119]
    s_and_b32 s73, s73, 0x1ffff
    ds_read_b128 a[48:51], v2 offset:4096
    ds_read_b128 a[52:55], v2 offset:5120
    v_cvt_pk_bf16_f32 v38, v4, v5
    v_mfma_f32_16x16x32_bf16 v[88:91], a[88:91], v[40:43], v[88:91]
    v_exp_f32 v6, v222
    v_mfma_f32_16x16x32_bf16 v[120:123], a[88:91], v[44:47], v[120:123]
    ds_read_b128 a[56:59], v2 offset:6144
    ds_read_b128 a[60:63], v2 offset:7168
    v_mfma_f32_16x16x32_bf16 v[92:95], a[92:95], v[40:43], v[92:95]
    v_exp_f32 v7, v223
    v_mfma_f32_16x16x32_bf16 v[124:127], a[92:95], v[44:47], v[124:127]
    s_waitcnt vmcnt(26) lgkmcnt(4)
    v_cvt_pk_bf16_f32 v39, v6, v7
    v_add_u32 v2, s73, v1
    s_barrier
    v_accvgpr_read_b32 v9, a108
    v_accvgpr_read_b32 v11, a109
    v_accvgpr_read_b32 v10, a110
    v_add_f32 v9, v9, v11
    v_accvgpr_read_b32 v11, a111
    v_add_f32 v10, v10, v11
    v_add_f32 v11, v9, v10
    v_cmp_ngt_f32 vcc, s77, v11
    s_or_b64 s[86:87], s[86:87], vcc
    s_nop 0
    v_rcp_f32 v9, v9
    v_rcp_f32 v10, v10
    s_add_u32 s56, s82, 0
    v_pk_mul_f32 v[64:65], v[64:65], v[8:9] op_sel:[0,1] op_sel_hi:[1,1]
    v_pk_mul_f32 v[66:67], v[66:67], v[8:9] op_sel:[0,1] op_sel_hi:[1,1]
    v_pk_mul_f32 v[68:69], v[68:69], v[8:9] op_sel:[0,1] op_sel_hi:[1,1]
    v_pk_mul_f32 v[70:71], v[70:71], v[8:9] op_sel:[0,1] op_sel_hi:[1,1]
    v_cvt_pk_bf16_f32 v64, v64, v65
    v_cvt_pk_bf16_f32 v65, v66, v67
    v_cvt_pk_bf16_f32 v66, v68, v69
    v_cvt_pk_bf16_f32 v67, v70, v71
    buffer_store_dwordx4 v[64:67], v1, s[44:47], s56 offen offset:0 sc1
    v_pk_mul_f32 v[96:97], v[96:97], v[10:11] op_sel_hi:[1,0]
    v_pk_mul_f32 v[98:99], v[98:99], v[10:11] op_sel_hi:[1,0]
    v_pk_mul_f32 v[100:101], v[100:101], v[10:11] op_sel_hi:[1,0]
    v_pk_mul_f32 v[102:103], v[102:103], v[10:11] op_sel_hi:[1,0]
    v_cvt_pk_bf16_f32 v96, v96, v97
    v_cvt_pk_bf16_f32 v97, v98, v99
    v_cvt_pk_bf16_f32 v98, v100, v101
    v_cvt_pk_bf16_f32 v99, v102, v103
    buffer_store_dwordx4 v[96:99], v1, s[44:47], s56 offen offset:1024 sc1
    s_add_u32 s56, s82, 4096
    v_pk_mul_f32 v[72:73], v[72:73], v[8:9] op_sel:[0,1] op_sel_hi:[1,1]
    v_pk_mul_f32 v[74:75], v[74:75], v[8:9] op_sel:[0,1] op_sel_hi:[1,1]
    v_pk_mul_f32 v[76:77], v[76:77], v[8:9] op_sel:[0,1] op_sel_hi:[1,1]
    v_pk_mul_f32 v[78:79], v[78:79], v[8:9] op_sel:[0,1] op_sel_hi:[1,1]
    v_cvt_pk_bf16_f32 v72, v72, v73
    v_cvt_pk_bf16_f32 v73, v74, v75
    v_cvt_pk_bf16_f32 v74, v76, v77
    v_cvt_pk_bf16_f32 v75, v78, v79
    buffer_store_dwordx4 v[72:75], v1, s[44:47], s56 offen offset:0 sc1
    v_pk_mul_f32 v[104:105], v[104:105], v[10:11] op_sel_hi:[1,0]
    v_pk_mul_f32 v[106:107], v[106:107], v[10:11] op_sel_hi:[1,0]
    v_pk_mul_f32 v[108:109], v[108:109], v[10:11] op_sel_hi:[1,0]
    v_pk_mul_f32 v[110:111], v[110:111], v[10:11] op_sel_hi:[1,0]
    v_cvt_pk_bf16_f32 v104, v104, v105
    v_cvt_pk_bf16_f32 v105, v106, v107
    v_cvt_pk_bf16_f32 v106, v108, v109
    v_cvt_pk_bf16_f32 v107, v110, v111
    buffer_store_dwordx4 v[104:107], v1, s[44:47], s56 offen offset:1024 sc1
    s_add_u32 s56, s82, 8192
    v_pk_mul_f32 v[80:81], v[80:81], v[8:9] op_sel:[0,1] op_sel_hi:[1,1]
    v_pk_mul_f32 v[82:83], v[82:83], v[8:9] op_sel:[0,1] op_sel_hi:[1,1]
    v_pk_mul_f32 v[84:85], v[84:85], v[8:9] op_sel:[0,1] op_sel_hi:[1,1]
    v_pk_mul_f32 v[86:87], v[86:87], v[8:9] op_sel:[0,1] op_sel_hi:[1,1]
    v_cvt_pk_bf16_f32 v80, v80, v81
    v_cvt_pk_bf16_f32 v81, v82, v83
    v_cvt_pk_bf16_f32 v82, v84, v85
    v_cvt_pk_bf16_f32 v83, v86, v87
    buffer_store_dwordx4 v[80:83], v1, s[44:47], s56 offen offset:0 sc1
    v_pk_mul_f32 v[112:113], v[112:113], v[10:11] op_sel_hi:[1,0]
    v_pk_mul_f32 v[114:115], v[114:115], v[10:11] op_sel_hi:[1,0]
    v_pk_mul_f32 v[116:117], v[116:117], v[10:11] op_sel_hi:[1,0]
    v_pk_mul_f32 v[118:119], v[118:119], v[10:11] op_sel_hi:[1,0]
    v_cvt_pk_bf16_f32 v112, v112, v113
    v_cvt_pk_bf16_f32 v113, v114, v115
    v_cvt_pk_bf16_f32 v114, v116, v117
    v_cvt_pk_bf16_f32 v115, v118, v119
    buffer_store_dwordx4 v[112:115], v1, s[44:47], s56 offen offset:1024 sc1
    s_add_u32 s56, s82, 12288
    v_pk_mul_f32 v[88:89], v[88:89], v[8:9] op_sel:[0,1] op_sel_hi:[1,1]
    v_pk_mul_f32 v[90:91], v[90:91], v[8:9] op_sel:[0,1] op_sel_hi:[1,1]
    v_pk_mul_f32 v[92:93], v[92:93], v[8:9] op_sel:[0,1] op_sel_hi:[1,1]
    v_pk_mul_f32 v[94:95], v[94:95], v[8:9] op_sel:[0,1] op_sel_hi:[1,1]
    v_cvt_pk_bf16_f32 v88, v88, v89
    v_cvt_pk_bf16_f32 v89, v90, v91
    v_cvt_pk_bf16_f32 v90, v92, v93
    v_cvt_pk_bf16_f32 v91, v94, v95
    buffer_store_dwordx4 v[88:91], v1, s[44:47], s56 offen offset:0 sc1
    v_pk_mul_f32 v[120:121], v[120:121], v[10:11] op_sel_hi:[1,0]
    v_pk_mul_f32 v[122:123], v[122:123], v[10:11] op_sel_hi:[1,0]
    v_pk_mul_f32 v[124:125], v[124:125], v[10:11] op_sel_hi:[1,0]
    v_pk_mul_f32 v[126:127], v[126:127], v[10:11] op_sel_hi:[1,0]
    v_cvt_pk_bf16_f32 v120, v120, v121
    v_cvt_pk_bf16_f32 v121, v122, v123
    v_cvt_pk_bf16_f32 v122, v124, v125
    v_cvt_pk_bf16_f32 v123, v126, v127
    buffer_store_dwordx4 v[120:123], v1, s[44:47], s56 offen offset:1024 sc1
    s_waitcnt vmcnt(14)
    buffer_atomic_add v13, v29, s[44:47], s96 offen offset:1024
    s_mov_b32 s96, 0x3901000
    s_cmp_eq_u32 s75, 0
    v_mfma_f32_16x16x32_bf16 v[196:199], a[32:35], a[0:3], v[48:51]
    s_cbranch_scc1 K_SLAST_NB
    s_branch K_SINGLE_NB
.p2align 5
K_SINGLE:
    v_mfma_f32_16x16x32_bf16 v[196:199], a[32:35], a[0:3], v[48:51]
    s_barrier
K_SINGLE_NB:
    ds_read_b128 a[64:67], v2 offset:8192
    v_mfma_f32_16x16x32_bf16 v[196:199], a[36:39], a[4:7], v[196:199]
    s_mov_b32 m0, s74
    v_exp_f32 v4, v228
    v_mfma_f32_16x16x32_bf16 v[196:199], a[40:43], v[192:195], v[196:199]
    s_add_u32 s74, s74, 16384
    ds_read_b128 a[68:71], v2 offset:9216
    ds_read_b128 a[72:75], v2 offset:10240
    v_mfma_f32_16x16x32_bf16 v[196:199], a[44:47], v[200:203], v[196:199]
    s_and_b32 s74, s74, 0x1ffff
    v_exp_f32 v5, v229
    v_mfma_f32_16x16x32_bf16 v[212:215], a[44:47], v[216:219], v[52:55]
    s_add_u32 s83, s83, 16384
    ds_read_b128 a[76:79], v2 offset:11264
    v_cvt_pk_bf16_f32 v40, v4, v5
    v_mfma_f32_16x16x32_bf16 v[212:215], a[40:43], v[208:211], v[212:215]
    v_exp_f32 v6, v230
    v_mfma_f32_16x16x32_bf16 v[212:215], a[36:39], a[12:15], v[212:215]
    ds_read_b128 a[80:83], v2 offset:12288
    buffer_load_dwordx4 v1, s[48:51], s83 offen offset:0 sc1 lds
    v_mfma_f32_16x16x32_bf16 v[212:215], a[32:35], a[8:11], v[212:215]
    s_waitcnt lgkmcnt(5)
    v_exp_f32 v7, v231
    v_mfma_f32_16x16x32_bf16 v[220:223], a[48:51], a[8:11], v[60:63]
    ds_read_b128 a[84:87], v2 offset:13312
    v_cvt_pk_bf16_f32 v41, v6, v7
    v_mfma_f32_16x16x32_bf16 v[220:223], a[52:55], a[12:15], v[220:223]
    v_exp_f32 v4, v236
    v_mfma_f32_16x16x32_bf16 v[220:223], a[56:59], v[208:211], v[220:223]
    ds_read_b128 a[88:91], v2 offset:14336
    ds_read_b128 a[92:95], v2 offset:15360
    v_mfma_f32_16x16x32_bf16 v[220:223], a[60:63], v[216:219], v[220:223]
    v_exp_f32 v5, v237
    v_mfma_f32_16x16x32_bf16 v[204:207], a[60:63], v[200:203], v[56:59]
    ds_read_b128 a[32:35], v2 offset:0
    v_cvt_pk_bf16_f32 v42, v4, v5
    v_mfma_f32_16x16x32_bf16 v[204:207], a[56:59], v[192:195], v[204:207]
    v_exp_f32 v6, v238
    v_mfma_f32_16x16x32_bf16 v[204:207], a[52:55], a[4:7], v[204:207]
    buffer_load_dwordx4 v1, s[48:51], s83 offen offset:1024 sc1 lds
    v_mfma_f32_16x16x32_bf16 v[204:207], a[48:51], a[0:3], v[204:207]
    v_exp_f32 v7, v239
    v_smfmac_f32_16x16x64_bf16 a[100:103], a[96:99], v[32:39], v8
    s_waitcnt lgkmcnt(5)
    v_cvt_pk_bf16_f32 v43, v6, v7
    v_mfma_f32_16x16x32_bf16 v[128:131], a[64:67], v[32:35], v[128:131]
    v_exp_f32 v4, v244
    v_mfma_f32_16x16x32_bf16 v[160:163], a[64:67], v[36:39], v[160:163]
    ds_read_b128 a[36:39], v2 offset:1024
    ds_read_b128 a[40:43], v2 offset:2048
    v_mfma_f32_16x16x32_bf16 v[132:135], a[68:71], v[32:35], v[132:135]
    v_exp_f32 v5, v245
    v_mfma_f32_16x16x32_bf16 v[164:167], a[68:71], v[36:39], v[164:167]
    ds_read_b128 a[44:47], v2 offset:3072
    v_cvt_pk_bf16_f32 v44, v4, v5
    v_mfma_f32_16x16x32_bf16 v[136:139], a[72:75], v[32:35], v[136:139]
    v_exp_f32 v6, v246
    v_mfma_f32_16x16x32_bf16 v[168:171], a[72:75], v[36:39], v[168:171]
    buffer_load_dwordx4 v1, s[48:51], s83 offen offset:2048 sc1 lds
    v_mfma_f32_16x16x32_bf16 v[140:143], a[76:79], v[32:35], v[140:143]
    v_exp_f32 v7, v247
    v_mfma_f32_16x16x32_bf16 v[172:175], a[76:79], v[36:39], v[172:175]
    s_waitcnt lgkmcnt(4)
    ds_read_b128 a[48:51], v2 offset:4096
    v_cvt_pk_bf16_f32 v45, v6, v7
    v_mfma_f32_16x16x32_bf16 v[144:147], a[80:83], v[32:35], v[144:147]
    v_exp_f32 v4, v252
    v_mfma_f32_16x16x32_bf16 v[176:179], a[80:83], v[36:39], v[176:179]
    ds_read_b128 a[52:55], v2 offset:5120
    ds_read_b128 a[56:59], v2 offset:6144
    v_mfma_f32_16x16x32_bf16 v[148:151], a[84:87], v[32:35], v[148:151]
    s_add_u32 s73, s73, 16384
    v_exp_f32 v5, v253
    v_mfma_f32_16x16x32_bf16 v[180:183], a[84:87], v[36:39], v[180:183]
    s_and_b32 s73, s73, 0x1ffff
    ds_read_b128 a[60:63], v2 offset:7168
    v_cvt_pk_bf16_f32 v46, v4, v5
    v_mfma_f32_16x16x32_bf16 v[152:155], a[88:91], v[32:35], v[152:155]
    v_exp_f32 v6, v254
    v_mfma_f32_16x16x32_bf16 v[184:187], a[88:91], v[36:39], v[184:187]
    buffer_load_dwordx4 v1, s[48:51], s83 offen offset:3072 sc1 lds
    v_mfma_f32_16x16x32_bf16 v[156:159], a[92:95], v[32:35], v[156:159]
    v_exp_f32 v7, v255
    v_mfma_f32_16x16x32_bf16 v[188:191], a[92:95], v[36:39], v[188:191]
    s_waitcnt vmcnt(12) lgkmcnt(4)
    v_cvt_pk_bf16_f32 v47, v6, v7
    v_add_u32 v2, s73, v1
    v_mfma_f32_16x16x32_bf16 v[228:231], a[32:35], a[0:3], v[48:51]
    s_barrier
    ds_read_b128 a[64:67], v2 offset:8192
    v_mfma_f32_16x16x32_bf16 v[228:231], a[36:39], a[4:7], v[228:231]
    s_mov_b32 m0, s74
    v_exp_f32 v4, v196
    v_mfma_f32_16x16x32_bf16 v[228:231], a[40:43], v[192:195], v[228:231]
    s_add_u32 s74, s74, 16384
    ds_read_b128 a[68:71], v2 offset:9216
    ds_read_b128 a[72:75], v2 offset:10240
    v_mfma_f32_16x16x32_bf16 v[228:231], a[44:47], v[200:203], v[228:231]
    s_and_b32 s74, s74, 0x1ffff
    v_exp_f32 v5, v197
    v_mfma_f32_16x16x32_bf16 v[244:247], a[44:47], v[216:219], v[52:55]
    s_add_u32 s83, s83, 16384
    ds_read_b128 a[76:79], v2 offset:11264
    v_cvt_pk_bf16_f32 v32, v4, v5
    v_mfma_f32_16x16x32_bf16 v[244:247], a[40:43], v[208:211], v[244:247]
    v_exp_f32 v6, v198
    v_mfma_f32_16x16x32_bf16 v[244:247], a[36:39], a[12:15], v[244:247]
    ds_read_b128 a[80:83], v2 offset:12288
    buffer_load_dwordx4 v1, s[48:51], s83 offen offset:0 sc1 lds
    v_mfma_f32_16x16x32_bf16 v[244:247], a[32:35], a[8:11], v[244:247]
    s_waitcnt lgkmcnt(5)
    v_exp_f32 v7, v199
    v_mfma_f32_16x16x32_bf16 v[252:255], a[48:51], a[8:11], v[60:63]
    ds_read_b128 a[84:87], v2 offset:13312
    v_cvt_pk_bf16_f32 v33, v6, v7
    v_mfma_f32_16x16x32_bf16 v[252:255], a[52:55], a[12:15], v[252:255]
    v_exp_f32 v4, v204
    v_mfma_f32_16x16x32_bf16 v[252:255], a[56:59], v[208:211], v[252:255]
    ds_read_b128 a[88:91], v2 offset:14336
    ds_read_b128 a[92:95], v2 offset:15360
    v_mfma_f32_16x16x32_bf16 v[252:255], a[60:63], v[216:219], v[252:255]
    v_exp_f32 v5, v205
    v_mfma_f32_16x16x32_bf16 v[236:239], a[60:63], v[200:203], v[56:59]
    ds_read_b128 a[32:35], v2 offset:0
    v_cvt_pk_bf16_f32 v34, v4, v5
    v_mfma_f32_16x16x32_bf16 v[236:239], a[56:59], v[192:195], v[236:239]
    v_exp_f32 v6, v206
    v_mfma_f32_16x16x32_bf16 v[236:239], a[52:55], a[4:7], v[236:239]
    buffer_load_dwordx4 v1, s[48:51], s83 offen offset:1024 sc1 lds
    v_mfma_f32_16x16x32_bf16 v[236:239], a[48:51], a[0:3], v[236:239]
    v_exp_f32 v7, v207
    v_smfmac_f32_16x16x64_bf16 a[100:103], a[96:99], v[40:47], v8
    s_waitcnt lgkmcnt(5)
    v_cvt_pk_bf16_f32 v35, v6, v7
    v_mfma_f32_16x16x32_bf16 v[128:131], a[64:67], v[40:43], v[128:131]
    v_exp_f32 v4, v212
    v_mfma_f32_16x16x32_bf16 v[160:163], a[64:67], v[44:47], v[160:163]
    ds_read_b128 a[36:39], v2 offset:1024
    ds_read_b128 a[40:43], v2 offset:2048
    v_mfma_f32_16x16x32_bf16 v[132:135], a[68:71], v[40:43], v[132:135]
    v_exp_f32 v5, v213
    v_mfma_f32_16x16x32_bf16 v[164:167], a[68:71], v[44:47], v[164:167]
    ds_read_b128 a[44:47], v2 offset:3072
    v_cvt_pk_bf16_f32 v36, v4, v5
    v_mfma_f32_16x16x32_bf16 v[136:139], a[72:75], v[40:43], v[136:139]
    v_exp_f32 v6, v214
    v_mfma_f32_16x16x32_bf16 v[168:171], a[72:75], v[44:47], v[168:171]
    buffer_load_dwordx4 v1, s[48:51], s83 offen offset:2048 sc1 lds
    ds_read_b128 a[48:51], v2 offset:4096
    v_mfma_f32_16x16x32_bf16 v[140:143], a[76:79], v[40:43], v[140:143]
    v_exp_f32 v7, v215
    v_mfma_f32_16x16x32_bf16 v[172:175], a[76:79], v[44:47], v[172:175]
    s_waitcnt lgkmcnt(5)
    ds_read_b128 a[52:55], v2 offset:5120
    v_cvt_pk_bf16_f32 v37, v6, v7
    v_mfma_f32_16x16x32_bf16 v[144:147], a[80:83], v[40:43], v[144:147]
    v_exp_f32 v4, v220
    v_mfma_f32_16x16x32_bf16 v[176:179], a[80:83], v[44:47], v[176:179]
    buffer_load_dwordx4 v1, s[48:51], s83 offen offset:3072 sc1 lds
    ds_read_b128 a[56:59], v2 offset:6144
    v_mfma_f32_16x16x32_bf16 v[148:151], a[84:87], v[40:43], v[148:151]
    s_add_u32 s73, s73, 16384
    v_exp_f32 v5, v221
    v_mfma_f32_16x16x32_bf16 v[180:183], a[84:87], v[44:47], v[180:183]
    s_and_b32 s73, s73, 0x1ffff
    ds_read_b128 a[60:63], v2 offset:7168
    v_cvt_pk_bf16_f32 v38, v4, v5
    v_mfma_f32_16x16x32_bf16 v[152:155], a[88:91], v[40:43], v[152:155]
    s_sub_u32 s75, s75, 1
    v_exp_f32 v6, v222
    v_mfma_f32_16x16x32_bf16 v[184:187], a[88:91], v[44:47], v[184:187]
    s_cmp_lg_u32 s75, 0
    v_exp_f32 v7, v223
    v_mfma_f32_16x16x32_bf16 v[156:159], a[92:95], v[40:43], v[156:159]
    v_cvt_pk_bf16_f32 v39, v6, v7
    v_add_u32 v2, s73, v1
    v_mfma_f32_16x16x32_bf16 v[188:191], a[92:95], v[44:47], v[188:191]
    s_waitcnt vmcnt(12) lgkmcnt(4)
    s_cbranch_scc1 K_SINGLE
    v_mfma_f32_16x16x32_bf16 v[196:199], a[32:35], a[0:3], v[48:51]
    s_barrier
K_SLAST_NB:
    ds_read_b128 a[64:67], v2 offset:8192
    v_mfma_f32_16x16x32_bf16 v[196:199], a[36:39], a[4:7], v[196:199]
    v_exp_f32 v4, v228
    v_mfma_f32_16x16x32_bf16 v[196:199], a[40:43], v[192:195], v[196:199]
    ds_read_b128 a[68:71], v2 offset:9216
    ds_read_b128 a[72:75], v2 offset:10240
    v_mfma_f32_16x16x32_bf16 v[196:199], a[44:47], v[200:203], v[196:199]
    v_exp_f32 v5, v229
    v_mfma_f32_16x16x32_bf16 v[212:215], a[44:47], v[216:219], v[52:55]
    ds_read_b128 a[76:79], v2 offset:11264
    v_cvt_pk_bf16_f32 v40, v4, v5
    v_mfma_f32_16x16x32_bf16 v[212:215], a[40:43], v[208:211], v[212:215]
    v_exp_f32 v6, v230
    v_mfma_f32_16x16x32_bf16 v[212:215], a[36:39], a[12:15], v[212:215]
    ds_read_b128 a[80:83], v2 offset:12288
    buffer_load_dword v13, v30, s[44:47], s96 offen sc1
    v_mfma_f32_16x16x32_bf16 v[212:215], a[32:35], a[8:11], v[212:215]
    s_waitcnt lgkmcnt(5)
    v_exp_f32 v7, v231
    v_mfma_f32_16x16x32_bf16 v[220:223], a[48:51], a[8:11], v[60:63]
    ds_read_b128 a[84:87], v2 offset:13312
    v_cvt_pk_bf16_f32 v41, v6, v7
    v_mfma_f32_16x16x32_bf16 v[220:223], a[52:55], a[12:15], v[220:223]
    v_exp_f32 v4, v236
    v_mfma_f32_16x16x32_bf16 v[220:223], a[56:59], v[208:211], v[220:223]
K_PG10:
    s_cmp_eq_u32 s100, 1
    s_cbranch_scc1 K_MAIN
    ds_read_b128 a[88:91], v2 offset:14336
    ds_read_b128 a[92:95], v2 offset:15360
    v_mfma_f32_16x16x32_bf16 v[220:223], a[60:63], v[216:219], v[220:223]
    v_exp_f32 v5, v237
    v_mfma_f32_16x16x32_bf16 v[204:207], a[60:63], v[200:203], v[56:59]
    ds_read_b128 a[32:35], v2 offset:0
    v_cvt_pk_bf16_f32 v42, v4, v5
    v_mfma_f32_16x16x32_bf16 v[204:207], a[56:59], v[192:195], v[204:207]
    v_exp_f32 v6, v238
    v_mfma_f32_16x16x32_bf16 v[204:207], a[52:55], a[4:7], v[204:207]
    v_mov_b32 v56, s76
    v_cndmask_b32 v48, v48, v56, s[88:89]
    v_cndmask_b32 v49, v49, v56, s[90:91]
    v_mfma_f32_16x16x32_bf16 v[204:207], a[48:51], a[0:3], v[204:207]
    v_exp_f32 v7, v239
    v_smfmac_f32_16x16x64_bf16 a[100:103], a[96:99], v[32:39], v8
    s_waitcnt lgkmcnt(5)
    v_cvt_pk_bf16_f32 v43, v6, v7
    v_mfma_f32_16x16x32_bf16 v[128:131], a[64:67], v[32:35], v[128:131]
    v_exp_f32 v4, v244
    v_mfma_f32_16x16x32_bf16 v[160:163], a[64:67], v[36:39], v[160:163]
    ds_read_b128 a[36:39], v2 offset:1024
    ds_read_b128 a[40:43], v2 offset:2048
    v_mfma_f32_16x16x32_bf16 v[132:135], a[68:71], v[32:35], v[132:135]
    v_exp_f32 v5, v245
    v_mfma_f32_16x16x32_bf16 v[164:167], a[68:71], v[36:39], v[164:167]
    ds_read_b128 a[44:47], v2 offset:3072
    v_cvt_pk_bf16_f32 v44, v4, v5
    v_mfma_f32_16x16x32_bf16 v[136:139], a[72:75], v[32:35], v[136:139]
    v_exp_f32 v6, v246
    v_mfma_f32_16x16x32_bf16 v[168:171], a[72:75], v[36:39], v[168:171]
    v_cndmask_b32 v50, v50, v56, s[92:93]
    v_cndmask_b32 v51, v51, v56, s[94:95]
    v_cndmask_b32 v60, v60, v56, s[88:89]
    v_mfma_f32_16x16x32_bf16 v[140:143], a[76:79], v[32:35], v[140:143]
    v_exp_f32 v7, v247
    v_mfma_f32_16x16x32_bf16 v[172:175], a[76:79], v[36:39], v[172:175]
    s_waitcnt lgkmcnt(4)
    ds_read_b128 a[48:51], v2 offset:4096
    v_cvt_pk_bf16_f32 v45, v6, v7
    v_mfma_f32_16x16x32_bf16 v[144:147], a[80:83], v[32:35], v[144:147]
    v_exp_f32 v4, v252
    v_mfma_f32_16x16x32_bf16 v[176:179], a[80:83], v[36:39], v[176:179]
    ds_read_b128 a[52:55], v2 offset:5120
    ds_read_b128 a[56:59], v2 offset:6144
    v_mfma_f32_16x16x32_bf16 v[148:151], a[84:87], v[32:35], v[148:151]
    s_add_u32 s73, s73, 16384
    v_exp_f32 v5, v253
    v_mfma_f32_16x16x32_bf16 v[180:183], a[84:87], v[36:39], v[180:183]
    s_and_b32 s73, s73, 0x1ffff
    ds_read_b128 a[60:63], v2 offset:7168
    v_cvt_pk_bf16_f32 v46, v4, v5
    v_mfma_f32_16x16x32_bf16 v[152:155], a[88:91], v[32:35], v[152:155]
    v_exp_f32 v6, v254
    v_mfma_f32_16x16x32_bf16 v[184:187], a[88:91], v[36:39], v[184:187]
    v_cndmask_b32 v61, v61, v56, s[90:91]
    v_cndmask_b32 v62, v62, v56, s[92:93]
    v_cndmask_b32 v63, v63, v56, s[94:95]
    v_mfma_f32_16x16x32_bf16 v[156:159], a[92:95], v[32:35], v[156:159]
    v_exp_f32 v7, v255
    v_mfma_f32_16x16x32_bf16 v[188:191], a[92:95], v[36:39], v[188:191]
    s_waitcnt vmcnt(9) lgkmcnt(4)
    v_cvt_pk_bf16_f32 v47, v6, v7
    v_add_u32 v2, s73, v1
    v_mfma_f32_16x16x32_bf16 v[228:231], a[32:35], a[0:3], v[48:51]
    s_barrier
    ds_read_b128 a[64:67], v2 offset:8192
    v_mfma_f32_16x16x32_bf16 v[228:231], a[36:39], a[4:7], v[228:231]
    s_add_u32 s73, s73, 16384
    v_exp_f32 v4, v196
    v_mfma_f32_16x16x32_bf16 v[228:231], a[40:43], v[192:195], v[228:231]
    s_and_b32 s73, s73, 0x1ffff
    ds_read_b128 a[68:71], v2 offset:9216
    v_mfma_f32_16x16x32_bf16 v[228:231], a[44:47], v[200:203], v[228:231]
    v_exp_f32 v5, v197
    v_mfma_f32_16x16x32_bf16 v[244:247], a[44:47], v[216:219], v[52:55]
    ds_read_b128 a[72:75], v2 offset:10240
    v_cvt_pk_bf16_f32 v32, v4, v5
    v_mfma_f32_16x16x32_bf16 v[244:247], a[40:43], v[208:211], v[244:247]
    v_exp_f32 v6, v198
    v_mfma_f32_16x16x32_bf16 v[244:247], a[36:39], a[12:15], v[244:247]
    ds_read_b128 a[76:79], v2 offset:11264
    v_add_u32 v3, s73, v1
    v_mfma_f32_16x16x32_bf16 v[244:247], a[32:35], a[8:11], v[244:247]
    s_waitcnt lgkmcnt(4)
    v_exp_f32 v7, v199
    v_mfma_f32_16x16x32_bf16 v[252:255], a[48:51], a[8:11], v[60:63]
    ds_read_b128 a[80:83], v2 offset:12288
    v_cvt_pk_bf16_f32 v33, v6, v7
    v_mfma_f32_16x16x32_bf16 v[252:255], a[52:55], a[12:15], v[252:255]
    v_exp_f32 v4, v204
    v_mfma_f32_16x16x32_bf16 v[252:255], a[56:59], v[208:211], v[252:255]
    s_waitcnt vmcnt(0)
    ds_read_b128 a[84:87], v2 offset:13312
    v_cmp_gt_u32 vcc, 128, v13
    v_mfma_f32_16x16x32_bf16 v[252:255], a[60:63], v[216:219], v[252:255]
    s_cbranch_vccnz S3
S3_RET:
    v_exp_f32 v5, v205
    v_mfma_f32_16x16x32_bf16 v[236:239], a[60:63], v[200:203], v[56:59]
    s_add_u32 m0, s72, 131072
    ds_read_b128 a[88:91], v2 offset:14336
    v_cvt_pk_bf16_f32 v34, v4, v5
    v_mfma_f32_16x16x32_bf16 v[236:239], a[56:59], v[192:195], v[236:239]
    s_add_u32 s58, s65, 8192
    v_exp_f32 v6, v206
    v_mfma_f32_16x16x32_bf16 v[236:239], a[52:55], a[4:7], v[236:239]
    ds_read_b128 a[92:95], v2 offset:15360
    buffer_load_dwordx4 v16, s[44:47], s58 offen offset:0 sc1 lds
    v_mfma_f32_16x16x32_bf16 v[236:239], a[48:51], a[0:3], v[236:239]
    v_exp_f32 v7, v207
    v_smfmac_f32_16x16x64_bf16 a[100:103], a[96:99], v[40:47], v8
    s_waitcnt lgkmcnt(4)
    buffer_load_dwordx4 v17, s[44:47], s58 offen offset:1024 sc1 lds
    v_cvt_pk_bf16_f32 v35, v6, v7
    v_mfma_f32_16x16x32_bf16 v[128:131], a[64:67], v[40:43], v[128:131]
    v_exp_f32 v4, v212
    v_mfma_f32_16x16x32_bf16 v[160:163], a[64:67], v[44:47], v[160:163]
    buffer_load_dwordx4 v18, s[44:47], s58 offen offset:2048 sc1 lds
    v_mfma_f32_16x16x32_bf16 v[132:135], a[68:71], v[40:43], v[132:135]
    v_exp_f32 v5, v213
    v_mfma_f32_16x16x32_bf16 v[164:167], a[68:71], v[44:47], v[164:167]
    buffer_load_dwordx4 v19, s[44:47], s58 offen offset:3072 sc1 lds
    v_cvt_pk_bf16_f32 v36, v4, v5
    v_mfma_f32_16x16x32_bf16 v[136:139], a[72:75], v[40:43], v[136:139]
    s_add_u32 m0, s72, 135168
    s_add_u32 s58, s65, 12288
    v_exp_f32 v6, v214
    v_mfma_f32_16x16x32_bf16 v[168:171], a[72:75], v[44:47], v[168:171]
    buffer_load_dwordx4 v16, s[44:47], s58 offen offset:0 sc1 lds
    v_mfma_f32_16x16x32_bf16 v[140:143], a[76:79], v[40:43], v[140:143]
    v_exp_f32 v7, v215
    v_mfma_f32_16x16x32_bf16 v[172:175], a[76:79], v[44:47], v[172:175]
    s_waitcnt lgkmcnt(0)
    buffer_load_dwordx4 v17, s[44:47], s58 offen offset:1024 sc1 lds
    ds_read_b128 a[32:35], v3 offset:8192
    v_cvt_pk_bf16_f32 v37, v6, v7
    v_mfma_f32_16x16x32_bf16 v[144:147], a[80:83], v[40:43], v[144:147]
    v_exp_f32 v4, v220
    v_mfma_f32_16x16x32_bf16 v[176:179], a[80:83], v[44:47], v[176:179]
    buffer_load_dwordx4 v18, s[44:47], s58 offen offset:2048 sc1 lds
    ds_read_b128 a[36:39], v3 offset:9216
    v_mfma_f32_16x16x32_bf16 v[148:151], a[84:87], v[40:43], v[148:151]
    s_add_u32 s73, s73, 16384
    v_exp_f32 v5, v221
    v_mfma_f32_16x16x32_bf16 v[180:183], a[84:87], v[44:47], v[180:183]
    s_and_b32 s73, s73, 0x1ffff
    buffer_load_dwordx4 v19, s[44:47], s58 offen offset:3072 sc1 lds
    ds_read_b128 a[40:43], v3 offset:10240
    v_cvt_pk_bf16_f32 v38, v4, v5
    v_mfma_f32_16x16x32_bf16 v[152:155], a[88:91], v[40:43], v[152:155]
    v_exp_f32 v6, v222
    v_mfma_f32_16x16x32_bf16 v[184:187], a[88:91], v[44:47], v[184:187]
    ds_read_b128 a[44:47], v3 offset:11264
    ds_read_b128 a[48:51], v3 offset:12288
    v_mfma_f32_16x16x32_bf16 v[156:159], a[92:95], v[40:43], v[156:159]
    v_exp_f32 v7, v223
    v_mfma_f32_16x16x32_bf16 v[188:191], a[92:95], v[44:47], v[188:191]
    ds_read_b128 a[52:55], v3 offset:13312
    ds_read_b128 a[56:59], v3 offset:14336
    ds_read_b128 a[60:63], v3 offset:15360
    v_cvt_pk_bf16_f32 v39, v6, v7
    v_add_u32 v2, s73, v1
    s_barrier
    v_smfmac_f32_16x16x64_bf16 a[100:103], a[96:99], v[32:39], v8
    s_waitcnt lgkmcnt(7)
    ds_read_b128 a[64:67], v2 offset:8192
    ds_read_b128 a[68:71], v2 offset:9216
    v_mfma_f32_16x16x32_bf16 v[128:131], a[32:35], v[32:35], v[128:131]
    v_exp_f32 v4, v228
    v_mfma_f32_16x16x32_bf16 v[160:163], a[32:35], v[36:39], v[160:163]
    s_waitcnt lgkmcnt(8)
    v_exp_f32 v5, v229
    v_mfma_f32_16x16x32_bf16 v[132:135], a[36:39], v[32:35], v[132:135]
    ds_read_b128 a[72:75], v2 offset:10240
    ds_read_b128 a[76:79], v2 offset:11264
    v_cvt_pk_bf16_f32 v40, v4, v5
    v_mfma_f32_16x16x32_bf16 v[164:167], a[36:39], v[36:39], v[164:167]
    s_waitcnt lgkmcnt(9)
    v_exp_f32 v6, v230
    v_mfma_f32_16x16x32_bf16 v[136:139], a[40:43], v[32:35], v[136:139]
    v_exp_f32 v7, v231
    v_mfma_f32_16x16x32_bf16 v[168:171], a[40:43], v[36:39], v[168:171]
    s_waitcnt lgkmcnt(8)
    ds_read_b128 a[80:83], v2 offset:12288
    ds_read_b128 a[84:87], v2 offset:13312
    v_cvt_pk_bf16_f32 v41, v6, v7
    v_mfma_f32_16x16x32_bf16 v[140:143], a[44:47], v[32:35], v[140:143]
    v_exp_f32 v4, v244
    v_mfma_f32_16x16x32_bf16 v[172:175], a[44:47], v[36:39], v[172:175]
    s_waitcnt lgkmcnt(9)
    v_exp_f32 v5, v245
    v_mfma_f32_16x16x32_bf16 v[144:147], a[48:51], v[32:35], v[144:147]
    ds_read_b128 a[88:91], v2 offset:14336
    ds_read_b128 a[92:95], v2 offset:15360
    v_cvt_pk_bf16_f32 v44, v4, v5
    v_mfma_f32_16x16x32_bf16 v[176:179], a[48:51], v[36:39], v[176:179]
    s_waitcnt lgkmcnt(10)
    v_exp_f32 v6, v246
    v_mfma_f32_16x16x32_bf16 v[148:151], a[52:55], v[32:35], v[148:151]
    v_exp_f32 v7, v247
    v_mfma_f32_16x16x32_bf16 v[180:183], a[52:55], v[36:39], v[180:183]
    s_waitcnt lgkmcnt(9)
    v_cvt_pk_bf16_f32 v45, v6, v7
    v_exp_f32 v4, v252
    v_mfma_f32_16x16x32_bf16 v[152:155], a[56:59], v[32:35], v[152:155]
    v_exp_f32 v5, v253
    v_mfma_f32_16x16x32_bf16 v[184:187], a[56:59], v[36:39], v[184:187]
    s_waitcnt lgkmcnt(8)
    v_cvt_pk_bf16_f32 v46, v4, v5
    v_exp_f32 v6, v254
    v_mfma_f32_16x16x32_bf16 v[156:159], a[60:63], v[32:35], v[156:159]
    v_exp_f32 v7, v255
    v_mfma_f32_16x16x32_bf16 v[188:191], a[60:63], v[36:39], v[188:191]
    v_cvt_pk_bf16_f32 v47, v6, v7
    v_mov_b32 v42, 0
    v_mov_b32 v43, 0
    buffer_load_dwordx4 a[160:163], v1, s[44:47], s0 offen offset:0 sc1
    buffer_load_dwordx4 a[176:179], v1, s[44:47], s61 offen offset:0 sc1
    v_smfmac_f32_16x16x64_bf16 a[100:103], a[96:99], v[40:47], v8
    s_waitcnt lgkmcnt(7)
    buffer_load_dwordx4 a[128:131], v25, s[44:47], s1 offen offset:0 sc1
    v_mfma_f32_16x16x32_bf16 v[128:131], a[64:67], v[40:43], v[128:131]
    buffer_load_dwordx4 a[144:147], v25, s[44:47], s57 offen offset:0 sc1
    v_mfma_f32_16x16x32_bf16 v[160:163], a[64:67], v[44:47], v[160:163]
    s_waitcnt lgkmcnt(6)
    buffer_load_dwordx4 a[132:135], v26, s[44:47], s1 offen offset:0 sc1
    v_mfma_f32_16x16x32_bf16 v[132:135], a[68:71], v[40:43], v[132:135]
    buffer_load_dwordx4 a[148:151], v26, s[44:47], s57 offen offset:0 sc1
    v_mfma_f32_16x16x32_bf16 v[164:167], a[68:71], v[44:47], v[164:167]
    s_waitcnt lgkmcnt(5)
    buffer_load_dwordx4 a[136:139], v27, s[44:47], s1 offen offset:0 sc1
    v_mfma_f32_16x16x32_bf16 v[136:139], a[72:75], v[40:43], v[136:139]
    buffer_load_dwordx4 a[152:155], v27, s[44:47], s57 offen offset:0 sc1
    v_mfma_f32_16x16x32_bf16 v[168:171], a[72:75], v[44:47], v[168:171]
    s_waitcnt lgkmcnt(4)
    buffer_load_dwordx4 a[140:143], v28, s[44:47], s1 offen offset:0 sc1
    v_mfma_f32_16x16x32_bf16 v[140:143], a[76:79], v[40:43], v[140:143]
    v_mfma_f32_16x16x32_bf16 v[172:175], a[76:79], v[44:47], v[172:175]
    s_waitcnt lgkmcnt(3)
    buffer_load_dwordx4 a[156:159], v28, s[44:47], s57 offen offset:0 sc1
    v_mfma_f32_16x16x32_bf16 v[144:147], a[80:83], v[40:43], v[144:147]
    buffer_load_dwordx4 a[164:167], v1, s[44:47], s0 offen offset:1024 sc1
    v_mfma_f32_16x16x32_bf16 v[176:179], a[80:83], v[44:47], v[176:179]
    s_waitcnt lgkmcnt(2)
    buffer_load_dwordx4 a[180:183], v1, s[44:47], s61 offen offset:1024 sc1
    v_mfma_f32_16x16x32_bf16 v[148:151], a[84:87], v[40:43], v[148:151]
    buffer_load_dwordx4 a[168:171], v1, s[44:47], s0 offen offset:2048 sc1
    v_mfma_f32_16x16x32_bf16 v[180:183], a[84:87], v[44:47], v[180:183]
    s_waitcnt lgkmcnt(1)
    buffer_load_dwordx4 a[184:187], v1, s[44:47], s61 offen offset:2048 sc1
    v_mfma_f32_16x16x32_bf16 v[152:155], a[88:91], v[40:43], v[152:155]
    buffer_load_dwordx4 a[172:175], v1, s[44:47], s0 offen offset:3072 sc1
    v_mfma_f32_16x16x32_bf16 v[184:187], a[88:91], v[44:47], v[184:187]
    s_waitcnt lgkmcnt(0)
    buffer_load_dwordx4 a[188:191], v1, s[44:47], s61 offen offset:3072 sc1
    v_mfma_f32_16x16x32_bf16 v[156:159], a[92:95], v[40:43], v[156:159]
    v_mfma_f32_16x16x32_bf16 v[188:191], a[92:95], v[44:47], v[188:191]
    s_lshl_b32 s75, s3, 2
    s_lshr_b32 s78, 18, s75
    s_lshr_b32 s75, 273, s75
    s_and_b32 s75, s75, 15
K_XB:
    s_cmp_eq_u32 s75, 0
    s_cbranch_scc0 K_XBL
K_XBD:
    v_accvgpr_read_b32 v9, a100
    v_accvgpr_read_b32 v11, a101
    v_accvgpr_read_b32 v10, a102
    v_add_f32 v9, v9, v11
    v_accvgpr_read_b32 v11, a103
    v_add_f32 v10, v10, v11
    v_add_f32 v11, v9, v10
    v_cmp_ngt_f32 vcc, s77, v11
    s_or_b64 s[86:87], s[86:87], vcc
    s_cbranch_scc1 K_SLOW
K_SLOW_RET:
    v_rcp_f32 v9, v9
    v_rcp_f32 v10, v10
    s_add_u32 s56, s81, 0
    v_pk_mul_f32 v[128:129], v[128:129], v[8:9] op_sel:[0,1] op_sel_hi:[1,1]
    v_pk_mul_f32 v[130:131], v[130:131], v[8:9] op_sel:[0,1] op_sel_hi:[1,1]
    v_pk_mul_f32 v[132:133], v[132:133], v[8:9] op_sel:[0,1] op_sel_hi:[1,1]
    v_pk_mul_f32 v[134:135], v[134:135], v[8:9] op_sel:[0,1] op_sel_hi:[1,1]
    v_cvt_pk_bf16_f32 v128, v128, v129
    v_cvt_pk_bf16_f32 v129, v130, v131
    v_cvt_pk_bf16_f32 v130, v132, v133
    v_cvt_pk_bf16_f32 v131, v134, v135
    buffer_store_dwordx4 v[128:131], v1, s[44:47], s56 offen offset:0 sc1
    v_pk_mul_f32 v[160:161], v[160:161], v[10:11] op_sel_hi:[1,0]
    v_pk_mul_f32 v[162:163], v[162:163], v[10:11] op_sel_hi:[1,0]
    v_pk_mul_f32 v[164:165], v[164:165], v[10:11] op_sel_hi:[1,0]
    v_pk_mul_f32 v[166:167], v[166:167], v[10:11] op_sel_hi:[1,0]
    v_cvt_pk_bf16_f32 v160, v160, v161
    v_cvt_pk_bf16_f32 v161, v162, v163
    v_cvt_pk_bf16_f32 v162, v164, v165
    v_cvt_pk_bf16_f32 v163, v166, v167
    buffer_store_dwordx4 v[160:163], v1, s[44:47], s56 offen offset:1024 sc1
    s_add_u32 s56, s81, 4096
    v_pk_mul_f32 v[136:137], v[136:137], v[8:9] op_sel:[0,1] op_sel_hi:[1,1]
    v_pk_mul_f32 v[138:139], v[138:139], v[8:9] op_sel:[0,1] op_sel_hi:[1,1]
    v_pk_mul_f32 v[140:141], v[140:141], v[8:9] op_sel:[0,1] op_sel_hi:[1,1]
    v_pk_mul_f32 v[142:143], v[142:143], v[8:9] op_sel:[0,1] op_sel_hi:[1,1]
    v_cvt_pk_bf16_f32 v136, v136, v137
    v_cvt_pk_bf16_f32 v137, v138, v139
    v_cvt_pk_bf16_f32 v138, v140, v141
    v_cvt_pk_bf16_f32 v139, v142, v143
    buffer_store_dwordx4 v[136:139], v1, s[44:47], s56 offen offset:0 sc1
    v_pk_mul_f32 v[168:169], v[168:169], v[10:11] op_sel_hi:[1,0]
    v_pk_mul_f32 v[170:171], v[170:171], v[10:11] op_sel_hi:[1,0]
    v_pk_mul_f32 v[172:173], v[172:173], v[10:11] op_sel_hi:[1,0]
    v_pk_mul_f32 v[174:175], v[174:175], v[10:11] op_sel_hi:[1,0]
    v_cvt_pk_bf16_f32 v168, v168, v169
    v_cvt_pk_bf16_f32 v169, v170, v171
    v_cvt_pk_bf16_f32 v170, v172, v173
    v_cvt_pk_bf16_f32 v171, v174, v175
    buffer_store_dwordx4 v[168:171], v1, s[44:47], s56 offen offset:1024 sc1
    s_add_u32 s56, s81, 8192
    v_pk_mul_f32 v[144:145], v[144:145], v[8:9] op_sel:[0,1] op_sel_hi:[1,1]
    v_pk_mul_f32 v[146:147], v[146:147], v[8:9] op_sel:[0,1] op_sel_hi:[1,1]
    v_pk_mul_f32 v[148:149], v[148:149], v[8:9] op_sel:[0,1] op_sel_hi:[1,1]
    v_pk_mul_f32 v[150:151], v[150:151], v[8:9] op_sel:[0,1] op_sel_hi:[1,1]
    v_cvt_pk_bf16_f32 v144, v144, v145
    v_cvt_pk_bf16_f32 v145, v146, v147
    v_cvt_pk_bf16_f32 v146, v148, v149
    v_cvt_pk_bf16_f32 v147, v150, v151
    buffer_store_dwordx4 v[144:147], v1, s[44:47], s56 offen offset:0 sc1
    v_pk_mul_f32 v[176:177], v[176:177], v[10:11] op_sel_hi:[1,0]
    v_pk_mul_f32 v[178:179], v[178:179], v[10:11] op_sel_hi:[1,0]
    v_pk_mul_f32 v[180:181], v[180:181], v[10:11] op_sel_hi:[1,0]
    v_pk_mul_f32 v[182:183], v[182:183], v[10:11] op_sel_hi:[1,0]
    v_cvt_pk_bf16_f32 v176, v176, v177
    v_cvt_pk_bf16_f32 v177, v178, v179
    v_cvt_pk_bf16_f32 v178, v180, v181
    v_cvt_pk_bf16_f32 v179, v182, v183
    buffer_store_dwordx4 v[176:179], v1, s[44:47], s56 offen offset:1024 sc1
    s_add_u32 s56, s81, 12288
    v_pk_mul_f32 v[152:153], v[152:153], v[8:9] op_sel:[0,1] op_sel_hi:[1,1]
    v_pk_mul_f32 v[154:155], v[154:155], v[8:9] op_sel:[0,1] op_sel_hi:[1,1]
    v_pk_mul_f32 v[156:157], v[156:157], v[8:9] op_sel:[0,1] op_sel_hi:[1,1]
    v_pk_mul_f32 v[158:159], v[158:159], v[8:9] op_sel:[0,1] op_sel_hi:[1,1]
    v_cvt_pk_bf16_f32 v152, v152, v153
    v_cvt_pk_bf16_f32 v153, v154, v155
    v_cvt_pk_bf16_f32 v154, v156, v157
    v_cvt_pk_bf16_f32 v155, v158, v159
    buffer_store_dwordx4 v[152:155], v1, s[44:47], s56 offen offset:0 sc1
    v_pk_mul_f32 v[184:185], v[184:185], v[10:11] op_sel_hi:[1,0]
    v_pk_mul_f32 v[186:187], v[186:187], v[10:11] op_sel_hi:[1,0]
    v_pk_mul_f32 v[188:189], v[188:189], v[10:11] op_sel_hi:[1,0]
    v_pk_mul_f32 v[190:191], v[190:191], v[10:11] op_sel_hi:[1,0]
    v_cvt_pk_bf16_f32 v184, v184, v185
    v_cvt_pk_bf16_f32 v185, v186, v187
    v_cvt_pk_bf16_f32 v186, v188, v189
    v_cvt_pk_bf16_f32 v187, v190, v191
    buffer_store_dwordx4 v[184:187], v1, s[44:47], s56 offen offset:1024 sc1
    s_and_b32 s78, s78, 15
    s_cbranch_scc1 K_YBL
K_YBD:
    s_waitcnt vmcnt(21)
    v_mfma_f32_16x16x32_bf16 v[64:67], a[160:163], a[128:131], 0
    s_waitcnt vmcnt(20) lgkmcnt(0)
    v_mfma_f32_16x16x32_bf16 v[64:67], a[176:179], a[144:147], v[64:67]
    s_barrier
    ds_read_b128 a[224:227], v23 offset:32768
    s_waitcnt vmcnt(18)
    v_mfma_f32_16x16x32_bf16 v[80:83], a[176:179], a[148:151], 0
    ds_read_b128 a[240:243], v23 offset:36864
    s_add_u32 m0, s72, 32768
    s_add_u32 s58, s65, 16384
    buffer_load_dwordx4 v16, s[44:47], s58 offen offset:0 sc1 lds
    v_mfma_f32_16x16x32_bf16 v[80:83], a[160:163], a[132:135], v[80:83]
    s_waitcnt vmcnt(18)
    ds_read_b128 a[192:195], v22 offset:32768
    buffer_load_dwordx4 v17, s[44:47], s58 offen offset:1024 sc1 lds
    v_mfma_f32_16x16x32_bf16 v[96:99], a[160:163], a[136:139], 0
    s_waitcnt vmcnt(18)
    s_lshl_b32 s60, s63, 2
    v_mfma_f32_16x16x32_bf16 v[96:99], a[176:179], a[152:155], v[96:99]
    s_waitcnt vmcnt(16)
    s_add_u32 s59, s67, s60
    ds_read_b128 a[208:211], v22 offset:36864
    buffer_load_dwordx4 v18, s[44:47], s58 offen offset:2048 sc1 lds
    v_mfma_f32_16x16x32_bf16 v[112:115], a[176:179], a[156:159], 0
    s_lshl_b32 s59, s59, 7
    ds_read_b128 a[196:199], v22 offset:33792
    v_mfma_f32_16x16x32_bf16 v[112:115], a[160:163], a[140:143], v[112:115]
    s_waitcnt vmcnt(16)
    s_add_u32 s96, s59, 0x3902000
    ds_read_b128 a[212:215], v22 offset:37888
    buffer_load_dwordx4 v19, s[44:47], s58 offen offset:3072 sc1 lds
    v_mfma_f32_16x16x32_bf16 v[116:119], a[164:167], a[140:143], 0
    s_waitcnt vmcnt(16)
    v_mov_b32 v13, 1
    v_mov_b32 v12, 0
    v_mfma_f32_16x16x32_bf16 v[116:119], a[180:183], a[156:159], v[116:119]
    ds_read_b128 a[200:203], v22 offset:34816
    s_add_u32 m0, s72, 36864
    s_add_u32 s58, s65, 20480
    buffer_load_dwordx4 v16, s[44:47], s58 offen offset:0 sc1 lds
    v_mfma_f32_16x16x32_bf16 v[100:103], a[180:183], a[152:155], 0
    ds_read_b128 a[216:219], v22 offset:38912
    v_mfma_f32_16x16x32_bf16 v[100:103], a[164:167], a[136:139], v[100:103]
    ds_read_b128 a[204:207], v22 offset:35840
    buffer_load_dwordx4 v17, s[44:47], s58 offen offset:1024 sc1 lds
    v_mfma_f32_16x16x32_bf16 v[84:87], a[164:167], a[132:135], 0
    buffer_load_dwordx4 v18, s[44:47], s58 offen offset:2048 sc1 lds
    v_mfma_f32_16x16x32_bf16 v[84:87], a[180:183], a[148:151], v[84:87]
    ds_read_b128 a[220:223], v22 offset:39936
    v_mfma_f32_16x16x32_bf16 v[68:71], a[180:183], a[144:147], 0
    ds_read_b128 a[228:231], v23 offset:33792
    buffer_load_dwordx4 v19, s[44:47], s58 offen offset:3072 sc1 lds
    v_mfma_f32_16x16x32_bf16 v[68:71], a[164:167], a[128:131], v[68:71]
    s_waitcnt vmcnt(19)
    ds_read_b128 a[244:247], v23 offset:37888
    v_mfma_f32_16x16x32_bf16 v[72:75], a[168:171], a[128:131], 0
    s_waitcnt vmcnt(18)
    s_add_u32 m0, s72, 65536
    s_add_u32 s58, s65, 24576
    buffer_load_dwordx4 v16, s[44:47], s58 offen offset:0 sc1 lds
    v_mfma_f32_16x16x32_bf16 v[72:75], a[184:187], a[144:147], v[72:75]
    ds_read_b128 a[232:235], v23 offset:34816
    v_mfma_f32_16x16x32_bf16 v[88:91], a[184:187], a[148:151], 0
    ds_read_b128 a[248:251], v23 offset:38912
    buffer_load_dwordx4 v17, s[44:47], s58 offen offset:1024 sc1 lds
    v_mfma_f32_16x16x32_bf16 v[88:91], a[168:171], a[132:135], v[88:91]
    ds_read_b128 a[236:239], v23 offset:35840
    v_mfma_f32_16x16x32_bf16 v[104:107], a[168:171], a[136:139], 0
    buffer_load_dwordx4 v18, s[44:47], s58 offen offset:2048 sc1 lds
    v_mfma_f32_16x16x32_bf16 v[104:107], a[184:187], a[152:155], v[104:107]
    s_waitcnt lgkmcnt(11)
    ds_read_b128 a[252:255], v23 offset:39936
    buffer_load_dwordx4 v19, s[44:47], s58 offen offset:3072 sc1 lds
    v_mfma_f32_16x16x32_bf16 v[120:123], a[184:187], a[156:159], 0
    v_mfma_f32_16x16x32_bf16 v[120:123], a[168:171], a[140:143], v[120:123]
    s_waitcnt vmcnt(21)
    s_add_u32 m0, s72, 69632
    s_add_u32 s58, s65, 28672
    buffer_load_dwordx4 v16, s[44:47], s58 offen offset:0 sc1 lds
    v_mfma_f32_16x16x32_bf16 v[124:127], a[172:175], a[140:143], 0
    s_waitcnt vmcnt(21)
    v_mfma_f32_16x16x32_bf16 v[124:127], a[188:191], a[156:159], v[124:127]
    buffer_load_dwordx4 v17, s[44:47], s58 offen offset:1024 sc1 lds
    v_mfma_f32_16x16x32_bf16 v[108:111], a[188:191], a[152:155], 0
    v_mfma_f32_16x16x32_bf16 v[108:111], a[172:175], a[136:139], v[108:111]
    buffer_load_dwordx4 v18, s[44:47], s58 offen offset:2048 sc1 lds
    v_mfma_f32_16x16x32_bf16 v[92:95], a[172:175], a[132:135], 0
    v_mfma_f32_16x16x32_bf16 v[92:95], a[188:191], a[148:151], v[92:95]
    buffer_load_dwordx4 v19, s[44:47], s58 offen offset:3072 sc1 lds
    v_mfma_f32_16x16x32_bf16 v[76:79], a[188:191], a[144:147], 0
    v_mfma_f32_16x16x32_bf16 v[76:79], a[172:175], a[128:131], v[76:79]
    v_mfma_f32_16x16x32_bf16 v[64:67], a[224:227], a[192:195], v[64:67]
    s_waitcnt vmcnt(8) lgkmcnt(0)
    v_mfma_f32_16x16x32_bf16 v[64:67], a[240:243], a[208:211], v[64:67]
    s_barrier
    buffer_atomic_add v13, v14, s[44:47], s96 offen
    ds_read_b128 a[160:163], v21 offset:0
    v_mfma_f32_16x16x32_bf16 v[80:83], a[240:243], a[212:215], v[80:83]
    s_add_u32 m0, s72, 98304
    ds_read_b128 a[176:179], v21 offset:4096
    v_mfma_f32_16x16x32_bf16 v[80:83], a[224:227], a[196:199], v[80:83]
    s_add_u32 s58, s65, 32768
    ds_read_b128 a[128:131], v20 offset:0
    v_mfma_f32_16x16x32_bf16 v[96:99], a[224:227], a[200:203], v[96:99]
    buffer_load_dwordx4 v16, s[44:47], s58 offen offset:0 sc1 lds
    v_mfma_f32_16x16x32_bf16 v[96:99], a[240:243], a[216:219], v[96:99]
    ds_read_b128 a[144:147], v20 offset:4096
    v_mfma_f32_16x16x32_bf16 v[112:115], a[240:243], a[220:223], v[112:115]
    ds_read_b128 a[132:135], v20 offset:1024
    v_mfma_f32_16x16x32_bf16 v[112:115], a[224:227], a[204:207], v[112:115]
    ds_read_b128 a[148:151], v20 offset:5120
    v_mfma_f32_16x16x32_bf16 v[116:119], a[228:231], a[204:207], v[116:119]
    buffer_load_dwordx4 v17, s[44:47], s58 offen offset:1024 sc1 lds
    v_mfma_f32_16x16x32_bf16 v[116:119], a[244:247], a[220:223], v[116:119]
    ds_read_b128 a[136:139], v20 offset:2048
    v_mfma_f32_16x16x32_bf16 v[100:103], a[244:247], a[216:219], v[100:103]
    ds_read_b128 a[152:155], v20 offset:6144
    v_mfma_f32_16x16x32_bf16 v[100:103], a[228:231], a[200:203], v[100:103]
    ds_read_b128 a[140:143], v20 offset:3072
    v_mfma_f32_16x16x32_bf16 v[84:87], a[228:231], a[196:199], v[84:87]
    buffer_load_dwordx4 v18, s[44:47], s58 offen offset:2048 sc1 lds
    v_mfma_f32_16x16x32_bf16 v[84:87], a[244:247], a[212:215], v[84:87]
    ds_read_b128 a[156:159], v20 offset:7168
    v_mfma_f32_16x16x32_bf16 v[68:71], a[244:247], a[208:211], v[68:71]
    ds_read_b128 a[164:167], v21 offset:1024
    v_mfma_f32_16x16x32_bf16 v[68:71], a[228:231], a[192:195], v[68:71]
    ds_read_b128 a[180:183], v21 offset:5120
    v_mfma_f32_16x16x32_bf16 v[72:75], a[232:235], a[192:195], v[72:75]
    buffer_load_dwordx4 v19, s[44:47], s58 offen offset:3072 sc1 lds
    v_mfma_f32_16x16x32_bf16 v[72:75], a[248:251], a[208:211], v[72:75]
    ds_read_b128 a[168:171], v21 offset:2048
    v_mfma_f32_16x16x32_bf16 v[88:91], a[248:251], a[212:215], v[88:91]
    s_add_u32 m0, s72, 102400
    ds_read_b128 a[184:187], v21 offset:6144
    v_mfma_f32_16x16x32_bf16 v[88:91], a[232:235], a[196:199], v[88:91]
    s_add_u32 s58, s65, 36864
    ds_read_b128 a[172:175], v21 offset:3072
    v_mfma_f32_16x16x32_bf16 v[104:107], a[232:235], a[200:203], v[104:107]
    buffer_load_dwordx4 v16, s[44:47], s58 offen offset:0 sc1 lds
    v_mfma_f32_16x16x32_bf16 v[104:107], a[248:251], a[216:219], v[104:107]
    s_waitcnt lgkmcnt(11)
    ds_read_b128 a[188:191], v21 offset:7168
    v_mfma_f32_16x16x32_bf16 v[120:123], a[248:251], a[220:223], v[120:123]
    v_mfma_f32_16x16x32_bf16 v[120:123], a[232:235], a[204:207], v[120:123]
    v_mfma_f32_16x16x32_bf16 v[124:127], a[236:239], a[204:207], v[124:127]
    buffer_load_dwordx4 v17, s[44:47], s58 offen offset:1024 sc1 lds
    v_mfma_f32_16x16x32_bf16 v[124:127], a[252:255], a[220:223], v[124:127]
    v_mfma_f32_16x16x32_bf16 v[108:111], a[252:255], a[216:219], v[108:111]
    v_mfma_f32_16x16x32_bf16 v[108:111], a[236:239], a[200:203], v[108:111]
    buffer_load_dwordx4 v18, s[44:47], s58 offen offset:2048 sc1 lds
    v_mfma_f32_16x16x32_bf16 v[92:95], a[236:239], a[196:199], v[92:95]
    v_mfma_f32_16x16x32_bf16 v[92:95], a[252:255], a[212:215], v[92:95]
    v_mfma_f32_16x16x32_bf16 v[76:79], a[252:255], a[208:211], v[76:79]
    buffer_load_dwordx4 v19, s[44:47], s58 offen offset:3072 sc1 lds
    v_mfma_f32_16x16x32_bf16 v[76:79], a[236:239], a[192:195], v[76:79]
    v_mfma_f32_16x16x32_bf16 v[64:67], a[160:163], a[128:131], v[64:67]
    s_waitcnt vmcnt(9) lgkmcnt(0)
    v_mfma_f32_16x16x32_bf16 v[64:67], a[176:179], a[144:147], v[64:67]
    s_barrier
    ds_read_b128 a[224:227], v21 offset:32768
    v_mfma_f32_16x16x32_bf16 v[80:83], a[176:179], a[148:151], v[80:83]
    s_add_u32 m0, s72, 131072
    ds_read_b128 a[240:243], v21 offset:36864
    v_mfma_f32_16x16x32_bf16 v[80:83], a[160:163], a[132:135], v[80:83]
    s_add_u32 s58, s65, 40960
    ds_read_b128 a[192:195], v20 offset:32768
    v_mfma_f32_16x16x32_bf16 v[96:99], a[160:163], a[136:139], v[96:99]
    buffer_load_dwordx4 v16, s[44:47], s58 offen offset:0 sc1 lds
    v_mfma_f32_16x16x32_bf16 v[96:99], a[176:179], a[152:155], v[96:99]
    ds_read_b128 a[208:211], v20 offset:36864
    v_mfma_f32_16x16x32_bf16 v[112:115], a[176:179], a[156:159], v[112:115]
    ds_read_b128 a[196:199], v20 offset:33792
    v_mfma_f32_16x16x32_bf16 v[112:115], a[160:163], a[140:143], v[112:115]
    ds_read_b128 a[212:215], v20 offset:37888
    v_mfma_f32_16x16x32_bf16 v[116:119], a[164:167], a[140:143], v[116:119]
    buffer_load_dwordx4 v17, s[44:47], s58 offen offset:1024 sc1 lds
    v_mfma_f32_16x16x32_bf16 v[116:119], a[180:183], a[156:159], v[116:119]
    ds_read_b128 a[200:203], v20 offset:34816
    v_mfma_f32_16x16x32_bf16 v[100:103], a[180:183], a[152:155], v[100:103]
    ds_read_b128 a[216:219], v20 offset:38912
    v_mfma_f32_16x16x32_bf16 v[100:103], a[164:167], a[136:139], v[100:103]
    ds_read_b128 a[204:207], v20 offset:35840
    v_mfma_f32_16x16x32_bf16 v[84:87], a[164:167], a[132:135], v[84:87]
    buffer_load_dwordx4 v18, s[44:47], s58 offen offset:2048 sc1 lds
    v_mfma_f32_16x16x32_bf16 v[84:87], a[180:183], a[148:151], v[84:87]
    ds_read_b128 a[220:223], v20 offset:39936
    v_mfma_f32_16x16x32_bf16 v[68:71], a[180:183], a[144:147], v[68:71]
    ds_read_b128 a[228:231], v21 offset:33792
    v_mfma_f32_16x16x32_bf16 v[68:71], a[164:167], a[128:131], v[68:71]
    ds_read_b128 a[244:247], v21 offset:37888
    v_mfma_f32_16x16x32_bf16 v[72:75], a[168:171], a[128:131], v[72:75]
    buffer_load_dwordx4 v19, s[44:47], s58 offen offset:3072 sc1 lds
    v_mfma_f32_16x16x32_bf16 v[72:75], a[184:187], a[144:147], v[72:75]
    ds_read_b128 a[232:235], v21 offset:34816
    v_mfma_f32_16x16x32_bf16 v[88:91], a[184:187], a[148:151], v[88:91]
    s_add_u32 m0, s72, 135168
    ds_read_b128 a[248:251], v21 offset:38912
    v_mfma_f32_16x16x32_bf16 v[88:91], a[168:171], a[132:135], v[88:91]
    s_add_u32 s58, s65, 45056
    ds_read_b128 a[236:239], v21 offset:35840
    v_mfma_f32_16x16x32_bf16 v[104:107], a[168:171], a[136:139], v[104:107]
    buffer_load_dwordx4 v16, s[44:47], s58 offen offset:0 sc1 lds
    v_mfma_f32_16x16x32_bf16 v[104:107], a[184:187], a[152:155], v[104:107]
    s_waitcnt lgkmcnt(11)
    ds_read_b128 a[252:255], v21 offset:39936
    v_mfma_f32_16x16x32_bf16 v[120:123], a[184:187], a[156:159], v[120:123]
    v_mfma_f32_16x16x32_bf16 v[120:123], a[168:171], a[140:143], v[120:123]
    v_mfma_f32_16x16x32_bf16 v[124:127], a[172:175], a[140:143], v[124:127]
    buffer_load_dwordx4 v17, s[44:47], s58 offen offset:1024 sc1 lds
    v_mfma_f32_16x16x32_bf16 v[124:127], a[188:191], a[156:159], v[124:127]
    v_mfma_f32_16x16x32_bf16 v[108:111], a[188:191], a[152:155], v[108:111]
    v_mfma_f32_16x16x32_bf16 v[108:111], a[172:175], a[136:139], v[108:111]
    buffer_load_dwordx4 v18, s[44:47], s58 offen offset:2048 sc1 lds
    v_mfma_f32_16x16x32_bf16 v[92:95], a[172:175], a[132:135], v[92:95]
K_PG11:
    s_cmp_eq_u32 s100, 1
    s_cbranch_scc1 K_MAIN
    v_mfma_f32_16x16x32_bf16 v[92:95], a[188:191], a[148:151], v[92:95]
    v_mfma_f32_16x16x32_bf16 v[76:79], a[188:191], a[144:147], v[76:79]
    buffer_load_dwordx4 v19, s[44:47], s58 offen offset:3072 sc1 lds
    v_mfma_f32_16x16x32_bf16 v[76:79], a[172:175], a[128:131], v[76:79]
    v_mfma_f32_16x16x32_bf16 v[64:67], a[224:227], a[192:195], v[64:67]
    s_waitcnt vmcnt(8) lgkmcnt(0)
    v_mfma_f32_16x16x32_bf16 v[64:67], a[240:243], a[208:211], v[64:67]
    s_barrier
    ds_read_b128 a[160:163], v23 offset:0
    v_mfma_f32_16x16x32_bf16 v[80:83], a[240:243], a[212:215], v[80:83]
    s_add_u32 m0, s72, 32768
    ds_read_b128 a[176:179], v23 offset:4096
    v_mfma_f32_16x16x32_bf16 v[80:83], a[224:227], a[196:199], v[80:83]
    s_add_u32 s58, s65, 49152
    ds_read_b128 a[128:131], v22 offset:0
    v_mfma_f32_16x16x32_bf16 v[96:99], a[224:227], a[200:203], v[96:99]
    buffer_load_dwordx4 v16, s[44:47], s58 offen offset:0 sc1 lds
    v_mfma_f32_16x16x32_bf16 v[96:99], a[240:243], a[216:219], v[96:99]
    ds_read_b128 a[144:147], v22 offset:4096
    v_mfma_f32_16x16x32_bf16 v[112:115], a[240:243], a[220:223], v[112:115]
    ds_read_b128 a[132:135], v22 offset:1024
    v_mfma_f32_16x16x32_bf16 v[112:115], a[224:227], a[204:207], v[112:115]
    ds_read_b128 a[148:151], v22 offset:5120
    v_mfma_f32_16x16x32_bf16 v[116:119], a[228:231], a[204:207], v[116:119]
    buffer_load_dwordx4 v17, s[44:47], s58 offen offset:1024 sc1 lds
    buffer_load_dword v13, v12, s[44:47], s71 offen sc1
    v_mfma_f32_16x16x32_bf16 v[116:119], a[244:247], a[220:223], v[116:119]
    ds_read_b128 a[136:139], v22 offset:2048
    v_mfma_f32_16x16x32_bf16 v[100:103], a[244:247], a[216:219], v[100:103]
    ds_read_b128 a[152:155], v22 offset:6144
    v_mfma_f32_16x16x32_bf16 v[100:103], a[228:231], a[200:203], v[100:103]
    ds_read_b128 a[140:143], v22 offset:3072
    v_mfma_f32_16x16x32_bf16 v[84:87], a[228:231], a[196:199], v[84:87]
    buffer_load_dwordx4 v18, s[44:47], s58 offen offset:2048 sc1 lds
    v_mfma_f32_16x16x32_bf16 v[84:87], a[244:247], a[212:215], v[84:87]
    ds_read_b128 a[156:159], v22 offset:7168
    v_mfma_f32_16x16x32_bf16 v[68:71], a[244:247], a[208:211], v[68:71]
    ds_read_b128 a[164:167], v23 offset:1024
    v_mfma_f32_16x16x32_bf16 v[68:71], a[228:231], a[192:195], v[68:71]
    ds_read_b128 a[180:183], v23 offset:5120
    v_mfma_f32_16x16x32_bf16 v[72:75], a[232:235], a[192:195], v[72:75]
    buffer_load_dwordx4 v19, s[44:47], s58 offen offset:3072 sc1 lds
    v_mfma_f32_16x16x32_bf16 v[72:75], a[248:251], a[208:211], v[72:75]
    ds_read_b128 a[168:171], v23 offset:2048
    v_mfma_f32_16x16x32_bf16 v[88:91], a[248:251], a[212:215], v[88:91]
    s_add_u32 m0, s72, 36864
    ds_read_b128 a[184:187], v23 offset:6144
    v_mfma_f32_16x16x32_bf16 v[88:91], a[232:235], a[196:199], v[88:91]
    s_add_u32 s58, s65, 53248
    ds_read_b128 a[172:175], v23 offset:3072
    v_mfma_f32_16x16x32_bf16 v[104:107], a[232:235], a[200:203], v[104:107]
    buffer_load_dwordx4 v16, s[44:47], s58 offen offset:0 sc1 lds
    v_mfma_f32_16x16x32_bf16 v[104:107], a[248:251], a[216:219], v[104:107]
    s_waitcnt lgkmcnt(11)
    ds_read_b128 a[188:191], v23 offset:7168
    v_mfma_f32_16x16x32_bf16 v[120:123], a[248:251], a[220:223], v[120:123]
    v_mfma_f32_16x16x32_bf16 v[120:123], a[232:235], a[204:207], v[120:123]
    v_mfma_f32_16x16x32_bf16 v[124:127], a[236:239], a[204:207], v[124:127]
    buffer_load_dwordx4 v17, s[44:47], s58 offen offset:1024 sc1 lds
    v_mfma_f32_16x16x32_bf16 v[124:127], a[252:255], a[220:223], v[124:127]
    v_mfma_f32_16x16x32_bf16 v[108:111], a[252:255], a[216:219], v[108:111]
    v_mfma_f32_16x16x32_bf16 v[108:111], a[236:239], a[200:203], v[108:111]
    buffer_load_dwordx4 v18, s[44:47], s58 offen offset:2048 sc1 lds
    v_mfma_f32_16x16x32_bf16 v[92:95], a[236:239], a[196:199], v[92:95]
    v_mfma_f32_16x16x32_bf16 v[92:95], a[252:255], a[212:215], v[92:95]
    v_mfma_f32_16x16x32_bf16 v[76:79], a[252:255], a[208:211], v[76:79]
    buffer_load_dwordx4 v19, s[44:47], s58 offen offset:3072 sc1 lds
    v_mfma_f32_16x16x32_bf16 v[76:79], a[236:239], a[192:195], v[76:79]
    v_mfma_f32_16x16x32_bf16 v[64:67], a[160:163], a[128:131], v[64:67]
    s_waitcnt vmcnt(9) lgkmcnt(0)
    v_mfma_f32_16x16x32_bf16 v[64:67], a[176:179], a[144:147], v[64:67]
    s_barrier
    ds_read_b128 a[224:227], v23 offset:32768
    v_mfma_f32_16x16x32_bf16 v[80:83], a[176:179], a[148:151], v[80:83]
    s_waitcnt vmcnt(6)
    ds_read_b128 a[240:243], v23 offset:36864
    v_cmp_gt_u32 vcc, 8, v13
    v_mfma_f32_16x16x32_bf16 v[80:83], a[160:163], a[132:135], v[80:83]
    s_cbranch_vccnz S4
S4_RET:
    ds_read_b128 a[192:195], v22 offset:32768
    v_mfma_f32_16x16x32_bf16 v[96:99], a[160:163], a[136:139], v[96:99]
    s_add_u32 m0, s72, 65536
    s_add_u32 s58, s66, 0
    buffer_load_dwordx4 v16, s[44:47], s58 offen offset:0 sc1 lds
    v_mfma_f32_16x16x32_bf16 v[96:99], a[176:179], a[152:155], v[96:99]
    ds_read_b128 a[208:211], v22 offset:36864
    v_mfma_f32_16x16x32_bf16 v[112:115], a[176:179], a[156:159], v[112:115]
    ds_read_b128 a[196:199], v22 offset:33792
    v_mfma_f32_16x16x32_bf16 v[112:115], a[160:163], a[140:143], v[112:115]
    ds_read_b128 a[212:215], v22 offset:37888
    buffer_load_dwordx4 v17, s[44:47], s58 offen offset:1024 sc1 lds
    v_mfma_f32_16x16x32_bf16 v[116:119], a[164:167], a[140:143], v[116:119]
    v_mfma_f32_16x16x32_bf16 v[116:119], a[180:183], a[156:159], v[116:119]
    ds_read_b128 a[200:203], v22 offset:34816
    v_mfma_f32_16x16x32_bf16 v[100:103], a[180:183], a[152:155], v[100:103]
    ds_read_b128 a[216:219], v22 offset:38912
    buffer_load_dwordx4 v18, s[44:47], s58 offen offset:2048 sc1 lds
    v_mfma_f32_16x16x32_bf16 v[100:103], a[164:167], a[136:139], v[100:103]
    ds_read_b128 a[204:207], v22 offset:35840
    v_mfma_f32_16x16x32_bf16 v[84:87], a[164:167], a[132:135], v[84:87]
    v_mfma_f32_16x16x32_bf16 v[84:87], a[180:183], a[148:151], v[84:87]
    ds_read_b128 a[220:223], v22 offset:39936
    v_mfma_f32_16x16x32_bf16 v[68:71], a[180:183], a[144:147], v[68:71]
    ds_read_b128 a[228:231], v23 offset:33792
    buffer_load_dwordx4 v19, s[44:47], s58 offen offset:3072 sc1 lds
    v_mfma_f32_16x16x32_bf16 v[68:71], a[164:167], a[128:131], v[68:71]
    ds_read_b128 a[244:247], v23 offset:37888
    v_mfma_f32_16x16x32_bf16 v[72:75], a[168:171], a[128:131], v[72:75]
    v_mfma_f32_16x16x32_bf16 v[72:75], a[184:187], a[144:147], v[72:75]
    ds_read_b128 a[232:235], v23 offset:34816
    s_add_u32 m0, s72, 69632
    s_add_u32 s58, s66, 4096
    buffer_load_dwordx4 v16, s[44:47], s58 offen offset:0 sc1 lds
    v_mfma_f32_16x16x32_bf16 v[88:91], a[184:187], a[148:151], v[88:91]
    ds_read_b128 a[248:251], v23 offset:38912
    v_mfma_f32_16x16x32_bf16 v[88:91], a[168:171], a[132:135], v[88:91]
    ds_read_b128 a[236:239], v23 offset:35840
    v_mfma_f32_16x16x32_bf16 v[104:107], a[168:171], a[136:139], v[104:107]
    buffer_load_dwordx4 v17, s[44:47], s58 offen offset:1024 sc1 lds
    v_mfma_f32_16x16x32_bf16 v[104:107], a[184:187], a[152:155], v[104:107]
    s_waitcnt lgkmcnt(11)
    ds_read_b128 a[252:255], v23 offset:39936
    v_mfma_f32_16x16x32_bf16 v[120:123], a[184:187], a[156:159], v[120:123]
    v_mfma_f32_16x16x32_bf16 v[120:123], a[168:171], a[140:143], v[120:123]
    v_mfma_f32_16x16x32_bf16 v[124:127], a[172:175], a[140:143], v[124:127]
    buffer_load_dwordx4 v18, s[44:47], s58 offen offset:2048 sc1 lds
    v_mfma_f32_16x16x32_bf16 v[124:127], a[188:191], a[156:159], v[124:127]
    v_mfma_f32_16x16x32_bf16 v[108:111], a[188:191], a[152:155], v[108:111]
    v_mfma_f32_16x16x32_bf16 v[108:111], a[172:175], a[136:139], v[108:111]
    buffer_load_dwordx4 v19, s[44:47], s58 offen offset:3072 sc1 lds
    v_mfma_f32_16x16x32_bf16 v[92:95], a[172:175], a[132:135], v[92:95]
    v_mfma_f32_16x16x32_bf16 v[92:95], a[188:191], a[148:151], v[92:95]
    v_mfma_f32_16x16x32_bf16 v[76:79], a[188:191], a[144:147], v[76:79]
    v_mfma_f32_16x16x32_bf16 v[76:79], a[172:175], a[128:131], v[76:79]
    v_mfma_f32_16x16x32_bf16 v[64:67], a[224:227], a[192:195], v[64:67]
    s_waitcnt vmcnt(8) lgkmcnt(0)
    v_mfma_f32_16x16x32_bf16 v[64:67], a[240:243], a[208:211], v[64:67]
    s_barrier
    ds_read_b128 a[160:163], v21 offset:0
    v_mfma_f32_16x16x32_bf16 v[80:83], a[240:243], a[212:215], v[80:83]
    s_add_u32 m0, s72, 98304
    ds_read_b128 a[176:179], v21 offset:4096
    v_mfma_f32_16x16x32_bf16 v[80:83], a[224:227], a[196:199], v[80:83]
    s_add_u32 s58, s66, 8192
    ds_read_b128 a[128:131], v20 offset:0
    v_mfma_f32_16x16x32_bf16 v[96:99], a[224:227], a[200:203], v[96:99]
    buffer_load_dwordx4 v16, s[44:47], s58 offen offset:0 sc1 lds
    v_mfma_f32_16x16x32_bf16 v[96:99], a[240:243], a[216:219], v[96:99]
    ds_read_b128 a[144:147], v20 offset:4096
    v_mfma_f32_16x16x32_bf16 v[112:115], a[240:243], a[220:223], v[112:115]
    ds_read_b128 a[132:135], v20 offset:1024
    v_mfma_f32_16x16x32_bf16 v[112:115], a[224:227], a[204:207], v[112:115]
    ds_read_b128 a[148:151], v20 offset:5120
    v_mfma_f32_16x16x32_bf16 v[116:119], a[228:231], a[204:207], v[116:119]
    buffer_load_dwordx4 v17, s[44:47], s58 offen offset:1024 sc1 lds
    v_mfma_f32_16x16x32_bf16 v[116:119], a[244:247], a[220:223], v[116:119]
    ds_read_b128 a[136:139], v20 offset:2048
    v_mfma_f32_16x16x32_bf16 v[100:103], a[244:247], a[216:219], v[100:103]
    ds_read_b128 a[152:155], v20 offset:6144
    v_mfma_f32_16x16x32_bf16 v[100:103], a[228:231], a[200:203], v[100:103]
    ds_read_b128 a[140:143], v20 offset:3072
    v_mfma_f32_16x16x32_bf16 v[84:87], a[228:231], a[196:199], v[84:87]
    buffer_load_dwordx4 v18, s[44:47], s58 offen offset:2048 sc1 lds
    v_mfma_f32_16x16x32_bf16 v[84:87], a[244:247], a[212:215], v[84:87]
    ds_read_b128 a[156:159], v20 offset:7168
    v_mfma_f32_16x16x32_bf16 v[68:71], a[244:247], a[208:211], v[68:71]
    ds_read_b128 a[164:167], v21 offset:1024
    v_mfma_f32_16x16x32_bf16 v[68:71], a[228:231], a[192:195], v[68:71]
    ds_read_b128 a[180:183], v21 offset:5120
    v_mfma_f32_16x16x32_bf16 v[72:75], a[232:235], a[192:195], v[72:75]
    buffer_load_dwordx4 v19, s[44:47], s58 offen offset:3072 sc1 lds
    v_mfma_f32_16x16x32_bf16 v[72:75], a[248:251], a[208:211], v[72:75]
    ds_read_b128 a[168:171], v21 offset:2048
    v_mfma_f32_16x16x32_bf16 v[88:91], a[248:251], a[212:215], v[88:91]
    s_add_u32 m0, s72, 102400
    ds_read_b128 a[184:187], v21 offset:6144
    v_mfma_f32_16x16x32_bf16 v[88:91], a[232:235], a[196:199], v[88:91]
    s_add_u32 s58, s66, 12288
    ds_read_b128 a[172:175], v21 offset:3072
    v_mfma_f32_16x16x32_bf16 v[104:107], a[232:235], a[200:203], v[104:107]
    buffer_load_dwordx4 v16, s[44:47], s58 offen offset:0 sc1 lds
    v_mfma_f32_16x16x32_bf16 v[104:107], a[248:251], a[216:219], v[104:107]
    s_waitcnt lgkmcnt(11)
    ds_read_b128 a[188:191], v21 offset:7168
    v_mfma_f32_16x16x32_bf16 v[120:123], a[248:251], a[220:223], v[120:123]
    v_mfma_f32_16x16x32_bf16 v[120:123], a[232:235], a[204:207], v[120:123]
    v_mfma_f32_16x16x32_bf16 v[124:127], a[236:239], a[204:207], v[124:127]
    buffer_load_dwordx4 v17, s[44:47], s58 offen offset:1024 sc1 lds
    v_mfma_f32_16x16x32_bf16 v[124:127], a[252:255], a[220:223], v[124:127]
    v_mfma_f32_16x16x32_bf16 v[108:111], a[252:255], a[216:219], v[108:111]
    v_mfma_f32_16x16x32_bf16 v[108:111], a[236:239], a[200:203], v[108:111]
    buffer_load_dwordx4 v18, s[44:47], s58 offen offset:2048 sc1 lds
    v_mfma_f32_16x16x32_bf16 v[92:95], a[236:239], a[196:199], v[92:95]
    v_mfma_f32_16x16x32_bf16 v[92:95], a[252:255], a[212:215], v[92:95]
    v_mfma_f32_16x16x32_bf16 v[76:79], a[252:255], a[208:211], v[76:79]
    buffer_load_dwordx4 v19, s[44:47], s58 offen offset:3072 sc1 lds
    v_mfma_f32_16x16x32_bf16 v[76:79], a[236:239], a[192:195], v[76:79]
    v_mfma_f32_16x16x32_bf16 v[64:67], a[160:163], a[128:131], v[64:67]
    s_waitcnt vmcnt(8) lgkmcnt(0)
    v_mfma_f32_16x16x32_bf16 v[64:67], a[176:179], a[144:147], v[64:67]
    s_barrier
    ds_read_b128 a[224:227], v21 offset:32768
    v_mfma_f32_16x16x32_bf16 v[80:83], a[176:179], a[148:151], v[80:83]
    s_add_u32 m0, s72, 131072
    ds_read_b128 a[240:243], v21 offset:36864
    v_mfma_f32_16x16x32_bf16 v[80:83], a[160:163], a[132:135], v[80:83]
    s_add_u32 s58, s66, 16384
    ds_read_b128 a[192:195], v20 offset:32768
    v_mfma_f32_16x16x32_bf16 v[96:99], a[160:163], a[136:139], v[96:99]
    buffer_load_dwordx4 v16, s[44:47], s58 offen offset:0 sc1 lds
    v_mfma_f32_16x16x32_bf16 v[96:99], a[176:179], a[152:155], v[96:99]
    ds_read_b128 a[208:211], v20 offset:36864
    v_mfma_f32_16x16x32_bf16 v[112:115], a[176:179], a[156:159], v[112:115]
    ds_read_b128 a[196:199], v20 offset:33792
    v_mfma_f32_16x16x32_bf16 v[112:115], a[160:163], a[140:143], v[112:115]
    ds_read_b128 a[212:215], v20 offset:37888
    v_mfma_f32_16x16x32_bf16 v[116:119], a[164:167], a[140:143], v[116:119]
    buffer_load_dwordx4 v17, s[44:47], s58 offen offset:1024 sc1 lds
    v_mfma_f32_16x16x32_bf16 v[116:119], a[180:183], a[156:159], v[116:119]
    ds_read_b128 a[200:203], v20 offset:34816
    v_mfma_f32_16x16x32_bf16 v[100:103], a[180:183], a[152:155], v[100:103]
    ds_read_b128 a[216:219], v20 offset:38912
    v_mfma_f32_16x16x32_bf16 v[100:103], a[164:167], a[136:139], v[100:103]
    ds_read_b128 a[204:207], v20 offset:35840
    v_mfma_f32_16x16x32_bf16 v[84:87], a[164:167], a[132:135], v[84:87]
    buffer_load_dwordx4 v18, s[44:47], s58 offen offset:2048 sc1 lds
    v_mfma_f32_16x16x32_bf16 v[84:87], a[180:183], a[148:151], v[84:87]
    ds_read_b128 a[220:223], v20 offset:39936
    v_mfma_f32_16x16x32_bf16 v[68:71], a[180:183], a[144:147], v[68:71]
    ds_read_b128 a[228:231], v21 offset:33792
    v_mfma_f32_16x16x32_bf16 v[68:71], a[164:167], a[128:131], v[68:71]
    ds_read_b128 a[244:247], v21 offset:37888
    v_mfma_f32_16x16x32_bf16 v[72:75], a[168:171], a[128:131], v[72:75]
    buffer_load_dwordx4 v19, s[44:47], s58 offen offset:3072 sc1 lds
    v_mfma_f32_16x16x32_bf16 v[72:75], a[184:187], a[144:147], v[72:75]
    ds_read_b128 a[232:235], v21 offset:34816
    v_mfma_f32_16x16x32_bf16 v[88:91], a[184:187], a[148:151], v[88:91]
    s_add_u32 m0, s72, 135168
    ds_read_b128 a[248:251], v21 offset:38912
    v_mfma_f32_16x16x32_bf16 v[88:91], a[168:171], a[132:135], v[88:91]
    s_add_u32 s58, s66, 20480
    ds_read_b128 a[236:239], v21 offset:35840
    v_mfma_f32_16x16x32_bf16 v[104:107], a[168:171], a[136:139], v[104:107]
    buffer_load_dwordx4 v16, s[44:47], s58 offen offset:0 sc1 lds
    v_mfma_f32_16x16x32_bf16 v[104:107], a[184:187], a[152:155], v[104:107]
    s_waitcnt lgkmcnt(11)
    ds_read_b128 a[252:255], v21 offset:39936
    v_mfma_f32_16x16x32_bf16 v[120:123], a[184:187], a[156:159], v[120:123]
    v_mfma_f32_16x16x32_bf16 v[120:123], a[168:171], a[140:143], v[120:123]
    v_mfma_f32_16x16x32_bf16 v[124:127], a[172:175], a[140:143], v[124:127]
    buffer_load_dwordx4 v17, s[44:47], s58 offen offset:1024 sc1 lds
    v_mfma_f32_16x16x32_bf16 v[124:127], a[188:191], a[156:159], v[124:127]
    v_mfma_f32_16x16x32_bf16 v[108:111], a[188:191], a[152:155], v[108:111]
    v_mfma_f32_16x16x32_bf16 v[108:111], a[172:175], a[136:139], v[108:111]
    buffer_load_dwordx4 v18, s[44:47], s58 offen offset:2048 sc1 lds
    v_mfma_f32_16x16x32_bf16 v[92:95], a[172:175], a[132:135], v[92:95]
    v_mfma_f32_16x16x32_bf16 v[92:95], a[188:191], a[148:151], v[92:95]
    v_mfma_f32_16x16x32_bf16 v[76:79], a[188:191], a[144:147], v[76:79]
    buffer_load_dwordx4 v19, s[44:47], s58 offen offset:3072 sc1 lds
    v_mfma_f32_16x16x32_bf16 v[76:79], a[172:175], a[128:131], v[76:79]
    v_mfma_f32_16x16x32_bf16 v[64:67], a[224:227], a[192:195], v[64:67]
    s_waitcnt vmcnt(8) lgkmcnt(0)
    v_mfma_f32_16x16x32_bf16 v[64:67], a[240:243], a[208:211], v[64:67]
    s_barrier
    ds_read_b128 a[160:163], v23 offset:0
    v_mfma_f32_16x16x32_bf16 v[80:83], a[240:243], a[212:215], v[80:83]
    s_add_u32 m0, s72, 32768
    ds_read_b128 a[176:179], v23 offset:4096
    v_mfma_f32_16x16x32_bf16 v[80:83], a[224:227], a[196:199], v[80:83]
    s_add_u32 s58, s66, 24576
    ds_read_b128 a[128:131], v22 offset:0
    v_mfma_f32_16x16x32_bf16 v[96:99], a[224:227], a[200:203], v[96:99]
    buffer_load_dwordx4 v16, s[44:47], s58 offen offset:0 sc1 lds
    v_mfma_f32_16x16x32_bf16 v[96:99], a[240:243], a[216:219], v[96:99]
    ds_read_b128 a[144:147], v22 offset:4096
    v_mfma_f32_16x16x32_bf16 v[112:115], a[240:243], a[220:223], v[112:115]
    ds_read_b128 a[132:135], v22 offset:1024
    v_mfma_f32_16x16x32_bf16 v[112:115], a[224:227], a[204:207], v[112:115]
    ds_read_b128 a[148:151], v22 offset:5120
    v_mfma_f32_16x16x32_bf16 v[116:119], a[228:231], a[204:207], v[116:119]
    buffer_load_dwordx4 v17, s[44:47], s58 offen offset:1024 sc1 lds
    v_mfma_f32_16x16x32_bf16 v[116:119], a[244:247], a[220:223], v[116:119]
    ds_read_b128 a[136:139], v22 offset:2048
    v_mfma_f32_16x16x32_bf16 v[100:103], a[244:247], a[216:219], v[100:103]
    ds_read_b128 a[152:155], v22 offset:6144
    v_mfma_f32_16x16x32_bf16 v[100:103], a[228:231], a[200:203], v[100:103]
    ds_read_b128 a[140:143], v22 offset:3072
    v_mfma_f32_16x16x32_bf16 v[84:87], a[228:231], a[196:199], v[84:87]
    buffer_load_dwordx4 v18, s[44:47], s58 offen offset:2048 sc1 lds
    v_mfma_f32_16x16x32_bf16 v[84:87], a[244:247], a[212:215], v[84:87]
    ds_read_b128 a[156:159], v22 offset:7168
    v_mfma_f32_16x16x32_bf16 v[68:71], a[244:247], a[208:211], v[68:71]
    ds_read_b128 a[164:167], v23 offset:1024
    v_mfma_f32_16x16x32_bf16 v[68:71], a[228:231], a[192:195], v[68:71]
    ds_read_b128 a[180:183], v23 offset:5120
    v_mfma_f32_16x16x32_bf16 v[72:75], a[232:235], a[192:195], v[72:75]
    buffer_load_dwordx4 v19, s[44:47], s58 offen offset:3072 sc1 lds
    v_mfma_f32_16x16x32_bf16 v[72:75], a[248:251], a[208:211], v[72:75]
    ds_read_b128 a[168:171], v23 offset:2048
    v_mfma_f32_16x16x32_bf16 v[88:91], a[248:251], a[212:215], v[88:91]
    s_add_u32 m0, s72, 36864
    ds_read_b128 a[184:187], v23 offset:6144
    v_mfma_f32_16x16x32_bf16 v[88:91], a[232:235], a[196:199], v[88:91]
    s_add_u32 s58, s66, 28672
    ds_read_b128 a[172:175], v23 offset:3072
    v_mfma_f32_16x16x32_bf16 v[104:107], a[232:235], a[200:203], v[104:107]
    buffer_load_dwordx4 v16, s[44:47], s58 offen offset:0 sc1 lds
    v_mfma_f32_16x16x32_bf16 v[104:107], a[248:251], a[216:219], v[104:107]
    s_waitcnt lgkmcnt(11)
    ds_read_b128 a[188:191], v23 offset:7168
    v_mfma_f32_16x16x32_bf16 v[120:123], a[248:251], a[220:223], v[120:123]
    v_mfma_f32_16x16x32_bf16 v[120:123], a[232:235], a[204:207], v[120:123]
    v_mfma_f32_16x16x32_bf16 v[124:127], a[236:239], a[204:207], v[124:127]
    buffer_load_dwordx4 v17, s[44:47], s58 offen offset:1024 sc1 lds
    v_mfma_f32_16x16x32_bf16 v[124:127], a[252:255], a[220:223], v[124:127]
    v_mfma_f32_16x16x32_bf16 v[108:111], a[252:255], a[216:219], v[108:111]
    v_mfma_f32_16x16x32_bf16 v[108:111], a[236:239], a[200:203], v[108:111]
    buffer_load_dwordx4 v18, s[44:47], s58 offen offset:2048 sc1 lds
    v_mfma_f32_16x16x32_bf16 v[92:95], a[236:239], a[196:199], v[92:95]
    v_mfma_f32_16x16x32_bf16 v[92:95], a[252:255], a[212:215], v[92:95]
    v_mfma_f32_16x16x32_bf16 v[76:79], a[252:255], a[208:211], v[76:79]
    buffer_load_dwordx4 v19, s[44:47], s58 offen offset:3072 sc1 lds
    v_mfma_f32_16x16x32_bf16 v[76:79], a[236:239], a[192:195], v[76:79]
    v_mfma_f32_16x16x32_bf16 v[64:67], a[160:163], a[128:131], v[64:67]
    s_waitcnt vmcnt(8) lgkmcnt(0)
    v_mfma_f32_16x16x32_bf16 v[64:67], a[176:179], a[144:147], v[64:67]
    s_barrier
    ds_read_b128 a[224:227], v23 offset:32768
    v_mfma_f32_16x16x32_bf16 v[80:83], a[176:179], a[148:151], v[80:83]
    s_add_u32 m0, s72, 65536
    ds_read_b128 a[240:243], v23 offset:36864
    v_mfma_f32_16x16x32_bf16 v[80:83], a[160:163], a[132:135], v[80:83]
    s_add_u32 s58, s66, 32768
    ds_read_b128 a[192:195], v22 offset:32768
    v_mfma_f32_16x16x32_bf16 v[96:99], a[160:163], a[136:139], v[96:99]
    buffer_load_dwordx4 v16, s[44:47], s58 offen offset:0 sc1 lds
    v_mfma_f32_16x16x32_bf16 v[96:99], a[176:179], a[152:155], v[96:99]
    ds_read_b128 a[208:211], v22 offset:36864
    v_mfma_f32_16x16x32_bf16 v[112:115], a[176:179], a[156:159], v[112:115]
    ds_read_b128 a[196:199], v22 offset:33792
    v_mfma_f32_16x16x32_bf16 v[112:115], a[160:163], a[140:143], v[112:115]
    ds_read_b128 a[212:215], v22 offset:37888
    v_mfma_f32_16x16x32_bf16 v[116:119], a[164:167], a[140:143], v[116:119]
    buffer_load_dwordx4 v17, s[44:47], s58 offen offset:1024 sc1 lds
    v_mfma_f32_16x16x32_bf16 v[116:119], a[180:183], a[156:159], v[116:119]
    ds_read_b128 a[200:203], v22 offset:34816
    v_mfma_f32_16x16x32_bf16 v[100:103], a[180:183], a[152:155], v[100:103]
    ds_read_b128 a[216:219], v22 offset:38912
    v_mfma_f32_16x16x32_bf16 v[100:103], a[164:167], a[136:139], v[100:103]
    ds_read_b128 a[204:207], v22 offset:35840
    v_mfma_f32_16x16x32_bf16 v[84:87], a[164:167], a[132:135], v[84:87]
    buffer_load_dwordx4 v18, s[44:47], s58 offen offset:2048 sc1 lds
    v_mfma_f32_16x16x32_bf16 v[84:87], a[180:183], a[148:151], v[84:87]
    ds_read_b128 a[220:223], v22 offset:39936
    v_mfma_f32_16x16x32_bf16 v[68:71], a[180:183], a[144:147], v[68:71]
    ds_read_b128 a[228:231], v23 offset:33792
    v_mfma_f32_16x16x32_bf16 v[68:71], a[164:167], a[128:131], v[68:71]
    ds_read_b128 a[244:247], v23 offset:37888
    v_mfma_f32_16x16x32_bf16 v[72:75], a[168:171], a[128:131], v[72:75]
    buffer_load_dwordx4 v19, s[44:47], s58 offen offset:3072 sc1 lds
    v_mfma_f32_16x16x32_bf16 v[72:75], a[184:187], a[144:147], v[72:75]
    ds_read_b128 a[232:235], v23 offset:34816
    v_mfma_f32_16x16x32_bf16 v[88:91], a[184:187], a[148:151], v[88:91]
    s_add_u32 m0, s72, 69632
    ds_read_b128 a[248:251], v23 offset:38912
    v_mfma_f32_16x16x32_bf16 v[88:91], a[168:171], a[132:135], v[88:91]
    s_add_u32 s58, s66, 36864
    ds_read_b128 a[236:239], v23 offset:35840
    v_mfma_f32_16x16x32_bf16 v[104:107], a[168:171], a[136:139], v[104:107]
    buffer_load_dwordx4 v16, s[44:47], s58 offen offset:0 sc1 lds
    v_mfma_f32_16x16x32_bf16 v[104:107], a[184:187], a[152:155], v[104:107]
    s_waitcnt lgkmcnt(11)
    ds_read_b128 a[252:255], v23 offset:39936
    v_mfma_f32_16x16x32_bf16 v[120:123], a[184:187], a[156:159], v[120:123]
    v_mfma_f32_16x16x32_bf16 v[120:123], a[168:171], a[140:143], v[120:123]
    v_mfma_f32_16x16x32_bf16 v[124:127], a[172:175], a[140:143], v[124:127]
    buffer_load_dwordx4 v17, s[44:47], s58 offen offset:1024 sc1 lds
    v_mfma_f32_16x16x32_bf16 v[124:127], a[188:191], a[156:159], v[124:127]
    v_mfma_f32_16x16x32_bf16 v[108:111], a[188:191], a[152:155], v[108:111]
    v_mfma_f32_16x16x32_bf16 v[108:111], a[172:175], a[136:139], v[108:111]
    buffer_load_dwordx4 v18, s[44:47], s58 offen offset:2048 sc1 lds
    v_mfma_f32_16x16x32_bf16 v[92:95], a[172:175], a[132:135], v[92:95]
    v_mfma_f32_16x16x32_bf16 v[92:95], a[188:191], a[148:151], v[92:95]
    v_mfma_f32_16x16x32_bf16 v[76:79], a[188:191], a[144:147], v[76:79]
    buffer_load_dwordx4 v19, s[44:47], s58 offen offset:3072 sc1 lds
    v_mfma_f32_16x16x32_bf16 v[76:79], a[172:175], a[128:131], v[76:79]
    v_mfma_f32_16x16x32_bf16 v[64:67], a[224:227], a[192:195], v[64:67]
    s_waitcnt vmcnt(8) lgkmcnt(0)
    v_mfma_f32_16x16x32_bf16 v[64:67], a[240:243], a[208:211], v[64:67]
    s_barrier
    ds_read_b128 a[160:163], v21 offset:0
    v_mfma_f32_16x16x32_bf16 v[80:83], a[240:243], a[212:215], v[80:83]
    s_add_u32 m0, s72, 98304
    ds_read_b128 a[176:179], v21 offset:4096
    v_mfma_f32_16x16x32_bf16 v[80:83], a[224:227], a[196:199], v[80:83]
    s_add_u32 s58, s66, 40960
    ds_read_b128 a[128:131], v20 offset:0
    v_mfma_f32_16x16x32_bf16 v[96:99], a[224:227], a[200:203], v[96:99]
    buffer_load_dwordx4 v16, s[44:47], s58 offen offset:0 sc1 lds
    v_mfma_f32_16x16x32_bf16 v[96:99], a[240:243], a[216:219], v[96:99]
    ds_read_b128 a[144:147], v20 offset:4096
    v_mfma_f32_16x16x32_bf16 v[112:115], a[240:243], a[220:223], v[112:115]
    ds_read_b128 a[132:135], v20 offset:1024
    v_mfma_f32_16x16x32_bf16 v[112:115], a[224:227], a[204:207], v[112:115]
    ds_read_b128 a[148:151], v20 offset:5120
    v_mfma_f32_16x16x32_bf16 v[116:119], a[228:231], a[204:207], v[116:119]
    buffer_load_dwordx4 v17, s[44:47], s58 offen offset:1024 sc1 lds
    v_mfma_f32_16x16x32_bf16 v[116:119], a[244:247], a[220:223], v[116:119]
    ds_read_b128 a[136:139], v20 offset:2048
    v_mfma_f32_16x16x32_bf16 v[100:103], a[244:247], a[216:219], v[100:103]
    ds_read_b128 a[152:155], v20 offset:6144
    v_mfma_f32_16x16x32_bf16 v[100:103], a[228:231], a[200:203], v[100:103]
    ds_read_b128 a[140:143], v20 offset:3072
    v_mfma_f32_16x16x32_bf16 v[84:87], a[228:231], a[196:199], v[84:87]
    buffer_load_dwordx4 v18, s[44:47], s58 offen offset:2048 sc1 lds
    v_mfma_f32_16x16x32_bf16 v[84:87], a[244:247], a[212:215], v[84:87]
    ds_read_b128 a[156:159], v20 offset:7168
    v_mfma_f32_16x16x32_bf16 v[68:71], a[244:247], a[208:211], v[68:71]
    ds_read_b128 a[164:167], v21 offset:1024
    v_mfma_f32_16x16x32_bf16 v[68:71], a[228:231], a[192:195], v[68:71]
    ds_read_b128 a[180:183], v21 offset:5120
    v_mfma_f32_16x16x32_bf16 v[72:75], a[232:235], a[192:195], v[72:75]
    buffer_load_dwordx4 v19, s[44:47], s58 offen offset:3072 sc1 lds
    v_mfma_f32_16x16x32_bf16 v[72:75], a[248:251], a[208:211], v[72:75]
    ds_read_b128 a[168:171], v21 offset:2048
    v_mfma_f32_16x16x32_bf16 v[88:91], a[248:251], a[212:215], v[88:91]
    s_add_u32 m0, s72, 102400
    ds_read_b128 a[184:187], v21 offset:6144
    v_mfma_f32_16x16x32_bf16 v[88:91], a[232:235], a[196:199], v[88:91]
    s_add_u32 s58, s66, 45056
    ds_read_b128 a[172:175], v21 offset:3072
    v_mfma_f32_16x16x32_bf16 v[104:107], a[232:235], a[200:203], v[104:107]
    buffer_load_dwordx4 v16, s[44:47], s58 offen offset:0 sc1 lds
    v_mfma_f32_16x16x32_bf16 v[104:107], a[248:251], a[216:219], v[104:107]
    s_waitcnt lgkmcnt(11)
    ds_read_b128 a[188:191], v21 offset:7168
    v_mfma_f32_16x16x32_bf16 v[120:123], a[248:251], a[220:223], v[120:123]
    v_mfma_f32_16x16x32_bf16 v[120:123], a[232:235], a[204:207], v[120:123]
    v_mfma_f32_16x16x32_bf16 v[124:127], a[236:239], a[204:207], v[124:127]
    buffer_load_dwordx4 v17, s[44:47], s58 offen offset:1024 sc1 lds
    v_mfma_f32_16x16x32_bf16 v[124:127], a[252:255], a[220:223], v[124:127]
    v_mfma_f32_16x16x32_bf16 v[108:111], a[252:255], a[216:219], v[108:111]
    v_mfma_f32_16x16x32_bf16 v[108:111], a[236:239], a[200:203], v[108:111]
    buffer_load_dwordx4 v18, s[44:47], s58 offen offset:2048 sc1 lds
    v_mfma_f32_16x16x32_bf16 v[92:95], a[236:239], a[196:199], v[92:95]
    v_mfma_f32_16x16x32_bf16 v[92:95], a[252:255], a[212:215], v[92:95]
    v_mfma_f32_16x16x32_bf16 v[76:79], a[252:255], a[208:211], v[76:79]
    buffer_load_dwordx4 v19, s[44:47], s58 offen offset:3072 sc1 lds
    v_mfma_f32_16x16x32_bf16 v[76:79], a[236:239], a[192:195], v[76:79]
    v_mfma_f32_16x16x32_bf16 v[64:67], a[160:163], a[128:131], v[64:67]
    s_waitcnt vmcnt(8) lgkmcnt(0)
    v_and_b32 v10, 15, v0
    v_and_b32 v11, 48, v0
    v_mfma_f32_16x16x32_bf16 v[64:67], a[176:179], a[144:147], v[64:67]
    s_barrier
    ds_read_b128 a[224:227], v21 offset:32768
    v_lshl_add_u32 v9, v10, 10, v11
    v_mfma_f32_16x16x32_bf16 v[80:83], a[176:179], a[148:151], v[80:83]
    s_add_u32 m0, s72, 131072
    ds_read_b128 a[240:243], v21 offset:36864
    v_accvgpr_read_b32 v24, a120
    v_mfma_f32_16x16x32_bf16 v[80:83], a[160:163], a[132:135], v[80:83]
    s_add_u32 s58, s66, 49152
    ds_read_b128 a[192:195], v20 offset:32768
    v_accvgpr_read_b32 v25, a121
    v_mfma_f32_16x16x32_bf16 v[96:99], a[160:163], a[136:139], v[96:99]
    buffer_load_dwordx4 v16, s[44:47], s58 offen offset:0 sc1 lds
    v_accvgpr_read_b32 v26, a122
    v_mfma_f32_16x16x32_bf16 v[96:99], a[176:179], a[152:155], v[96:99]
    ds_read_b128 a[208:211], v20 offset:36864
    v_accvgpr_read_b32 v27, a123
    v_mfma_f32_16x16x32_bf16 v[112:115], a[176:179], a[156:159], v[112:115]
    ds_read_b128 a[196:199], v20 offset:33792
    v_accvgpr_read_b32 v28, a124
    v_mfma_f32_16x16x32_bf16 v[112:115], a[160:163], a[140:143], v[112:115]
    ds_read_b128 a[212:215], v20 offset:37888
    v_accvgpr_read_b32 v29, a125
    v_mfma_f32_16x16x32_bf16 v[116:119], a[164:167], a[140:143], v[116:119]
    buffer_load_dwordx4 v17, s[44:47], s58 offen offset:1024 sc1 lds
    v_accvgpr_read_b32 v30, a126
    v_mfma_f32_16x16x32_bf16 v[116:119], a[180:183], a[156:159], v[116:119]
    ds_read_b128 a[200:203], v20 offset:34816
    v_accvgpr_read_b32 v31, a127
    v_mfma_f32_16x16x32_bf16 v[100:103], a[180:183], a[152:155], v[100:103]
    ds_read_b128 a[216:219], v20 offset:38912
    v_mfma_f32_16x16x32_bf16 v[100:103], a[164:167], a[136:139], v[100:103]
    ds_read_b128 a[204:207], v20 offset:35840
    v_mfma_f32_16x16x32_bf16 v[84:87], a[164:167], a[132:135], v[84:87]
    buffer_load_dwordx4 v18, s[44:47], s58 offen offset:2048 sc1 lds
    v_mfma_f32_16x16x32_bf16 v[84:87], a[180:183], a[148:151], v[84:87]
    ds_read_b128 a[220:223], v20 offset:39936
    v_mfma_f32_16x16x32_bf16 v[68:71], a[180:183], a[144:147], v[68:71]
    ds_read_b128 a[228:231], v21 offset:33792
    v_mfma_f32_16x16x32_bf16 v[68:71], a[164:167], a[128:131], v[68:71]
    ds_read_b128 a[244:247], v21 offset:37888
    v_mfma_f32_16x16x32_bf16 v[72:75], a[168:171], a[128:131], v[72:75]
    buffer_load_dwordx4 v19, s[44:47], s58 offen offset:3072 sc1 lds
    v_mfma_f32_16x16x32_bf16 v[72:75], a[184:187], a[144:147], v[72:75]
    ds_read_b128 a[232:235], v21 offset:34816
    v_mfma_f32_16x16x32_bf16 v[88:91], a[184:187], a[148:151], v[88:91]
    s_add_u32 m0, s72, 135168
    ds_read_b128 a[248:251], v21 offset:38912
    v_mfma_f32_16x16x32_bf16 v[88:91], a[168:171], a[132:135], v[88:91]
    s_add_u32 s58, s66, 53248
    ds_read_b128 a[236:239], v21 offset:35840
    v_mfma_f32_16x16x32_bf16 v[104:107], a[168:171], a[136:139], v[104:107]
    buffer_load_dwordx4 v16, s[44:47], s58 offen offset:0 sc1 lds
    v_mfma_f32_16x16x32_bf16 v[104:107], a[184:187], a[152:155], v[104:107]
    s_waitcnt lgkmcnt(11)
    ds_read_b128 a[252:255], v21 offset:39936
    v_mfma_f32_16x16x32_bf16 v[120:123], a[184:187], a[156:159], v[120:123]
    v_mfma_f32_16x16x32_bf16 v[120:123], a[168:171], a[140:143], v[120:123]
    v_mfma_f32_16x16x32_bf16 v[124:127], a[172:175], a[140:143], v[124:127]
    buffer_load_dwordx4 v17, s[44:47], s58 offen offset:1024 sc1 lds
    v_mfma_f32_16x16x32_bf16 v[124:127], a[188:191], a[156:159], v[124:127]
    v_mfma_f32_16x16x32_bf16 v[108:111], a[188:191], a[152:155], v[108:111]
    v_mfma_f32_16x16x32_bf16 v[108:111], a[172:175], a[136:139], v[108:111]
    buffer_load_dwordx4 v18, s[44:47], s58 offen offset:2048 sc1 lds
    v_mfma_f32_16x16x32_bf16 v[92:95], a[172:175], a[132:135], v[92:95]
    v_mfma_f32_16x16x32_bf16 v[92:95], a[188:191], a[148:151], v[92:95]
    v_mfma_f32_16x16x32_bf16 v[76:79], a[188:191], a[144:147], v[76:79]
    buffer_load_dwordx4 v19, s[44:47], s58 offen offset:3072 sc1 lds
    v_mfma_f32_16x16x32_bf16 v[76:79], a[172:175], a[128:131], v[76:79]
    v_mfma_f32_16x16x32_bf16 v[64:67], a[224:227], a[192:195], v[64:67]
    s_waitcnt vmcnt(8) lgkmcnt(0)
    v_mfma_f32_16x16x32_bf16 v[64:67], a[240:243], a[208:211], v[64:67]
K_PG12:
    s_cmp_eq_u32 s100, 1
    s_cbranch_scc1 K_MAIN
    s_barrier
    ds_read_b128 a[160:163], v23 offset:0
    v_mfma_f32_16x16x32_bf16 v[80:83], a[240:243], a[212:215], v[80:83]
    s_add_u32 m0, s72, 32768
    ds_read_b128 a[176:179], v23 offset:4096
    v_mfma_f32_16x16x32_bf16 v[80:83], a[224:227], a[196:199], v[80:83]
    s_add_u32 s58, s66, 57344
    ds_read_b128 a[128:131], v22 offset:0
    v_mfma_f32_16x16x32_bf16 v[96:99], a[224:227], a[200:203], v[96:99]
    buffer_load_dwordx4 v16, s[44:47], s58 offen offset:0 sc1 lds
    v_mfma_f32_16x16x32_bf16 v[96:99], a[240:243], a[216:219], v[96:99]
    ds_read_b128 a[144:147], v22 offset:4096
    v_mfma_f32_16x16x32_bf16 v[112:115], a[240:243], a[220:223], v[112:115]
    ds_read_b128 a[132:135], v22 offset:1024
    v_mfma_f32_16x16x32_bf16 v[112:115], a[224:227], a[204:207], v[112:115]
    ds_read_b128 a[148:151], v22 offset:5120
    v_mfma_f32_16x16x32_bf16 v[116:119], a[228:231], a[204:207], v[116:119]
    buffer_load_dwordx4 v17, s[44:47], s58 offen offset:1024 sc1 lds
    v_mfma_f32_16x16x32_bf16 v[116:119], a[244:247], a[220:223], v[116:119]
    ds_read_b128 a[136:139], v22 offset:2048
    v_mfma_f32_16x16x32_bf16 v[100:103], a[244:247], a[216:219], v[100:103]
    ds_read_b128 a[152:155], v22 offset:6144
    v_mfma_f32_16x16x32_bf16 v[100:103], a[228:231], a[200:203], v[100:103]
    ds_read_b128 a[140:143], v22 offset:3072
    v_mfma_f32_16x16x32_bf16 v[84:87], a[228:231], a[196:199], v[84:87]
    buffer_load_dwordx4 v18, s[44:47], s58 offen offset:2048 sc1 lds
    v_mfma_f32_16x16x32_bf16 v[84:87], a[244:247], a[212:215], v[84:87]
    ds_read_b128 a[156:159], v22 offset:7168
    v_mfma_f32_16x16x32_bf16 v[68:71], a[244:247], a[208:211], v[68:71]
    ds_read_b128 a[164:167], v23 offset:1024
    v_mfma_f32_16x16x32_bf16 v[68:71], a[228:231], a[192:195], v[68:71]
    ds_read_b128 a[180:183], v23 offset:5120
    v_mfma_f32_16x16x32_bf16 v[72:75], a[232:235], a[192:195], v[72:75]
    buffer_load_dwordx4 v19, s[44:47], s58 offen offset:3072 sc1 lds
    v_mfma_f32_16x16x32_bf16 v[72:75], a[248:251], a[208:211], v[72:75]
    ds_read_b128 a[168:171], v23 offset:2048
    v_mfma_f32_16x16x32_bf16 v[88:91], a[248:251], a[212:215], v[88:91]
    s_add_u32 m0, s72, 36864
    ds_read_b128 a[184:187], v23 offset:6144
    v_mfma_f32_16x16x32_bf16 v[88:91], a[232:235], a[196:199], v[88:91]
    s_add_u32 s58, s66, 61440
    ds_read_b128 a[172:175], v23 offset:3072
    v_mfma_f32_16x16x32_bf16 v[104:107], a[232:235], a[200:203], v[104:107]
    buffer_load_dwordx4 v16, s[44:47], s58 offen offset:0 sc1 lds
    v_mfma_f32_16x16x32_bf16 v[104:107], a[248:251], a[216:219], v[104:107]
    s_waitcnt lgkmcnt(11)
    ds_read_b128 a[188:191], v23 offset:7168
    v_mfma_f32_16x16x32_bf16 v[120:123], a[248:251], a[220:223], v[120:123]
    v_mfma_f32_16x16x32_bf16 v[120:123], a[232:235], a[204:207], v[120:123]
    v_mfma_f32_16x16x32_bf16 v[124:127], a[236:239], a[204:207], v[124:127]
    buffer_load_dwordx4 v17, s[44:47], s58 offen offset:1024 sc1 lds
    v_mfma_f32_16x16x32_bf16 v[124:127], a[252:255], a[220:223], v[124:127]
    v_mfma_f32_16x16x32_bf16 v[108:111], a[252:255], a[216:219], v[108:111]
    v_mfma_f32_16x16x32_bf16 v[108:111], a[236:239], a[200:203], v[108:111]
    buffer_load_dwordx4 v18, s[44:47], s58 offen offset:2048 sc1 lds
    v_mfma_f32_16x16x32_bf16 v[92:95], a[236:239], a[196:199], v[92:95]
    v_mfma_f32_16x16x32_bf16 v[92:95], a[252:255], a[212:215], v[92:95]
    v_mfma_f32_16x16x32_bf16 v[76:79], a[252:255], a[208:211], v[76:79]
    buffer_load_dwordx4 v19, s[44:47], s58 offen offset:3072 sc1 lds
    v_mfma_f32_16x16x32_bf16 v[76:79], a[236:239], a[192:195], v[76:79]
    v_mfma_f32_16x16x32_bf16 v[64:67], a[160:163], a[128:131], v[64:67]
    s_waitcnt vmcnt(8) lgkmcnt(0)
    v_lshlrev_b32 v32, 16, v24
    v_and_b32 v33, 0xffff0000, v24
    v_mfma_f32_16x16x32_bf16 v[64:67], a[176:179], a[144:147], v[64:67]
    s_barrier
    ds_read_b128 a[224:227], v23 offset:32768
    v_lshlrev_b32 v34, 16, v25
    v_mfma_f32_16x16x32_bf16 v[80:83], a[176:179], a[148:151], v[80:83]
    s_add_u32 m0, s72, 65536
    ds_read_b128 a[240:243], v23 offset:36864
    v_and_b32 v35, 0xffff0000, v25
    v_mfma_f32_16x16x32_bf16 v[80:83], a[160:163], a[132:135], v[80:83]
    s_add_u32 s58, s66, 65536
    ds_read_b128 a[192:195], v22 offset:32768
    v_lshlrev_b32 v36, 16, v26
    v_mfma_f32_16x16x32_bf16 v[96:99], a[160:163], a[136:139], v[96:99]
    buffer_load_dwordx4 v16, s[44:47], s58 offen offset:0 sc1 lds
    v_and_b32 v37, 0xffff0000, v26
    v_mfma_f32_16x16x32_bf16 v[96:99], a[176:179], a[152:155], v[96:99]
    ds_read_b128 a[208:211], v22 offset:36864
    v_lshlrev_b32 v38, 16, v27
    v_mfma_f32_16x16x32_bf16 v[112:115], a[176:179], a[156:159], v[112:115]
    ds_read_b128 a[196:199], v22 offset:33792
    v_and_b32 v39, 0xffff0000, v27
    v_mfma_f32_16x16x32_bf16 v[112:115], a[160:163], a[140:143], v[112:115]
    ds_read_b128 a[212:215], v22 offset:37888
    v_lshlrev_b32 v40, 16, v28
    v_mfma_f32_16x16x32_bf16 v[116:119], a[164:167], a[140:143], v[116:119]
    buffer_load_dwordx4 v17, s[44:47], s58 offen offset:1024 sc1 lds
    v_and_b32 v41, 0xffff0000, v28
    v_mfma_f32_16x16x32_bf16 v[116:119], a[180:183], a[156:159], v[116:119]
    ds_read_b128 a[200:203], v22 offset:34816
    v_lshlrev_b32 v42, 16, v29
    v_mfma_f32_16x16x32_bf16 v[100:103], a[180:183], a[152:155], v[100:103]
    ds_read_b128 a[216:219], v22 offset:38912
    v_and_b32 v43, 0xffff0000, v29
    v_mfma_f32_16x16x32_bf16 v[100:103], a[164:167], a[136:139], v[100:103]
    ds_read_b128 a[204:207], v22 offset:35840
    v_lshlrev_b32 v44, 16, v30
    v_mfma_f32_16x16x32_bf16 v[84:87], a[164:167], a[132:135], v[84:87]
    buffer_load_dwordx4 v18, s[44:47], s58 offen offset:2048 sc1 lds
    v_and_b32 v45, 0xffff0000, v30
    v_mfma_f32_16x16x32_bf16 v[84:87], a[180:183], a[148:151], v[84:87]
    ds_read_b128 a[220:223], v22 offset:39936
    v_lshlrev_b32 v46, 16, v31
    v_mfma_f32_16x16x32_bf16 v[68:71], a[180:183], a[144:147], v[68:71]
    ds_read_b128 a[228:231], v23 offset:33792
    v_and_b32 v47, 0xffff0000, v31
    v_mfma_f32_16x16x32_bf16 v[68:71], a[164:167], a[128:131], v[68:71]
    ds_read_b128 a[244:247], v23 offset:37888
    v_mfma_f32_16x16x32_bf16 v[72:75], a[168:171], a[128:131], v[72:75]
    buffer_load_dwordx4 v19, s[44:47], s58 offen offset:3072 sc1 lds
    v_mfma_f32_16x16x32_bf16 v[72:75], a[184:187], a[144:147], v[72:75]
    ds_read_b128 a[232:235], v23 offset:34816
    v_mfma_f32_16x16x32_bf16 v[88:91], a[184:187], a[148:151], v[88:91]
    s_add_u32 m0, s72, 69632
    ds_read_b128 a[248:251], v23 offset:38912
    v_mfma_f32_16x16x32_bf16 v[88:91], a[168:171], a[132:135], v[88:91]
    s_add_u32 s58, s66, 69632
    ds_read_b128 a[236:239], v23 offset:35840
    v_mfma_f32_16x16x32_bf16 v[104:107], a[168:171], a[136:139], v[104:107]
    buffer_load_dwordx4 v16, s[44:47], s58 offen offset:0 sc1 lds
    v_mfma_f32_16x16x32_bf16 v[104:107], a[184:187], a[152:155], v[104:107]
    s_waitcnt lgkmcnt(11)
    ds_read_b128 a[252:255], v23 offset:39936
    v_mfma_f32_16x16x32_bf16 v[120:123], a[184:187], a[156:159], v[120:123]
    v_mfma_f32_16x16x32_bf16 v[120:123], a[168:171], a[140:143], v[120:123]
    v_mfma_f32_16x16x32_bf16 v[124:127], a[172:175], a[140:143], v[124:127]
    buffer_load_dwordx4 v17, s[44:47], s58 offen offset:1024 sc1 lds
    v_mfma_f32_16x16x32_bf16 v[124:127], a[188:191], a[156:159], v[124:127]
    v_mfma_f32_16x16x32_bf16 v[108:111], a[188:191], a[152:155], v[108:111]
    v_mfma_f32_16x16x32_bf16 v[108:111], a[172:175], a[136:139], v[108:111]
    buffer_load_dwordx4 v18, s[44:47], s58 offen offset:2048 sc1 lds
    v_mfma_f32_16x16x32_bf16 v[92:95], a[172:175], a[132:135], v[92:95]
    v_mfma_f32_16x16x32_bf16 v[92:95], a[188:191], a[148:151], v[92:95]
    v_mfma_f32_16x16x32_bf16 v[76:79], a[188:191], a[144:147], v[76:79]
    buffer_load_dwordx4 v19, s[44:47], s58 offen offset:3072 sc1 lds
    v_mfma_f32_16x16x32_bf16 v[76:79], a[172:175], a[128:131], v[76:79]
    v_mfma_f32_16x16x32_bf16 v[64:67], a[224:227], a[192:195], v[64:67]
    s_waitcnt vmcnt(8) lgkmcnt(0)
    v_mfma_f32_16x16x32_bf16 v[64:67], a[240:243], a[208:211], v[64:67]
    s_barrier
    ds_read_b128 a[160:163], v21 offset:0
    v_mfma_f32_16x16x32_bf16 v[80:83], a[240:243], a[212:215], v[80:83]
    s_add_u32 m0, s72, 98304
    ds_read_b128 a[176:179], v21 offset:4096
    v_mfma_f32_16x16x32_bf16 v[80:83], a[224:227], a[196:199], v[80:83]
    s_add_u32 s58, s66, 73728
    ds_read_b128 a[128:131], v20 offset:0
    v_mfma_f32_16x16x32_bf16 v[96:99], a[224:227], a[200:203], v[96:99]
    buffer_load_dwordx4 v16, s[44:47], s58 offen offset:0 sc1 lds
    v_mfma_f32_16x16x32_bf16 v[96:99], a[240:243], a[216:219], v[96:99]
    ds_read_b128 a[144:147], v20 offset:4096
    v_mfma_f32_16x16x32_bf16 v[112:115], a[240:243], a[220:223], v[112:115]
    ds_read_b128 a[132:135], v20 offset:1024
    v_mfma_f32_16x16x32_bf16 v[112:115], a[224:227], a[204:207], v[112:115]
    ds_read_b128 a[148:151], v20 offset:5120
    v_mfma_f32_16x16x32_bf16 v[116:119], a[228:231], a[204:207], v[116:119]
    buffer_load_dwordx4 v17, s[44:47], s58 offen offset:1024 sc1 lds
    v_mfma_f32_16x16x32_bf16 v[116:119], a[244:247], a[220:223], v[116:119]
    ds_read_b128 a[136:139], v20 offset:2048
    v_mfma_f32_16x16x32_bf16 v[100:103], a[244:247], a[216:219], v[100:103]
    ds_read_b128 a[152:155], v20 offset:6144
    v_mfma_f32_16x16x32_bf16 v[100:103], a[228:231], a[200:203], v[100:103]
    ds_read_b128 a[140:143], v20 offset:3072
    v_mfma_f32_16x16x32_bf16 v[84:87], a[228:231], a[196:199], v[84:87]
    buffer_load_dwordx4 v18, s[44:47], s58 offen offset:2048 sc1 lds
    v_mfma_f32_16x16x32_bf16 v[84:87], a[244:247], a[212:215], v[84:87]
    ds_read_b128 a[156:159], v20 offset:7168
    v_mfma_f32_16x16x32_bf16 v[68:71], a[244:247], a[208:211], v[68:71]
    ds_read_b128 a[164:167], v21 offset:1024
    v_mfma_f32_16x16x32_bf16 v[68:71], a[228:231], a[192:195], v[68:71]
    ds_read_b128 a[180:183], v21 offset:5120
    v_mfma_f32_16x16x32_bf16 v[72:75], a[232:235], a[192:195], v[72:75]
    buffer_load_dwordx4 v19, s[44:47], s58 offen offset:3072 sc1 lds
    v_mfma_f32_16x16x32_bf16 v[72:75], a[248:251], a[208:211], v[72:75]
    ds_read_b128 a[168:171], v21 offset:2048
    v_mfma_f32_16x16x32_bf16 v[88:91], a[248:251], a[212:215], v[88:91]
    s_add_u32 m0, s72, 102400
    ds_read_b128 a[184:187], v21 offset:6144
    v_mfma_f32_16x16x32_bf16 v[88:91], a[232:235], a[196:199], v[88:91]
    s_add_u32 s58, s66, 77824
    ds_read_b128 a[172:175], v21 offset:3072
    v_mfma_f32_16x16x32_bf16 v[104:107], a[232:235], a[200:203], v[104:107]
    buffer_load_dwordx4 v16, s[44:47], s58 offen offset:0 sc1 lds
    v_mfma_f32_16x16x32_bf16 v[104:107], a[248:251], a[216:219], v[104:107]
    s_waitcnt lgkmcnt(11)
    ds_read_b128 a[188:191], v21 offset:7168
    v_mfma_f32_16x16x32_bf16 v[120:123], a[248:251], a[220:223], v[120:123]
    v_mfma_f32_16x16x32_bf16 v[120:123], a[232:235], a[204:207], v[120:123]
    v_mfma_f32_16x16x32_bf16 v[124:127], a[236:239], a[204:207], v[124:127]
    buffer_load_dwordx4 v17, s[44:47], s58 offen offset:1024 sc1 lds
    v_mfma_f32_16x16x32_bf16 v[124:127], a[252:255], a[220:223], v[124:127]
    v_mfma_f32_16x16x32_bf16 v[108:111], a[252:255], a[216:219], v[108:111]
    v_mfma_f32_16x16x32_bf16 v[108:111], a[236:239], a[200:203], v[108:111]
    buffer_load_dwordx4 v18, s[44:47], s58 offen offset:2048 sc1 lds
    v_mfma_f32_16x16x32_bf16 v[92:95], a[236:239], a[196:199], v[92:95]
    v_mfma_f32_16x16x32_bf16 v[92:95], a[252:255], a[212:215], v[92:95]
    v_mfma_f32_16x16x32_bf16 v[76:79], a[252:255], a[208:211], v[76:79]
    buffer_load_dwordx4 v19, s[44:47], s58 offen offset:3072 sc1 lds
    v_mfma_f32_16x16x32_bf16 v[76:79], a[236:239], a[192:195], v[76:79]
    v_mfma_f32_16x16x32_bf16 v[64:67], a[160:163], a[128:131], v[64:67]
    s_waitcnt vmcnt(8) lgkmcnt(0)
    v_mfma_f32_16x16x32_bf16 v[64:67], a[176:179], a[144:147], v[64:67]
    s_barrier
    ds_read_b128 a[224:227], v21 offset:32768
    v_mfma_f32_16x16x32_bf16 v[80:83], a[176:179], a[148:151], v[80:83]
    s_add_u32 m0, s72, 131072
    ds_read_b128 a[240:243], v21 offset:36864
    v_mfma_f32_16x16x32_bf16 v[80:83], a[160:163], a[132:135], v[80:83]
    s_add_u32 s58, s66, 81920
    ds_read_b128 a[192:195], v20 offset:32768
    v_mfma_f32_16x16x32_bf16 v[96:99], a[160:163], a[136:139], v[96:99]
    buffer_load_dwordx4 v16, s[44:47], s58 offen offset:0 sc1 lds
    v_mfma_f32_16x16x32_bf16 v[96:99], a[176:179], a[152:155], v[96:99]
    ds_read_b128 a[208:211], v20 offset:36864
    v_mfma_f32_16x16x32_bf16 v[112:115], a[176:179], a[156:159], v[112:115]
    ds_read_b128 a[196:199], v20 offset:33792
    v_mfma_f32_16x16x32_bf16 v[112:115], a[160:163], a[140:143], v[112:115]
    ds_read_b128 a[212:215], v20 offset:37888
    v_mfma_f32_16x16x32_bf16 v[116:119], a[164:167], a[140:143], v[116:119]
    buffer_load_dwordx4 v17, s[44:47], s58 offen offset:1024 sc1 lds
    v_mfma_f32_16x16x32_bf16 v[116:119], a[180:183], a[156:159], v[116:119]
    ds_read_b128 a[200:203], v20 offset:34816
    v_mfma_f32_16x16x32_bf16 v[100:103], a[180:183], a[152:155], v[100:103]
    ds_read_b128 a[216:219], v20 offset:38912
    v_mfma_f32_16x16x32_bf16 v[100:103], a[164:167], a[136:139], v[100:103]
    ds_read_b128 a[204:207], v20 offset:35840
    v_mfma_f32_16x16x32_bf16 v[84:87], a[164:167], a[132:135], v[84:87]
    buffer_load_dwordx4 v18, s[44:47], s58 offen offset:2048 sc1 lds
    v_mfma_f32_16x16x32_bf16 v[84:87], a[180:183], a[148:151], v[84:87]
    ds_read_b128 a[220:223], v20 offset:39936
    v_mfma_f32_16x16x32_bf16 v[68:71], a[180:183], a[144:147], v[68:71]
    ds_read_b128 a[228:231], v21 offset:33792
    v_mfma_f32_16x16x32_bf16 v[68:71], a[164:167], a[128:131], v[68:71]
    ds_read_b128 a[244:247], v21 offset:37888
    v_mfma_f32_16x16x32_bf16 v[72:75], a[168:171], a[128:131], v[72:75]
    buffer_load_dwordx4 v19, s[44:47], s58 offen offset:3072 sc1 lds
    v_mfma_f32_16x16x32_bf16 v[72:75], a[184:187], a[144:147], v[72:75]
    ds_read_b128 a[232:235], v21 offset:34816
    v_mfma_f32_16x16x32_bf16 v[88:91], a[184:187], a[148:151], v[88:91]
    s_add_u32 m0, s72, 135168
    ds_read_b128 a[248:251], v21 offset:38912
    v_mfma_f32_16x16x32_bf16 v[88:91], a[168:171], a[132:135], v[88:91]
    s_add_u32 s58, s66, 86016
    ds_read_b128 a[236:239], v21 offset:35840
    v_mfma_f32_16x16x32_bf16 v[104:107], a[168:171], a[136:139], v[104:107]
    buffer_load_dwordx4 v16, s[44:47], s58 offen offset:0 sc1 lds
    v_mfma_f32_16x16x32_bf16 v[104:107], a[184:187], a[152:155], v[104:107]
    s_waitcnt lgkmcnt(11)
    ds_read_b128 a[252:255], v21 offset:39936
    v_mfma_f32_16x16x32_bf16 v[120:123], a[184:187], a[156:159], v[120:123]
    v_mfma_f32_16x16x32_bf16 v[120:123], a[168:171], a[140:143], v[120:123]
    v_mfma_f32_16x16x32_bf16 v[124:127], a[172:175], a[140:143], v[124:127]
    buffer_load_dwordx4 v17, s[44:47], s58 offen offset:1024 sc1 lds
    v_mfma_f32_16x16x32_bf16 v[124:127], a[188:191], a[156:159], v[124:127]
    v_mfma_f32_16x16x32_bf16 v[108:111], a[188:191], a[152:155], v[108:111]
    v_mfma_f32_16x16x32_bf16 v[108:111], a[172:175], a[136:139], v[108:111]
    buffer_load_dwordx4 v18, s[44:47], s58 offen offset:2048 sc1 lds
    v_mfma_f32_16x16x32_bf16 v[92:95], a[172:175], a[132:135], v[92:95]
    v_mfma_f32_16x16x32_bf16 v[92:95], a[188:191], a[148:151], v[92:95]
    v_mfma_f32_16x16x32_bf16 v[76:79], a[188:191], a[144:147], v[76:79]
    buffer_load_dwordx4 v19, s[44:47], s58 offen offset:3072 sc1 lds
    v_mfma_f32_16x16x32_bf16 v[76:79], a[172:175], a[128:131], v[76:79]
    v_mfma_f32_16x16x32_bf16 v[64:67], a[224:227], a[192:195], v[64:67]
    s_waitcnt vmcnt(8) lgkmcnt(0)
    v_mfma_f32_16x16x32_bf16 v[64:67], a[240:243], a[208:211], v[64:67]
    s_barrier
    ds_read_b128 a[160:163], v23 offset:0
    v_mfma_f32_16x16x32_bf16 v[80:83], a[240:243], a[212:215], v[80:83]
    s_add_u32 m0, s72, 32768
    ds_read_b128 a[176:179], v23 offset:4096
    v_mfma_f32_16x16x32_bf16 v[80:83], a[224:227], a[196:199], v[80:83]
    s_add_u32 s58, s66, 90112
    ds_read_b128 a[128:131], v22 offset:0
    v_mfma_f32_16x16x32_bf16 v[96:99], a[224:227], a[200:203], v[96:99]
    buffer_load_dwordx4 v16, s[44:47], s58 offen offset:0 sc1 lds
    v_mfma_f32_16x16x32_bf16 v[96:99], a[240:243], a[216:219], v[96:99]
    ds_read_b128 a[144:147], v22 offset:4096
    v_mfma_f32_16x16x32_bf16 v[112:115], a[240:243], a[220:223], v[112:115]
    ds_read_b128 a[132:135], v22 offset:1024
    v_mfma_f32_16x16x32_bf16 v[112:115], a[224:227], a[204:207], v[112:115]
    ds_read_b128 a[148:151], v22 offset:5120
    v_mfma_f32_16x16x32_bf16 v[116:119], a[228:231], a[204:207], v[116:119]
    buffer_load_dwordx4 v17, s[44:47], s58 offen offset:1024 sc1 lds
    v_mfma_f32_16x16x32_bf16 v[116:119], a[244:247], a[220:223], v[116:119]
    ds_read_b128 a[136:139], v22 offset:2048
    v_mfma_f32_16x16x32_bf16 v[100:103], a[244:247], a[216:219], v[100:103]
    ds_read_b128 a[152:155], v22 offset:6144
    v_mfma_f32_16x16x32_bf16 v[100:103], a[228:231], a[200:203], v[100:103]
    ds_read_b128 a[140:143], v22 offset:3072
    v_mfma_f32_16x16x32_bf16 v[84:87], a[228:231], a[196:199], v[84:87]
    buffer_load_dwordx4 v18, s[44:47], s58 offen offset:2048 sc1 lds
    v_mfma_f32_16x16x32_bf16 v[84:87], a[244:247], a[212:215], v[84:87]
    ds_read_b128 a[156:159], v22 offset:7168
    v_mfma_f32_16x16x32_bf16 v[68:71], a[244:247], a[208:211], v[68:71]
    ds_read_b128 a[164:167], v23 offset:1024
    v_mfma_f32_16x16x32_bf16 v[68:71], a[228:231], a[192:195], v[68:71]
    ds_read_b128 a[180:183], v23 offset:5120
    v_mfma_f32_16x16x32_bf16 v[72:75], a[232:235], a[192:195], v[72:75]
    buffer_load_dwordx4 v19, s[44:47], s58 offen offset:3072 sc1 lds
    v_mfma_f32_16x16x32_bf16 v[72:75], a[248:251], a[208:211], v[72:75]
    ds_read_b128 a[168:171], v23 offset:2048
    v_mfma_f32_16x16x32_bf16 v[88:91], a[248:251], a[212:215], v[88:91]
    s_add_u32 m0, s72, 36864
    ds_read_b128 a[184:187], v23 offset:6144
    v_mfma_f32_16x16x32_bf16 v[88:91], a[232:235], a[196:199], v[88:91]
    s_add_u32 s58, s66, 94208
    ds_read_b128 a[172:175], v23 offset:3072
    v_mfma_f32_16x16x32_bf16 v[104:107], a[232:235], a[200:203], v[104:107]
    buffer_load_dwordx4 v16, s[44:47], s58 offen offset:0 sc1 lds
    v_mfma_f32_16x16x32_bf16 v[104:107], a[248:251], a[216:219], v[104:107]
    s_waitcnt lgkmcnt(11)
    ds_read_b128 a[188:191], v23 offset:7168
    v_mfma_f32_16x16x32_bf16 v[120:123], a[248:251], a[220:223], v[120:123]
    v_mfma_f32_16x16x32_bf16 v[120:123], a[232:235], a[204:207], v[120:123]
    v_mfma_f32_16x16x32_bf16 v[124:127], a[236:239], a[204:207], v[124:127]
    buffer_load_dwordx4 v17, s[44:47], s58 offen offset:1024 sc1 lds
    v_mfma_f32_16x16x32_bf16 v[124:127], a[252:255], a[220:223], v[124:127]
    v_mfma_f32_16x16x32_bf16 v[108:111], a[252:255], a[216:219], v[108:111]
    v_mfma_f32_16x16x32_bf16 v[108:111], a[236:239], a[200:203], v[108:111]
    buffer_load_dwordx4 v18, s[44:47], s58 offen offset:2048 sc1 lds
    v_mfma_f32_16x16x32_bf16 v[92:95], a[236:239], a[196:199], v[92:95]
    v_mfma_f32_16x16x32_bf16 v[92:95], a[252:255], a[212:215], v[92:95]
    v_mfma_f32_16x16x32_bf16 v[76:79], a[252:255], a[208:211], v[76:79]
    buffer_load_dwordx4 v19, s[44:47], s58 offen offset:3072 sc1 lds
    v_mfma_f32_16x16x32_bf16 v[76:79], a[236:239], a[192:195], v[76:79]
    v_mfma_f32_16x16x32_bf16 v[64:67], a[160:163], a[128:131], v[64:67]
    s_waitcnt vmcnt(8) lgkmcnt(0)
    v_and_b32 v12, 3, v0
    v_lshlrev_b32 v12, 7, v12
    v_mfma_f32_16x16x32_bf16 v[64:67], a[176:179], a[144:147], v[64:67]
    s_barrier
    ds_read_b128 a[224:227], v23 offset:32768
    v_mfma_f32_16x16x32_bf16 v[80:83], a[176:179], a[148:151], v[80:83]
    s_add_u32 m0, s72, 65536
    ds_read_b128 a[240:243], v23 offset:36864
    v_mfma_f32_16x16x32_bf16 v[80:83], a[160:163], a[132:135], v[80:83]
    s_add_u32 s58, s66, 98304
    ds_read_b128 a[192:195], v22 offset:32768
    v_mfma_f32_16x16x32_bf16 v[96:99], a[160:163], a[136:139], v[96:99]
    s_lshl_b32 s96, s63, 9
    buffer_load_dwordx4 v16, s[44:47], s58 offen offset:0 sc1 lds
    v_mfma_f32_16x16x32_bf16 v[96:99], a[176:179], a[152:155], v[96:99]
    s_add_u32 s96, s96, 0x3902000
    ds_read_b128 a[208:211], v22 offset:36864
    v_mfma_f32_16x16x32_bf16 v[112:115], a[176:179], a[156:159], v[112:115]
    ds_read_b128 a[196:199], v22 offset:33792
    v_mfma_f32_16x16x32_bf16 v[112:115], a[160:163], a[140:143], v[112:115]
    ds_read_b128 a[212:215], v22 offset:37888
    v_mfma_f32_16x16x32_bf16 v[116:119], a[164:167], a[140:143], v[116:119]
    buffer_load_dwordx4 v17, s[44:47], s58 offen offset:1024 sc1 lds
    v_mfma_f32_16x16x32_bf16 v[116:119], a[180:183], a[156:159], v[116:119]
    ds_read_b128 a[200:203], v22 offset:34816
    v_mfma_f32_16x16x32_bf16 v[100:103], a[180:183], a[152:155], v[100:103]
    ds_read_b128 a[216:219], v22 offset:38912
    v_mfma_f32_16x16x32_bf16 v[100:103], a[164:167], a[136:139], v[100:103]
    ds_read_b128 a[204:207], v22 offset:35840
    v_mfma_f32_16x16x32_bf16 v[84:87], a[164:167], a[132:135], v[84:87]
    buffer_load_dwordx4 v18, s[44:47], s58 offen offset:2048 sc1 lds
    v_mfma_f32_16x16x32_bf16 v[84:87], a[180:183], a[148:151], v[84:87]
    ds_read_b128 a[220:223], v22 offset:39936
    v_mfma_f32_16x16x32_bf16 v[68:71], a[180:183], a[144:147], v[68:71]
    ds_read_b128 a[228:231], v23 offset:33792
    v_mfma_f32_16x16x32_bf16 v[68:71], a[164:167], a[128:131], v[68:71]
    ds_read_b128 a[244:247], v23 offset:37888
    v_mfma_f32_16x16x32_bf16 v[72:75], a[168:171], a[128:131], v[72:75]
    buffer_load_dwordx4 v19, s[44:47], s58 offen offset:3072 sc1 lds
    v_mfma_f32_16x16x32_bf16 v[72:75], a[184:187], a[144:147], v[72:75]
    ds_read_b128 a[232:235], v23 offset:34816
    v_mfma_f32_16x16x32_bf16 v[88:91], a[184:187], a[148:151], v[88:91]
    s_add_u32 m0, s72, 69632
    ds_read_b128 a[248:251], v23 offset:38912
    v_mfma_f32_16x16x32_bf16 v[88:91], a[168:171], a[132:135], v[88:91]
    s_add_u32 s58, s66, 102400
    ds_read_b128 a[236:239], v23 offset:35840
    v_mfma_f32_16x16x32_bf16 v[104:107], a[168:171], a[136:139], v[104:107]
    buffer_load_dwordx4 v16, s[44:47], s58 offen offset:0 sc1 lds
    v_mfma_f32_16x16x32_bf16 v[104:107], a[184:187], a[152:155], v[104:107]
    s_waitcnt lgkmcnt(11)
    ds_read_b128 a[252:255], v23 offset:39936
    v_mfma_f32_16x16x32_bf16 v[120:123], a[184:187], a[156:159], v[120:123]
    v_mfma_f32_16x16x32_bf16 v[120:123], a[168:171], a[140:143], v[120:123]
    v_mfma_f32_16x16x32_bf16 v[124:127], a[172:175], a[140:143], v[124:127]
    buffer_load_dwordx4 v17, s[44:47], s58 offen offset:1024 sc1 lds
    v_mfma_f32_16x16x32_bf16 v[124:127], a[188:191], a[156:159], v[124:127]
    v_mfma_f32_16x16x32_bf16 v[108:111], a[188:191], a[152:155], v[108:111]
    v_mfma_f32_16x16x32_bf16 v[108:111], a[172:175], a[136:139], v[108:111]
    buffer_load_dwordx4 v18, s[44:47], s58 offen offset:2048 sc1 lds
    v_mfma_f32_16x16x32_bf16 v[92:95], a[172:175], a[132:135], v[92:95]
    v_mfma_f32_16x16x32_bf16 v[92:95], a[188:191], a[148:151], v[92:95]
    v_mfma_f32_16x16x32_bf16 v[76:79], a[188:191], a[144:147], v[76:79]
    buffer_load_dwordx4 v19, s[44:47], s58 offen offset:3072 sc1 lds
    v_mfma_f32_16x16x32_bf16 v[76:79], a[172:175], a[128:131], v[76:79]
    v_mfma_f32_16x16x32_bf16 v[64:67], a[224:227], a[192:195], v[64:67]
    s_waitcnt vmcnt(8) lgkmcnt(0)
    buffer_load_dword v13, v12, s[44:47], s96 offen sc1
    v_mfma_f32_16x16x32_bf16 v[64:67], a[240:243], a[208:211], v[64:67]
    s_barrier
    ds_read_b128 a[160:163], v21 offset:0
    v_mfma_f32_16x16x32_bf16 v[80:83], a[240:243], a[212:215], v[80:83]
    s_add_u32 m0, s72, 98304
    ds_read_b128 a[176:179], v21 offset:4096
    v_mfma_f32_16x16x32_bf16 v[80:83], a[224:227], a[196:199], v[80:83]
    s_add_u32 s58, s66, 106496
    ds_read_b128 a[128:131], v20 offset:0
    v_mfma_f32_16x16x32_bf16 v[96:99], a[224:227], a[200:203], v[96:99]
    buffer_load_dwordx4 v16, s[44:47], s58 offen offset:0 sc1 lds
    v_mfma_f32_16x16x32_bf16 v[96:99], a[240:243], a[216:219], v[96:99]
    ds_read_b128 a[144:147], v20 offset:4096
    v_mfma_f32_16x16x32_bf16 v[112:115], a[240:243], a[220:223], v[112:115]
    ds_read_b128 a[132:135], v20 offset:1024
    v_mfma_f32_16x16x32_bf16 v[112:115], a[224:227], a[204:207], v[112:115]
    ds_read_b128 a[148:151], v20 offset:5120
    v_mfma_f32_16x16x32_bf16 v[116:119], a[228:231], a[204:207], v[116:119]
    buffer_load_dwordx4 v17, s[44:47], s58 offen offset:1024 sc1 lds
    v_mfma_f32_16x16x32_bf16 v[116:119], a[244:247], a[220:223], v[116:119]
    ds_read_b128 a[136:139], v20 offset:2048
    v_mfma_f32_16x16x32_bf16 v[100:103], a[244:247], a[216:219], v[100:103]
    ds_read_b128 a[152:155], v20 offset:6144
    v_mfma_f32_16x16x32_bf16 v[100:103], a[228:231], a[200:203], v[100:103]
    ds_read_b128 a[140:143], v20 offset:3072
    v_mfma_f32_16x16x32_bf16 v[84:87], a[228:231], a[196:199], v[84:87]
    buffer_load_dwordx4 v18, s[44:47], s58 offen offset:2048 sc1 lds
    v_mfma_f32_16x16x32_bf16 v[84:87], a[244:247], a[212:215], v[84:87]
    ds_read_b128 a[156:159], v20 offset:7168
    v_mfma_f32_16x16x32_bf16 v[68:71], a[244:247], a[208:211], v[68:71]
    ds_read_b128 a[164:167], v21 offset:1024
    v_mfma_f32_16x16x32_bf16 v[68:71], a[228:231], a[192:195], v[68:71]
    ds_read_b128 a[180:183], v21 offset:5120
    v_mfma_f32_16x16x32_bf16 v[72:75], a[232:235], a[192:195], v[72:75]
    buffer_load_dwordx4 v19, s[44:47], s58 offen offset:3072 sc1 lds
    v_mfma_f32_16x16x32_bf16 v[72:75], a[248:251], a[208:211], v[72:75]
    ds_read_b128 a[168:171], v21 offset:2048
    v_mfma_f32_16x16x32_bf16 v[88:91], a[248:251], a[212:215], v[88:91]
    s_add_u32 m0, s72, 102400
    ds_read_b128 a[184:187], v21 offset:6144
    v_mfma_f32_16x16x32_bf16 v[88:91], a[232:235], a[196:199], v[88:91]
    s_add_u32 s58, s66, 110592
    ds_read_b128 a[172:175], v21 offset:3072
    v_mfma_f32_16x16x32_bf16 v[104:107], a[232:235], a[200:203], v[104:107]
    buffer_load_dwordx4 v16, s[44:47], s58 offen offset:0 sc1 lds
    v_mfma_f32_16x16x32_bf16 v[104:107], a[248:251], a[216:219], v[104:107]
    s_waitcnt lgkmcnt(11)
    ds_read_b128 a[188:191], v21 offset:7168
    v_mfma_f32_16x16x32_bf16 v[120:123], a[248:251], a[220:223], v[120:123]
    v_mfma_f32_16x16x32_bf16 v[120:123], a[232:235], a[204:207], v[120:123]
    v_mfma_f32_16x16x32_bf16 v[124:127], a[236:239], a[204:207], v[124:127]
    buffer_load_dwordx4 v17, s[44:47], s58 offen offset:1024 sc1 lds
    v_mfma_f32_16x16x32_bf16 v[124:127], a[252:255], a[220:223], v[124:127]
    v_mfma_f32_16x16x32_bf16 v[108:111], a[252:255], a[216:219], v[108:111]
    v_mfma_f32_16x16x32_bf16 v[108:111], a[236:239], a[200:203], v[108:111]
    buffer_load_dwordx4 v18, s[44:47], s58 offen offset:2048 sc1 lds
    v_mfma_f32_16x16x32_bf16 v[92:95], a[236:239], a[196:199], v[92:95]
    v_mfma_f32_16x16x32_bf16 v[92:95], a[252:255], a[212:215], v[92:95]
    v_mfma_f32_16x16x32_bf16 v[76:79], a[252:255], a[208:211], v[76:79]
    buffer_load_dwordx4 v19, s[44:47], s58 offen offset:3072 sc1 lds
    v_mfma_f32_16x16x32_bf16 v[76:79], a[236:239], a[192:195], v[76:79]
    v_mfma_f32_16x16x32_bf16 v[64:67], a[160:163], a[128:131], v[64:67]
    s_waitcnt vmcnt(9) lgkmcnt(0)
    v_mfma_f32_16x16x32_bf16 v[64:67], a[176:179], a[144:147], v[64:67]
    s_barrier
    ds_read_b128 a[224:227], v21 offset:32768
    v_mfma_f32_16x16x32_bf16 v[80:83], a[176:179], a[148:151], v[80:83]
    s_add_u32 m0, s72, 131072
    ds_read_b128 a[240:243], v21 offset:36864
    v_mfma_f32_16x16x32_bf16 v[80:83], a[160:163], a[132:135], v[80:83]
    s_add_u32 s58, s66, 114688
    ds_read_b128 a[192:195], v20 offset:32768
    v_mfma_f32_16x16x32_bf16 v[96:99], a[160:163], a[136:139], v[96:99]
    buffer_load_dwordx4 v16, s[44:47], s58 offen offset:0 sc1 lds
    v_mfma_f32_16x16x32_bf16 v[96:99], a[176:179], a[152:155], v[96:99]
    ds_read_b128 a[208:211], v20 offset:36864
    v_mfma_f32_16x16x32_bf16 v[112:115], a[176:179], a[156:159], v[112:115]
    ds_read_b128 a[196:199], v20 offset:33792
    v_mfma_f32_16x16x32_bf16 v[112:115], a[160:163], a[140:143], v[112:115]
    ds_read_b128 a[212:215], v20 offset:37888
    v_mfma_f32_16x16x32_bf16 v[116:119], a[164:167], a[140:143], v[116:119]
    buffer_load_dwordx4 v17, s[44:47], s58 offen offset:1024 sc1 lds
    v_mfma_f32_16x16x32_bf16 v[116:119], a[180:183], a[156:159], v[116:119]
    ds_read_b128 a[200:203], v20 offset:34816
    v_mfma_f32_16x16x32_bf16 v[100:103], a[180:183], a[152:155], v[100:103]
    ds_read_b128 a[216:219], v20 offset:38912
    v_mfma_f32_16x16x32_bf16 v[100:103], a[164:167], a[136:139], v[100:103]
    ds_read_b128 a[204:207], v20 offset:35840
    v_mfma_f32_16x16x32_bf16 v[84:87], a[164:167], a[132:135], v[84:87]
    buffer_load_dwordx4 v18, s[44:47], s58 offen offset:2048 sc1 lds
    v_mfma_f32_16x16x32_bf16 v[84:87], a[180:183], a[148:151], v[84:87]
    ds_read_b128 a[220:223], v20 offset:39936
    v_mfma_f32_16x16x32_bf16 v[68:71], a[180:183], a[144:147], v[68:71]
    ds_read_b128 a[228:231], v21 offset:33792
    v_mfma_f32_16x16x32_bf16 v[68:71], a[164:167], a[128:131], v[68:71]
    ds_read_b128 a[244:247], v21 offset:37888
    v_mfma_f32_16x16x32_bf16 v[72:75], a[168:171], a[128:131], v[72:75]
    buffer_load_dwordx4 v19, s[44:47], s58 offen offset:3072 sc1 lds
    v_mfma_f32_16x16x32_bf16 v[72:75], a[184:187], a[144:147], v[72:75]
    ds_read_b128 a[232:235], v21 offset:34816
    v_mfma_f32_16x16x32_bf16 v[88:91], a[184:187], a[148:151], v[88:91]
    s_add_u32 m0, s72, 135168
    ds_read_b128 a[248:251], v21 offset:38912
    v_mfma_f32_16x16x32_bf16 v[88:91], a[168:171], a[132:135], v[88:91]
    s_add_u32 s58, s66, 118784
    ds_read_b128 a[236:239], v21 offset:35840
    v_mfma_f32_16x16x32_bf16 v[104:107], a[168:171], a[136:139], v[104:107]
    buffer_load_dwordx4 v16, s[44:47], s58 offen offset:0 sc1 lds
    v_mfma_f32_16x16x32_bf16 v[104:107], a[184:187], a[152:155], v[104:107]
    s_waitcnt lgkmcnt(11)
    ds_read_b128 a[252:255], v21 offset:39936
    v_mfma_f32_16x16x32_bf16 v[120:123], a[184:187], a[156:159], v[120:123]
    v_mfma_f32_16x16x32_bf16 v[120:123], a[168:171], a[140:143], v[120:123]
    v_mfma_f32_16x16x32_bf16 v[124:127], a[172:175], a[140:143], v[124:127]
    buffer_load_dwordx4 v17, s[44:47], s58 offen offset:1024 sc1 lds
    v_mfma_f32_16x16x32_bf16 v[124:127], a[188:191], a[156:159], v[124:127]
    v_mfma_f32_16x16x32_bf16 v[108:111], a[188:191], a[152:155], v[108:111]
    v_mfma_f32_16x16x32_bf16 v[108:111], a[172:175], a[136:139], v[108:111]
    buffer_load_dwordx4 v18, s[44:47], s58 offen offset:2048 sc1 lds
    v_mfma_f32_16x16x32_bf16 v[92:95], a[172:175], a[132:135], v[92:95]
    v_mfma_f32_16x16x32_bf16 v[92:95], a[188:191], a[148:151], v[92:95]
    v_mfma_f32_16x16x32_bf16 v[76:79], a[188:191], a[144:147], v[76:79]
    buffer_load_dwordx4 v19, s[44:47], s58 offen offset:3072 sc1 lds
    v_mfma_f32_16x16x32_bf16 v[76:79], a[172:175], a[128:131], v[76:79]
    v_mfma_f32_16x16x32_bf16 v[64:67], a[224:227], a[192:195], v[64:67]
    s_waitcnt vmcnt(8) lgkmcnt(0)
    v_mfma_f32_16x16x32_bf16 v[64:67], a[240:243], a[208:211], v[64:67]
    s_barrier
    ds_read_b128 a[160:163], v23 offset:0
    v_mfma_f32_16x16x32_bf16 v[80:83], a[240:243], a[212:215], v[80:83]
    s_add_u32 m0, s72, 32768
    ds_read_b128 a[176:179], v23 offset:4096
    v_mfma_f32_16x16x32_bf16 v[80:83], a[224:227], a[196:199], v[80:83]
    s_add_u32 s58, s66, 122880
    ds_read_b128 a[128:131], v22 offset:0
    v_mfma_f32_16x16x32_bf16 v[96:99], a[224:227], a[200:203], v[96:99]
K_PG13:
    s_cmp_eq_u32 s100, 1
    s_cbranch_scc1 K_MAIN
    buffer_load_dwordx4 v16, s[44:47], s58 offen offset:0 sc1 lds
    v_mfma_f32_16x16x32_bf16 v[96:99], a[240:243], a[216:219], v[96:99]
    ds_read_b128 a[144:147], v22 offset:4096
    v_mfma_f32_16x16x32_bf16 v[112:115], a[240:243], a[220:223], v[112:115]
    ds_read_b128 a[132:135], v22 offset:1024
    v_mfma_f32_16x16x32_bf16 v[112:115], a[224:227], a[204:207], v[112:115]
    ds_read_b128 a[148:151], v22 offset:5120
    v_mfma_f32_16x16x32_bf16 v[116:119], a[228:231], a[204:207], v[116:119]
    buffer_load_dwordx4 v17, s[44:47], s58 offen offset:1024 sc1 lds
    v_mfma_f32_16x16x32_bf16 v[116:119], a[244:247], a[220:223], v[116:119]
    ds_read_b128 a[136:139], v22 offset:2048
    v_mfma_f32_16x16x32_bf16 v[100:103], a[244:247], a[216:219], v[100:103]
    ds_read_b128 a[152:155], v22 offset:6144
    v_mfma_f32_16x16x32_bf16 v[100:103], a[228:231], a[200:203], v[100:103]
    ds_read_b128 a[140:143], v22 offset:3072
    v_mfma_f32_16x16x32_bf16 v[84:87], a[228:231], a[196:199], v[84:87]
    buffer_load_dwordx4 v18, s[44:47], s58 offen offset:2048 sc1 lds
    v_mfma_f32_16x16x32_bf16 v[84:87], a[244:247], a[212:215], v[84:87]
    ds_read_b128 a[156:159], v22 offset:7168
    v_mfma_f32_16x16x32_bf16 v[68:71], a[244:247], a[208:211], v[68:71]
    ds_read_b128 a[164:167], v23 offset:1024
    v_mfma_f32_16x16x32_bf16 v[68:71], a[228:231], a[192:195], v[68:71]
    ds_read_b128 a[180:183], v23 offset:5120
    v_mfma_f32_16x16x32_bf16 v[72:75], a[232:235], a[192:195], v[72:75]
    buffer_load_dwordx4 v19, s[44:47], s58 offen offset:3072 sc1 lds
    v_mfma_f32_16x16x32_bf16 v[72:75], a[248:251], a[208:211], v[72:75]
    ds_read_b128 a[168:171], v23 offset:2048
    v_mfma_f32_16x16x32_bf16 v[88:91], a[248:251], a[212:215], v[88:91]
    s_add_u32 m0, s72, 36864
    ds_read_b128 a[184:187], v23 offset:6144
    v_mfma_f32_16x16x32_bf16 v[88:91], a[232:235], a[196:199], v[88:91]
    s_add_u32 s58, s66, 126976
    ds_read_b128 a[172:175], v23 offset:3072
    v_mfma_f32_16x16x32_bf16 v[104:107], a[232:235], a[200:203], v[104:107]
    buffer_load_dwordx4 v16, s[44:47], s58 offen offset:0 sc1 lds
    v_mfma_f32_16x16x32_bf16 v[104:107], a[248:251], a[216:219], v[104:107]
    s_waitcnt lgkmcnt(11)
    ds_read_b128 a[188:191], v23 offset:7168
    v_mfma_f32_16x16x32_bf16 v[120:123], a[248:251], a[220:223], v[120:123]
    v_mfma_f32_16x16x32_bf16 v[120:123], a[232:235], a[204:207], v[120:123]
    v_mfma_f32_16x16x32_bf16 v[124:127], a[236:239], a[204:207], v[124:127]
    buffer_load_dwordx4 v17, s[44:47], s58 offen offset:1024 sc1 lds
    v_mfma_f32_16x16x32_bf16 v[124:127], a[252:255], a[220:223], v[124:127]
    v_mfma_f32_16x16x32_bf16 v[108:111], a[252:255], a[216:219], v[108:111]
    v_mfma_f32_16x16x32_bf16 v[108:111], a[236:239], a[200:203], v[108:111]
    buffer_load_dwordx4 v18, s[44:47], s58 offen offset:2048 sc1 lds
    v_mfma_f32_16x16x32_bf16 v[92:95], a[236:239], a[196:199], v[92:95]
    v_mfma_f32_16x16x32_bf16 v[92:95], a[252:255], a[212:215], v[92:95]
    v_mfma_f32_16x16x32_bf16 v[76:79], a[252:255], a[208:211], v[76:79]
    buffer_load_dwordx4 v19, s[44:47], s58 offen offset:3072 sc1 lds
    v_mfma_f32_16x16x32_bf16 v[76:79], a[236:239], a[192:195], v[76:79]
    v_mfma_f32_16x16x32_bf16 v[64:67], a[160:163], a[128:131], v[64:67]
    s_waitcnt vmcnt(8) lgkmcnt(0)
    v_mfma_f32_16x16x32_bf16 v[64:67], a[176:179], a[144:147], v[64:67]
    s_barrier
    ds_read_b128 a[224:227], v23 offset:32768
    v_mfma_f32_16x16x32_bf16 v[80:83], a[176:179], a[148:151], v[80:83]
    s_add_u32 s56, s67, 1
    ds_read_b128 a[240:243], v23 offset:36864
    v_mfma_f32_16x16x32_bf16 v[80:83], a[160:163], a[132:135], v[80:83]
    s_and_b32 s56, s56, 3
    ds_read_b128 a[196:199], v22 offset:33792
    v_mfma_f32_16x16x32_bf16 v[96:99], a[160:163], a[136:139], v[96:99]
    s_mul_i32 s56, s56, 24576
    ds_read_b128 a[212:215], v22 offset:37888
    v_cmp_gt_u32 vcc, 8, v13
    v_mfma_f32_16x16x32_bf16 v[96:99], a[176:179], a[152:155], v[96:99]
    s_cbranch_vccnz S7
S7_RET:
    ds_read_b128 a[228:231], v23 offset:33792
    v_mfma_f32_16x16x32_bf16 v[112:115], a[176:179], a[156:159], v[112:115]
    s_add_u32 s56, s56, s68
    ds_read_b128 a[244:247], v23 offset:37888
    v_mfma_f32_16x16x32_bf16 v[112:115], a[160:163], a[140:143], v[112:115]
    s_add_u32 s56, s56, 0
    ds_read_b128 a[232:235], v23 offset:34816
    v_mfma_f32_16x16x32_bf16 v[116:119], a[164:167], a[140:143], v[116:119]
    s_add_u32 s57, s67, 2
    ds_read_b128 a[248:251], v23 offset:38912
    v_mfma_f32_16x16x32_bf16 v[116:119], a[180:183], a[156:159], v[116:119]
    s_and_b32 s57, s57, 3
    ds_read_b128 a[236:239], v23 offset:35840
    v_mfma_f32_16x16x32_bf16 v[100:103], a[180:183], a[152:155], v[100:103]
    s_mul_i32 s57, s57, 24576
    ds_read_b128 a[252:255], v23 offset:39936
    v_mfma_f32_16x16x32_bf16 v[100:103], a[164:167], a[136:139], v[100:103]
    s_add_u32 s57, s57, s68
    ds_read_b128 a[200:203], v22 offset:34816
    v_mfma_f32_16x16x32_bf16 v[84:87], a[164:167], a[132:135], v[84:87]
    s_add_u32 s57, s57, 2048
    ds_read_b128 a[216:219], v22 offset:38912
    v_mfma_f32_16x16x32_bf16 v[84:87], a[180:183], a[148:151], v[84:87]
    s_add_u32 s58, s67, 3
    ds_read_b128 a[204:207], v22 offset:35840
    v_mfma_f32_16x16x32_bf16 v[68:71], a[180:183], a[144:147], v[68:71]
    s_and_b32 s58, s58, 3
    ds_read_b128 a[220:223], v22 offset:39936
    v_mfma_f32_16x16x32_bf16 v[68:71], a[164:167], a[128:131], v[68:71]
    s_mul_i32 s58, s58, 24576
    ds_read_b128 a[192:195], v22 offset:32768
    v_mfma_f32_16x16x32_bf16 v[72:75], a[168:171], a[128:131], v[72:75]
    s_waitcnt lgkmcnt(11)
    s_add_u32 s58, s58, s68
    ds_read_b128 a[208:211], v22 offset:36864
    v_mfma_f32_16x16x32_bf16 v[72:75], a[184:187], a[144:147], v[72:75]
    s_add_u32 s58, s58, 4096
    v_mfma_f32_16x16x32_bf16 v[88:91], a[184:187], a[148:151], v[88:91]
    v_mfma_f32_16x16x32_bf16 v[88:91], a[168:171], a[132:135], v[88:91]
    v_mfma_f32_16x16x32_bf16 v[104:107], a[168:171], a[136:139], v[104:107]
    s_add_u32 s60, s70, 4096
    v_mfma_f32_16x16x32_bf16 v[104:107], a[184:187], a[152:155], v[104:107]
    s_mov_b32 s97, 524288
    v_mfma_f32_16x16x32_bf16 v[120:123], a[184:187], a[156:159], v[120:123]
    s_waitcnt vmcnt(0)
    v_mfma_f32_16x16x32_bf16 v[120:123], a[168:171], a[140:143], v[120:123]
    s_barrier
    ds_read_b128 a[32:35], v21 offset:0
    v_mfma_f32_16x16x32_bf16 v[124:127], a[172:175], a[140:143], v[124:127]
    s_mov_b32 s59, 0
    ds_read_b128 a[48:51], v21 offset:4096
    v_mfma_f32_16x16x32_bf16 v[124:127], a[188:191], a[156:159], v[124:127]
    ds_read_b128 a[4:7], v20 offset:1024
    v_min_u32 v10, 2, v0
    v_mfma_f32_16x16x32_bf16 v[108:111], a[188:191], a[152:155], v[108:111]
    s_waitcnt lgkmcnt(11)
    ds_read_b128 a[20:23], v20 offset:5120
    v_lshlrev_b32 v10, 11, v10
    v_mfma_f32_16x16x32_bf16 v[108:111], a[172:175], a[136:139], v[108:111]
    ds_read_b128 a[36:39], v21 offset:1024
    v_mfma_f32_16x16x32_bf16 v[92:95], a[172:175], a[132:135], v[92:95]
    ds_read_b128 a[52:55], v21 offset:5120
    v_mfma_f32_16x16x32_bf16 v[92:95], a[188:191], a[148:151], v[92:95]
    ds_read_b128 a[40:43], v21 offset:2048
    v_mfma_f32_16x16x32_bf16 v[76:79], a[188:191], a[144:147], v[76:79]
    s_waitcnt lgkmcnt(11)
    ds_read_b128 a[56:59], v21 offset:6144
    v_mfma_f32_16x16x32_bf16 v[76:79], a[172:175], a[128:131], v[76:79]
    ds_read_b128 a[44:47], v21 offset:3072
    v_mfma_f32_16x16x32_bf16 v[80:83], a[224:227], a[196:199], v[80:83]
    ds_read_b128 a[60:63], v21 offset:7168
    v_mfma_f32_16x16x32_bf16 v[80:83], a[240:243], a[212:215], v[80:83]
    s_waitcnt lgkmcnt(7)
    ds_read_b128 a[8:11], v20 offset:2048
    v_mfma_f32_16x16x32_bf16 v[80:83], a[32:35], a[4:7], v[80:83]
    s_waitcnt lgkmcnt(7)
    ds_read_b128 a[24:27], v20 offset:6144
    v_mfma_f32_16x16x32_bf16 v[80:83], a[48:51], a[20:23], v[80:83]
    ds_read_b128 a[12:15], v20 offset:3072
    v_mfma_f32_16x16x32_bf16 v[84:87], a[228:231], a[196:199], v[84:87]
    ds_read_b128 a[28:31], v20 offset:7168
    v_mfma_f32_16x16x32_bf16 v[84:87], a[244:247], a[212:215], v[84:87]
    s_waitcnt lgkmcnt(9)
    ds_read_b128 a[0:3], v20 offset:0
    v_mfma_f32_16x16x32_bf16 v[84:87], a[36:39], a[4:7], v[84:87]
    s_waitcnt lgkmcnt(9)
    ds_read_b128 a[16:19], v20 offset:4096
    v_mfma_f32_16x16x32_bf16 v[84:87], a[52:55], a[20:23], v[84:87]
    v_mfma_f32_16x16x32_bf16 v[88:91], a[232:235], a[196:199], v[88:91]
    v_mfma_f32_16x16x32_bf16 v[88:91], a[248:251], a[212:215], v[88:91]
    s_waitcnt lgkmcnt(9)
    v_mfma_f32_16x16x32_bf16 v[88:91], a[40:43], a[4:7], v[88:91]
    s_waitcnt lgkmcnt(8)
    v_mfma_f32_16x16x32_bf16 v[88:91], a[56:59], a[20:23], v[88:91]
    v_mfma_f32_16x16x32_bf16 v[92:95], a[236:239], a[196:199], v[92:95]
    v_mfma_f32_16x16x32_bf16 v[92:95], a[252:255], a[212:215], v[92:95]
    s_waitcnt lgkmcnt(7)
    v_mfma_f32_16x16x32_bf16 v[92:95], a[44:47], a[4:7], v[92:95]
    s_waitcnt lgkmcnt(6)
    v_mfma_f32_16x16x32_bf16 v[92:95], a[60:63], a[20:23], v[92:95]
    v_cvt_pk_bf16_f32 v80, v80, v81
    v_cvt_pk_bf16_f32 v81, v82, v83
    v_mfma_f32_16x16x32_bf16 v[96:99], a[224:227], a[200:203], v[96:99]
    v_cvt_pk_bf16_f32 v82, v84, v85
    v_cvt_pk_bf16_f32 v83, v86, v87
    v_mfma_f32_16x16x32_bf16 v[96:99], a[240:243], a[216:219], v[96:99]
    s_waitcnt lgkmcnt(5)
    buffer_store_dwordx4 v[80:83], v1, s[44:47], s56 offen offset:0 sc1
    v_mfma_f32_16x16x32_bf16 v[96:99], a[32:35], a[8:11], v[96:99]
    s_waitcnt lgkmcnt(4)
    v_mfma_f32_16x16x32_bf16 v[96:99], a[48:51], a[24:27], v[96:99]
    v_mfma_f32_16x16x32_bf16 v[100:103], a[228:231], a[200:203], v[100:103]
    v_mfma_f32_16x16x32_bf16 v[100:103], a[244:247], a[216:219], v[100:103]
    v_mfma_f32_16x16x32_bf16 v[100:103], a[36:39], a[8:11], v[100:103]
    v_mfma_f32_16x16x32_bf16 v[100:103], a[52:55], a[24:27], v[100:103]
    v_cvt_pk_bf16_f32 v88, v88, v89
    v_cvt_pk_bf16_f32 v89, v90, v91
    v_mfma_f32_16x16x32_bf16 v[104:107], a[232:235], a[200:203], v[104:107]
    v_cvt_pk_bf16_f32 v90, v92, v93
    v_cvt_pk_bf16_f32 v91, v94, v95
    v_mfma_f32_16x16x32_bf16 v[104:107], a[248:251], a[216:219], v[104:107]
    buffer_store_dwordx4 v[88:91], v1, s[44:47], s56 offen offset:1024 sc1
    v_mfma_f32_16x16x32_bf16 v[104:107], a[40:43], a[8:11], v[104:107]
    v_mfma_f32_16x16x32_bf16 v[104:107], a[56:59], a[24:27], v[104:107]
    v_mfma_f32_16x16x32_bf16 v[108:111], a[236:239], a[200:203], v[108:111]
    v_mfma_f32_16x16x32_bf16 v[108:111], a[252:255], a[216:219], v[108:111]
    v_mfma_f32_16x16x32_bf16 v[108:111], a[44:47], a[8:11], v[108:111]
    v_mfma_f32_16x16x32_bf16 v[108:111], a[60:63], a[24:27], v[108:111]
    v_cvt_pk_bf16_f32 v96, v96, v97
    v_cvt_pk_bf16_f32 v97, v98, v99
    v_mfma_f32_16x16x32_bf16 v[112:115], a[224:227], a[204:207], v[112:115]
    v_cvt_pk_bf16_f32 v98, v100, v101
    v_cvt_pk_bf16_f32 v99, v102, v103
    v_mfma_f32_16x16x32_bf16 v[112:115], a[240:243], a[220:223], v[112:115]
    s_waitcnt lgkmcnt(3)
    buffer_store_dwordx4 v[96:99], v1, s[44:47], s57 offen offset:0 sc1
    v_mfma_f32_16x16x32_bf16 v[112:115], a[32:35], a[12:15], v[112:115]
    s_waitcnt lgkmcnt(2)
    v_mfma_f32_16x16x32_bf16 v[112:115], a[48:51], a[28:31], v[112:115]
    v_mfma_f32_16x16x32_bf16 v[116:119], a[228:231], a[204:207], v[116:119]
    v_mfma_f32_16x16x32_bf16 v[116:119], a[244:247], a[220:223], v[116:119]
    v_mfma_f32_16x16x32_bf16 v[116:119], a[36:39], a[12:15], v[116:119]
    v_mfma_f32_16x16x32_bf16 v[116:119], a[52:55], a[28:31], v[116:119]
    v_cvt_pk_bf16_f32 v104, v104, v105
    v_cvt_pk_bf16_f32 v105, v106, v107
    v_mfma_f32_16x16x32_bf16 v[120:123], a[232:235], a[204:207], v[120:123]
    v_cvt_pk_bf16_f32 v106, v108, v109
    v_cvt_pk_bf16_f32 v107, v110, v111
    v_mfma_f32_16x16x32_bf16 v[120:123], a[248:251], a[220:223], v[120:123]
    buffer_store_dwordx4 v[104:107], v1, s[44:47], s57 offen offset:1024 sc1
    v_mfma_f32_16x16x32_bf16 v[120:123], a[40:43], a[12:15], v[120:123]
    v_mfma_f32_16x16x32_bf16 v[120:123], a[56:59], a[28:31], v[120:123]
    v_mfma_f32_16x16x32_bf16 v[124:127], a[236:239], a[204:207], v[124:127]
    v_mfma_f32_16x16x32_bf16 v[124:127], a[252:255], a[220:223], v[124:127]
    v_mfma_f32_16x16x32_bf16 v[124:127], a[44:47], a[12:15], v[124:127]
    v_mfma_f32_16x16x32_bf16 v[124:127], a[60:63], a[28:31], v[124:127]
    v_cvt_pk_bf16_f32 v112, v112, v113
    v_cvt_pk_bf16_f32 v113, v114, v115
    v_mfma_f32_16x16x32_bf16 v[64:67], a[224:227], a[192:195], v[64:67]
    v_cvt_pk_bf16_f32 v114, v116, v117
    v_cvt_pk_bf16_f32 v115, v118, v119
    v_mfma_f32_16x16x32_bf16 v[64:67], a[240:243], a[208:211], v[64:67]
    s_waitcnt lgkmcnt(1)
    buffer_store_dwordx4 v[112:115], v1, s[44:47], s58 offen offset:0 sc1
    v_mfma_f32_16x16x32_bf16 v[64:67], a[32:35], a[0:3], v[64:67]
    s_waitcnt lgkmcnt(0)
    v_mfma_f32_16x16x32_bf16 v[64:67], a[48:51], a[16:19], v[64:67]
    v_mfma_f32_16x16x32_bf16 v[68:71], a[228:231], a[192:195], v[68:71]
    v_mfma_f32_16x16x32_bf16 v[68:71], a[244:247], a[208:211], v[68:71]
    v_mfma_f32_16x16x32_bf16 v[68:71], a[36:39], a[0:3], v[68:71]
    v_mfma_f32_16x16x32_bf16 v[68:71], a[52:55], a[16:19], v[68:71]
    v_cvt_pk_bf16_f32 v120, v120, v121
    v_cvt_pk_bf16_f32 v121, v122, v123
    v_mfma_f32_16x16x32_bf16 v[72:75], a[232:235], a[192:195], v[72:75]
    v_cvt_pk_bf16_f32 v122, v124, v125
    v_cvt_pk_bf16_f32 v123, v126, v127
    v_mfma_f32_16x16x32_bf16 v[72:75], a[248:251], a[208:211], v[72:75]
    buffer_store_dwordx4 v[120:123], v1, s[44:47], s58 offen offset:1024 sc1
    v_mfma_f32_16x16x32_bf16 v[72:75], a[40:43], a[0:3], v[72:75]
    v_mfma_f32_16x16x32_bf16 v[72:75], a[56:59], a[16:19], v[72:75]
    v_mfma_f32_16x16x32_bf16 v[76:79], a[236:239], a[192:195], v[76:79]
    v_mfma_f32_16x16x32_bf16 v[76:79], a[252:255], a[208:211], v[76:79]
    v_mfma_f32_16x16x32_bf16 v[76:79], a[44:47], a[0:3], v[76:79]
    v_mfma_f32_16x16x32_bf16 v[76:79], a[60:63], a[16:19], v[76:79]
S5_RET:
K_XP:
    buffer_load_dword v11, v10, s[44:47], s70 offen offset:1920 sc1
    s_sub_u32 s97, s97, 1
    s_waitcnt vmcnt(0)
    s_cbranch_scc1 K_XQ
    v_cmp_eq_u32 vcc, -1, v11
    s_cbranch_vccnz K_XP
K_XQ:
    s_mov_b32 s97, 524288
    buffer_load_dwordx4 v[128:131], v1, s[44:47], s70 offen offset:0 sc1
    buffer_load_dwordx4 v[132:135], v1, s[44:47], s70 offen offset:1024 sc1
    buffer_load_dwordx4 v[136:139], v1, s[44:47], s70 offen offset:2048 sc1
    buffer_load_dwordx4 v[140:143], v1, s[44:47], s70 offen offset:3072 sc1
    buffer_load_dwordx4 v[144:147], v1, s[44:47], s60 offen offset:0 sc1
    buffer_load_dwordx4 v[148:151], v1, s[44:47], s60 offen offset:1024 sc1
    s_nop 0
    v_pk_add_f32 v[32:33], v[32:33], v[64:65]
    v_pk_add_f32 v[34:35], v[34:35], v[66:67]
    v_pk_add_f32 v[36:37], v[36:37], v[68:69]
    v_pk_add_f32 v[38:39], v[38:39], v[70:71]
    v_pk_add_f32 v[40:41], v[40:41], v[72:73]
    v_pk_add_f32 v[42:43], v[42:43], v[74:75]
    v_pk_add_f32 v[44:45], v[44:45], v[76:77]
    v_pk_add_f32 v[46:47], v[46:47], v[78:79]
    s_waitcnt vmcnt(0)
K_XL:
    s_bitcmp1_b32 s59, 0
    s_cbranch_scc1 K_XN0
    v_max3_u32 v10, v128, v129, v130
    v_max3_u32 v11, v131, v132, v133
    v_max3_u32 v10, v10, v134, v135
    v_max_u32 v10, v10, v11
    v_cmp_eq_u32 vcc, -1, v10
    v_lshlrev_b32 v160, 16, v128
    v_and_b32 v161, 0xffff0000, v128
    v_lshlrev_b32 v162, 16, v129
    v_and_b32 v163, 0xffff0000, v129
    v_lshlrev_b32 v164, 16, v130
    v_and_b32 v165, 0xffff0000, v130
    v_lshlrev_b32 v166, 16, v131
    v_and_b32 v167, 0xffff0000, v131
    v_lshlrev_b32 v168, 16, v132
    v_and_b32 v169, 0xffff0000, v132
    v_lshlrev_b32 v170, 16, v133
    v_and_b32 v171, 0xffff0000, v133
    v_lshlrev_b32 v172, 16, v134
    v_and_b32 v173, 0xffff0000, v134
    v_lshlrev_b32 v174, 16, v135
    v_and_b32 v175, 0xffff0000, v135
    s_cbranch_vccnz K_XR0
    s_or_b32 s59, s59, 1
K_XN0:
    s_bitcmp1_b32 s59, 1
    s_cbranch_scc1 K_XN1
    v_max3_u32 v10, v136, v137, v138
    v_max3_u32 v11, v139, v140, v141
    v_max3_u32 v10, v10, v142, v143
    v_max_u32 v10, v10, v11
    v_cmp_eq_u32 vcc, -1, v10
    v_lshlrev_b32 v176, 16, v136
    v_and_b32 v177, 0xffff0000, v136
    v_lshlrev_b32 v178, 16, v137
    v_and_b32 v179, 0xffff0000, v137
    v_lshlrev_b32 v180, 16, v138
    v_and_b32 v181, 0xffff0000, v138
    v_lshlrev_b32 v182, 16, v139
    v_and_b32 v183, 0xffff0000, v139
    v_lshlrev_b32 v184, 16, v140
    v_and_b32 v185, 0xffff0000, v140
    v_lshlrev_b32 v186, 16, v141
    v_and_b32 v187, 0xffff0000, v141
    v_lshlrev_b32 v188, 16, v142
    v_and_b32 v189, 0xffff0000, v142
    v_lshlrev_b32 v190, 16, v143
    v_and_b32 v191, 0xffff0000, v143
    s_cbranch_vccnz K_XR1
    s_or_b32 s59, s59, 2
K_XN1:
    s_bitcmp1_b32 s59, 2
    s_cbranch_scc1 K_XN2
    v_max3_u32 v10, v144, v145, v146
    v_max3_u32 v11, v147, v148, v149
    v_max3_u32 v10, v10, v150, v151
    v_max_u32 v10, v10, v11
    v_cmp_eq_u32 vcc, -1, v10
    v_lshlrev_b32 v192, 16, v144
    v_and_b32 v193, 0xffff0000, v144
    v_lshlrev_b32 v194, 16, v145
    v_and_b32 v195, 0xffff0000, v145
    v_lshlrev_b32 v196, 16, v146
    v_and_b32 v197, 0xffff0000, v146
    v_lshlrev_b32 v198, 16, v147
    v_and_b32 v199, 0xffff0000, v147
    v_lshlrev_b32 v200, 16, v148
    v_and_b32 v201, 0xffff0000, v148
    v_lshlrev_b32 v202, 16, v149
    v_and_b32 v203, 0xffff0000, v149
    v_lshlrev_b32 v204, 16, v150
    v_and_b32 v205, 0xffff0000, v150
    v_lshlrev_b32 v206, 16, v151
    v_and_b32 v207, 0xffff0000, v151
    s_cbranch_vccnz K_XR2
    s_or_b32 s59, s59, 4
K_XN2:
    s_cmp_lg_u32 s59, 7
    s_cbranch_scc1 K_XW
K_XD:
    v_pk_add_f32 v[32:33], v[32:33], v[160:161]
    v_pk_add_f32 v[34:35], v[34:35], v[162:163]
    v_pk_add_f32 v[36:37], v[36:37], v[164:165]
    v_pk_add_f32 v[38:39], v[38:39], v[166:167]
    v_pk_add_f32 v[32:33], v[32:33], v[176:177]
    v_pk_add_f32 v[34:35], v[34:35], v[178:179]
    v_pk_add_f32 v[36:37], v[36:37], v[180:181]
    v_pk_add_f32 v[38:39], v[38:39], v[182:183]
    v_pk_add_f32 v[32:33], v[32:33], v[192:193]
    v_pk_add_f32 v[34:35], v[34:35], v[194:195]
    v_pk_add_f32 v[36:37], v[36:37], v[196:197]
    v_pk_add_f32 v[38:39], v[38:39], v[198:199]
    v_cvt_pk_bf16_f32 v32, v32, v33
    v_cvt_pk_bf16_f32 v33, v34, v35
    v_cvt_pk_bf16_f32 v34, v36, v37
    v_cvt_pk_bf16_f32 v35, v38, v39
    buffer_store_dwordx4 v[32:35], v9, s[36:39], s69 offen offset:0
    v_pk_add_f32 v[40:41], v[40:41], v[168:169]
    v_pk_add_f32 v[42:43], v[42:43], v[170:171]
    v_pk_add_f32 v[44:45], v[44:45], v[172:173]
    v_pk_add_f32 v[46:47], v[46:47], v[174:175]
    v_pk_add_f32 v[40:41], v[40:41], v[184:185]
    v_pk_add_f32 v[42:43], v[42:43], v[186:187]
    v_pk_add_f32 v[44:45], v[44:45], v[188:189]
    v_pk_add_f32 v[46:47], v[46:47], v[190:191]
    v_pk_add_f32 v[40:41], v[40:41], v[200:201]
    v_pk_add_f32 v[42:43], v[42:43], v[202:203]
    v_pk_add_f32 v[44:45], v[44:45], v[204:205]
    v_pk_add_f32 v[46:47], v[46:47], v[206:207]
    v_cvt_pk_bf16_f32 v40, v40, v41
    v_cvt_pk_bf16_f32 v41, v42, v43
    v_cvt_pk_bf16_f32 v42, v44, v45
    v_cvt_pk_bf16_f32 v43, v46, v47
    buffer_store_dwordx4 v[40:43], v9, s[36:39], s69 offen offset:64
K_END:
    s_endpgm
K_LAST:
    s_endpgm
K_SLOW:
    s_waitcnt vmcnt(0) lgkmcnt(0)
    s_mov_b32 s73, 0
    s_mov_b32 s74, s85
K_SLOW_T:
    v_accvgpr_read_b32 v4, a0
    v_accvgpr_read_b32 v5, a16
    v_accvgpr_write_b32 a0, v5
    v_accvgpr_write_b32 a16, v4
    v_mov_b32 v4, v192
    v_mov_b32 v192, v224
    v_mov_b32 v224, v4
    v_accvgpr_read_b32 v4, a1
    v_accvgpr_read_b32 v5, a17
    v_accvgpr_write_b32 a1, v5
    v_accvgpr_write_b32 a17, v4
    v_mov_b32 v4, v193
    v_mov_b32 v193, v225
    v_mov_b32 v225, v4
    v_accvgpr_read_b32 v4, a2
    v_accvgpr_read_b32 v5, a18
    v_accvgpr_write_b32 a2, v5
    v_accvgpr_write_b32 a18, v4
    v_mov_b32 v4, v194
    v_mov_b32 v194, v226
    v_mov_b32 v226, v4
    v_accvgpr_read_b32 v4, a3
    v_accvgpr_read_b32 v5, a19
    v_accvgpr_write_b32 a3, v5
    v_accvgpr_write_b32 a19, v4
    v_mov_b32 v4, v195
    v_mov_b32 v195, v227
    v_mov_b32 v227, v4
    v_accvgpr_read_b32 v4, a4
    v_accvgpr_read_b32 v5, a20
    v_accvgpr_write_b32 a4, v5
    v_accvgpr_write_b32 a20, v4
    v_mov_b32 v4, v200
    v_mov_b32 v200, v232
    v_mov_b32 v232, v4
    v_accvgpr_read_b32 v4, a5
    v_accvgpr_read_b32 v5, a21
    v_accvgpr_write_b32 a5, v5
    v_accvgpr_write_b32 a21, v4
    v_mov_b32 v4, v201
    v_mov_b32 v201, v233
    v_mov_b32 v233, v4
    v_accvgpr_read_b32 v4, a6
    v_accvgpr_read_b32 v5, a22
    v_accvgpr_write_b32 a6, v5
    v_accvgpr_write_b32 a22, v4
    v_mov_b32 v4, v202
    v_mov_b32 v202, v234
    v_mov_b32 v234, v4
    v_accvgpr_read_b32 v4, a7
    v_accvgpr_read_b32 v5, a23
    v_accvgpr_write_b32 a7, v5
    v_accvgpr_write_b32 a23, v4
    v_mov_b32 v4, v203
    v_mov_b32 v203, v235
    v_mov_b32 v235, v4
    v_accvgpr_read_b32 v4, a8
    v_accvgpr_read_b32 v5, a24
    v_accvgpr_write_b32 a8, v5
    v_accvgpr_write_b32 a24, v4
    v_mov_b32 v4, v208
    v_mov_b32 v208, v240
    v_mov_b32 v240, v4
    v_accvgpr_read_b32 v4, a9
    v_accvgpr_read_b32 v5, a25
    v_accvgpr_write_b32 a9, v5
    v_accvgpr_write_b32 a25, v4
    v_mov_b32 v4, v209
    v_mov_b32 v209, v241
    v_mov_b32 v241, v4
    v_accvgpr_read_b32 v4, a10
    v_accvgpr_read_b32 v5, a26
    v_accvgpr_write_b32 a10, v5
    v_accvgpr_write_b32 a26, v4
    v_mov_b32 v4, v210
    v_mov_b32 v210, v242
    v_mov_b32 v242, v4
    v_accvgpr_read_b32 v4, a11
    v_accvgpr_read_b32 v5, a27
    v_accvgpr_write_b32 a11, v5
    v_accvgpr_write_b32 a27, v4
    v_mov_b32 v4, v211
    v_mov_b32 v211, v243
    v_mov_b32 v243, v4
    v_accvgpr_read_b32 v4, a12
    v_accvgpr_read_b32 v5, a28
    v_accvgpr_write_b32 a12, v5
    v_accvgpr_write_b32 a28, v4
    v_mov_b32 v4, v216
    v_mov_b32 v216, v248
    v_mov_b32 v248, v4
    v_accvgpr_read_b32 v4, a13
    v_accvgpr_read_b32 v5, a29
    v_accvgpr_write_b32 a13, v5
    v_accvgpr_write_b32 a29, v4
    v_mov_b32 v4, v217
    v_mov_b32 v217, v249
    v_mov_b32 v249, v4
    v_accvgpr_read_b32 v4, a14
    v_accvgpr_read_b32 v5, a30
    v_accvgpr_write_b32 a14, v5
    v_accvgpr_write_b32 a30, v4
    v_mov_b32 v4, v218
    v_mov_b32 v218, v250
    v_mov_b32 v250, v4
    v_accvgpr_read_b32 v4, a15
    v_accvgpr_read_b32 v5, a31
    v_accvgpr_write_b32 a15, v5
    v_accvgpr_write_b32 a31, v4
    v_mov_b32 v4, v219
    v_mov_b32 v219, v251
    v_mov_b32 v251, v4
    v_mov_b32 v128, 0
    v_mov_b32 v129, 0
    v_mov_b32 v130, 0
    v_mov_b32 v131, 0
    v_mov_b32 v132, 0
    v_mov_b32 v133, 0
    v_mov_b32 v134, 0
    v_mov_b32 v135, 0
    v_mov_b32 v136, 0
    v_mov_b32 v137, 0
    v_mov_b32 v138, 0
    v_mov_b32 v139, 0
    v_mov_b32 v140, 0
    v_mov_b32 v141, 0
    v_mov_b32 v142, 0
    v_mov_b32 v143, 0
    v_mov_b32 v144, 0
    v_mov_b32 v145, 0
    v_mov_b32 v146, 0
    v_mov_b32 v147, 0
    v_mov_b32 v148, 0
    v_mov_b32 v149, 0
    v_mov_b32 v150, 0
    v_mov_b32 v151, 0
    v_mov_b32 v152, 0
    v_mov_b32 v153, 0
    v_mov_b32 v154, 0
    v_mov_b32 v155, 0
    v_mov_b32 v156, 0
    v_mov_b32 v157, 0
    v_mov_b32 v158, 0
    v_mov_b32 v159, 0
    v_mov_b32 v160, 0
    v_mov_b32 v161, 0
    v_mov_b32 v162, 0
    v_mov_b32 v163, 0
    v_mov_b32 v164, 0
    v_mov_b32 v165, 0
    v_mov_b32 v166, 0
    v_mov_b32 v167, 0
    v_mov_b32 v168, 0
    v_mov_b32 v169, 0
    v_mov_b32 v170, 0
    v_mov_b32 v171, 0
    v_mov_b32 v172, 0
    v_mov_b32 v173, 0
    v_mov_b32 v174, 0
    v_mov_b32 v175, 0
    v_mov_b32 v176, 0
    v_mov_b32 v177, 0
    v_mov_b32 v178, 0
    v_mov_b32 v179, 0
    v_mov_b32 v180, 0
    v_mov_b32 v181, 0
    v_mov_b32 v182, 0
    v_mov_b32 v183, 0
    v_mov_b32 v184, 0
    v_mov_b32 v185, 0
    v_mov_b32 v186, 0
    v_mov_b32 v187, 0
    v_mov_b32 v188, 0
    v_mov_b32 v189, 0
    v_mov_b32 v190, 0
    v_mov_b32 v191, 0
    v_mov_b32 v24, 0
    v_mov_b32 v25, 0
    v_mov_b32 v26, 0
    v_mov_b32 v27, 0
    v_mov_b32 v28, 0
    v_mov_b32 v29, 0
    v_mov_b32 v30, 0
    v_mov_b32 v31, 0
    v_mov_b32 v2, 0xff000000
    v_mov_b32 v3, 0xff000000
    s_mov_b32 s75, 0
K_SLOW_L:
    s_lshl_b32 s56, s75, 14
    s_add_u32 s56, s56, 0
    buffer_load_dwordx4 a[32:35], v1, s[48:51], s56 offen offset:0 sc1
    buffer_load_dwordx4 a[36:39], v1, s[48:51], s56 offen offset:1024 sc1
    buffer_load_dwordx4 a[40:43], v1, s[48:51], s56 offen offset:2048 sc1
    buffer_load_dwordx4 a[44:47], v1, s[48:51], s56 offen offset:3072 sc1
    s_lshl_b32 s56, s75, 14
    s_add_u32 s56, s56, 4096
    buffer_load_dwordx4 a[48:51], v1, s[48:51], s56 offen offset:0 sc1
    buffer_load_dwordx4 a[52:55], v1, s[48:51], s56 offen offset:1024 sc1
    buffer_load_dwordx4 a[56:59], v1, s[48:51], s56 offen offset:2048 sc1
    buffer_load_dwordx4 a[60:63], v1, s[48:51], s56 offen offset:3072 sc1
    s_lshl_b32 s56, s75, 14
    s_add_u32 s56, s56, 8192
    buffer_load_dwordx4 a[64:67], v1, s[48:51], s56 offen offset:0 sc1
    buffer_load_dwordx4 a[68:71], v1, s[48:51], s56 offen offset:1024 sc1
    buffer_load_dwordx4 a[72:75], v1, s[48:51], s56 offen offset:2048 sc1
    buffer_load_dwordx4 a[76:79], v1, s[48:51], s56 offen offset:3072 sc1
    s_lshl_b32 s56, s75, 14
    s_add_u32 s56, s56, 12288
    buffer_load_dwordx4 a[80:83], v1, s[48:51], s56 offen offset:0 sc1
    buffer_load_dwordx4 a[84:87], v1, s[48:51], s56 offen offset:1024 sc1
    buffer_load_dwordx4 a[88:91], v1, s[48:51], s56 offen offset:2048 sc1
    buffer_load_dwordx4 a[92:95], v1, s[48:51], s56 offen offset:3072 sc1
    v_mov_b32 v48, 0
    v_mov_b32 v49, 0
    v_mov_b32 v50, 0
    v_mov_b32 v51, 0
    v_mov_b32 v52, 0
    v_mov_b32 v53, 0
    v_mov_b32 v54, 0
    v_mov_b32 v55, 0
    v_mov_b32 v56, 0
    v_mov_b32 v57, 0
    v_mov_b32 v58, 0
    v_mov_b32 v59, 0
    v_mov_b32 v60, 0
    v_mov_b32 v61, 0
    v_mov_b32 v62, 0
    v_mov_b32 v63, 0
    s_cmp_lg_u32 s75, s74
    s_cbranch_scc1 K_SLOW_M
    v_mov_b32 v56, s76
    v_mov_b32 v57, s76
    v_mov_b32 v58, s76
    v_mov_b32 v59, s76
    v_cndmask_b32 v48, v48, v56, s[88:89]
    v_cndmask_b32 v49, v49, v56, s[90:91]
    v_cndmask_b32 v50, v50, v56, s[92:93]
    v_cndmask_b32 v51, v51, v56, s[94:95]
    v_cndmask_b32 v60, v60, v56, s[88:89]
    v_cndmask_b32 v61, v61, v56, s[90:91]
    v_cndmask_b32 v62, v62, v56, s[92:93]
    v_cndmask_b32 v63, v63, v56, s[94:95]
K_SLOW_M:
    s_waitcnt vmcnt(0)
    s_nop 1
    v_mfma_f32_16x16x32_bf16 v[196:199], a[32:35], a[0:3], v[48:51]
    v_mfma_f32_16x16x32_bf16 v[196:199], a[36:39], a[4:7], v[196:199]
    v_mfma_f32_16x16x32_bf16 v[196:199], a[40:43], v[192:195], v[196:199]
    v_mfma_f32_16x16x32_bf16 v[196:199], a[44:47], v[200:203], v[196:199]
    v_mfma_f32_16x16x32_bf16 v[212:215], a[32:35], a[8:11], v[52:55]
    v_mfma_f32_16x16x32_bf16 v[212:215], a[36:39], a[12:15], v[212:215]
    v_mfma_f32_16x16x32_bf16 v[212:215], a[40:43], v[208:211], v[212:215]
    v_mfma_f32_16x16x32_bf16 v[212:215], a[44:47], v[216:219], v[212:215]
    v_mfma_f32_16x16x32_bf16 v[204:207], a[48:51], a[0:3], v[56:59]
    v_mfma_f32_16x16x32_bf16 v[204:207], a[52:55], a[4:7], v[204:207]
    v_mfma_f32_16x16x32_bf16 v[204:207], a[56:59], v[192:195], v[204:207]
    v_mfma_f32_16x16x32_bf16 v[204:207], a[60:63], v[200:203], v[204:207]
    v_mfma_f32_16x16x32_bf16 v[220:223], a[48:51], a[8:11], v[60:63]
    v_mfma_f32_16x16x32_bf16 v[220:223], a[52:55], a[12:15], v[220:223]
    v_mfma_f32_16x16x32_bf16 v[220:223], a[56:59], v[208:211], v[220:223]
    v_mfma_f32_16x16x32_bf16 v[220:223], a[60:63], v[216:219], v[220:223]
    s_nop 7
    v_max3_f32 v9, v196, v197, v198
    v_max3_f32 v11, v199, v204, v205
    v_max3_f32 v9, v9, v206, v207
    v_max_f32 v9, v9, v11
    v_max3_f32 v10, v212, v213, v214
    v_max3_f32 v40, v215, v220, v221
    v_max3_f32 v10, v10, v222, v223
    v_max_f32 v10, v10, v40
    v_mov_b32 v11, v9
    v_mov_b32 v40, v10
    s_nop 0
    v_permlane16_swap_b32 v9, v11
    v_permlane16_swap_b32 v10, v40
    v_max_f32 v9, v9, v11
    v_max_f32 v10, v10, v40
    v_mov_b32 v11, v9
    v_mov_b32 v40, v10
    s_nop 0
    v_permlane32_swap_b32 v9, v11
    v_permlane32_swap_b32 v10, v40
    v_max_f32 v9, v9, v11
    v_max_f32 v10, v10, v40
    v_max_f32 v9, v9, v2
    v_sub_f32 v6, v2, v9
    v_exp_f32 v6, v6
    v_mov_b32 v2, v9
    v_sub_f32 v196, v196, v9
    v_sub_f32 v197, v197, v9
    v_sub_f32 v198, v198, v9
    v_sub_f32 v199, v199, v9
    v_sub_f32 v204, v204, v9
    v_sub_f32 v205, v205, v9
    v_sub_f32 v206, v206, v9
    v_sub_f32 v207, v207, v9
    v_mul_f32 v128, v128, v6
    v_mul_f32 v129, v129, v6
    v_mul_f32 v130, v130, v6
    v_mul_f32 v131, v131, v6
    v_mul_f32 v132, v132, v6
    v_mul_f32 v133, v133, v6
    v_mul_f32 v134, v134, v6
    v_mul_f32 v135, v135, v6
    v_mul_f32 v136, v136, v6
    v_mul_f32 v137, v137, v6
    v_mul_f32 v138, v138, v6
    v_mul_f32 v139, v139, v6
    v_mul_f32 v140, v140, v6
    v_mul_f32 v141, v141, v6
    v_mul_f32 v142, v142, v6
    v_mul_f32 v143, v143, v6
    v_mul_f32 v144, v144, v6
    v_mul_f32 v145, v145, v6
    v_mul_f32 v146, v146, v6
    v_mul_f32 v147, v147, v6
    v_mul_f32 v148, v148, v6
    v_mul_f32 v149, v149, v6
    v_mul_f32 v150, v150, v6
    v_mul_f32 v151, v151, v6
    v_mul_f32 v152, v152, v6
    v_mul_f32 v153, v153, v6
    v_mul_f32 v154, v154, v6
    v_mul_f32 v155, v155, v6
    v_mul_f32 v156, v156, v6
    v_mul_f32 v157, v157, v6
    v_mul_f32 v158, v158, v6
    v_mul_f32 v159, v159, v6
    v_mul_f32 v24, v24, v6
    v_mul_f32 v25, v25, v6
    v_max_f32 v10, v10, v3
    v_sub_f32 v7, v3, v10
    v_exp_f32 v7, v7
    v_mov_b32 v3, v10
    v_sub_f32 v212, v212, v10
    v_sub_f32 v213, v213, v10
    v_sub_f32 v214, v214, v10
    v_sub_f32 v215, v215, v10
    v_sub_f32 v220, v220, v10
    v_sub_f32 v221, v221, v10
    v_sub_f32 v222, v222, v10
    v_sub_f32 v223, v223, v10
    v_mul_f32 v160, v160, v7
    v_mul_f32 v161, v161, v7
    v_mul_f32 v162, v162, v7
    v_mul_f32 v163, v163, v7
    v_mul_f32 v164, v164, v7
    v_mul_f32 v165, v165, v7
    v_mul_f32 v166, v166, v7
    v_mul_f32 v167, v167, v7
    v_mul_f32 v168, v168, v7
    v_mul_f32 v169, v169, v7
    v_mul_f32 v170, v170, v7
    v_mul_f32 v171, v171, v7
    v_mul_f32 v172, v172, v7
    v_mul_f32 v173, v173, v7
    v_mul_f32 v174, v174, v7
    v_mul_f32 v175, v175, v7
    v_mul_f32 v176, v176, v7
    v_mul_f32 v177, v177, v7
    v_mul_f32 v178, v178, v7
    v_mul_f32 v179, v179, v7
    v_mul_f32 v180, v180, v7
    v_mul_f32 v181, v181, v7
    v_mul_f32 v182, v182, v7
    v_mul_f32 v183, v183, v7
    v_mul_f32 v184, v184, v7
    v_mul_f32 v185, v185, v7
    v_mul_f32 v186, v186, v7
    v_mul_f32 v187, v187, v7
    v_mul_f32 v188, v188, v7
    v_mul_f32 v189, v189, v7
    v_mul_f32 v190, v190, v7
    v_mul_f32 v191, v191, v7
    v_mul_f32 v26, v26, v7
    v_mul_f32 v27, v27, v7
    v_exp_f32 v4, v196
    v_exp_f32 v5, v197
    s_nop 0
    v_cvt_pk_bf16_f32 v32, v4, v5
    v_exp_f32 v6, v198
    v_exp_f32 v7, v199
    s_nop 0
    v_cvt_pk_bf16_f32 v33, v6, v7
    v_exp_f32 v4, v204
    v_exp_f32 v5, v205
    s_nop 0
    v_cvt_pk_bf16_f32 v34, v4, v5
    v_exp_f32 v6, v206
    v_exp_f32 v7, v207
    s_nop 0
    v_cvt_pk_bf16_f32 v35, v6, v7
    v_exp_f32 v4, v212
    v_exp_f32 v5, v213
    s_nop 0
    v_cvt_pk_bf16_f32 v36, v4, v5
    v_exp_f32 v6, v214
    v_exp_f32 v7, v215
    s_nop 0
    v_cvt_pk_bf16_f32 v37, v6, v7
    v_exp_f32 v4, v220
    v_exp_f32 v5, v221
    s_nop 0
    v_cvt_pk_bf16_f32 v38, v4, v5
    v_exp_f32 v6, v222
    v_exp_f32 v7, v223
    s_nop 0
    v_cvt_pk_bf16_f32 v39, v6, v7
    s_nop 1
    v_smfmac_f32_16x16x64_bf16 v[24:27], a[96:99], v[32:39], v8
    v_mfma_f32_16x16x32_bf16 v[128:131], a[64:67], v[32:35], v[128:131]
    v_mfma_f32_16x16x32_bf16 v[160:163], a[64:67], v[36:39], v[160:163]
    v_mfma_f32_16x16x32_bf16 v[132:135], a[68:71], v[32:35], v[132:135]
    v_mfma_f32_16x16x32_bf16 v[164:167], a[68:71], v[36:39], v[164:167]
    v_mfma_f32_16x16x32_bf16 v[136:139], a[72:75], v[32:35], v[136:139]
    v_mfma_f32_16x16x32_bf16 v[168:171], a[72:75], v[36:39], v[168:171]
    v_mfma_f32_16x16x32_bf16 v[140:143], a[76:79], v[32:35], v[140:143]
    v_mfma_f32_16x16x32_bf16 v[172:175], a[76:79], v[36:39], v[172:175]
    v_mfma_f32_16x16x32_bf16 v[144:147], a[80:83], v[32:35], v[144:147]
    v_mfma_f32_16x16x32_bf16 v[176:179], a[80:83], v[36:39], v[176:179]
    v_mfma_f32_16x16x32_bf16 v[148:151], a[84:87], v[32:35], v[148:151]
    v_mfma_f32_16x16x32_bf16 v[180:183], a[84:87], v[36:39], v[180:183]
    v_mfma_f32_16x16x32_bf16 v[152:155], a[88:91], v[32:35], v[152:155]
    v_mfma_f32_16x16x32_bf16 v[184:187], a[88:91], v[36:39], v[184:187]
    v_mfma_f32_16x16x32_bf16 v[156:159], a[92:95], v[32:35], v[156:159]
    v_mfma_f32_16x16x32_bf16 v[188:191], a[92:95], v[36:39], v[188:191]
    s_nop 7
    s_add_u32 s75, s75, 1
    s_cmp_le_u32 s75, s74
    s_cbranch_scc1 K_SLOW_L
    v_add_f32 v9, v24, v25
    v_add_f32 v10, v26, v27
    s_cmp_eq_u32 s73, 1
    s_cbranch_scc1 K_SLOW_RET
    v_rcp_f32 v9, v9
    v_rcp_f32 v10, v10
    s_add_u32 s56, s82, 0
    v_pk_mul_f32 v[128:129], v[128:129], v[8:9] op_sel:[0,1] op_sel_hi:[1,1]
    v_pk_mul_f32 v[130:131], v[130:131], v[8:9] op_sel:[0,1] op_sel_hi:[1,1]
    v_pk_mul_f32 v[132:133], v[132:133], v[8:9] op_sel:[0,1] op_sel_hi:[1,1]
    v_pk_mul_f32 v[134:135], v[134:135], v[8:9] op_sel:[0,1] op_sel_hi:[1,1]
    v_cvt_pk_bf16_f32 v128, v128, v129
    v_cvt_pk_bf16_f32 v129, v130, v131
    v_cvt_pk_bf16_f32 v130, v132, v133
    v_cvt_pk_bf16_f32 v131, v134, v135
    buffer_store_dwordx4 v[128:131], v1, s[44:47], s56 offen offset:0 sc1
    v_pk_mul_f32 v[160:161], v[160:161], v[10:11] op_sel_hi:[1,0]
    v_pk_mul_f32 v[162:163], v[162:163], v[10:11] op_sel_hi:[1,0]
    v_pk_mul_f32 v[164:165], v[164:165], v[10:11] op_sel_hi:[1,0]
    v_pk_mul_f32 v[166:167], v[166:167], v[10:11] op_sel_hi:[1,0]
    v_cvt_pk_bf16_f32 v160, v160, v161
    v_cvt_pk_bf16_f32 v161, v162, v163
    v_cvt_pk_bf16_f32 v162, v164, v165
    v_cvt_pk_bf16_f32 v163, v166, v167
    buffer_store_dwordx4 v[160:163], v1, s[44:47], s56 offen offset:1024 sc1
    s_add_u32 s56, s82, 4096
    v_pk_mul_f32 v[136:137], v[136:137], v[8:9] op_sel:[0,1] op_sel_hi:[1,1]
    v_pk_mul_f32 v[138:139], v[138:139], v[8:9] op_sel:[0,1] op_sel_hi:[1,1]
    v_pk_mul_f32 v[140:141], v[140:141], v[8:9] op_sel:[0,1] op_sel_hi:[1,1]
    v_pk_mul_f32 v[142:143], v[142:143], v[8:9] op_sel:[0,1] op_sel_hi:[1,1]
    v_cvt_pk_bf16_f32 v136, v136, v137
    v_cvt_pk_bf16_f32 v137, v138, v139
    v_cvt_pk_bf16_f32 v138, v140, v141
    v_cvt_pk_bf16_f32 v139, v142, v143
    buffer_store_dwordx4 v[136:139], v1, s[44:47], s56 offen offset:0 sc1
    v_pk_mul_f32 v[168:169], v[168:169], v[10:11] op_sel_hi:[1,0]
    v_pk_mul_f32 v[170:171], v[170:171], v[10:11] op_sel_hi:[1,0]
    v_pk_mul_f32 v[172:173], v[172:173], v[10:11] op_sel_hi:[1,0]
    v_pk_mul_f32 v[174:175], v[174:175], v[10:11] op_sel_hi:[1,0]
    v_cvt_pk_bf16_f32 v168, v168, v169
    v_cvt_pk_bf16_f32 v169, v170, v171
    v_cvt_pk_bf16_f32 v170, v172, v173
    v_cvt_pk_bf16_f32 v171, v174, v175
    buffer_store_dwordx4 v[168:171], v1, s[44:47], s56 offen offset:1024 sc1
    s_add_u32 s56, s82, 8192
    v_pk_mul_f32 v[144:145], v[144:145], v[8:9] op_sel:[0,1] op_sel_hi:[1,1]
    v_pk_mul_f32 v[146:147], v[146:147], v[8:9] op_sel:[0,1] op_sel_hi:[1,1]
    v_pk_mul_f32 v[148:149], v[148:149], v[8:9] op_sel:[0,1] op_sel_hi:[1,1]
    v_pk_mul_f32 v[150:151], v[150:151], v[8:9] op_sel:[0,1] op_sel_hi:[1,1]
    v_cvt_pk_bf16_f32 v144, v144, v145
    v_cvt_pk_bf16_f32 v145, v146, v147
    v_cvt_pk_bf16_f32 v146, v148, v149
    v_cvt_pk_bf16_f32 v147, v150, v151
    buffer_store_dwordx4 v[144:147], v1, s[44:47], s56 offen offset:0 sc1
    v_pk_mul_f32 v[176:177], v[176:177], v[10:11] op_sel_hi:[1,0]
    v_pk_mul_f32 v[178:179], v[178:179], v[10:11] op_sel_hi:[1,0]
    v_pk_mul_f32 v[180:181], v[180:181], v[10:11] op_sel_hi:[1,0]
    v_pk_mul_f32 v[182:183], v[182:183], v[10:11] op_sel_hi:[1,0]
    v_cvt_pk_bf16_f32 v176, v176, v177
    v_cvt_pk_bf16_f32 v177, v178, v179
    v_cvt_pk_bf16_f32 v178, v180, v181
    v_cvt_pk_bf16_f32 v179, v182, v183
    buffer_store_dwordx4 v[176:179], v1, s[44:47], s56 offen offset:1024 sc1
    s_add_u32 s56, s82, 12288
    v_pk_mul_f32 v[152:153], v[152:153], v[8:9] op_sel:[0,1] op_sel_hi:[1,1]
    v_pk_mul_f32 v[154:155], v[154:155], v[8:9] op_sel:[0,1] op_sel_hi:[1,1]
    v_pk_mul_f32 v[156:157], v[156:157], v[8:9] op_sel:[0,1] op_sel_hi:[1,1]
    v_pk_mul_f32 v[158:159], v[158:159], v[8:9] op_sel:[0,1] op_sel_hi:[1,1]
    v_cvt_pk_bf16_f32 v152, v152, v153
    v_cvt_pk_bf16_f32 v153, v154, v155
    v_cvt_pk_bf16_f32 v154, v156, v157
    v_cvt_pk_bf16_f32 v155, v158, v159
    buffer_store_dwordx4 v[152:155], v1, s[44:47], s56 offen offset:0 sc1
    v_pk_mul_f32 v[184:185], v[184:185], v[10:11] op_sel_hi:[1,0]
    v_pk_mul_f32 v[186:187], v[186:187], v[10:11] op_sel_hi:[1,0]
    v_pk_mul_f32 v[188:189], v[188:189], v[10:11] op_sel_hi:[1,0]
    v_pk_mul_f32 v[190:191], v[190:191], v[10:11] op_sel_hi:[1,0]
    v_cvt_pk_bf16_f32 v184, v184, v185
    v_cvt_pk_bf16_f32 v185, v186, v187
    v_cvt_pk_bf16_f32 v186, v188, v189
    v_cvt_pk_bf16_f32 v187, v190, v191
    buffer_store_dwordx4 v[184:187], v1, s[44:47], s56 offen offset:1024 sc1
    s_mov_b32 s73, 1
    s_lshl_b32 s56, s63, 3
    s_sub_u32 s56, 60, s56
    s_add_u32 s74, s85, s56
    s_branch K_SLOW_T
K_TEXT_END:
.section .rodata,"a"
.p2align 6
.amdhsa_kernel parallel_sum__compressed_kv_cla__glu_gated_geglu__prompt_kernel
  .amdhsa_next_free_vgpr 512
  .amdhsa_next_free_sgpr 102
  .amdhsa_accum_offset 256
  .amdhsa_group_segment_fixed_size 0
  .amdhsa_kernarg_size 104
  .amdhsa_user_sgpr_count 2
  .amdhsa_user_sgpr_kernarg_segment_ptr 1
  .amdhsa_system_sgpr_workgroup_id_x 1
.end_amdhsa_kernel
```
